```python
import torch

def _softmax(x, axis=-1):
    return torch.softmax(x, dim=axis)
def _gelu(x):
    return torch.nn.functional.gelu(x, approximate="tanh")
def _silu(x):
    return torch.nn.functional.silu(x)
def _sigmoid(x):
    return torch.sigmoid(x)
def _layernorm(x, axis=-1, eps=1e-5):
    m = x.mean(dim=axis, keepdim=True)
    v = x.var(dim=axis, keepdim=True, unbiased=False)
    return (x - m) / torch.sqrt(v + eps)
def _scatter_add(tgt, idx, src, axis=0):
    return tgt.clone().index_add_(axis, idx, src)
def _segment_sum(src, seg, n):
    out = torch.zeros((n,) + src.shape[1:], dtype=src.dtype)
    return out.index_add_(0, seg, src)
def _pad(x, pw):
    flat = tuple(v for pair in reversed(pw) for v in pair)
    return torch.nn.functional.pad(x, flat)

kernel_name = 'gated_mix__softmax_full_mha__glu_gated_geglu__prompt'

def setup_inputs():

    _w = (lambda a: (lambda t: t.to(torch.bfloat16) if t.is_floating_point() else t)(torch.as_tensor(a)))
    def _A_setup():
        B, S, D = 1, 2048, 1024
        return {
            "x": _w((lambda *s: torch.randn(*s, dtype=torch.bfloat16) * 0.05)(B, S, D)),
            "wqkv": _w((lambda *s: torch.randn(*s, dtype=torch.bfloat16) * 0.4)(D, 3 * D)),
            "wo": _w((lambda *s: torch.randn(*s, dtype=torch.bfloat16) * 0.05)(D, D)),
        }
    _A_in = _A_setup()

    def _B_setup():
        B, S, Dm, Df = 1, 2048, 1024, 3584
        return {
            "x": _w((lambda *s: torch.randn(*s, dtype=torch.bfloat16) * 0.05)(B, S, Dm)),
            "w_gate": _w((lambda *s: torch.randn(*s, dtype=torch.bfloat16) * 1.6)(Dm, Df) * (Dm ** -0.5)),
            "w_up": _w((lambda *s: torch.randn(*s, dtype=torch.bfloat16) * 1.6)(Dm, Df) * (Dm ** -0.5)),
            "w_down": _w((lambda *s: torch.randn(*s, dtype=torch.bfloat16) * 1.6)(Df, Dm) * (Df ** -0.5)),
        }
    _B_in = _B_setup()

    return {
        "A_x": _A_in["x"],
        "A_wqkv": _A_in["wqkv"],
        "A_wo": _A_in["wo"],
        "B_x": _B_in["x"],
        "B_w_gate": _B_in["w_gate"],
        "B_w_up": _B_in["w_up"],
        "B_w_down": _B_in["w_down"],
        "gate_w": _w((lambda *s: torch.randn(*s, dtype=torch.bfloat16) * 0.05)(1024) * 16.0),
    }

def reference(A_x, A_wqkv, A_wo, B_x, B_w_gate, B_w_up, B_w_down, gate_w):
    def _A_ref(x, wqkv, wo):
        B, S, D = x.shape
        H = 32; Dh = D // H
        qkv = (lambda x, *d: x.permute(*d))((x @ wqkv).reshape(B, S, 3, H, Dh), 2, 0, 3, 1, 4)
        q, k, v = qkv[0], qkv[1], qkv[2]
        scale = Dh ** -0.5
        scores = torch.einsum("bhqd,bhkd->bhqk", q, k) * scale
        p = _softmax(scores, axis=-1)
        o = torch.einsum("bhqk,bhkd->bhqd", p, v)
        return (lambda x, *d: x.permute(*d))(o, 0, 2, 1, 3).reshape(B, S, D) @ wo

    def _B_ref(x, w_gate, w_up, w_down):
        g = torch.einsum("bsd,df->bsf", x, w_gate)
        u = torch.einsum("bsd,df->bsf", x, w_up)
        h = _gelu(g) * u
        return torch.einsum("bsf,fd->bsd", h, w_down)

    x = A_x
    g = _sigmoid((x * gate_w).sum(-1, keepdims=True))
    a = _A_ref(x, A_wqkv, A_wo)
    b = _B_ref(x, B_w_gate, B_w_up, B_w_down)
    return g * a + (1 - g) * b
```

```asm
; @launch grid=(256,1,1) block=(256,1,1) lds=163840
.amdgcn_target "amdgcn-amd-amdhsa--gfx950"
.text
.globl gated_mix__softmax_full_mha__glu_gated_geglu__prompt_kernel
.p2align 8
.type gated_mix__softmax_full_mha__glu_gated_geglu__prompt_kernel,@function
gated_mix__softmax_full_mha__glu_gated_geglu__prompt_kernel:
    s_cmp_ge_u32 s2, 256
    s_cbranch_scc1 k_exit
    s_load_dwordx4 s[4:7], s[0:1], 0
    s_load_dwordx4 s[8:11], s[0:1], 32
    s_load_dwordx2 s[12:13], s[0:1], 56
    s_load_dwordx2 s[14:15], s[0:1], 80
    s_load_dwordx2 s[64:65], s[0:1], 48
    s_load_dwordx2 s[68:69], s[0:1], 16
    s_load_dwordx2 s[72:73], s[0:1], 64
    s_load_dwordx2 s[76:77], s[0:1], 72
    v_lshrrev_b32 v2, 6, v0
    v_and_b32 v1, 63, v0
    v_readfirstlane_b32 s36, v2
    s_and_b32 s50, s2, 7
    s_lshr_b32 s51, s2, 3
    s_and_b32 s39, s51, 7
    s_lshr_b32 s51, s51, 3
    s_lshl_b32 s62, s50, 2
    s_add_u32 s62, s62, s51
    s_and_b32 s52, s51, 1
    s_lshl_b32 s40, s52, 3
    s_add_u32 s40, s40, s50
    s_lshl_b32 s41, s50, 1
    s_add_u32 s41, s41, s52
    s_and_b32 s37, s36, 1
    s_lshr_b32 s38, s36, 1
    s_getpc_b64 s[80:81]
k_pc:
    s_mov_b32 s82, code_end-k_pc
    s_mov_b32 s83, 0x20000
    s_lshr_b32 s52, s2, 3
    s_mul_i32 s52, s52, 2816
    v_lshlrev_b32 v3, 7, v0
    v_cmp_gt_u32 vcc, 22, v0
    v_mov_b32 v4, 0x40000000
    s_nop 0
    v_cndmask_b32 v3, v4, v3, vcc
    buffer_load_dword v246, v3, s[80:83], s52 offen
    s_cmp_ge_u32 s51, 2
    s_cbranch_scc1 p1_typeB
    v_lshrrev_b32 v2, 3, v1
    v_and_b32 v3, 6, v2
    v_and_b32 v4, 7, v1
    v_xor_b32 v3, v3, v4
    v_lshlrev_b32 v3, 4, v3
    v_lshl_add_u32 v232, v2, 11, v3
    v_add_u32 v233, 16384, v232
    v_add_u32 v234, 32768, v232
    v_add_u32 v235, 49152, v232
    v_add_u32 v236, 65536, v232
    v_add_u32 v237, 81920, v232
    v_add_u32 v238, 98304, v232
    v_add_u32 v239, 114688, v232
    s_lshl_b32 s50, s39, 19
    s_lshl_b32 s51, s36, 17
    s_add_u32 s42, s50, s51
    s_lshl_b32 s45, s36, 13
    s_mov_b32 s52, 6144
    s_mov_b32 s53, 7168
    v_lshrrev_b32 v2, 4, v1
    s_lshl_b32 s50, s37, 2
    v_or_b32 v3, s50, v2
    v_lshlrev_b32 v3, 1, v3
    v_and_b32 v4, 15, v1
    v_xor_b32 v3, v3, v4
    v_lshlrev_b32 v3, 4, v3
    s_lshl_b32 s50, s36, 3
    v_add_u32 v2, s50, v2
    v_mul_lo_u32 v2, v2, s52
    v_add_u32 v240, v2, v3
    v_add_u32 v241, 24576, v240
    s_lshl_b32 s43, s40, 8
    s_lshl_b32 s46, s36, 11
    s_add_u32 s46, s46, 65536
    s_mul_i32 s50, s37, 192
    s_mov_b32 s51, 0x15555556
    v_add_u32 v2, s50, v1
    v_mul_hi_u32 v3, v2, s51
    v_mul_u32_u24 v4, 12, v3
    v_sub_u32 v4, v2, v4
    v_lshrrev_b32 v5, 2, v3
    v_and_b32 v5, 2, v5
    v_xor_b32 v4, v4, v5
    v_mul_lo_u32 v3, v3, s53
    v_lshl_add_u32 v242, v4, 4, v3
    v_add_u32 v2, s50, v1
    v_add_u32 v2, 64, v2
    v_mul_hi_u32 v3, v2, s51
    v_mul_u32_u24 v4, 12, v3
    v_sub_u32 v4, v2, v4
    v_lshrrev_b32 v5, 2, v3
    v_and_b32 v5, 2, v5
    v_xor_b32 v4, v4, v5
    v_mul_lo_u32 v3, v3, s53
    v_lshl_add_u32 v243, v4, 4, v3
    v_add_u32 v2, s50, v1
    v_add_u32 v2, 128, v2
    v_mul_hi_u32 v3, v2, s51
    v_mul_u32_u24 v4, 12, v3
    v_sub_u32 v4, v2, v4
    v_lshrrev_b32 v5, 2, v3
    v_and_b32 v5, 2, v5
    v_xor_b32 v4, v4, v5
    v_mul_lo_u32 v3, v3, s53
    v_lshl_add_u32 v244, v4, 4, v3
    s_mul_i32 s44, s40, 192
    s_add_u32 s44, s44, 4096
    s_mul_i32 s47, s36, 3072
    s_add_u32 s47, s47, 98304
    s_waitcnt lgkmcnt(0)
    s_mov_b32 s16, s4
    s_mov_b32 s17, s5
    s_mov_b32 s18, 4194304
    s_mov_b32 s19, 0x20000
    s_add_u32 m0, s45, 0
    s_nop 0
    buffer_load_dwordx4 v232, s[16:19], s42 offen lds
    s_add_u32 m0, s45, 1024
    s_nop 0
    buffer_load_dwordx4 v233, s[16:19], s42 offen lds
    s_add_u32 m0, s45, 2048
    s_nop 0
    buffer_load_dwordx4 v234, s[16:19], s42 offen lds
    s_add_u32 m0, s45, 3072
    s_nop 0
    buffer_load_dwordx4 v235, s[16:19], s42 offen lds
    s_add_u32 m0, s45, 4096
    s_nop 0
    buffer_load_dwordx4 v236, s[16:19], s42 offen lds
    s_add_u32 m0, s45, 5120
    s_nop 0
    buffer_load_dwordx4 v237, s[16:19], s42 offen lds
    s_add_u32 m0, s45, 6144
    s_nop 0
    buffer_load_dwordx4 v238, s[16:19], s42 offen lds
    s_add_u32 m0, s45, 7168
    s_nop 0
    buffer_load_dwordx4 v239, s[16:19], s42 offen lds
    s_add_u32 s42, s42, 128
    s_mov_b32 s20, s6
    s_mov_b32 s21, s7
    s_mov_b32 s22, 6291456
    s_mov_b32 s23, 0x20000
    s_add_u32 m0, s46, 0
    s_nop 0
    buffer_load_dwordx4 v240, s[20:23], s43 offen lds
    s_add_u32 m0, s46, 1024
    s_nop 0
    buffer_load_dwordx4 v241, s[20:23], s43 offen lds
    s_add_u32 s43, s43, 196608
    s_add_u32 m0, s46, 8192
    s_nop 0
    buffer_load_dwordx4 v240, s[20:23], s43 offen lds
    s_add_u32 m0, s46, 9216
    s_nop 0
    buffer_load_dwordx4 v241, s[20:23], s43 offen lds
    s_add_u32 s43, s43, 196608
    s_cmp_lt_u32 s36, 2
    s_cselect_b32 s24, s8, s10
    s_cselect_b32 s25, s9, s11
    s_mov_b32 s26, 7340032
    s_mov_b32 s27, 0x20000
    s_add_u32 m0, s47, 0
    s_nop 0
    buffer_load_dwordx4 v242, s[24:27], s44 offen lds
    s_add_u32 m0, s47, 1024
    s_nop 0
    buffer_load_dwordx4 v243, s[24:27], s44 offen lds
    s_add_u32 m0, s47, 2048
    s_nop 0
    buffer_load_dwordx4 v244, s[24:27], s44 offen lds
    s_add_u32 s44, s44, 229376
    s_add_u32 m0, s47, 12288
    s_nop 0
    buffer_load_dwordx4 v242, s[24:27], s44 offen lds
    s_add_u32 m0, s47, 13312
    s_nop 0
    buffer_load_dwordx4 v243, s[24:27], s44 offen lds
    s_add_u32 m0, s47, 14336
    s_nop 0
    buffer_load_dwordx4 v244, s[24:27], s44 offen lds
    s_add_u32 s44, s44, 229376
    s_mov_b32 s28, s14
    s_mov_b32 s29, s15
    s_mov_b32 s30, 268435456
    s_mov_b32 s31, 0x20000
    s_mov_b32 s32, s12
    s_mov_b32 s33, s13
    s_mov_b32 s34, 2048
    s_mov_b32 s35, 0x20000
    s_mov_b32 s66, 7340032
    s_mov_b32 s67, 0x20000
    s_mov_b32 s70, 2097152
    s_mov_b32 s71, 0x20000
    s_mov_b32 s74, 4194304
    s_mov_b32 s75, 0x20000
    s_mov_b32 s78, 256
    s_mov_b32 s79, 0x20000
    s_lshl_b32 s52, s2, 2
    s_add_u32 s52, s52, s36
    s_lshl_b32 s53, s2, 1
    s_add_u32 s53, s53, s37
    v_lshlrev_b32 v4, 7, v1
    v_mov_b32 v5, 0x40000000
    v_cmp_gt_u32 vcc, 3, v1
    s_mul_i32 s50, s52, 384
    s_add_u32 s50, s50, 393216
    v_cndmask_b32 v6, v5, v4, vcc
    buffer_load_dword v246, v6, s[20:23], s50 offen
    v_cmp_gt_u32 vcc, 8, v1
    s_mul_i32 s50, s53, 896
    s_add_u32 s50, s50, 458752
    v_cndmask_b32 v245, v5, v4, vcc
    buffer_load_dword v246, v245, s[24:27], s50 offen
    v_lshrrev_b32 v6, 2, v1
    v_and_b32 v7, 3, v1
    v_lshlrev_b32 v7, 7, v7
    v_lshl_add_u32 v6, v6, 11, v7
    v_cndmask_b32 v0, v5, v6, vcc
    v_cmp_gt_u32 vcc, 14, v1
    s_lshl_b32 s63, s52, 12
    buffer_load_dword v246, v0, s[16:19], s63 offen
    s_add_u32 s63, s63, 512
    v_cndmask_b32 v247, v5, v4, vcc
    s_lshl_b32 s6, s52, 10
    s_mul_i32 s7, s52, 384
    s_add_u32 s7, s7, 786432
    s_mul_i32 s49, s53, 896
    s_add_u32 s49, s49, 917504
    v_cmp_gt_u32 vcc, 3, v1
    s_mul_i32 s5, s52, 384
    s_nop 0
    v_cndmask_b32 v254, v5, v4, vcc
    s_mov_b32 s53, s40
    s_mul_i32 s84, s53, 4224
    s_lshl_b32 s52, s39, 2
    s_add_u32 s84, s84, s52
    s_add_u32 s84, s84, 34734080
    s_mul_i32 s85, s39, 4224
    s_lshl_b32 s52, s53, 2
    s_add_u32 s85, s85, s52
    s_add_u32 s52, s85, 34603008
    s_add_u32 s85, s85, 34668544
    v_mov_b32 v15, 0
    v_mov_b32 v3, 0x40000000
    v_mov_b32 v248, 0x40000000
    v_mov_b32 v249, 1
    s_cmp_eq_u32 s36, 0
    s_cselect_b32 s50, 0, 0x40000000
    v_writelane_b32 v3, s84, 0
    v_writelane_b32 v3, s85, 1
    v_writelane_b32 v3, s52, 2
    v_writelane_b32 v248, s50, 0
    buffer_store_dword v15, v3, s[28:31], s50 offen sc1
    s_lshr_b32 s86, s2, 3
    s_and_b32 s86, s86, 3
    s_add_u32 s86, s86, 2
    v_and_b32 v2, 15, v1
    v_lshrrev_b32 v3, 4, v1
    v_and_b32 v4, 6, v2
    v_xor_b32 v4, v4, v3
    v_lshlrev_b32 v4, 4, v4
    s_lshl_b32 s50, s37, 14
    v_lshl_add_u32 v4, v2, 7, v4
    v_add_u32 v224, s50, v4
    v_xor_b32 v225, 64, v224
    v_lshrrev_b32 v4, 2, v2
    v_lshl_add_u32 v5, v3, 3, v4
    v_and_b32 v8, 3, v2
    v_lshlrev_b32 v8, 3, v8
    v_and_b32 v9, 1, v3
    v_lshl_or_b32 v10, v9, 2, v4
    v_lshl_add_u32 v11, v5, 8, v8
    v_add_u32 v11, 65536, v11
    s_lshl_b32 s50, s38, 2
    s_add_u32 s51, s50, 0
    v_xor_b32 v12, s51, v10
    v_lshl_add_u32 v226, v12, 5, v11
    s_add_u32 s51, s50, 1
    v_xor_b32 v12, s51, v10
    v_lshl_add_u32 v227, v12, 5, v11
    s_add_u32 s51, s50, 2
    v_xor_b32 v12, s51, v10
    v_lshl_add_u32 v228, v12, 5, v11
    s_add_u32 s51, s50, 3
    v_xor_b32 v12, s51, v10
    v_lshl_add_u32 v229, v12, 5, v11
    v_mul_u32_u24 v11, 192, v5
    v_add_u32 v11, v11, v8
    s_mul_i32 s50, s38, 96
    s_add_u32 s50, s50, 98304
    v_add_u32 v11, s50, v11
    v_lshlrev_b32 v12, 5, v9
    v_add_u32 v13, v11, v12
    v_sub_u32 v11, v11, v12
    s_cmp_eq_u32 s38, 0
    s_cselect_b64 vcc, -1, 0
    v_cndmask_b32 v230, v11, v13, vcc
    v_cndmask_b32 v231, v13, v11, vcc
    s_mov_b32 s54, 0xbdd2d3e8
    s_mov_b32 s55, 0xbdd2d3e8
    v_and_b32 v2, 31, v1
    v_lshlrev_b32 v252, 6, v2
    v_lshrrev_b32 v3, 5, v1
    v_lshl_add_u32 v253, v3, 11, v252
    s_lshl_b32 s50, s39, 8
    s_lshl_b32 s51, s62, 3
    s_add_u32 s50, s50, s51
    s_lshl_b32 s51, s36, 1
    s_add_u32 s50, s50, s51
    s_lshl_b32 s60, s50, 2
    s_add_u32 s60, s60, 33554432
    s_lshl_b32 s61, s50, 11
    s_lshl_b32 s51, s39, 3
    s_lshl_b32 s52, s37, 2
    s_add_u32 s51, s51, s52
    s_lshl_b32 s50, s40, 2
    s_lshl_b32 s52, s38, 1
    s_add_u32 s50, s50, s52
    s_lshl_b32 s50, s50, 17
    s_lshl_b32 s52, s51, 11
    s_add_u32 s58, s50, s52
    s_mul_i32 s50, s51, 288
    s_mul_i32 s51, s40, 6
    s_add_u32 s51, s51, 192
    s_mul_i32 s52, s38, 3
    s_add_u32 s50, s50, s51
    s_add_u32 s50, s50, s52
    s_lshl_b32 s50, s50, 10
    s_add_u32 s90, s50, 12582912
    s_add_u32 s91, s50, 12877824
    s_add_u32 s92, s50, 13172736
    s_add_u32 s93, s50, 13467648
    s_cmp_lt_u32 s40, 8
    s_cselect_b32 s56, 0x3e8293ee, 1.0
    s_cselect_b32 s53, 0, 0x80
    s_mov_b32 s57, s56
    s_and_b32 s50, s2, 7
    s_lshr_b32 s51, s2, 3
    s_and_b32 s81, s51, 7
    s_lshr_b32 s52, s51, 3
    s_lshl_b32 s80, s50, 2
    s_add_u32 s80, s80, s52
    s_lshl_b32 s82, s81, 3
    s_lshl_b32 s52, s36, 1
    s_add_u32 s82, s82, s52
    s_and_b32 s83, s51, 3
    s_lshr_b32 s8, s51, 2
    s_lshr_b32 s52, s50, 1
    s_lshl_b32 s52, s52, 2
    s_add_u32 s83, s83, s52
    s_and_b32 s52, s50, 1
    s_lshl_b32 s52, s52, 3
    s_add_u32 s8, s8, s52
    s_lshl_b32 s11, s36, 11
    s_xor_b32 s12, s11, 0x8000
    s_lshl_b32 s50, s80, 17
    s_add_u32 s9, s50, s11
    s_add_u32 s10, s9, 8404992
    s_add_u32 s9, s9, 4210688
    s_lshl_b32 s51, s82, 11
    s_add_u32 s88, s50, s51
    s_lshl_b32 s41, s82, 7
    s_add_u32 s41, s41, 33554432
    s_lshl_b32 s62, s83, 9
    s_add_u32 s62, s62, 33554432
    s_mul_i32 s94, s83, 1179648
    s_add_u32 s94, s94, 12582912
    s_mul_i32 s52, s36, 57344
    s_add_u32 s13, s94, s52
    s_add_u32 s13, s13, 65536
    s_mul_i32 s52, s36, 16384
    s_add_u32 s94, s94, s52
    s_lshl_b32 s95, s8, 7
    s_mul_i32 s52, s36, 1835008
    s_add_u32 s14, s95, s52
    s_mul_i32 s52, s36, 524288
    s_add_u32 s95, s95, s52
    s_lshl_b32 s40, s36, 14
    s_add_u32 s15, s40, 98304
    s_lshl_b32 s4, s36, 13
    s_add_u32 s4, s4, 65536
    s_mul_i32 s3, s81, 4224
    s_lshl_b32 s50, s80, 2
    s_add_u32 s3, s3, s50
    s_add_u32 s3, s3, 34603008
    s_waitcnt vmcnt(10)
    s_barrier
    ds_read_b64_tr_b16 v[208:209], v226 offset:0
    ds_read_b64_tr_b16 v[210:211], v226 offset:1024
    ds_read_b64_tr_b16 v[212:213], v226 offset:8192
    ds_read_b64_tr_b16 v[214:215], v226 offset:9216
    ds_read_b128 v[16:19], v224 offset:0
    ds_read_b128 v[20:23], v225 offset:0
    ds_read_b128 v[24:27], v224 offset:2048
    ds_read_b128 v[28:31], v225 offset:2048
    ds_read_b128 v[32:35], v224 offset:4096
    ds_read_b128 v[36:39], v225 offset:4096
    ds_read_b128 v[40:43], v224 offset:6144
    ds_read_b128 v[44:47], v225 offset:6144
    ds_read_b128 v[48:51], v224 offset:8192
    ds_read_b128 v[52:55], v225 offset:8192
    ds_read_b128 v[56:59], v224 offset:10240
    ds_read_b128 v[60:63], v225 offset:10240
    ds_read_b128 v[64:67], v224 offset:12288
    ds_read_b128 v[68:71], v225 offset:12288
    ds_read_b128 v[72:75], v224 offset:14336
    ds_read_b128 v[76:79], v225 offset:14336
    s_mov_b32 s48, 7
    s_waitcnt lgkmcnt(0)
    s_barrier
    v_mfma_f32_16x16x32_bf16 a[0:3], v[208:211], v[16:19], 0
    s_add_u32 m0, s45, 32768
    v_mfma_f32_16x16x32_bf16 a[0:3], v[212:215], v[20:23], a[0:3]
    ds_read_b64_tr_b16 v[216:217], v227 offset:0
    buffer_load_dwordx4 v232, s[16:19], s42 offen lds
    v_mfma_f32_16x16x32_bf16 a[4:7], v[208:211], v[24:27], 0
    v_mfma_f32_16x16x32_bf16 a[4:7], v[212:215], v[28:31], a[4:7]
    ds_read_b64_tr_b16 v[218:219], v227 offset:1024
    v_mfma_f32_16x16x32_bf16 a[8:11], v[208:211], v[32:35], 0
    s_add_u32 m0, s45, 33792
    v_mfma_f32_16x16x32_bf16 a[8:11], v[212:215], v[36:39], a[8:11]
    ds_read_b64_tr_b16 v[220:221], v227 offset:8192
    buffer_load_dwordx4 v233, s[16:19], s42 offen lds
    v_mfma_f32_16x16x32_bf16 a[12:15], v[208:211], v[40:43], 0
    v_mfma_f32_16x16x32_bf16 a[12:15], v[212:215], v[44:47], a[12:15]
    ds_read_b64_tr_b16 v[222:223], v227 offset:9216
    v_mfma_f32_16x16x32_bf16 a[16:19], v[208:211], v[48:51], 0
    s_add_u32 m0, s45, 34816
    v_mfma_f32_16x16x32_bf16 a[16:19], v[212:215], v[52:55], a[16:19]
    buffer_load_dwordx4 v234, s[16:19], s42 offen lds
    v_mfma_f32_16x16x32_bf16 a[20:23], v[208:211], v[56:59], 0
    v_mfma_f32_16x16x32_bf16 a[20:23], v[212:215], v[60:63], a[20:23]
    v_mfma_f32_16x16x32_bf16 a[24:27], v[208:211], v[64:67], 0
    s_add_u32 m0, s45, 35840
    v_mfma_f32_16x16x32_bf16 a[24:27], v[212:215], v[68:71], a[24:27]
    buffer_load_dwordx4 v235, s[16:19], s42 offen lds
    v_mfma_f32_16x16x32_bf16 a[28:31], v[208:211], v[72:75], 0
    v_mfma_f32_16x16x32_bf16 a[28:31], v[212:215], v[76:79], a[28:31]
    s_waitcnt lgkmcnt(0)
    v_mfma_f32_16x16x32_bf16 a[32:35], v[216:219], v[16:19], 0
    s_add_u32 m0, s45, 36864
    v_mfma_f32_16x16x32_bf16 a[32:35], v[220:223], v[20:23], a[32:35]
    ds_read_b64_tr_b16 v[208:209], v228 offset:0
    buffer_load_dwordx4 v236, s[16:19], s42 offen lds
    v_mfma_f32_16x16x32_bf16 a[36:39], v[216:219], v[24:27], 0
    v_mfma_f32_16x16x32_bf16 a[36:39], v[220:223], v[28:31], a[36:39]
    ds_read_b64_tr_b16 v[210:211], v228 offset:1024
    v_mfma_f32_16x16x32_bf16 a[40:43], v[216:219], v[32:35], 0
    s_add_u32 m0, s45, 37888
    v_mfma_f32_16x16x32_bf16 a[40:43], v[220:223], v[36:39], a[40:43]
    ds_read_b64_tr_b16 v[212:213], v228 offset:8192
    buffer_load_dwordx4 v237, s[16:19], s42 offen lds
    v_mfma_f32_16x16x32_bf16 a[44:47], v[216:219], v[40:43], 0
    v_mfma_f32_16x16x32_bf16 a[44:47], v[220:223], v[44:47], a[44:47]
    ds_read_b64_tr_b16 v[214:215], v228 offset:9216
    v_mfma_f32_16x16x32_bf16 a[48:51], v[216:219], v[48:51], 0
    s_add_u32 m0, s45, 38912
    v_mfma_f32_16x16x32_bf16 a[48:51], v[220:223], v[52:55], a[48:51]
    buffer_load_dwordx4 v238, s[16:19], s42 offen lds
    v_mfma_f32_16x16x32_bf16 a[52:55], v[216:219], v[56:59], 0
    v_mfma_f32_16x16x32_bf16 a[52:55], v[220:223], v[60:63], a[52:55]
    v_mfma_f32_16x16x32_bf16 a[56:59], v[216:219], v[64:67], 0
    s_add_u32 m0, s45, 39936
    v_mfma_f32_16x16x32_bf16 a[56:59], v[220:223], v[68:71], a[56:59]
    buffer_load_dwordx4 v239, s[16:19], s42 offen lds
    s_add_u32 s42, s42, 128
    v_mfma_f32_16x16x32_bf16 a[60:63], v[216:219], v[72:75], 0
    v_mfma_f32_16x16x32_bf16 a[60:63], v[220:223], v[76:79], a[60:63]
    s_waitcnt lgkmcnt(0)
    v_mfma_f32_16x16x32_bf16 a[64:67], v[208:211], v[16:19], 0
    s_add_u32 m0, s46, 16384
    v_mfma_f32_16x16x32_bf16 a[64:67], v[212:215], v[20:23], a[64:67]
    ds_read_b64_tr_b16 v[216:217], v229 offset:0
    buffer_load_dwordx4 v240, s[20:23], s43 offen lds
    v_mfma_f32_16x16x32_bf16 a[68:71], v[208:211], v[24:27], 0
    v_mfma_f32_16x16x32_bf16 a[68:71], v[212:215], v[28:31], a[68:71]
    ds_read_b64_tr_b16 v[218:219], v229 offset:1024
    v_mfma_f32_16x16x32_bf16 a[72:75], v[208:211], v[32:35], 0
    s_add_u32 m0, s46, 17408
    v_mfma_f32_16x16x32_bf16 a[72:75], v[212:215], v[36:39], a[72:75]
    ds_read_b64_tr_b16 v[220:221], v229 offset:8192
    buffer_load_dwordx4 v241, s[20:23], s43 offen lds
    s_add_u32 s43, s43, 196608
    v_mfma_f32_16x16x32_bf16 a[76:79], v[208:211], v[40:43], 0
    v_mfma_f32_16x16x32_bf16 a[76:79], v[212:215], v[44:47], a[76:79]
    ds_read_b64_tr_b16 v[222:223], v229 offset:9216
    v_mfma_f32_16x16x32_bf16 a[80:83], v[208:211], v[48:51], 0
    s_add_u32 m0, s46, 24576
    v_mfma_f32_16x16x32_bf16 a[80:83], v[212:215], v[52:55], a[80:83]
    buffer_load_dwordx4 v240, s[20:23], s43 offen lds
    v_mfma_f32_16x16x32_bf16 a[84:87], v[208:211], v[56:59], 0
    v_mfma_f32_16x16x32_bf16 a[84:87], v[212:215], v[60:63], a[84:87]
    v_mfma_f32_16x16x32_bf16 a[88:91], v[208:211], v[64:67], 0
    s_add_u32 m0, s46, 25600
    v_mfma_f32_16x16x32_bf16 a[88:91], v[212:215], v[68:71], a[88:91]
    buffer_load_dwordx4 v241, s[20:23], s43 offen lds
    s_add_u32 s43, s43, 196608
    v_mfma_f32_16x16x32_bf16 a[92:95], v[208:211], v[72:75], 0
    s_waitcnt vmcnt(16)
    v_mfma_f32_16x16x32_bf16 a[92:95], v[212:215], v[76:79], a[92:95]
    s_waitcnt lgkmcnt(0)
    s_barrier
    v_mfma_f32_16x16x32_bf16 a[96:99], v[216:219], v[16:19], 0
    s_add_u32 m0, s47, 24576
    v_mfma_f32_16x16x32_bf16 a[96:99], v[220:223], v[20:23], a[96:99]
    ds_read_b64_tr_b16 v[208:209], v230 offset:0
    buffer_load_dwordx4 v242, s[24:27], s44 offen lds
    v_mfma_f32_16x16x32_bf16 a[100:103], v[216:219], v[24:27], 0
    v_mfma_f32_16x16x32_bf16 a[100:103], v[220:223], v[28:31], a[100:103]
    ds_read_b64_tr_b16 v[210:211], v230 offset:768
    v_mfma_f32_16x16x32_bf16 a[104:107], v[216:219], v[32:35], 0
    s_add_u32 m0, s47, 25600
    v_mfma_f32_16x16x32_bf16 a[104:107], v[220:223], v[36:39], a[104:107]
    ds_read_b64_tr_b16 v[212:213], v230 offset:12288
    buffer_load_dwordx4 v243, s[24:27], s44 offen lds
    v_mfma_f32_16x16x32_bf16 a[108:111], v[216:219], v[40:43], 0
    v_mfma_f32_16x16x32_bf16 a[108:111], v[220:223], v[44:47], a[108:111]
    ds_read_b64_tr_b16 v[214:215], v230 offset:13056
    v_mfma_f32_16x16x32_bf16 a[112:115], v[216:219], v[48:51], 0
    s_add_u32 m0, s47, 26624
    v_mfma_f32_16x16x32_bf16 a[112:115], v[220:223], v[52:55], a[112:115]
    buffer_load_dwordx4 v244, s[24:27], s44 offen lds
    s_add_u32 s44, s44, 229376
    v_mfma_f32_16x16x32_bf16 a[116:119], v[216:219], v[56:59], 0
    v_mfma_f32_16x16x32_bf16 a[116:119], v[220:223], v[60:63], a[116:119]
    v_mfma_f32_16x16x32_bf16 a[120:123], v[216:219], v[64:67], 0
    s_add_u32 m0, s47, 36864
    v_mfma_f32_16x16x32_bf16 a[120:123], v[220:223], v[68:71], a[120:123]
    buffer_load_dwordx4 v242, s[24:27], s44 offen lds
    v_mfma_f32_16x16x32_bf16 a[124:127], v[216:219], v[72:75], 0
    v_mfma_f32_16x16x32_bf16 a[124:127], v[220:223], v[76:79], a[124:127]
    s_waitcnt lgkmcnt(0)
    v_mfma_f32_16x16x32_bf16 a[128:131], v[208:211], v[16:19], 0
    s_add_u32 m0, s47, 37888
    v_mfma_f32_16x16x32_bf16 a[128:131], v[212:215], v[20:23], a[128:131]
    ds_read_b64_tr_b16 v[216:217], v230 offset:6144
    buffer_load_dwordx4 v243, s[24:27], s44 offen lds
    v_mfma_f32_16x16x32_bf16 a[132:135], v[208:211], v[24:27], 0
    v_mfma_f32_16x16x32_bf16 a[132:135], v[212:215], v[28:31], a[132:135]
    ds_read_b64_tr_b16 v[218:219], v230 offset:6912
    v_mfma_f32_16x16x32_bf16 a[136:139], v[208:211], v[32:35], 0
    s_add_u32 m0, s47, 38912
    v_mfma_f32_16x16x32_bf16 a[136:139], v[212:215], v[36:39], a[136:139]
    ds_read_b64_tr_b16 v[220:221], v230 offset:18432
    buffer_load_dwordx4 v244, s[24:27], s44 offen lds
    s_add_u32 s44, s44, 229376
    v_mfma_f32_16x16x32_bf16 a[140:143], v[208:211], v[40:43], 0
    v_mfma_f32_16x16x32_bf16 a[140:143], v[212:215], v[44:47], a[140:143]
    ds_read_b64_tr_b16 v[222:223], v230 offset:19200
    v_mfma_f32_16x16x32_bf16 a[144:147], v[208:211], v[48:51], 0
    s_add_u32 m0, s45, 0
    v_mfma_f32_16x16x32_bf16 a[144:147], v[212:215], v[52:55], a[144:147]
    buffer_load_dwordx4 v232, s[16:19], s42 offen lds
    v_mfma_f32_16x16x32_bf16 a[148:151], v[208:211], v[56:59], 0
    v_mfma_f32_16x16x32_bf16 a[148:151], v[212:215], v[60:63], a[148:151]
    v_mfma_f32_16x16x32_bf16 a[152:155], v[208:211], v[64:67], 0
    s_add_u32 m0, s45, 1024
    v_mfma_f32_16x16x32_bf16 a[152:155], v[212:215], v[68:71], a[152:155]
    buffer_load_dwordx4 v233, s[16:19], s42 offen lds
    v_mfma_f32_16x16x32_bf16 a[156:159], v[208:211], v[72:75], 0
    s_waitcnt vmcnt(12)
    v_mfma_f32_16x16x32_bf16 a[156:159], v[212:215], v[76:79], a[156:159]
    s_waitcnt lgkmcnt(0)
    s_barrier
    v_mfma_f32_16x16x32_bf16 a[160:163], v[216:219], v[16:19], 0
    s_add_u32 m0, s45, 2048
    v_mfma_f32_16x16x32_bf16 a[160:163], v[220:223], v[20:23], a[160:163]
    ds_read_b64_tr_b16 v[208:209], v231 offset:32
    buffer_load_dwordx4 v234, s[16:19], s42 offen lds
    v_mfma_f32_16x16x32_bf16 a[164:167], v[216:219], v[24:27], 0
    v_mfma_f32_16x16x32_bf16 a[164:167], v[220:223], v[28:31], a[164:167]
    ds_read_b64_tr_b16 v[210:211], v231 offset:800
    v_mfma_f32_16x16x32_bf16 a[168:171], v[216:219], v[32:35], 0
    s_add_u32 m0, s45, 3072
    v_mfma_f32_16x16x32_bf16 a[168:171], v[220:223], v[36:39], a[168:171]
    ds_read_b64_tr_b16 v[212:213], v231 offset:12320
    buffer_load_dwordx4 v235, s[16:19], s42 offen lds
    v_mfma_f32_16x16x32_bf16 a[172:175], v[216:219], v[40:43], 0
    v_mfma_f32_16x16x32_bf16 a[172:175], v[220:223], v[44:47], a[172:175]
    ds_read_b64_tr_b16 v[214:215], v231 offset:13088
    v_mfma_f32_16x16x32_bf16 a[176:179], v[216:219], v[48:51], 0
    ds_read_b128 v[80:83], v224 offset:32768
    s_add_u32 m0, s45, 4096
    v_mfma_f32_16x16x32_bf16 a[176:179], v[220:223], v[52:55], a[176:179]
    buffer_load_dwordx4 v236, s[16:19], s42 offen lds
    v_mfma_f32_16x16x32_bf16 a[180:183], v[216:219], v[56:59], 0
    ds_read_b128 v[84:87], v225 offset:32768
    v_mfma_f32_16x16x32_bf16 a[180:183], v[220:223], v[60:63], a[180:183]
    v_mfma_f32_16x16x32_bf16 a[184:187], v[216:219], v[64:67], 0
    ds_read_b128 v[88:91], v224 offset:34816
    s_add_u32 m0, s45, 5120
    v_mfma_f32_16x16x32_bf16 a[184:187], v[220:223], v[68:71], a[184:187]
    buffer_load_dwordx4 v237, s[16:19], s42 offen lds
    v_mfma_f32_16x16x32_bf16 a[188:191], v[216:219], v[72:75], 0
    ds_read_b128 v[92:95], v225 offset:34816
    v_mfma_f32_16x16x32_bf16 a[188:191], v[220:223], v[76:79], a[188:191]
    s_waitcnt lgkmcnt(4)
    v_mfma_f32_16x16x32_bf16 a[192:195], v[208:211], v[16:19], 0
    s_add_u32 m0, s45, 6144
    v_mfma_f32_16x16x32_bf16 a[192:195], v[212:215], v[20:23], a[192:195]
    ds_read_b64_tr_b16 v[216:217], v231 offset:6176
    buffer_load_dwordx4 v238, s[16:19], s42 offen lds
    v_mfma_f32_16x16x32_bf16 a[196:199], v[208:211], v[24:27], 0
    v_mfma_f32_16x16x32_bf16 a[196:199], v[212:215], v[28:31], a[196:199]
    ds_read_b64_tr_b16 v[218:219], v231 offset:6944
    v_mfma_f32_16x16x32_bf16 a[200:203], v[208:211], v[32:35], 0
    s_add_u32 m0, s45, 7168
    v_mfma_f32_16x16x32_bf16 a[200:203], v[212:215], v[36:39], a[200:203]
    ds_read_b64_tr_b16 v[220:221], v231 offset:18464
    buffer_load_dwordx4 v239, s[16:19], s42 offen lds
    s_add_u32 s42, s42, 128
    v_mfma_f32_16x16x32_bf16 a[204:207], v[208:211], v[40:43], 0
    v_mfma_f32_16x16x32_bf16 a[204:207], v[212:215], v[44:47], a[204:207]
    ds_read_b64_tr_b16 v[222:223], v231 offset:19232
    v_mfma_f32_16x16x32_bf16 a[208:211], v[208:211], v[48:51], 0
    ds_read_b128 v[96:99], v224 offset:36864
    v_mfma_f32_16x16x32_bf16 a[208:211], v[212:215], v[52:55], a[208:211]
    v_mfma_f32_16x16x32_bf16 a[212:215], v[208:211], v[56:59], 0
    ds_read_b128 v[100:103], v225 offset:36864
    v_mfma_f32_16x16x32_bf16 a[212:215], v[212:215], v[60:63], a[212:215]
    v_mfma_f32_16x16x32_bf16 a[216:219], v[208:211], v[64:67], 0
    ds_read_b128 v[104:107], v224 offset:38912
    s_add_u32 m0, s46, 0
    v_mfma_f32_16x16x32_bf16 a[216:219], v[212:215], v[68:71], a[216:219]
    buffer_load_dwordx4 v240, s[20:23], s43 offen lds
    v_mfma_f32_16x16x32_bf16 a[220:223], v[208:211], v[72:75], 0
    ds_read_b128 v[108:111], v225 offset:38912
    v_mfma_f32_16x16x32_bf16 a[220:223], v[212:215], v[76:79], a[220:223]
    s_waitcnt lgkmcnt(4)
    v_mfma_f32_16x16x32_bf16 a[224:227], v[216:219], v[16:19], 0
    s_add_u32 m0, s46, 1024
    v_mfma_f32_16x16x32_bf16 a[224:227], v[220:223], v[20:23], a[224:227]
    ds_read_b64_tr_b16 v[208:209], v230 offset:64
    buffer_load_dwordx4 v241, s[20:23], s43 offen lds
    s_add_u32 s43, s43, 196608
    v_mfma_f32_16x16x32_bf16 a[228:231], v[216:219], v[24:27], 0
    v_mfma_f32_16x16x32_bf16 a[228:231], v[220:223], v[28:31], a[228:231]
    ds_read_b64_tr_b16 v[210:211], v230 offset:832
    v_mfma_f32_16x16x32_bf16 a[232:235], v[216:219], v[32:35], 0
    s_add_u32 m0, s46, 8192
    v_mfma_f32_16x16x32_bf16 a[232:235], v[220:223], v[36:39], a[232:235]
    ds_read_b64_tr_b16 v[212:213], v230 offset:12352
    buffer_load_dwordx4 v240, s[20:23], s43 offen lds
    v_mfma_f32_16x16x32_bf16 a[236:239], v[216:219], v[40:43], 0
    v_mfma_f32_16x16x32_bf16 a[236:239], v[220:223], v[44:47], a[236:239]
    ds_read_b64_tr_b16 v[214:215], v230 offset:13120
    v_mfma_f32_16x16x32_bf16 a[240:243], v[216:219], v[48:51], 0
    ds_read_b128 v[112:115], v224 offset:40960
    s_add_u32 m0, s46, 9216
    v_mfma_f32_16x16x32_bf16 a[240:243], v[220:223], v[52:55], a[240:243]
    buffer_load_dwordx4 v241, s[20:23], s43 offen lds
    s_add_u32 s43, s43, 196608
    v_mfma_f32_16x16x32_bf16 a[244:247], v[216:219], v[56:59], 0
    ds_read_b128 v[116:119], v225 offset:40960
    v_mfma_f32_16x16x32_bf16 a[244:247], v[220:223], v[60:63], a[244:247]
    v_mfma_f32_16x16x32_bf16 a[248:251], v[216:219], v[64:67], 0
    ds_read_b128 v[120:123], v224 offset:43008
    v_mfma_f32_16x16x32_bf16 a[248:251], v[220:223], v[68:71], a[248:251]
    v_mfma_f32_16x16x32_bf16 a[252:255], v[216:219], v[72:75], 0
    ds_read_b128 v[124:127], v225 offset:43008
    v_mfma_f32_16x16x32_bf16 a[252:255], v[220:223], v[76:79], a[252:255]
    s_waitcnt lgkmcnt(4)
    v_mfma_f32_16x16x32_bf16 v[144:147], v[208:211], v[16:19], 0
    buffer_load_dword v246, v254, s[68:71], s5 offen
    v_mfma_f32_16x16x32_bf16 v[144:147], v[212:215], v[20:23], v[144:147]
    ds_read_b64_tr_b16 v[216:217], v230 offset:6208
    s_add_u32 s5, s5, 393216
    v_mfma_f32_16x16x32_bf16 v[148:151], v[208:211], v[24:27], 0
    v_mfma_f32_16x16x32_bf16 v[148:151], v[212:215], v[28:31], v[148:151]
    ds_read_b64_tr_b16 v[218:219], v230 offset:6976
    v_mfma_f32_16x16x32_bf16 v[152:155], v[208:211], v[32:35], 0
    buffer_load_dword v246, v254, s[20:23], s7 offen
    v_mfma_f32_16x16x32_bf16 v[152:155], v[212:215], v[36:39], v[152:155]
    ds_read_b64_tr_b16 v[220:221], v230 offset:18496
    s_add_u32 s7, s7, 393216
    v_mfma_f32_16x16x32_bf16 v[156:159], v[208:211], v[40:43], 0
    buffer_load_dword v246, v245, s[24:27], s49 offen
    v_mfma_f32_16x16x32_bf16 v[156:159], v[212:215], v[44:47], v[156:159]
    ds_read_b64_tr_b16 v[222:223], v230 offset:19264
    s_add_u32 s49, s49, 458752
    v_mfma_f32_16x16x32_bf16 v[160:163], v[208:211], v[48:51], 0
    ds_read_b128 v[128:131], v224 offset:45056
    v_mfma_f32_16x16x32_bf16 v[160:163], v[212:215], v[52:55], v[160:163]
    buffer_load_dword v246, v0, s[16:19], s63 offen
    v_mfma_f32_16x16x32_bf16 v[164:167], v[208:211], v[56:59], 0
    ds_read_b128 v[132:135], v225 offset:45056
    s_add_u32 s63, s63, 512
    v_mfma_f32_16x16x32_bf16 v[164:167], v[212:215], v[60:63], v[164:167]
    v_mfma_f32_16x16x32_bf16 v[168:171], v[208:211], v[64:67], 0
    ds_read_b128 v[136:139], v224 offset:47104
    v_mfma_f32_16x16x32_bf16 v[168:171], v[212:215], v[68:71], v[168:171]
    v_mfma_f32_16x16x32_bf16 v[172:175], v[208:211], v[72:75], 0
    ds_read_b128 v[140:143], v225 offset:47104
    s_waitcnt vmcnt(22)
    v_mfma_f32_16x16x32_bf16 v[172:175], v[212:215], v[76:79], v[172:175]
    s_waitcnt lgkmcnt(0)
    s_barrier
    v_mfma_f32_16x16x32_bf16 v[176:179], v[216:219], v[16:19], 0
    ds_read_b64_tr_b16 v[208:209], v226 offset:16384
    v_mfma_f32_16x16x32_bf16 v[176:179], v[220:223], v[20:23], v[176:179]
    s_add_u32 m0, s47, 0
    v_mfma_f32_16x16x32_bf16 v[180:183], v[216:219], v[24:27], 0
    ds_read_b64_tr_b16 v[210:211], v226 offset:17408
    buffer_load_dwordx4 v242, s[24:27], s44 offen lds
    v_mfma_f32_16x16x32_bf16 v[180:183], v[220:223], v[28:31], v[180:183]
    v_mfma_f32_16x16x32_bf16 v[184:187], v[216:219], v[32:35], 0
    ds_read_b64_tr_b16 v[212:213], v226 offset:24576
    v_mfma_f32_16x16x32_bf16 v[184:187], v[220:223], v[36:39], v[184:187]
    v_mfma_f32_16x16x32_bf16 v[188:191], v[216:219], v[40:43], 0
    ds_read_b64_tr_b16 v[214:215], v226 offset:25600
    v_mfma_f32_16x16x32_bf16 v[188:191], v[220:223], v[44:47], v[188:191]
    v_mfma_f32_16x16x32_bf16 v[192:195], v[216:219], v[48:51], 0
    s_add_u32 m0, s47, 1024
    v_mfma_f32_16x16x32_bf16 v[192:195], v[220:223], v[52:55], v[192:195]
    buffer_load_dwordx4 v243, s[24:27], s44 offen lds
    v_mfma_f32_16x16x32_bf16 v[196:199], v[216:219], v[56:59], 0
    v_mfma_f32_16x16x32_bf16 v[196:199], v[220:223], v[60:63], v[196:199]
    v_mfma_f32_16x16x32_bf16 v[200:203], v[216:219], v[64:67], 0
    v_mfma_f32_16x16x32_bf16 v[200:203], v[220:223], v[68:71], v[200:203]
    v_mfma_f32_16x16x32_bf16 v[204:207], v[216:219], v[72:75], 0
    v_mfma_f32_16x16x32_bf16 v[204:207], v[220:223], v[76:79], v[204:207]
    s_waitcnt lgkmcnt(0)
    v_mfma_f32_16x16x32_bf16 a[0:3], v[208:211], v[80:83], a[0:3]
    s_add_u32 m0, s47, 2048
    v_mfma_f32_16x16x32_bf16 a[0:3], v[212:215], v[84:87], a[0:3]
    ds_read_b64_tr_b16 v[216:217], v227 offset:16384
    buffer_load_dwordx4 v244, s[24:27], s44 offen lds
    s_add_u32 s44, s44, 229376
    v_mfma_f32_16x16x32_bf16 a[4:7], v[208:211], v[88:91], a[4:7]
    v_mfma_f32_16x16x32_bf16 a[4:7], v[212:215], v[92:95], a[4:7]
    ds_read_b64_tr_b16 v[218:219], v227 offset:17408
    v_mfma_f32_16x16x32_bf16 a[8:11], v[208:211], v[96:99], a[8:11]
    v_mfma_f32_16x16x32_bf16 a[8:11], v[212:215], v[100:103], a[8:11]
    ds_read_b64_tr_b16 v[220:221], v227 offset:24576
    v_mfma_f32_16x16x32_bf16 a[12:15], v[208:211], v[104:107], a[12:15]
    v_mfma_f32_16x16x32_bf16 a[12:15], v[212:215], v[108:111], a[12:15]
    ds_read_b64_tr_b16 v[222:223], v227 offset:25600
    v_mfma_f32_16x16x32_bf16 a[16:19], v[208:211], v[112:115], a[16:19]
    v_mfma_f32_16x16x32_bf16 a[16:19], v[212:215], v[116:119], a[16:19]
    s_add_u32 m0, s47, 12288
    v_mfma_f32_16x16x32_bf16 a[20:23], v[208:211], v[120:123], a[20:23]
    buffer_load_dwordx4 v242, s[24:27], s44 offen lds
    v_mfma_f32_16x16x32_bf16 a[20:23], v[212:215], v[124:127], a[20:23]
    v_mfma_f32_16x16x32_bf16 a[24:27], v[208:211], v[128:131], a[24:27]
    v_mfma_f32_16x16x32_bf16 a[24:27], v[212:215], v[132:135], a[24:27]
    v_mfma_f32_16x16x32_bf16 a[28:31], v[208:211], v[136:139], a[28:31]
    v_mfma_f32_16x16x32_bf16 a[28:31], v[212:215], v[140:143], a[28:31]
    s_waitcnt lgkmcnt(0)
    v_mfma_f32_16x16x32_bf16 a[32:35], v[216:219], v[80:83], a[32:35]
    v_mfma_f32_16x16x32_bf16 a[32:35], v[220:223], v[84:87], a[32:35]
    ds_read_b64_tr_b16 v[208:209], v228 offset:16384
    v_mfma_f32_16x16x32_bf16 a[36:39], v[216:219], v[88:91], a[36:39]
    s_add_u32 m0, s47, 13312
    v_mfma_f32_16x16x32_bf16 a[36:39], v[220:223], v[92:95], a[36:39]
    ds_read_b64_tr_b16 v[210:211], v228 offset:17408
    buffer_load_dwordx4 v243, s[24:27], s44 offen lds
    v_mfma_f32_16x16x32_bf16 a[40:43], v[216:219], v[96:99], a[40:43]
    v_mfma_f32_16x16x32_bf16 a[40:43], v[220:223], v[100:103], a[40:43]
    ds_read_b64_tr_b16 v[212:213], v228 offset:24576
    v_mfma_f32_16x16x32_bf16 a[44:47], v[216:219], v[104:107], a[44:47]
    v_mfma_f32_16x16x32_bf16 a[44:47], v[220:223], v[108:111], a[44:47]
    ds_read_b64_tr_b16 v[214:215], v228 offset:25600
    v_mfma_f32_16x16x32_bf16 a[48:51], v[216:219], v[112:115], a[48:51]
    v_mfma_f32_16x16x32_bf16 a[48:51], v[220:223], v[116:119], a[48:51]
    v_mfma_f32_16x16x32_bf16 a[52:55], v[216:219], v[120:123], a[52:55]
    v_mfma_f32_16x16x32_bf16 a[52:55], v[220:223], v[124:127], a[52:55]
    s_add_u32 m0, s47, 14336
    v_mfma_f32_16x16x32_bf16 a[56:59], v[216:219], v[128:131], a[56:59]
    buffer_load_dwordx4 v244, s[24:27], s44 offen lds
    s_add_u32 s44, s44, 229376
    v_mfma_f32_16x16x32_bf16 a[56:59], v[220:223], v[132:135], a[56:59]
    v_mfma_f32_16x16x32_bf16 a[60:63], v[216:219], v[136:139], a[60:63]
    v_mfma_f32_16x16x32_bf16 a[60:63], v[220:223], v[140:143], a[60:63]
    s_waitcnt lgkmcnt(0)
    v_mfma_f32_16x16x32_bf16 a[64:67], v[208:211], v[80:83], a[64:67]
    v_mfma_f32_16x16x32_bf16 a[64:67], v[212:215], v[84:87], a[64:67]
    ds_read_b64_tr_b16 v[216:217], v229 offset:16384
    v_mfma_f32_16x16x32_bf16 a[68:71], v[208:211], v[88:91], a[68:71]
    v_mfma_f32_16x16x32_bf16 a[68:71], v[212:215], v[92:95], a[68:71]
    ds_read_b64_tr_b16 v[218:219], v229 offset:17408
    v_mfma_f32_16x16x32_bf16 a[72:75], v[208:211], v[96:99], a[72:75]
    s_add_u32 m0, s45, 32768
    v_mfma_f32_16x16x32_bf16 a[72:75], v[212:215], v[100:103], a[72:75]
    ds_read_b64_tr_b16 v[220:221], v229 offset:24576
    buffer_load_dwordx4 v232, s[16:19], s42 offen lds
    v_mfma_f32_16x16x32_bf16 a[76:79], v[208:211], v[104:107], a[76:79]
    v_mfma_f32_16x16x32_bf16 a[76:79], v[212:215], v[108:111], a[76:79]
    ds_read_b64_tr_b16 v[222:223], v229 offset:25600
    v_mfma_f32_16x16x32_bf16 a[80:83], v[208:211], v[112:115], a[80:83]
    v_mfma_f32_16x16x32_bf16 a[80:83], v[212:215], v[116:119], a[80:83]
    v_mfma_f32_16x16x32_bf16 a[84:87], v[208:211], v[120:123], a[84:87]
    v_mfma_f32_16x16x32_bf16 a[84:87], v[212:215], v[124:127], a[84:87]
    v_mfma_f32_16x16x32_bf16 a[88:91], v[208:211], v[128:131], a[88:91]
    v_mfma_f32_16x16x32_bf16 a[88:91], v[212:215], v[132:135], a[88:91]
    s_add_u32 m0, s45, 33792
    v_mfma_f32_16x16x32_bf16 a[92:95], v[208:211], v[136:139], a[92:95]
    s_waitcnt vmcnt(15)
    buffer_load_dwordx4 v233, s[16:19], s42 offen lds
    v_mfma_f32_16x16x32_bf16 a[92:95], v[212:215], v[140:143], a[92:95]
    s_waitcnt lgkmcnt(0)
    s_barrier
    v_mfma_f32_16x16x32_bf16 a[96:99], v[216:219], v[80:83], a[96:99]
    v_mfma_f32_16x16x32_bf16 a[96:99], v[220:223], v[84:87], a[96:99]
    ds_read_b64_tr_b16 v[208:209], v230 offset:24576
    v_mfma_f32_16x16x32_bf16 a[100:103], v[216:219], v[88:91], a[100:103]
    v_mfma_f32_16x16x32_bf16 a[100:103], v[220:223], v[92:95], a[100:103]
    ds_read_b64_tr_b16 v[210:211], v230 offset:25344
    v_mfma_f32_16x16x32_bf16 a[104:107], v[216:219], v[96:99], a[104:107]
    v_mfma_f32_16x16x32_bf16 a[104:107], v[220:223], v[100:103], a[104:107]
    ds_read_b64_tr_b16 v[212:213], v230 offset:36864
    v_mfma_f32_16x16x32_bf16 a[108:111], v[216:219], v[104:107], a[108:111]
    s_add_u32 m0, s45, 34816
    v_mfma_f32_16x16x32_bf16 a[108:111], v[220:223], v[108:111], a[108:111]
    ds_read_b64_tr_b16 v[214:215], v230 offset:37632
    buffer_load_dwordx4 v234, s[16:19], s42 offen lds
    v_mfma_f32_16x16x32_bf16 a[112:115], v[216:219], v[112:115], a[112:115]
    ds_read_b128 v[16:19], v224 offset:0
    v_mfma_f32_16x16x32_bf16 a[112:115], v[220:223], v[116:119], a[112:115]
    v_mfma_f32_16x16x32_bf16 a[116:119], v[216:219], v[120:123], a[116:119]
    ds_read_b128 v[20:23], v225 offset:0
    v_mfma_f32_16x16x32_bf16 a[116:119], v[220:223], v[124:127], a[116:119]
    v_mfma_f32_16x16x32_bf16 a[120:123], v[216:219], v[128:131], a[120:123]
    v_mfma_f32_16x16x32_bf16 a[120:123], v[220:223], v[132:135], a[120:123]
    v_mfma_f32_16x16x32_bf16 a[124:127], v[216:219], v[136:139], a[124:127]
    ds_read_b128 v[24:27], v224 offset:2048
    v_mfma_f32_16x16x32_bf16 a[124:127], v[220:223], v[140:143], a[124:127]
    s_waitcnt lgkmcnt(3)
    s_add_u32 m0, s45, 35840
    v_mfma_f32_16x16x32_bf16 a[128:131], v[208:211], v[80:83], a[128:131]
    buffer_load_dwordx4 v235, s[16:19], s42 offen lds
    v_mfma_f32_16x16x32_bf16 a[128:131], v[212:215], v[84:87], a[128:131]
    ds_read_b64_tr_b16 v[216:217], v230 offset:30720
    v_mfma_f32_16x16x32_bf16 a[132:135], v[208:211], v[88:91], a[132:135]
    v_mfma_f32_16x16x32_bf16 a[132:135], v[212:215], v[92:95], a[132:135]
    ds_read_b64_tr_b16 v[218:219], v230 offset:31488
    v_mfma_f32_16x16x32_bf16 a[136:139], v[208:211], v[96:99], a[136:139]
    v_mfma_f32_16x16x32_bf16 a[136:139], v[212:215], v[100:103], a[136:139]
    ds_read_b64_tr_b16 v[220:221], v230 offset:43008
    v_mfma_f32_16x16x32_bf16 a[140:143], v[208:211], v[104:107], a[140:143]
    v_mfma_f32_16x16x32_bf16 a[140:143], v[212:215], v[108:111], a[140:143]
    ds_read_b64_tr_b16 v[222:223], v230 offset:43776
    v_mfma_f32_16x16x32_bf16 a[144:147], v[208:211], v[112:115], a[144:147]
    ds_read_b128 v[28:31], v225 offset:2048
    s_add_u32 m0, s45, 36864
    v_mfma_f32_16x16x32_bf16 a[144:147], v[212:215], v[116:119], a[144:147]
    buffer_load_dwordx4 v236, s[16:19], s42 offen lds
    v_mfma_f32_16x16x32_bf16 a[148:151], v[208:211], v[120:123], a[148:151]
    v_mfma_f32_16x16x32_bf16 a[148:151], v[212:215], v[124:127], a[148:151]
    v_mfma_f32_16x16x32_bf16 a[152:155], v[208:211], v[128:131], a[152:155]
    ds_read_b128 v[32:35], v224 offset:4096
    v_mfma_f32_16x16x32_bf16 a[152:155], v[212:215], v[132:135], a[152:155]
    v_mfma_f32_16x16x32_bf16 a[156:159], v[208:211], v[136:139], a[156:159]
    ds_read_b128 v[36:39], v225 offset:4096
    v_mfma_f32_16x16x32_bf16 a[156:159], v[212:215], v[140:143], a[156:159]
    s_waitcnt lgkmcnt(3)
    v_mfma_f32_16x16x32_bf16 a[160:163], v[216:219], v[80:83], a[160:163]
    v_mfma_f32_16x16x32_bf16 a[160:163], v[220:223], v[84:87], a[160:163]
    ds_read_b64_tr_b16 v[208:209], v231 offset:24608
    s_add_u32 m0, s45, 37888
    v_mfma_f32_16x16x32_bf16 a[164:167], v[216:219], v[88:91], a[164:167]
    buffer_load_dwordx4 v237, s[16:19], s42 offen lds
    v_mfma_f32_16x16x32_bf16 a[164:167], v[220:223], v[92:95], a[164:167]
    ds_read_b64_tr_b16 v[210:211], v231 offset:25376
    v_mfma_f32_16x16x32_bf16 a[168:171], v[216:219], v[96:99], a[168:171]
    v_mfma_f32_16x16x32_bf16 a[168:171], v[220:223], v[100:103], a[168:171]
    ds_read_b64_tr_b16 v[212:213], v231 offset:36896
    v_mfma_f32_16x16x32_bf16 a[172:175], v[216:219], v[104:107], a[172:175]
    v_mfma_f32_16x16x32_bf16 a[172:175], v[220:223], v[108:111], a[172:175]
    ds_read_b64_tr_b16 v[214:215], v231 offset:37664
    v_mfma_f32_16x16x32_bf16 a[176:179], v[216:219], v[112:115], a[176:179]
    v_mfma_f32_16x16x32_bf16 a[176:179], v[220:223], v[116:119], a[176:179]
    v_mfma_f32_16x16x32_bf16 a[180:183], v[216:219], v[120:123], a[180:183]
    ds_read_b128 v[40:43], v224 offset:6144
    s_add_u32 m0, s45, 38912
    v_mfma_f32_16x16x32_bf16 a[180:183], v[220:223], v[124:127], a[180:183]
    buffer_load_dwordx4 v238, s[16:19], s42 offen lds
    v_mfma_f32_16x16x32_bf16 a[184:187], v[216:219], v[128:131], a[184:187]
    ds_read_b128 v[44:47], v225 offset:6144
    v_mfma_f32_16x16x32_bf16 a[184:187], v[220:223], v[132:135], a[184:187]
    v_mfma_f32_16x16x32_bf16 a[188:191], v[216:219], v[136:139], a[188:191]
    v_mfma_f32_16x16x32_bf16 a[188:191], v[220:223], v[140:143], a[188:191]
    s_waitcnt lgkmcnt(2)
    v_mfma_f32_16x16x32_bf16 a[192:195], v[208:211], v[80:83], a[192:195]
    v_mfma_f32_16x16x32_bf16 a[192:195], v[212:215], v[84:87], a[192:195]
    ds_read_b64_tr_b16 v[216:217], v231 offset:30752
    v_mfma_f32_16x16x32_bf16 a[196:199], v[208:211], v[88:91], a[196:199]
    v_mfma_f32_16x16x32_bf16 a[196:199], v[212:215], v[92:95], a[196:199]
    ds_read_b64_tr_b16 v[218:219], v231 offset:31520
    s_add_u32 m0, s45, 39936
    v_mfma_f32_16x16x32_bf16 a[200:203], v[208:211], v[96:99], a[200:203]
    buffer_load_dwordx4 v239, s[16:19], s42 offen lds
    s_add_u32 s42, s42, 128
    v_mfma_f32_16x16x32_bf16 a[200:203], v[212:215], v[100:103], a[200:203]
    ds_read_b64_tr_b16 v[220:221], v231 offset:43040
    v_mfma_f32_16x16x32_bf16 a[204:207], v[208:211], v[104:107], a[204:207]
    v_mfma_f32_16x16x32_bf16 a[204:207], v[212:215], v[108:111], a[204:207]
    ds_read_b64_tr_b16 v[222:223], v231 offset:43808
    v_mfma_f32_16x16x32_bf16 a[208:211], v[208:211], v[112:115], a[208:211]
    ds_read_b128 v[48:51], v224 offset:8192
    v_mfma_f32_16x16x32_bf16 a[208:211], v[212:215], v[116:119], a[208:211]
    v_mfma_f32_16x16x32_bf16 a[212:215], v[208:211], v[120:123], a[212:215]
    ds_read_b128 v[52:55], v225 offset:8192
    v_mfma_f32_16x16x32_bf16 a[212:215], v[212:215], v[124:127], a[212:215]
    v_mfma_f32_16x16x32_bf16 a[216:219], v[208:211], v[128:131], a[216:219]
    s_add_u32 m0, s46, 16384
    v_mfma_f32_16x16x32_bf16 a[216:219], v[212:215], v[132:135], a[216:219]
    buffer_load_dwordx4 v240, s[20:23], s43 offen lds
    v_mfma_f32_16x16x32_bf16 a[220:223], v[208:211], v[136:139], a[220:223]
    ds_read_b128 v[56:59], v224 offset:10240
    v_mfma_f32_16x16x32_bf16 a[220:223], v[212:215], v[140:143], a[220:223]
    s_waitcnt lgkmcnt(3)
    v_mfma_f32_16x16x32_bf16 a[224:227], v[216:219], v[80:83], a[224:227]
    s_add_u32 m0, s46, 17408
    v_mfma_f32_16x16x32_bf16 a[224:227], v[220:223], v[84:87], a[224:227]
    ds_read_b64_tr_b16 v[208:209], v230 offset:24640
    buffer_load_dwordx4 v241, s[20:23], s43 offen lds
    s_add_u32 s43, s43, 196608
    v_mfma_f32_16x16x32_bf16 a[228:231], v[216:219], v[88:91], a[228:231]
    v_mfma_f32_16x16x32_bf16 a[228:231], v[220:223], v[92:95], a[228:231]
    ds_read_b64_tr_b16 v[210:211], v230 offset:25408
    v_mfma_f32_16x16x32_bf16 a[232:235], v[216:219], v[96:99], a[232:235]
    s_add_u32 m0, s46, 24576
    v_mfma_f32_16x16x32_bf16 a[232:235], v[220:223], v[100:103], a[232:235]
    ds_read_b64_tr_b16 v[212:213], v230 offset:36928
    buffer_load_dwordx4 v240, s[20:23], s43 offen lds
    v_mfma_f32_16x16x32_bf16 a[236:239], v[216:219], v[104:107], a[236:239]
    v_mfma_f32_16x16x32_bf16 a[236:239], v[220:223], v[108:111], a[236:239]
    ds_read_b64_tr_b16 v[214:215], v230 offset:37696
    v_mfma_f32_16x16x32_bf16 a[240:243], v[216:219], v[112:115], a[240:243]
    ds_read_b128 v[60:63], v225 offset:10240
    s_add_u32 m0, s46, 25600
    v_mfma_f32_16x16x32_bf16 a[240:243], v[220:223], v[116:119], a[240:243]
    buffer_load_dwordx4 v241, s[20:23], s43 offen lds
    s_add_u32 s43, s43, 196608
    v_mfma_f32_16x16x32_bf16 a[244:247], v[216:219], v[120:123], a[244:247]
    v_mfma_f32_16x16x32_bf16 a[244:247], v[220:223], v[124:127], a[244:247]
    v_mfma_f32_16x16x32_bf16 a[248:251], v[216:219], v[128:131], a[248:251]
    ds_read_b128 v[64:67], v224 offset:12288
    v_mfma_f32_16x16x32_bf16 a[248:251], v[220:223], v[132:135], a[248:251]
    v_mfma_f32_16x16x32_bf16 a[252:255], v[216:219], v[136:139], a[252:255]
    ds_read_b128 v[68:71], v225 offset:12288
    buffer_load_dword v246, v245, s[64:67], s6 offen
    v_mfma_f32_16x16x32_bf16 a[252:255], v[220:223], v[140:143], a[252:255]
    s_waitcnt lgkmcnt(3)
    s_add_u32 s6, s6, 1048576
    v_mfma_f32_16x16x32_bf16 v[144:147], v[208:211], v[80:83], v[144:147]
    s_cmp_eq_u32 s48, s86
    v_mfma_f32_16x16x32_bf16 v[144:147], v[212:215], v[84:87], v[144:147]
    ds_read_b64_tr_b16 v[216:217], v230 offset:30784
    s_cselect_b32 s87, 0, 0x40000000
    v_mfma_f32_16x16x32_bf16 v[148:151], v[208:211], v[88:91], v[148:151]
    buffer_atomic_add v249, v248, s[76:79], s87 offen sc1
    v_mfma_f32_16x16x32_bf16 v[148:151], v[212:215], v[92:95], v[148:151]
    ds_read_b64_tr_b16 v[218:219], v230 offset:31552
    v_mfma_f32_16x16x32_bf16 v[152:155], v[208:211], v[96:99], v[152:155]
    buffer_load_dword v246, v254, s[20:23], s7 offen
    v_mfma_f32_16x16x32_bf16 v[152:155], v[212:215], v[100:103], v[152:155]
    ds_read_b64_tr_b16 v[220:221], v230 offset:43072
    s_add_u32 s7, s7, 393216
    v_mfma_f32_16x16x32_bf16 v[156:159], v[208:211], v[104:107], v[156:159]
    buffer_load_dword v246, v245, s[24:27], s49 offen
    v_mfma_f32_16x16x32_bf16 v[156:159], v[212:215], v[108:111], v[156:159]
    ds_read_b64_tr_b16 v[222:223], v230 offset:43840
    s_add_u32 s49, s49, 458752
    v_mfma_f32_16x16x32_bf16 v[160:163], v[208:211], v[112:115], v[160:163]
    v_mfma_f32_16x16x32_bf16 v[160:163], v[212:215], v[116:119], v[160:163]
    v_mfma_f32_16x16x32_bf16 v[164:167], v[208:211], v[120:123], v[164:167]
    ds_read_b128 v[72:75], v224 offset:14336
    v_mfma_f32_16x16x32_bf16 v[164:167], v[212:215], v[124:127], v[164:167]
    v_mfma_f32_16x16x32_bf16 v[168:171], v[208:211], v[128:131], v[168:171]
    ds_read_b128 v[76:79], v225 offset:14336
    v_mfma_f32_16x16x32_bf16 v[168:171], v[212:215], v[132:135], v[168:171]
    v_mfma_f32_16x16x32_bf16 v[172:175], v[208:211], v[136:139], v[172:175]
    s_waitcnt vmcnt(26)
    v_mfma_f32_16x16x32_bf16 v[172:175], v[212:215], v[140:143], v[172:175]
    s_waitcnt lgkmcnt(0)
    s_barrier
    v_mfma_f32_16x16x32_bf16 v[176:179], v[216:219], v[80:83], v[176:179]
    ds_read_b64_tr_b16 v[208:209], v226 offset:0
    v_mfma_f32_16x16x32_bf16 v[176:179], v[220:223], v[84:87], v[176:179]
    s_add_u32 m0, s47, 24576
    v_mfma_f32_16x16x32_bf16 v[180:183], v[216:219], v[88:91], v[180:183]
    ds_read_b64_tr_b16 v[210:211], v226 offset:1024
    buffer_load_dwordx4 v242, s[24:27], s44 offen lds
    v_mfma_f32_16x16x32_bf16 v[180:183], v[220:223], v[92:95], v[180:183]
    v_mfma_f32_16x16x32_bf16 v[184:187], v[216:219], v[96:99], v[184:187]
    ds_read_b64_tr_b16 v[212:213], v226 offset:8192
    v_mfma_f32_16x16x32_bf16 v[184:187], v[220:223], v[100:103], v[184:187]
    v_mfma_f32_16x16x32_bf16 v[188:191], v[216:219], v[104:107], v[188:191]
    ds_read_b64_tr_b16 v[214:215], v226 offset:9216
    v_mfma_f32_16x16x32_bf16 v[188:191], v[220:223], v[108:111], v[188:191]
    v_mfma_f32_16x16x32_bf16 v[192:195], v[216:219], v[112:115], v[192:195]
    s_add_u32 m0, s47, 25600
    v_mfma_f32_16x16x32_bf16 v[192:195], v[220:223], v[116:119], v[192:195]
    buffer_load_dwordx4 v243, s[24:27], s44 offen lds
    v_mfma_f32_16x16x32_bf16 v[196:199], v[216:219], v[120:123], v[196:199]
    v_mfma_f32_16x16x32_bf16 v[196:199], v[220:223], v[124:127], v[196:199]
    v_mfma_f32_16x16x32_bf16 v[200:203], v[216:219], v[128:131], v[200:203]
    v_mfma_f32_16x16x32_bf16 v[200:203], v[220:223], v[132:135], v[200:203]
    v_mfma_f32_16x16x32_bf16 v[204:207], v[216:219], v[136:139], v[204:207]
    v_mfma_f32_16x16x32_bf16 v[204:207], v[220:223], v[140:143], v[204:207]
    s_waitcnt lgkmcnt(0)
    s_mov_b32 s48, 6
.p2align 6
p1A_loop:
    v_mfma_f32_16x16x32_bf16 a[0:3], v[208:211], v[16:19], a[0:3]
    s_add_u32 m0, s47, 26624
    v_mfma_f32_16x16x32_bf16 a[0:3], v[212:215], v[20:23], a[0:3]
    ds_read_b64_tr_b16 v[216:217], v227 offset:0
    buffer_load_dwordx4 v244, s[24:27], s44 offen lds
    s_add_u32 s44, s44, 229376
    v_mfma_f32_16x16x32_bf16 a[4:7], v[208:211], v[24:27], a[4:7]
    v_mfma_f32_16x16x32_bf16 a[4:7], v[212:215], v[28:31], a[4:7]
    ds_read_b64_tr_b16 v[218:219], v227 offset:1024
    v_mfma_f32_16x16x32_bf16 a[8:11], v[208:211], v[32:35], a[8:11]
    v_mfma_f32_16x16x32_bf16 a[8:11], v[212:215], v[36:39], a[8:11]
    ds_read_b64_tr_b16 v[220:221], v227 offset:8192
    v_mfma_f32_16x16x32_bf16 a[12:15], v[208:211], v[40:43], a[12:15]
    v_mfma_f32_16x16x32_bf16 a[12:15], v[212:215], v[44:47], a[12:15]
    ds_read_b64_tr_b16 v[222:223], v227 offset:9216
    v_mfma_f32_16x16x32_bf16 a[16:19], v[208:211], v[48:51], a[16:19]
    v_mfma_f32_16x16x32_bf16 a[16:19], v[212:215], v[52:55], a[16:19]
    s_add_u32 m0, s47, 36864
    v_mfma_f32_16x16x32_bf16 a[20:23], v[208:211], v[56:59], a[20:23]
    buffer_load_dwordx4 v242, s[24:27], s44 offen lds
    v_mfma_f32_16x16x32_bf16 a[20:23], v[212:215], v[60:63], a[20:23]
    v_mfma_f32_16x16x32_bf16 a[24:27], v[208:211], v[64:67], a[24:27]
    v_mfma_f32_16x16x32_bf16 a[24:27], v[212:215], v[68:71], a[24:27]
    v_mfma_f32_16x16x32_bf16 a[28:31], v[208:211], v[72:75], a[28:31]
    v_mfma_f32_16x16x32_bf16 a[28:31], v[212:215], v[76:79], a[28:31]
    s_waitcnt lgkmcnt(0)
    v_mfma_f32_16x16x32_bf16 a[32:35], v[216:219], v[16:19], a[32:35]
    v_mfma_f32_16x16x32_bf16 a[32:35], v[220:223], v[20:23], a[32:35]
    ds_read_b64_tr_b16 v[208:209], v228 offset:0
    v_mfma_f32_16x16x32_bf16 a[36:39], v[216:219], v[24:27], a[36:39]
    s_add_u32 m0, s47, 37888
    v_mfma_f32_16x16x32_bf16 a[36:39], v[220:223], v[28:31], a[36:39]
    ds_read_b64_tr_b16 v[210:211], v228 offset:1024
    buffer_load_dwordx4 v243, s[24:27], s44 offen lds
    v_mfma_f32_16x16x32_bf16 a[40:43], v[216:219], v[32:35], a[40:43]
    v_mfma_f32_16x16x32_bf16 a[40:43], v[220:223], v[36:39], a[40:43]
    ds_read_b64_tr_b16 v[212:213], v228 offset:8192
    v_mfma_f32_16x16x32_bf16 a[44:47], v[216:219], v[40:43], a[44:47]
    v_mfma_f32_16x16x32_bf16 a[44:47], v[220:223], v[44:47], a[44:47]
    ds_read_b64_tr_b16 v[214:215], v228 offset:9216
    v_mfma_f32_16x16x32_bf16 a[48:51], v[216:219], v[48:51], a[48:51]
    v_mfma_f32_16x16x32_bf16 a[48:51], v[220:223], v[52:55], a[48:51]
    v_mfma_f32_16x16x32_bf16 a[52:55], v[216:219], v[56:59], a[52:55]
    v_mfma_f32_16x16x32_bf16 a[52:55], v[220:223], v[60:63], a[52:55]
    s_add_u32 m0, s47, 38912
    v_mfma_f32_16x16x32_bf16 a[56:59], v[216:219], v[64:67], a[56:59]
    buffer_load_dwordx4 v244, s[24:27], s44 offen lds
    s_add_u32 s44, s44, 229376
    v_mfma_f32_16x16x32_bf16 a[56:59], v[220:223], v[68:71], a[56:59]
    v_mfma_f32_16x16x32_bf16 a[60:63], v[216:219], v[72:75], a[60:63]
    v_mfma_f32_16x16x32_bf16 a[60:63], v[220:223], v[76:79], a[60:63]
    s_waitcnt lgkmcnt(0)
    v_mfma_f32_16x16x32_bf16 a[64:67], v[208:211], v[16:19], a[64:67]
    v_mfma_f32_16x16x32_bf16 a[64:67], v[212:215], v[20:23], a[64:67]
    ds_read_b64_tr_b16 v[216:217], v229 offset:0
    v_mfma_f32_16x16x32_bf16 a[68:71], v[208:211], v[24:27], a[68:71]
    v_mfma_f32_16x16x32_bf16 a[68:71], v[212:215], v[28:31], a[68:71]
    ds_read_b64_tr_b16 v[218:219], v229 offset:1024
    v_mfma_f32_16x16x32_bf16 a[72:75], v[208:211], v[32:35], a[72:75]
    s_add_u32 m0, s45, 0
    v_mfma_f32_16x16x32_bf16 a[72:75], v[212:215], v[36:39], a[72:75]
    ds_read_b64_tr_b16 v[220:221], v229 offset:8192
    buffer_load_dwordx4 v232, s[16:19], s42 offen lds
    v_mfma_f32_16x16x32_bf16 a[76:79], v[208:211], v[40:43], a[76:79]
    v_mfma_f32_16x16x32_bf16 a[76:79], v[212:215], v[44:47], a[76:79]
    ds_read_b64_tr_b16 v[222:223], v229 offset:9216
    v_mfma_f32_16x16x32_bf16 a[80:83], v[208:211], v[48:51], a[80:83]
    v_mfma_f32_16x16x32_bf16 a[80:83], v[212:215], v[52:55], a[80:83]
    v_mfma_f32_16x16x32_bf16 a[84:87], v[208:211], v[56:59], a[84:87]
    v_mfma_f32_16x16x32_bf16 a[84:87], v[212:215], v[60:63], a[84:87]
    v_mfma_f32_16x16x32_bf16 a[88:91], v[208:211], v[64:67], a[88:91]
    v_mfma_f32_16x16x32_bf16 a[88:91], v[212:215], v[68:71], a[88:91]
    s_add_u32 m0, s45, 1024
    v_mfma_f32_16x16x32_bf16 a[92:95], v[208:211], v[72:75], a[92:95]
    s_waitcnt vmcnt(15)
    buffer_load_dwordx4 v233, s[16:19], s42 offen lds
    v_mfma_f32_16x16x32_bf16 a[92:95], v[212:215], v[76:79], a[92:95]
    s_waitcnt lgkmcnt(0)
    s_barrier
    v_mfma_f32_16x16x32_bf16 a[96:99], v[216:219], v[16:19], a[96:99]
    v_mfma_f32_16x16x32_bf16 a[96:99], v[220:223], v[20:23], a[96:99]
    ds_read_b64_tr_b16 v[208:209], v230 offset:0
    v_mfma_f32_16x16x32_bf16 a[100:103], v[216:219], v[24:27], a[100:103]
    v_mfma_f32_16x16x32_bf16 a[100:103], v[220:223], v[28:31], a[100:103]
    ds_read_b64_tr_b16 v[210:211], v230 offset:768
    v_mfma_f32_16x16x32_bf16 a[104:107], v[216:219], v[32:35], a[104:107]
    v_mfma_f32_16x16x32_bf16 a[104:107], v[220:223], v[36:39], a[104:107]
    ds_read_b64_tr_b16 v[212:213], v230 offset:12288
    v_mfma_f32_16x16x32_bf16 a[108:111], v[216:219], v[40:43], a[108:111]
    s_add_u32 m0, s45, 2048
    v_mfma_f32_16x16x32_bf16 a[108:111], v[220:223], v[44:47], a[108:111]
    ds_read_b64_tr_b16 v[214:215], v230 offset:13056
    buffer_load_dwordx4 v234, s[16:19], s42 offen lds
    v_mfma_f32_16x16x32_bf16 a[112:115], v[216:219], v[48:51], a[112:115]
    ds_read_b128 v[80:83], v224 offset:32768
    v_mfma_f32_16x16x32_bf16 a[112:115], v[220:223], v[52:55], a[112:115]
    v_mfma_f32_16x16x32_bf16 a[116:119], v[216:219], v[56:59], a[116:119]
    ds_read_b128 v[84:87], v225 offset:32768
    v_mfma_f32_16x16x32_bf16 a[116:119], v[220:223], v[60:63], a[116:119]
    v_mfma_f32_16x16x32_bf16 a[120:123], v[216:219], v[64:67], a[120:123]
    v_mfma_f32_16x16x32_bf16 a[120:123], v[220:223], v[68:71], a[120:123]
    v_mfma_f32_16x16x32_bf16 a[124:127], v[216:219], v[72:75], a[124:127]
    ds_read_b128 v[88:91], v224 offset:34816
    v_mfma_f32_16x16x32_bf16 a[124:127], v[220:223], v[76:79], a[124:127]
    s_waitcnt lgkmcnt(3)
    s_add_u32 m0, s45, 3072
    v_mfma_f32_16x16x32_bf16 a[128:131], v[208:211], v[16:19], a[128:131]
    buffer_load_dwordx4 v235, s[16:19], s42 offen lds
    v_mfma_f32_16x16x32_bf16 a[128:131], v[212:215], v[20:23], a[128:131]
    ds_read_b64_tr_b16 v[216:217], v230 offset:6144
    v_mfma_f32_16x16x32_bf16 a[132:135], v[208:211], v[24:27], a[132:135]
    v_mfma_f32_16x16x32_bf16 a[132:135], v[212:215], v[28:31], a[132:135]
    ds_read_b64_tr_b16 v[218:219], v230 offset:6912
    v_mfma_f32_16x16x32_bf16 a[136:139], v[208:211], v[32:35], a[136:139]
    v_mfma_f32_16x16x32_bf16 a[136:139], v[212:215], v[36:39], a[136:139]
    ds_read_b64_tr_b16 v[220:221], v230 offset:18432
    v_mfma_f32_16x16x32_bf16 a[140:143], v[208:211], v[40:43], a[140:143]
    v_mfma_f32_16x16x32_bf16 a[140:143], v[212:215], v[44:47], a[140:143]
    ds_read_b64_tr_b16 v[222:223], v230 offset:19200
    v_mfma_f32_16x16x32_bf16 a[144:147], v[208:211], v[48:51], a[144:147]
    ds_read_b128 v[92:95], v225 offset:34816
    s_add_u32 m0, s45, 4096
    v_mfma_f32_16x16x32_bf16 a[144:147], v[212:215], v[52:55], a[144:147]
    buffer_load_dwordx4 v236, s[16:19], s42 offen lds
    v_mfma_f32_16x16x32_bf16 a[148:151], v[208:211], v[56:59], a[148:151]
    v_mfma_f32_16x16x32_bf16 a[148:151], v[212:215], v[60:63], a[148:151]
    v_mfma_f32_16x16x32_bf16 a[152:155], v[208:211], v[64:67], a[152:155]
    ds_read_b128 v[96:99], v224 offset:36864
    v_mfma_f32_16x16x32_bf16 a[152:155], v[212:215], v[68:71], a[152:155]
    v_mfma_f32_16x16x32_bf16 a[156:159], v[208:211], v[72:75], a[156:159]
    ds_read_b128 v[100:103], v225 offset:36864
    v_mfma_f32_16x16x32_bf16 a[156:159], v[212:215], v[76:79], a[156:159]
    s_waitcnt lgkmcnt(3)
    v_mfma_f32_16x16x32_bf16 a[160:163], v[216:219], v[16:19], a[160:163]
    v_mfma_f32_16x16x32_bf16 a[160:163], v[220:223], v[20:23], a[160:163]
    ds_read_b64_tr_b16 v[208:209], v231 offset:32
    s_add_u32 m0, s45, 5120
    v_mfma_f32_16x16x32_bf16 a[164:167], v[216:219], v[24:27], a[164:167]
    buffer_load_dwordx4 v237, s[16:19], s42 offen lds
    v_mfma_f32_16x16x32_bf16 a[164:167], v[220:223], v[28:31], a[164:167]
    ds_read_b64_tr_b16 v[210:211], v231 offset:800
    v_mfma_f32_16x16x32_bf16 a[168:171], v[216:219], v[32:35], a[168:171]
    v_mfma_f32_16x16x32_bf16 a[168:171], v[220:223], v[36:39], a[168:171]
    ds_read_b64_tr_b16 v[212:213], v231 offset:12320
    v_mfma_f32_16x16x32_bf16 a[172:175], v[216:219], v[40:43], a[172:175]
    v_mfma_f32_16x16x32_bf16 a[172:175], v[220:223], v[44:47], a[172:175]
    ds_read_b64_tr_b16 v[214:215], v231 offset:13088
    v_mfma_f32_16x16x32_bf16 a[176:179], v[216:219], v[48:51], a[176:179]
    v_mfma_f32_16x16x32_bf16 a[176:179], v[220:223], v[52:55], a[176:179]
    v_mfma_f32_16x16x32_bf16 a[180:183], v[216:219], v[56:59], a[180:183]
    ds_read_b128 v[104:107], v224 offset:38912
    s_add_u32 m0, s45, 6144
    v_mfma_f32_16x16x32_bf16 a[180:183], v[220:223], v[60:63], a[180:183]
    buffer_load_dwordx4 v238, s[16:19], s42 offen lds
    v_mfma_f32_16x16x32_bf16 a[184:187], v[216:219], v[64:67], a[184:187]
    ds_read_b128 v[108:111], v225 offset:38912
    v_mfma_f32_16x16x32_bf16 a[184:187], v[220:223], v[68:71], a[184:187]
    v_mfma_f32_16x16x32_bf16 a[188:191], v[216:219], v[72:75], a[188:191]
    v_mfma_f32_16x16x32_bf16 a[188:191], v[220:223], v[76:79], a[188:191]
    s_waitcnt lgkmcnt(2)
    v_mfma_f32_16x16x32_bf16 a[192:195], v[208:211], v[16:19], a[192:195]
    v_mfma_f32_16x16x32_bf16 a[192:195], v[212:215], v[20:23], a[192:195]
    ds_read_b64_tr_b16 v[216:217], v231 offset:6176
    v_mfma_f32_16x16x32_bf16 a[196:199], v[208:211], v[24:27], a[196:199]
    v_mfma_f32_16x16x32_bf16 a[196:199], v[212:215], v[28:31], a[196:199]
    ds_read_b64_tr_b16 v[218:219], v231 offset:6944
    s_add_u32 m0, s45, 7168
    v_mfma_f32_16x16x32_bf16 a[200:203], v[208:211], v[32:35], a[200:203]
    buffer_load_dwordx4 v239, s[16:19], s42 offen lds
    s_add_u32 s42, s42, 128
    v_mfma_f32_16x16x32_bf16 a[200:203], v[212:215], v[36:39], a[200:203]
    ds_read_b64_tr_b16 v[220:221], v231 offset:18464
    v_mfma_f32_16x16x32_bf16 a[204:207], v[208:211], v[40:43], a[204:207]
    v_mfma_f32_16x16x32_bf16 a[204:207], v[212:215], v[44:47], a[204:207]
    ds_read_b64_tr_b16 v[222:223], v231 offset:19232
    v_mfma_f32_16x16x32_bf16 a[208:211], v[208:211], v[48:51], a[208:211]
    ds_read_b128 v[112:115], v224 offset:40960
    v_mfma_f32_16x16x32_bf16 a[208:211], v[212:215], v[52:55], a[208:211]
    v_mfma_f32_16x16x32_bf16 a[212:215], v[208:211], v[56:59], a[212:215]
    ds_read_b128 v[116:119], v225 offset:40960
    v_mfma_f32_16x16x32_bf16 a[212:215], v[212:215], v[60:63], a[212:215]
    v_mfma_f32_16x16x32_bf16 a[216:219], v[208:211], v[64:67], a[216:219]
    s_add_u32 m0, s46, 0
    v_mfma_f32_16x16x32_bf16 a[216:219], v[212:215], v[68:71], a[216:219]
    buffer_load_dwordx4 v240, s[20:23], s43 offen lds
    v_mfma_f32_16x16x32_bf16 a[220:223], v[208:211], v[72:75], a[220:223]
    ds_read_b128 v[120:123], v224 offset:43008
    v_mfma_f32_16x16x32_bf16 a[220:223], v[212:215], v[76:79], a[220:223]
    s_waitcnt lgkmcnt(3)
    v_mfma_f32_16x16x32_bf16 a[224:227], v[216:219], v[16:19], a[224:227]
    s_add_u32 m0, s46, 1024
    v_mfma_f32_16x16x32_bf16 a[224:227], v[220:223], v[20:23], a[224:227]
    ds_read_b64_tr_b16 v[208:209], v230 offset:64
    buffer_load_dwordx4 v241, s[20:23], s43 offen lds
    s_add_u32 s43, s43, 196608
    v_mfma_f32_16x16x32_bf16 a[228:231], v[216:219], v[24:27], a[228:231]
    v_mfma_f32_16x16x32_bf16 a[228:231], v[220:223], v[28:31], a[228:231]
    ds_read_b64_tr_b16 v[210:211], v230 offset:832
    v_mfma_f32_16x16x32_bf16 a[232:235], v[216:219], v[32:35], a[232:235]
    s_add_u32 m0, s46, 8192
    v_mfma_f32_16x16x32_bf16 a[232:235], v[220:223], v[36:39], a[232:235]
    ds_read_b64_tr_b16 v[212:213], v230 offset:12352
    buffer_load_dwordx4 v240, s[20:23], s43 offen lds
    v_mfma_f32_16x16x32_bf16 a[236:239], v[216:219], v[40:43], a[236:239]
    v_mfma_f32_16x16x32_bf16 a[236:239], v[220:223], v[44:47], a[236:239]
    ds_read_b64_tr_b16 v[214:215], v230 offset:13120
    v_mfma_f32_16x16x32_bf16 a[240:243], v[216:219], v[48:51], a[240:243]
    ds_read_b128 v[124:127], v225 offset:43008
    s_add_u32 m0, s46, 9216
    v_mfma_f32_16x16x32_bf16 a[240:243], v[220:223], v[52:55], a[240:243]
    buffer_load_dwordx4 v241, s[20:23], s43 offen lds
    s_add_u32 s43, s43, 196608
    v_mfma_f32_16x16x32_bf16 a[244:247], v[216:219], v[56:59], a[244:247]
    v_mfma_f32_16x16x32_bf16 a[244:247], v[220:223], v[60:63], a[244:247]
    v_mfma_f32_16x16x32_bf16 a[248:251], v[216:219], v[64:67], a[248:251]
    ds_read_b128 v[128:131], v224 offset:45056
    v_mfma_f32_16x16x32_bf16 a[248:251], v[220:223], v[68:71], a[248:251]
    v_mfma_f32_16x16x32_bf16 a[252:255], v[216:219], v[72:75], a[252:255]
    ds_read_b128 v[132:135], v225 offset:45056
    v_mfma_f32_16x16x32_bf16 a[252:255], v[220:223], v[76:79], a[252:255]
    s_waitcnt lgkmcnt(3)
    v_mfma_f32_16x16x32_bf16 v[144:147], v[208:211], v[16:19], v[144:147]
    buffer_load_dword v246, v254, s[68:71], s5 offen
    v_mfma_f32_16x16x32_bf16 v[144:147], v[212:215], v[20:23], v[144:147]
    ds_read_b64_tr_b16 v[216:217], v230 offset:6208
    s_add_u32 s5, s5, 393216
    v_mfma_f32_16x16x32_bf16 v[148:151], v[208:211], v[24:27], v[148:151]
    v_mfma_f32_16x16x32_bf16 v[148:151], v[212:215], v[28:31], v[148:151]
    ds_read_b64_tr_b16 v[218:219], v230 offset:6976
    v_mfma_f32_16x16x32_bf16 v[152:155], v[208:211], v[32:35], v[152:155]
    buffer_load_dword v246, v254, s[20:23], s7 offen
    v_mfma_f32_16x16x32_bf16 v[152:155], v[212:215], v[36:39], v[152:155]
    ds_read_b64_tr_b16 v[220:221], v230 offset:18496
    s_add_u32 s7, s7, 393216
    v_mfma_f32_16x16x32_bf16 v[156:159], v[208:211], v[40:43], v[156:159]
    buffer_load_dword v246, v245, s[24:27], s49 offen
    v_mfma_f32_16x16x32_bf16 v[156:159], v[212:215], v[44:47], v[156:159]
    ds_read_b64_tr_b16 v[222:223], v230 offset:19264
    s_add_u32 s49, s49, 458752
    v_mfma_f32_16x16x32_bf16 v[160:163], v[208:211], v[48:51], v[160:163]
    v_mfma_f32_16x16x32_bf16 v[160:163], v[212:215], v[52:55], v[160:163]
    buffer_load_dword v246, v0, s[16:19], s63 offen
    v_mfma_f32_16x16x32_bf16 v[164:167], v[208:211], v[56:59], v[164:167]
    ds_read_b128 v[136:139], v224 offset:47104
    s_add_u32 s63, s63, 512
    v_mfma_f32_16x16x32_bf16 v[164:167], v[212:215], v[60:63], v[164:167]
    v_mfma_f32_16x16x32_bf16 v[168:171], v[208:211], v[64:67], v[168:171]
    ds_read_b128 v[140:143], v225 offset:47104
    v_mfma_f32_16x16x32_bf16 v[168:171], v[212:215], v[68:71], v[168:171]
    v_mfma_f32_16x16x32_bf16 v[172:175], v[208:211], v[72:75], v[172:175]
    s_waitcnt vmcnt(26)
    v_mfma_f32_16x16x32_bf16 v[172:175], v[212:215], v[76:79], v[172:175]
    s_waitcnt lgkmcnt(0)
    s_barrier
    v_mfma_f32_16x16x32_bf16 v[176:179], v[216:219], v[16:19], v[176:179]
    ds_read_b64_tr_b16 v[208:209], v226 offset:16384
    v_mfma_f32_16x16x32_bf16 v[176:179], v[220:223], v[20:23], v[176:179]
    s_add_u32 m0, s47, 0
    v_mfma_f32_16x16x32_bf16 v[180:183], v[216:219], v[24:27], v[180:183]
    ds_read_b64_tr_b16 v[210:211], v226 offset:17408
    buffer_load_dwordx4 v242, s[24:27], s44 offen lds
    v_mfma_f32_16x16x32_bf16 v[180:183], v[220:223], v[28:31], v[180:183]
    v_mfma_f32_16x16x32_bf16 v[184:187], v[216:219], v[32:35], v[184:187]
    ds_read_b64_tr_b16 v[212:213], v226 offset:24576
    v_mfma_f32_16x16x32_bf16 v[184:187], v[220:223], v[36:39], v[184:187]
    v_mfma_f32_16x16x32_bf16 v[188:191], v[216:219], v[40:43], v[188:191]
    ds_read_b64_tr_b16 v[214:215], v226 offset:25600
    v_mfma_f32_16x16x32_bf16 v[188:191], v[220:223], v[44:47], v[188:191]
    v_mfma_f32_16x16x32_bf16 v[192:195], v[216:219], v[48:51], v[192:195]
    s_add_u32 m0, s47, 1024
    v_mfma_f32_16x16x32_bf16 v[192:195], v[220:223], v[52:55], v[192:195]
    buffer_load_dwordx4 v243, s[24:27], s44 offen lds
    v_mfma_f32_16x16x32_bf16 v[196:199], v[216:219], v[56:59], v[196:199]
    v_mfma_f32_16x16x32_bf16 v[196:199], v[220:223], v[60:63], v[196:199]
    v_mfma_f32_16x16x32_bf16 v[200:203], v[216:219], v[64:67], v[200:203]
    v_mfma_f32_16x16x32_bf16 v[200:203], v[220:223], v[68:71], v[200:203]
    v_mfma_f32_16x16x32_bf16 v[204:207], v[216:219], v[72:75], v[204:207]
    v_mfma_f32_16x16x32_bf16 v[204:207], v[220:223], v[76:79], v[204:207]
    s_waitcnt lgkmcnt(0)
    v_mfma_f32_16x16x32_bf16 a[0:3], v[208:211], v[80:83], a[0:3]
    s_add_u32 m0, s47, 2048
    v_mfma_f32_16x16x32_bf16 a[0:3], v[212:215], v[84:87], a[0:3]
    ds_read_b64_tr_b16 v[216:217], v227 offset:16384
    buffer_load_dwordx4 v244, s[24:27], s44 offen lds
    s_add_u32 s44, s44, 229376
    v_mfma_f32_16x16x32_bf16 a[4:7], v[208:211], v[88:91], a[4:7]
    v_mfma_f32_16x16x32_bf16 a[4:7], v[212:215], v[92:95], a[4:7]
    ds_read_b64_tr_b16 v[218:219], v227 offset:17408
    v_mfma_f32_16x16x32_bf16 a[8:11], v[208:211], v[96:99], a[8:11]
    v_mfma_f32_16x16x32_bf16 a[8:11], v[212:215], v[100:103], a[8:11]
    ds_read_b64_tr_b16 v[220:221], v227 offset:24576
    v_mfma_f32_16x16x32_bf16 a[12:15], v[208:211], v[104:107], a[12:15]
    v_mfma_f32_16x16x32_bf16 a[12:15], v[212:215], v[108:111], a[12:15]
    ds_read_b64_tr_b16 v[222:223], v227 offset:25600
    v_mfma_f32_16x16x32_bf16 a[16:19], v[208:211], v[112:115], a[16:19]
    v_mfma_f32_16x16x32_bf16 a[16:19], v[212:215], v[116:119], a[16:19]
    s_add_u32 m0, s47, 12288
    v_mfma_f32_16x16x32_bf16 a[20:23], v[208:211], v[120:123], a[20:23]
    buffer_load_dwordx4 v242, s[24:27], s44 offen lds
    v_mfma_f32_16x16x32_bf16 a[20:23], v[212:215], v[124:127], a[20:23]
    v_mfma_f32_16x16x32_bf16 a[24:27], v[208:211], v[128:131], a[24:27]
    v_mfma_f32_16x16x32_bf16 a[24:27], v[212:215], v[132:135], a[24:27]
    v_mfma_f32_16x16x32_bf16 a[28:31], v[208:211], v[136:139], a[28:31]
    v_mfma_f32_16x16x32_bf16 a[28:31], v[212:215], v[140:143], a[28:31]
    s_waitcnt lgkmcnt(0)
    v_mfma_f32_16x16x32_bf16 a[32:35], v[216:219], v[80:83], a[32:35]
    v_mfma_f32_16x16x32_bf16 a[32:35], v[220:223], v[84:87], a[32:35]
    ds_read_b64_tr_b16 v[208:209], v228 offset:16384
    v_mfma_f32_16x16x32_bf16 a[36:39], v[216:219], v[88:91], a[36:39]
    s_add_u32 m0, s47, 13312
    v_mfma_f32_16x16x32_bf16 a[36:39], v[220:223], v[92:95], a[36:39]
    ds_read_b64_tr_b16 v[210:211], v228 offset:17408
    buffer_load_dwordx4 v243, s[24:27], s44 offen lds
    v_mfma_f32_16x16x32_bf16 a[40:43], v[216:219], v[96:99], a[40:43]
    v_mfma_f32_16x16x32_bf16 a[40:43], v[220:223], v[100:103], a[40:43]
    ds_read_b64_tr_b16 v[212:213], v228 offset:24576
    v_mfma_f32_16x16x32_bf16 a[44:47], v[216:219], v[104:107], a[44:47]
    v_mfma_f32_16x16x32_bf16 a[44:47], v[220:223], v[108:111], a[44:47]
    ds_read_b64_tr_b16 v[214:215], v228 offset:25600
    v_mfma_f32_16x16x32_bf16 a[48:51], v[216:219], v[112:115], a[48:51]
    v_mfma_f32_16x16x32_bf16 a[48:51], v[220:223], v[116:119], a[48:51]
    v_mfma_f32_16x16x32_bf16 a[52:55], v[216:219], v[120:123], a[52:55]
    v_mfma_f32_16x16x32_bf16 a[52:55], v[220:223], v[124:127], a[52:55]
    s_add_u32 m0, s47, 14336
    v_mfma_f32_16x16x32_bf16 a[56:59], v[216:219], v[128:131], a[56:59]
    buffer_load_dwordx4 v244, s[24:27], s44 offen lds
    s_add_u32 s44, s44, 229376
    v_mfma_f32_16x16x32_bf16 a[56:59], v[220:223], v[132:135], a[56:59]
    v_mfma_f32_16x16x32_bf16 a[60:63], v[216:219], v[136:139], a[60:63]
    v_mfma_f32_16x16x32_bf16 a[60:63], v[220:223], v[140:143], a[60:63]
    s_waitcnt lgkmcnt(0)
    v_mfma_f32_16x16x32_bf16 a[64:67], v[208:211], v[80:83], a[64:67]
    v_mfma_f32_16x16x32_bf16 a[64:67], v[212:215], v[84:87], a[64:67]
    ds_read_b64_tr_b16 v[216:217], v229 offset:16384
    v_mfma_f32_16x16x32_bf16 a[68:71], v[208:211], v[88:91], a[68:71]
    v_mfma_f32_16x16x32_bf16 a[68:71], v[212:215], v[92:95], a[68:71]
    ds_read_b64_tr_b16 v[218:219], v229 offset:17408
    v_mfma_f32_16x16x32_bf16 a[72:75], v[208:211], v[96:99], a[72:75]
    s_add_u32 m0, s45, 32768
    v_mfma_f32_16x16x32_bf16 a[72:75], v[212:215], v[100:103], a[72:75]
    ds_read_b64_tr_b16 v[220:221], v229 offset:24576
    buffer_load_dwordx4 v232, s[16:19], s42 offen lds
    v_mfma_f32_16x16x32_bf16 a[76:79], v[208:211], v[104:107], a[76:79]
    v_mfma_f32_16x16x32_bf16 a[76:79], v[212:215], v[108:111], a[76:79]
    ds_read_b64_tr_b16 v[222:223], v229 offset:25600
    v_mfma_f32_16x16x32_bf16 a[80:83], v[208:211], v[112:115], a[80:83]
    v_mfma_f32_16x16x32_bf16 a[80:83], v[212:215], v[116:119], a[80:83]
    v_mfma_f32_16x16x32_bf16 a[84:87], v[208:211], v[120:123], a[84:87]
    v_mfma_f32_16x16x32_bf16 a[84:87], v[212:215], v[124:127], a[84:87]
    v_mfma_f32_16x16x32_bf16 a[88:91], v[208:211], v[128:131], a[88:91]
    v_mfma_f32_16x16x32_bf16 a[88:91], v[212:215], v[132:135], a[88:91]
    s_add_u32 m0, s45, 33792
    v_mfma_f32_16x16x32_bf16 a[92:95], v[208:211], v[136:139], a[92:95]
    s_waitcnt vmcnt(15)
    buffer_load_dwordx4 v233, s[16:19], s42 offen lds
    v_mfma_f32_16x16x32_bf16 a[92:95], v[212:215], v[140:143], a[92:95]
    s_waitcnt lgkmcnt(0)
    s_barrier
    v_mfma_f32_16x16x32_bf16 a[96:99], v[216:219], v[80:83], a[96:99]
    v_mfma_f32_16x16x32_bf16 a[96:99], v[220:223], v[84:87], a[96:99]
    ds_read_b64_tr_b16 v[208:209], v230 offset:24576
    v_mfma_f32_16x16x32_bf16 a[100:103], v[216:219], v[88:91], a[100:103]
    v_mfma_f32_16x16x32_bf16 a[100:103], v[220:223], v[92:95], a[100:103]
    ds_read_b64_tr_b16 v[210:211], v230 offset:25344
    v_mfma_f32_16x16x32_bf16 a[104:107], v[216:219], v[96:99], a[104:107]
    v_mfma_f32_16x16x32_bf16 a[104:107], v[220:223], v[100:103], a[104:107]
    ds_read_b64_tr_b16 v[212:213], v230 offset:36864
    v_mfma_f32_16x16x32_bf16 a[108:111], v[216:219], v[104:107], a[108:111]
    s_add_u32 m0, s45, 34816
    v_mfma_f32_16x16x32_bf16 a[108:111], v[220:223], v[108:111], a[108:111]
    ds_read_b64_tr_b16 v[214:215], v230 offset:37632
    buffer_load_dwordx4 v234, s[16:19], s42 offen lds
    v_mfma_f32_16x16x32_bf16 a[112:115], v[216:219], v[112:115], a[112:115]
    ds_read_b128 v[16:19], v224 offset:0
    v_mfma_f32_16x16x32_bf16 a[112:115], v[220:223], v[116:119], a[112:115]
    v_mfma_f32_16x16x32_bf16 a[116:119], v[216:219], v[120:123], a[116:119]
    ds_read_b128 v[20:23], v225 offset:0
    v_mfma_f32_16x16x32_bf16 a[116:119], v[220:223], v[124:127], a[116:119]
    v_mfma_f32_16x16x32_bf16 a[120:123], v[216:219], v[128:131], a[120:123]
    v_mfma_f32_16x16x32_bf16 a[120:123], v[220:223], v[132:135], a[120:123]
    v_mfma_f32_16x16x32_bf16 a[124:127], v[216:219], v[136:139], a[124:127]
    ds_read_b128 v[24:27], v224 offset:2048
    v_mfma_f32_16x16x32_bf16 a[124:127], v[220:223], v[140:143], a[124:127]
    s_waitcnt lgkmcnt(3)
    s_add_u32 m0, s45, 35840
    v_mfma_f32_16x16x32_bf16 a[128:131], v[208:211], v[80:83], a[128:131]
    buffer_load_dwordx4 v235, s[16:19], s42 offen lds
    v_mfma_f32_16x16x32_bf16 a[128:131], v[212:215], v[84:87], a[128:131]
    ds_read_b64_tr_b16 v[216:217], v230 offset:30720
    v_mfma_f32_16x16x32_bf16 a[132:135], v[208:211], v[88:91], a[132:135]
    v_mfma_f32_16x16x32_bf16 a[132:135], v[212:215], v[92:95], a[132:135]
    ds_read_b64_tr_b16 v[218:219], v230 offset:31488
    v_mfma_f32_16x16x32_bf16 a[136:139], v[208:211], v[96:99], a[136:139]
    v_mfma_f32_16x16x32_bf16 a[136:139], v[212:215], v[100:103], a[136:139]
    ds_read_b64_tr_b16 v[220:221], v230 offset:43008
    v_mfma_f32_16x16x32_bf16 a[140:143], v[208:211], v[104:107], a[140:143]
    v_mfma_f32_16x16x32_bf16 a[140:143], v[212:215], v[108:111], a[140:143]
    ds_read_b64_tr_b16 v[222:223], v230 offset:43776
    v_mfma_f32_16x16x32_bf16 a[144:147], v[208:211], v[112:115], a[144:147]
    ds_read_b128 v[28:31], v225 offset:2048
    s_add_u32 m0, s45, 36864
    v_mfma_f32_16x16x32_bf16 a[144:147], v[212:215], v[116:119], a[144:147]
    buffer_load_dwordx4 v236, s[16:19], s42 offen lds
    v_mfma_f32_16x16x32_bf16 a[148:151], v[208:211], v[120:123], a[148:151]
    v_mfma_f32_16x16x32_bf16 a[148:151], v[212:215], v[124:127], a[148:151]
    v_mfma_f32_16x16x32_bf16 a[152:155], v[208:211], v[128:131], a[152:155]
    ds_read_b128 v[32:35], v224 offset:4096
    v_mfma_f32_16x16x32_bf16 a[152:155], v[212:215], v[132:135], a[152:155]
    v_mfma_f32_16x16x32_bf16 a[156:159], v[208:211], v[136:139], a[156:159]
    ds_read_b128 v[36:39], v225 offset:4096
    v_mfma_f32_16x16x32_bf16 a[156:159], v[212:215], v[140:143], a[156:159]
    s_waitcnt lgkmcnt(3)
    v_mfma_f32_16x16x32_bf16 a[160:163], v[216:219], v[80:83], a[160:163]
    v_mfma_f32_16x16x32_bf16 a[160:163], v[220:223], v[84:87], a[160:163]
    ds_read_b64_tr_b16 v[208:209], v231 offset:24608
    s_add_u32 m0, s45, 37888
    v_mfma_f32_16x16x32_bf16 a[164:167], v[216:219], v[88:91], a[164:167]
    buffer_load_dwordx4 v237, s[16:19], s42 offen lds
    v_mfma_f32_16x16x32_bf16 a[164:167], v[220:223], v[92:95], a[164:167]
    ds_read_b64_tr_b16 v[210:211], v231 offset:25376
    v_mfma_f32_16x16x32_bf16 a[168:171], v[216:219], v[96:99], a[168:171]
    v_mfma_f32_16x16x32_bf16 a[168:171], v[220:223], v[100:103], a[168:171]
    ds_read_b64_tr_b16 v[212:213], v231 offset:36896
    v_mfma_f32_16x16x32_bf16 a[172:175], v[216:219], v[104:107], a[172:175]
    v_mfma_f32_16x16x32_bf16 a[172:175], v[220:223], v[108:111], a[172:175]
    ds_read_b64_tr_b16 v[214:215], v231 offset:37664
    v_mfma_f32_16x16x32_bf16 a[176:179], v[216:219], v[112:115], a[176:179]
    v_mfma_f32_16x16x32_bf16 a[176:179], v[220:223], v[116:119], a[176:179]
    v_mfma_f32_16x16x32_bf16 a[180:183], v[216:219], v[120:123], a[180:183]
    ds_read_b128 v[40:43], v224 offset:6144
    s_add_u32 m0, s45, 38912
    v_mfma_f32_16x16x32_bf16 a[180:183], v[220:223], v[124:127], a[180:183]
    buffer_load_dwordx4 v238, s[16:19], s42 offen lds
    v_mfma_f32_16x16x32_bf16 a[184:187], v[216:219], v[128:131], a[184:187]
    ds_read_b128 v[44:47], v225 offset:6144
    v_mfma_f32_16x16x32_bf16 a[184:187], v[220:223], v[132:135], a[184:187]
    v_mfma_f32_16x16x32_bf16 a[188:191], v[216:219], v[136:139], a[188:191]
    v_mfma_f32_16x16x32_bf16 a[188:191], v[220:223], v[140:143], a[188:191]
    s_waitcnt lgkmcnt(2)
    v_mfma_f32_16x16x32_bf16 a[192:195], v[208:211], v[80:83], a[192:195]
    v_mfma_f32_16x16x32_bf16 a[192:195], v[212:215], v[84:87], a[192:195]
    ds_read_b64_tr_b16 v[216:217], v231 offset:30752
    v_mfma_f32_16x16x32_bf16 a[196:199], v[208:211], v[88:91], a[196:199]
    v_mfma_f32_16x16x32_bf16 a[196:199], v[212:215], v[92:95], a[196:199]
    ds_read_b64_tr_b16 v[218:219], v231 offset:31520
    s_add_u32 m0, s45, 39936
    v_mfma_f32_16x16x32_bf16 a[200:203], v[208:211], v[96:99], a[200:203]
    buffer_load_dwordx4 v239, s[16:19], s42 offen lds
    s_add_u32 s42, s42, 128
    v_mfma_f32_16x16x32_bf16 a[200:203], v[212:215], v[100:103], a[200:203]
    ds_read_b64_tr_b16 v[220:221], v231 offset:43040
    v_mfma_f32_16x16x32_bf16 a[204:207], v[208:211], v[104:107], a[204:207]
    v_mfma_f32_16x16x32_bf16 a[204:207], v[212:215], v[108:111], a[204:207]
    ds_read_b64_tr_b16 v[222:223], v231 offset:43808
    v_mfma_f32_16x16x32_bf16 a[208:211], v[208:211], v[112:115], a[208:211]
    ds_read_b128 v[48:51], v224 offset:8192
    v_mfma_f32_16x16x32_bf16 a[208:211], v[212:215], v[116:119], a[208:211]
    v_mfma_f32_16x16x32_bf16 a[212:215], v[208:211], v[120:123], a[212:215]
    ds_read_b128 v[52:55], v225 offset:8192
    v_mfma_f32_16x16x32_bf16 a[212:215], v[212:215], v[124:127], a[212:215]
    v_mfma_f32_16x16x32_bf16 a[216:219], v[208:211], v[128:131], a[216:219]
    s_add_u32 m0, s46, 16384
    v_mfma_f32_16x16x32_bf16 a[216:219], v[212:215], v[132:135], a[216:219]
    buffer_load_dwordx4 v240, s[20:23], s43 offen lds
    v_mfma_f32_16x16x32_bf16 a[220:223], v[208:211], v[136:139], a[220:223]
    ds_read_b128 v[56:59], v224 offset:10240
    v_mfma_f32_16x16x32_bf16 a[220:223], v[212:215], v[140:143], a[220:223]
    s_waitcnt lgkmcnt(3)
    v_mfma_f32_16x16x32_bf16 a[224:227], v[216:219], v[80:83], a[224:227]
    s_add_u32 m0, s46, 17408
    v_mfma_f32_16x16x32_bf16 a[224:227], v[220:223], v[84:87], a[224:227]
    ds_read_b64_tr_b16 v[208:209], v230 offset:24640
    buffer_load_dwordx4 v241, s[20:23], s43 offen lds
    s_add_u32 s43, s43, 196608
    v_mfma_f32_16x16x32_bf16 a[228:231], v[216:219], v[88:91], a[228:231]
    v_mfma_f32_16x16x32_bf16 a[228:231], v[220:223], v[92:95], a[228:231]
    ds_read_b64_tr_b16 v[210:211], v230 offset:25408
    v_mfma_f32_16x16x32_bf16 a[232:235], v[216:219], v[96:99], a[232:235]
    s_add_u32 m0, s46, 24576
    v_mfma_f32_16x16x32_bf16 a[232:235], v[220:223], v[100:103], a[232:235]
    ds_read_b64_tr_b16 v[212:213], v230 offset:36928
    buffer_load_dwordx4 v240, s[20:23], s43 offen lds
    v_mfma_f32_16x16x32_bf16 a[236:239], v[216:219], v[104:107], a[236:239]
    v_mfma_f32_16x16x32_bf16 a[236:239], v[220:223], v[108:111], a[236:239]
    ds_read_b64_tr_b16 v[214:215], v230 offset:37696
    v_mfma_f32_16x16x32_bf16 a[240:243], v[216:219], v[112:115], a[240:243]
    ds_read_b128 v[60:63], v225 offset:10240
    s_add_u32 m0, s46, 25600
    v_mfma_f32_16x16x32_bf16 a[240:243], v[220:223], v[116:119], a[240:243]
    buffer_load_dwordx4 v241, s[20:23], s43 offen lds
    s_add_u32 s43, s43, 196608
    v_mfma_f32_16x16x32_bf16 a[244:247], v[216:219], v[120:123], a[244:247]
    v_mfma_f32_16x16x32_bf16 a[244:247], v[220:223], v[124:127], a[244:247]
    v_mfma_f32_16x16x32_bf16 a[248:251], v[216:219], v[128:131], a[248:251]
    ds_read_b128 v[64:67], v224 offset:12288
    v_mfma_f32_16x16x32_bf16 a[248:251], v[220:223], v[132:135], a[248:251]
    v_mfma_f32_16x16x32_bf16 a[252:255], v[216:219], v[136:139], a[252:255]
    ds_read_b128 v[68:71], v225 offset:12288
    buffer_load_dword v246, v245, s[64:67], s6 offen
    v_mfma_f32_16x16x32_bf16 a[252:255], v[220:223], v[140:143], a[252:255]
    s_waitcnt lgkmcnt(3)
    s_add_u32 s6, s6, 1048576
    v_mfma_f32_16x16x32_bf16 v[144:147], v[208:211], v[80:83], v[144:147]
    s_cmp_eq_u32 s48, s86
    v_mfma_f32_16x16x32_bf16 v[144:147], v[212:215], v[84:87], v[144:147]
    ds_read_b64_tr_b16 v[216:217], v230 offset:30784
    s_cselect_b32 s87, 0, 0x40000000
    v_mfma_f32_16x16x32_bf16 v[148:151], v[208:211], v[88:91], v[148:151]
    buffer_atomic_add v249, v248, s[76:79], s87 offen sc1
    v_mfma_f32_16x16x32_bf16 v[148:151], v[212:215], v[92:95], v[148:151]
    ds_read_b64_tr_b16 v[218:219], v230 offset:31552
    v_mfma_f32_16x16x32_bf16 v[152:155], v[208:211], v[96:99], v[152:155]
    buffer_load_dword v246, v254, s[20:23], s7 offen
    v_mfma_f32_16x16x32_bf16 v[152:155], v[212:215], v[100:103], v[152:155]
    ds_read_b64_tr_b16 v[220:221], v230 offset:43072
    s_add_u32 s7, s7, 393216
    v_mfma_f32_16x16x32_bf16 v[156:159], v[208:211], v[104:107], v[156:159]
    buffer_load_dword v246, v245, s[24:27], s49 offen
    v_mfma_f32_16x16x32_bf16 v[156:159], v[212:215], v[108:111], v[156:159]
    ds_read_b64_tr_b16 v[222:223], v230 offset:43840
    s_add_u32 s49, s49, 458752
    v_mfma_f32_16x16x32_bf16 v[160:163], v[208:211], v[112:115], v[160:163]
    v_mfma_f32_16x16x32_bf16 v[160:163], v[212:215], v[116:119], v[160:163]
    v_mfma_f32_16x16x32_bf16 v[164:167], v[208:211], v[120:123], v[164:167]
    ds_read_b128 v[72:75], v224 offset:14336
    v_mfma_f32_16x16x32_bf16 v[164:167], v[212:215], v[124:127], v[164:167]
    v_mfma_f32_16x16x32_bf16 v[168:171], v[208:211], v[128:131], v[168:171]
    ds_read_b128 v[76:79], v225 offset:14336
    v_mfma_f32_16x16x32_bf16 v[168:171], v[212:215], v[132:135], v[168:171]
    v_mfma_f32_16x16x32_bf16 v[172:175], v[208:211], v[136:139], v[172:175]
    s_waitcnt vmcnt(26)
    v_mfma_f32_16x16x32_bf16 v[172:175], v[212:215], v[140:143], v[172:175]
    s_waitcnt lgkmcnt(0)
    s_barrier
    v_mfma_f32_16x16x32_bf16 v[176:179], v[216:219], v[80:83], v[176:179]
    ds_read_b64_tr_b16 v[208:209], v226 offset:0
    v_mfma_f32_16x16x32_bf16 v[176:179], v[220:223], v[84:87], v[176:179]
    s_add_u32 m0, s47, 24576
    v_mfma_f32_16x16x32_bf16 v[180:183], v[216:219], v[88:91], v[180:183]
    ds_read_b64_tr_b16 v[210:211], v226 offset:1024
    buffer_load_dwordx4 v242, s[24:27], s44 offen lds
    v_mfma_f32_16x16x32_bf16 v[180:183], v[220:223], v[92:95], v[180:183]
    v_mfma_f32_16x16x32_bf16 v[184:187], v[216:219], v[96:99], v[184:187]
    ds_read_b64_tr_b16 v[212:213], v226 offset:8192
    v_mfma_f32_16x16x32_bf16 v[184:187], v[220:223], v[100:103], v[184:187]
    v_mfma_f32_16x16x32_bf16 v[188:191], v[216:219], v[104:107], v[188:191]
    ds_read_b64_tr_b16 v[214:215], v226 offset:9216
    v_mfma_f32_16x16x32_bf16 v[188:191], v[220:223], v[108:111], v[188:191]
    v_mfma_f32_16x16x32_bf16 v[192:195], v[216:219], v[112:115], v[192:195]
    s_add_u32 m0, s47, 25600
    v_mfma_f32_16x16x32_bf16 v[192:195], v[220:223], v[116:119], v[192:195]
    buffer_load_dwordx4 v243, s[24:27], s44 offen lds
    v_mfma_f32_16x16x32_bf16 v[196:199], v[216:219], v[120:123], v[196:199]
    v_mfma_f32_16x16x32_bf16 v[196:199], v[220:223], v[124:127], v[196:199]
    v_mfma_f32_16x16x32_bf16 v[200:203], v[216:219], v[128:131], v[200:203]
    v_mfma_f32_16x16x32_bf16 v[200:203], v[220:223], v[132:135], v[200:203]
    v_mfma_f32_16x16x32_bf16 v[204:207], v[216:219], v[136:139], v[204:207]
    v_mfma_f32_16x16x32_bf16 v[204:207], v[220:223], v[140:143], v[204:207]
    s_waitcnt lgkmcnt(0)
    s_sub_u32 s48, s48, 1
    s_cmp_lg_u32 s48, 0
    s_cbranch_scc1 p1A_loop
    v_mfma_f32_16x16x32_bf16 a[0:3], v[208:211], v[16:19], a[0:3]
    s_add_u32 m0, s47, 26624
    v_mfma_f32_16x16x32_bf16 a[0:3], v[212:215], v[20:23], a[0:3]
    ds_read_b64_tr_b16 v[216:217], v227 offset:0
    buffer_load_dwordx4 v244, s[24:27], s44 offen lds
    s_add_u32 s44, s44, 229376
    v_mfma_f32_16x16x32_bf16 a[4:7], v[208:211], v[24:27], a[4:7]
    v_mfma_f32_16x16x32_bf16 a[4:7], v[212:215], v[28:31], a[4:7]
    ds_read_b64_tr_b16 v[218:219], v227 offset:1024
    v_mfma_f32_16x16x32_bf16 a[8:11], v[208:211], v[32:35], a[8:11]
    v_mfma_f32_16x16x32_bf16 a[8:11], v[212:215], v[36:39], a[8:11]
    ds_read_b64_tr_b16 v[220:221], v227 offset:8192
    v_mfma_f32_16x16x32_bf16 a[12:15], v[208:211], v[40:43], a[12:15]
    v_mfma_f32_16x16x32_bf16 a[12:15], v[212:215], v[44:47], a[12:15]
    ds_read_b64_tr_b16 v[222:223], v227 offset:9216
    v_mfma_f32_16x16x32_bf16 a[16:19], v[208:211], v[48:51], a[16:19]
    v_mfma_f32_16x16x32_bf16 a[16:19], v[212:215], v[52:55], a[16:19]
    v_mfma_f32_16x16x32_bf16 a[20:23], v[208:211], v[56:59], a[20:23]
    v_mfma_f32_16x16x32_bf16 a[20:23], v[212:215], v[60:63], a[20:23]
    v_mfma_f32_16x16x32_bf16 a[24:27], v[208:211], v[64:67], a[24:27]
    v_mfma_f32_16x16x32_bf16 a[24:27], v[212:215], v[68:71], a[24:27]
    v_mfma_f32_16x16x32_bf16 a[28:31], v[208:211], v[72:75], a[28:31]
    v_mfma_f32_16x16x32_bf16 a[28:31], v[212:215], v[76:79], a[28:31]
    s_waitcnt lgkmcnt(0)
    v_mfma_f32_16x16x32_bf16 a[32:35], v[216:219], v[16:19], a[32:35]
    v_mfma_f32_16x16x32_bf16 a[32:35], v[220:223], v[20:23], a[32:35]
    ds_read_b64_tr_b16 v[208:209], v228 offset:0
    v_mfma_f32_16x16x32_bf16 a[36:39], v[216:219], v[24:27], a[36:39]
    v_mfma_f32_16x16x32_bf16 a[36:39], v[220:223], v[28:31], a[36:39]
    ds_read_b64_tr_b16 v[210:211], v228 offset:1024
    v_mfma_f32_16x16x32_bf16 a[40:43], v[216:219], v[32:35], a[40:43]
    v_mfma_f32_16x16x32_bf16 a[40:43], v[220:223], v[36:39], a[40:43]
    ds_read_b64_tr_b16 v[212:213], v228 offset:8192
    v_mfma_f32_16x16x32_bf16 a[44:47], v[216:219], v[40:43], a[44:47]
    v_mfma_f32_16x16x32_bf16 a[44:47], v[220:223], v[44:47], a[44:47]
    ds_read_b64_tr_b16 v[214:215], v228 offset:9216
    v_mfma_f32_16x16x32_bf16 a[48:51], v[216:219], v[48:51], a[48:51]
    v_mfma_f32_16x16x32_bf16 a[48:51], v[220:223], v[52:55], a[48:51]
    v_mfma_f32_16x16x32_bf16 a[52:55], v[216:219], v[56:59], a[52:55]
    v_mfma_f32_16x16x32_bf16 a[52:55], v[220:223], v[60:63], a[52:55]
    s_add_u32 m0, s47, 36864
    v_mfma_f32_16x16x32_bf16 a[56:59], v[216:219], v[64:67], a[56:59]
    buffer_load_dwordx4 v242, s[24:27], s44 offen lds
    v_mfma_f32_16x16x32_bf16 a[56:59], v[220:223], v[68:71], a[56:59]
    v_mfma_f32_16x16x32_bf16 a[60:63], v[216:219], v[72:75], a[60:63]
    v_mfma_f32_16x16x32_bf16 a[60:63], v[220:223], v[76:79], a[60:63]
    s_waitcnt lgkmcnt(0)
    v_mfma_f32_16x16x32_bf16 a[64:67], v[208:211], v[16:19], a[64:67]
    v_mfma_f32_16x16x32_bf16 a[64:67], v[212:215], v[20:23], a[64:67]
    ds_read_b64_tr_b16 v[216:217], v229 offset:0
    v_mfma_f32_16x16x32_bf16 a[68:71], v[208:211], v[24:27], a[68:71]
    v_mfma_f32_16x16x32_bf16 a[68:71], v[212:215], v[28:31], a[68:71]
    ds_read_b64_tr_b16 v[218:219], v229 offset:1024
    v_mfma_f32_16x16x32_bf16 a[72:75], v[208:211], v[32:35], a[72:75]
    v_mfma_f32_16x16x32_bf16 a[72:75], v[212:215], v[36:39], a[72:75]
    ds_read_b64_tr_b16 v[220:221], v229 offset:8192
    v_mfma_f32_16x16x32_bf16 a[76:79], v[208:211], v[40:43], a[76:79]
    v_mfma_f32_16x16x32_bf16 a[76:79], v[212:215], v[44:47], a[76:79]
    ds_read_b64_tr_b16 v[222:223], v229 offset:9216
    v_mfma_f32_16x16x32_bf16 a[80:83], v[208:211], v[48:51], a[80:83]
    v_mfma_f32_16x16x32_bf16 a[80:83], v[212:215], v[52:55], a[80:83]
    v_mfma_f32_16x16x32_bf16 a[84:87], v[208:211], v[56:59], a[84:87]
    v_mfma_f32_16x16x32_bf16 a[84:87], v[212:215], v[60:63], a[84:87]
    v_mfma_f32_16x16x32_bf16 a[88:91], v[208:211], v[64:67], a[88:91]
    v_mfma_f32_16x16x32_bf16 a[88:91], v[212:215], v[68:71], a[88:91]
    v_mfma_f32_16x16x32_bf16 a[92:95], v[208:211], v[72:75], a[92:95]
    s_waitcnt vmcnt(12)
    v_mfma_f32_16x16x32_bf16 a[92:95], v[212:215], v[76:79], a[92:95]
    s_waitcnt lgkmcnt(0)
    s_barrier
    v_mfma_f32_16x16x32_bf16 a[96:99], v[216:219], v[16:19], a[96:99]
    v_mfma_f32_16x16x32_bf16 a[96:99], v[220:223], v[20:23], a[96:99]
    ds_read_b64_tr_b16 v[208:209], v230 offset:0
    v_mfma_f32_16x16x32_bf16 a[100:103], v[216:219], v[24:27], a[100:103]
    v_mfma_f32_16x16x32_bf16 a[100:103], v[220:223], v[28:31], a[100:103]
    ds_read_b64_tr_b16 v[210:211], v230 offset:768
    v_mfma_f32_16x16x32_bf16 a[104:107], v[216:219], v[32:35], a[104:107]
    v_mfma_f32_16x16x32_bf16 a[104:107], v[220:223], v[36:39], a[104:107]
    ds_read_b64_tr_b16 v[212:213], v230 offset:12288
    v_mfma_f32_16x16x32_bf16 a[108:111], v[216:219], v[40:43], a[108:111]
    s_add_u32 m0, s47, 37888
    v_mfma_f32_16x16x32_bf16 a[108:111], v[220:223], v[44:47], a[108:111]
    ds_read_b64_tr_b16 v[214:215], v230 offset:13056
    buffer_load_dwordx4 v243, s[24:27], s44 offen lds
    v_mfma_f32_16x16x32_bf16 a[112:115], v[216:219], v[48:51], a[112:115]
    ds_read_b128 v[80:83], v224 offset:32768
    v_mfma_f32_16x16x32_bf16 a[112:115], v[220:223], v[52:55], a[112:115]
    v_mfma_f32_16x16x32_bf16 a[116:119], v[216:219], v[56:59], a[116:119]
    ds_read_b128 v[84:87], v225 offset:32768
    v_mfma_f32_16x16x32_bf16 a[116:119], v[220:223], v[60:63], a[116:119]
    v_mfma_f32_16x16x32_bf16 a[120:123], v[216:219], v[64:67], a[120:123]
    v_mfma_f32_16x16x32_bf16 a[120:123], v[220:223], v[68:71], a[120:123]
    v_mfma_f32_16x16x32_bf16 a[124:127], v[216:219], v[72:75], a[124:127]
    ds_read_b128 v[88:91], v224 offset:34816
    v_mfma_f32_16x16x32_bf16 a[124:127], v[220:223], v[76:79], a[124:127]
    s_waitcnt lgkmcnt(3)
    v_mfma_f32_16x16x32_bf16 a[128:131], v[208:211], v[16:19], a[128:131]
    v_mfma_f32_16x16x32_bf16 a[128:131], v[212:215], v[20:23], a[128:131]
    ds_read_b64_tr_b16 v[216:217], v230 offset:6144
    v_mfma_f32_16x16x32_bf16 a[132:135], v[208:211], v[24:27], a[132:135]
    v_mfma_f32_16x16x32_bf16 a[132:135], v[212:215], v[28:31], a[132:135]
    ds_read_b64_tr_b16 v[218:219], v230 offset:6912
    v_mfma_f32_16x16x32_bf16 a[136:139], v[208:211], v[32:35], a[136:139]
    v_mfma_f32_16x16x32_bf16 a[136:139], v[212:215], v[36:39], a[136:139]
    ds_read_b64_tr_b16 v[220:221], v230 offset:18432
    v_mfma_f32_16x16x32_bf16 a[140:143], v[208:211], v[40:43], a[140:143]
    v_mfma_f32_16x16x32_bf16 a[140:143], v[212:215], v[44:47], a[140:143]
    ds_read_b64_tr_b16 v[222:223], v230 offset:19200
    v_mfma_f32_16x16x32_bf16 a[144:147], v[208:211], v[48:51], a[144:147]
    ds_read_b128 v[92:95], v225 offset:34816
    v_mfma_f32_16x16x32_bf16 a[144:147], v[212:215], v[52:55], a[144:147]
    v_mfma_f32_16x16x32_bf16 a[148:151], v[208:211], v[56:59], a[148:151]
    v_mfma_f32_16x16x32_bf16 a[148:151], v[212:215], v[60:63], a[148:151]
    v_mfma_f32_16x16x32_bf16 a[152:155], v[208:211], v[64:67], a[152:155]
    ds_read_b128 v[96:99], v224 offset:36864
    v_mfma_f32_16x16x32_bf16 a[152:155], v[212:215], v[68:71], a[152:155]
    v_mfma_f32_16x16x32_bf16 a[156:159], v[208:211], v[72:75], a[156:159]
    ds_read_b128 v[100:103], v225 offset:36864
    v_mfma_f32_16x16x32_bf16 a[156:159], v[212:215], v[76:79], a[156:159]
    s_waitcnt lgkmcnt(3)
    v_mfma_f32_16x16x32_bf16 a[160:163], v[216:219], v[16:19], a[160:163]
    v_mfma_f32_16x16x32_bf16 a[160:163], v[220:223], v[20:23], a[160:163]
    ds_read_b64_tr_b16 v[208:209], v231 offset:32
    s_add_u32 m0, s47, 38912
    v_mfma_f32_16x16x32_bf16 a[164:167], v[216:219], v[24:27], a[164:167]
    buffer_load_dwordx4 v244, s[24:27], s44 offen lds
    s_add_u32 s44, s44, 229376
    v_mfma_f32_16x16x32_bf16 a[164:167], v[220:223], v[28:31], a[164:167]
    ds_read_b64_tr_b16 v[210:211], v231 offset:800
    v_mfma_f32_16x16x32_bf16 a[168:171], v[216:219], v[32:35], a[168:171]
    v_mfma_f32_16x16x32_bf16 a[168:171], v[220:223], v[36:39], a[168:171]
    ds_read_b64_tr_b16 v[212:213], v231 offset:12320
    v_mfma_f32_16x16x32_bf16 a[172:175], v[216:219], v[40:43], a[172:175]
    v_mfma_f32_16x16x32_bf16 a[172:175], v[220:223], v[44:47], a[172:175]
    ds_read_b64_tr_b16 v[214:215], v231 offset:13088
    v_mfma_f32_16x16x32_bf16 a[176:179], v[216:219], v[48:51], a[176:179]
    v_mfma_f32_16x16x32_bf16 a[176:179], v[220:223], v[52:55], a[176:179]
    v_mfma_f32_16x16x32_bf16 a[180:183], v[216:219], v[56:59], a[180:183]
    ds_read_b128 v[104:107], v224 offset:38912
    v_mfma_f32_16x16x32_bf16 a[180:183], v[220:223], v[60:63], a[180:183]
    v_mfma_f32_16x16x32_bf16 a[184:187], v[216:219], v[64:67], a[184:187]
    ds_read_b128 v[108:111], v225 offset:38912
    v_mfma_f32_16x16x32_bf16 a[184:187], v[220:223], v[68:71], a[184:187]
    v_mfma_f32_16x16x32_bf16 a[188:191], v[216:219], v[72:75], a[188:191]
    v_mfma_f32_16x16x32_bf16 a[188:191], v[220:223], v[76:79], a[188:191]
    s_waitcnt lgkmcnt(2)
    v_mfma_f32_16x16x32_bf16 a[192:195], v[208:211], v[16:19], a[192:195]
    v_mfma_f32_16x16x32_bf16 a[192:195], v[212:215], v[20:23], a[192:195]
    ds_read_b64_tr_b16 v[216:217], v231 offset:6176
    v_mfma_f32_16x16x32_bf16 a[196:199], v[208:211], v[24:27], a[196:199]
    v_mfma_f32_16x16x32_bf16 a[196:199], v[212:215], v[28:31], a[196:199]
    ds_read_b64_tr_b16 v[218:219], v231 offset:6944
    v_mfma_f32_16x16x32_bf16 a[200:203], v[208:211], v[32:35], a[200:203]
    v_mfma_f32_16x16x32_bf16 a[200:203], v[212:215], v[36:39], a[200:203]
    ds_read_b64_tr_b16 v[220:221], v231 offset:18464
    v_mfma_f32_16x16x32_bf16 a[204:207], v[208:211], v[40:43], a[204:207]
    v_mfma_f32_16x16x32_bf16 a[204:207], v[212:215], v[44:47], a[204:207]
    ds_read_b64_tr_b16 v[222:223], v231 offset:19232
    v_mfma_f32_16x16x32_bf16 a[208:211], v[208:211], v[48:51], a[208:211]
    ds_read_b128 v[112:115], v224 offset:40960
    v_mfma_f32_16x16x32_bf16 a[208:211], v[212:215], v[52:55], a[208:211]
    v_mfma_f32_16x16x32_bf16 a[212:215], v[208:211], v[56:59], a[212:215]
    ds_read_b128 v[116:119], v225 offset:40960
    v_mfma_f32_16x16x32_bf16 a[212:215], v[212:215], v[60:63], a[212:215]
    v_mfma_f32_16x16x32_bf16 a[216:219], v[208:211], v[64:67], a[216:219]
    v_mfma_f32_16x16x32_bf16 a[216:219], v[212:215], v[68:71], a[216:219]
    v_mfma_f32_16x16x32_bf16 a[220:223], v[208:211], v[72:75], a[220:223]
    ds_read_b128 v[120:123], v224 offset:43008
    v_mfma_f32_16x16x32_bf16 a[220:223], v[212:215], v[76:79], a[220:223]
    s_waitcnt lgkmcnt(3)
    v_mfma_f32_16x16x32_bf16 a[224:227], v[216:219], v[16:19], a[224:227]
    v_mfma_f32_16x16x32_bf16 a[224:227], v[220:223], v[20:23], a[224:227]
    ds_read_b64_tr_b16 v[208:209], v230 offset:64
    v_mfma_f32_16x16x32_bf16 a[228:231], v[216:219], v[24:27], a[228:231]
    v_mfma_f32_16x16x32_bf16 a[228:231], v[220:223], v[28:31], a[228:231]
    ds_read_b64_tr_b16 v[210:211], v230 offset:832
    v_mfma_f32_16x16x32_bf16 a[232:235], v[216:219], v[32:35], a[232:235]
    v_mfma_f32_16x16x32_bf16 a[232:235], v[220:223], v[36:39], a[232:235]
    ds_read_b64_tr_b16 v[212:213], v230 offset:12352
    v_mfma_f32_16x16x32_bf16 a[236:239], v[216:219], v[40:43], a[236:239]
    v_mfma_f32_16x16x32_bf16 a[236:239], v[220:223], v[44:47], a[236:239]
    ds_read_b64_tr_b16 v[214:215], v230 offset:13120
    v_mfma_f32_16x16x32_bf16 a[240:243], v[216:219], v[48:51], a[240:243]
    ds_read_b128 v[124:127], v225 offset:43008
    v_mfma_f32_16x16x32_bf16 a[240:243], v[220:223], v[52:55], a[240:243]
    v_mfma_f32_16x16x32_bf16 a[244:247], v[216:219], v[56:59], a[244:247]
    v_mfma_f32_16x16x32_bf16 a[244:247], v[220:223], v[60:63], a[244:247]
    v_mfma_f32_16x16x32_bf16 a[248:251], v[216:219], v[64:67], a[248:251]
    ds_read_b128 v[128:131], v224 offset:45056
    v_mfma_f32_16x16x32_bf16 a[248:251], v[220:223], v[68:71], a[248:251]
    v_mfma_f32_16x16x32_bf16 a[252:255], v[216:219], v[72:75], a[252:255]
    ds_read_b128 v[132:135], v225 offset:45056
    v_mfma_f32_16x16x32_bf16 a[252:255], v[220:223], v[76:79], a[252:255]
    s_waitcnt lgkmcnt(3)
    v_mfma_f32_16x16x32_bf16 v[144:147], v[208:211], v[16:19], v[144:147]
    v_mfma_f32_16x16x32_bf16 v[144:147], v[212:215], v[20:23], v[144:147]
    ds_read_b64_tr_b16 v[216:217], v230 offset:6208
    v_mfma_f32_16x16x32_bf16 v[148:151], v[208:211], v[24:27], v[148:151]
    v_mfma_f32_16x16x32_bf16 v[148:151], v[212:215], v[28:31], v[148:151]
    ds_read_b64_tr_b16 v[218:219], v230 offset:6976
    v_mfma_f32_16x16x32_bf16 v[152:155], v[208:211], v[32:35], v[152:155]
    v_mfma_f32_16x16x32_bf16 v[152:155], v[212:215], v[36:39], v[152:155]
    ds_read_b64_tr_b16 v[220:221], v230 offset:18496
    v_mfma_f32_16x16x32_bf16 v[156:159], v[208:211], v[40:43], v[156:159]
    v_mfma_f32_16x16x32_bf16 v[156:159], v[212:215], v[44:47], v[156:159]
    ds_read_b64_tr_b16 v[222:223], v230 offset:19264
    v_mfma_f32_16x16x32_bf16 v[160:163], v[208:211], v[48:51], v[160:163]
    v_mfma_f32_16x16x32_bf16 v[160:163], v[212:215], v[52:55], v[160:163]
    v_mfma_f32_16x16x32_bf16 v[164:167], v[208:211], v[56:59], v[164:167]
    ds_read_b128 v[136:139], v224 offset:47104
    v_mfma_f32_16x16x32_bf16 v[164:167], v[212:215], v[60:63], v[164:167]
    v_mfma_f32_16x16x32_bf16 v[168:171], v[208:211], v[64:67], v[168:171]
    ds_read_b128 v[140:143], v225 offset:47104
    v_mfma_f32_16x16x32_bf16 v[168:171], v[212:215], v[68:71], v[168:171]
    v_mfma_f32_16x16x32_bf16 v[172:175], v[208:211], v[72:75], v[172:175]
    s_waitcnt vmcnt(10)
    v_mfma_f32_16x16x32_bf16 v[172:175], v[212:215], v[76:79], v[172:175]
    s_waitcnt lgkmcnt(0)
    s_barrier
    v_mfma_f32_16x16x32_bf16 v[176:179], v[216:219], v[16:19], v[176:179]
    ds_read_b64_tr_b16 v[208:209], v226 offset:16384
    v_mfma_f32_16x16x32_bf16 v[176:179], v[220:223], v[20:23], v[176:179]
    v_mfma_f32_16x16x32_bf16 v[180:183], v[216:219], v[24:27], v[180:183]
    ds_read_b64_tr_b16 v[210:211], v226 offset:17408
    v_mfma_f32_16x16x32_bf16 v[180:183], v[220:223], v[28:31], v[180:183]
    v_mfma_f32_16x16x32_bf16 v[184:187], v[216:219], v[32:35], v[184:187]
    ds_read_b64_tr_b16 v[212:213], v226 offset:24576
    v_mfma_f32_16x16x32_bf16 v[184:187], v[220:223], v[36:39], v[184:187]
    v_mfma_f32_16x16x32_bf16 v[188:191], v[216:219], v[40:43], v[188:191]
    ds_read_b64_tr_b16 v[214:215], v226 offset:25600
    v_mfma_f32_16x16x32_bf16 v[188:191], v[220:223], v[44:47], v[188:191]
    v_mfma_f32_16x16x32_bf16 v[192:195], v[216:219], v[48:51], v[192:195]
    v_mfma_f32_16x16x32_bf16 v[192:195], v[220:223], v[52:55], v[192:195]
    v_mfma_f32_16x16x32_bf16 v[196:199], v[216:219], v[56:59], v[196:199]
    v_mfma_f32_16x16x32_bf16 v[196:199], v[220:223], v[60:63], v[196:199]
    v_mfma_f32_16x16x32_bf16 v[200:203], v[216:219], v[64:67], v[200:203]
    v_mfma_f32_16x16x32_bf16 v[200:203], v[220:223], v[68:71], v[200:203]
    v_mfma_f32_16x16x32_bf16 v[204:207], v[216:219], v[72:75], v[204:207]
    v_mfma_f32_16x16x32_bf16 v[204:207], v[220:223], v[76:79], v[204:207]
    s_waitcnt lgkmcnt(0)
    v_mfma_f32_16x16x32_bf16 a[0:3], v[208:211], v[80:83], a[0:3]
    v_mfma_f32_16x16x32_bf16 a[0:3], v[212:215], v[84:87], a[0:3]
    ds_read_b64_tr_b16 v[216:217], v227 offset:16384
    v_mfma_f32_16x16x32_bf16 a[4:7], v[208:211], v[88:91], a[4:7]
    buffer_load_dwordx4 v[16:19], v253, s[16:19], s61 offen offset:0
    v_mfma_f32_16x16x32_bf16 a[4:7], v[212:215], v[92:95], a[4:7]
    ds_read_b64_tr_b16 v[218:219], v227 offset:17408
    v_mfma_f32_16x16x32_bf16 a[8:11], v[208:211], v[96:99], a[8:11]
    v_mfma_f32_16x16x32_bf16 a[8:11], v[212:215], v[100:103], a[8:11]
    ds_read_b64_tr_b16 v[220:221], v227 offset:24576
    buffer_load_dwordx4 v[20:23], v253, s[16:19], s61 offen offset:16
    v_mfma_f32_16x16x32_bf16 a[12:15], v[208:211], v[104:107], a[12:15]
    v_mfma_f32_16x16x32_bf16 a[12:15], v[212:215], v[108:111], a[12:15]
    ds_read_b64_tr_b16 v[222:223], v227 offset:25600
    v_mfma_f32_16x16x32_bf16 a[16:19], v[208:211], v[112:115], a[16:19]
    buffer_load_dwordx4 v[24:27], v253, s[16:19], s61 offen offset:32
    v_mfma_f32_16x16x32_bf16 a[16:19], v[212:215], v[116:119], a[16:19]
    v_mfma_f32_16x16x32_bf16 a[20:23], v[208:211], v[120:123], a[20:23]
    v_mfma_f32_16x16x32_bf16 a[20:23], v[212:215], v[124:127], a[20:23]
    buffer_load_dwordx4 v[28:31], v253, s[16:19], s61 offen offset:48
    v_mfma_f32_16x16x32_bf16 a[24:27], v[208:211], v[128:131], a[24:27]
    v_mfma_f32_16x16x32_bf16 a[24:27], v[212:215], v[132:135], a[24:27]
    v_mfma_f32_16x16x32_bf16 a[28:31], v[208:211], v[136:139], a[28:31]
    buffer_load_dwordx4 v[32:35], v252, s[32:35], 0 offen offset:0
    v_mfma_f32_16x16x32_bf16 a[28:31], v[212:215], v[140:143], a[28:31]
    s_waitcnt lgkmcnt(0)
    v_mfma_f32_16x16x32_bf16 a[32:35], v[216:219], v[80:83], a[32:35]
    v_mfma_f32_16x16x32_bf16 a[32:35], v[220:223], v[84:87], a[32:35]
    ds_read_b64_tr_b16 v[208:209], v228 offset:16384
    buffer_load_dwordx4 v[36:39], v252, s[32:35], 0 offen offset:16
    v_mfma_f32_16x16x32_bf16 a[36:39], v[216:219], v[88:91], a[36:39]
    v_mfma_f32_16x16x32_bf16 a[36:39], v[220:223], v[92:95], a[36:39]
    ds_read_b64_tr_b16 v[210:211], v228 offset:17408
    v_mfma_f32_16x16x32_bf16 a[40:43], v[216:219], v[96:99], a[40:43]
    buffer_load_dwordx4 v[40:43], v252, s[32:35], 0 offen offset:32
    v_mfma_f32_16x16x32_bf16 a[40:43], v[220:223], v[100:103], a[40:43]
    ds_read_b64_tr_b16 v[212:213], v228 offset:24576
    v_mfma_f32_16x16x32_bf16 a[44:47], v[216:219], v[104:107], a[44:47]
    v_mfma_f32_16x16x32_bf16 a[44:47], v[220:223], v[108:111], a[44:47]
    ds_read_b64_tr_b16 v[214:215], v228 offset:25600
    buffer_load_dwordx4 v[44:47], v252, s[32:35], 0 offen offset:48
    v_mfma_f32_16x16x32_bf16 a[48:51], v[216:219], v[112:115], a[48:51]
    v_mfma_f32_16x16x32_bf16 a[48:51], v[220:223], v[116:119], a[48:51]
    v_mfma_f32_16x16x32_bf16 a[52:55], v[216:219], v[120:123], a[52:55]
    buffer_load_dword v14, v15, s[76:79], 0 offen sc1
    v_mfma_f32_16x16x32_bf16 a[52:55], v[220:223], v[124:127], a[52:55]
    v_and_b32 v2, 15, v1
    v_mfma_f32_16x16x32_bf16 a[56:59], v[216:219], v[128:131], a[56:59]
    v_lshrrev_b32 v3, 4, v1
    v_lshlrev_b32 v3, 9, v3
    v_mfma_f32_16x16x32_bf16 a[56:59], v[220:223], v[132:135], a[56:59]
    v_lshl_add_u32 v4, v2, 4, v3
    v_lshrrev_b32 v5, 3, v2
    v_mfma_f32_16x16x32_bf16 a[60:63], v[216:219], v[136:139], a[60:63]
    v_mul_u32_u24 v5, s53, v5
    v_add_u32 v76, v5, v4
    v_mfma_f32_16x16x32_bf16 a[60:63], v[220:223], v[140:143], a[60:63]
    s_waitcnt lgkmcnt(0)
    v_subrev_u32 v5, s53, v76
    v_mfma_f32_16x16x32_bf16 a[64:67], v[208:211], v[80:83], a[64:67]
    v_add_u32 v77, 0x100, v5
    v_lshlrev_b32 v0, 4, v1
    v_mfma_f32_16x16x32_bf16 a[64:67], v[212:215], v[84:87], a[64:67]
    ds_read_b64_tr_b16 v[216:217], v229 offset:16384
    v_mov_b32 v72, 0xc0135761
    v_mfma_f32_16x16x32_bf16 a[68:71], v[208:211], v[88:91], a[68:71]
    v_mov_b32 v73, 0xc0135761
    v_mov_b32 v74, 1.0
    v_mfma_f32_16x16x32_bf16 a[68:71], v[212:215], v[92:95], a[68:71]
    ds_read_b64_tr_b16 v[218:219], v229 offset:17408
    v_mov_b32 v75, 1.0
    v_mfma_f32_16x16x32_bf16 a[72:75], v[208:211], v[96:99], a[72:75]
    v_mfma_f32_16x16x32_bf16 a[72:75], v[212:215], v[100:103], a[72:75]
    ds_read_b64_tr_b16 v[220:221], v229 offset:24576
    v_mfma_f32_16x16x32_bf16 a[76:79], v[208:211], v[104:107], a[76:79]
    v_mfma_f32_16x16x32_bf16 a[76:79], v[212:215], v[108:111], a[76:79]
    ds_read_b64_tr_b16 v[222:223], v229 offset:25600
    v_mfma_f32_16x16x32_bf16 a[80:83], v[208:211], v[112:115], a[80:83]
    v_accvgpr_read_b32 v48, a0
    v_accvgpr_read_b32 v49, a1
    v_mfma_f32_16x16x32_bf16 a[80:83], v[212:215], v[116:119], a[80:83]
    v_accvgpr_read_b32 v50, a2
    v_accvgpr_read_b32 v51, a3
    v_mfma_f32_16x16x32_bf16 a[84:87], v[208:211], v[120:123], a[84:87]
    v_accvgpr_read_b32 v52, a32
    v_accvgpr_read_b32 v53, a33
    v_mfma_f32_16x16x32_bf16 a[84:87], v[212:215], v[124:127], a[84:87]
    v_accvgpr_read_b32 v54, a34
    v_accvgpr_read_b32 v55, a35
    v_mfma_f32_16x16x32_bf16 a[88:91], v[208:211], v[128:131], a[88:91]
    v_mul_f32 v48, s56, v48
    v_mul_f32 v49, s56, v49
    v_mfma_f32_16x16x32_bf16 a[88:91], v[212:215], v[132:135], a[88:91]
    v_mul_f32 v50, s56, v50
    v_mul_f32 v51, s56, v51
    v_mfma_f32_16x16x32_bf16 a[92:95], v[208:211], v[136:139], a[92:95]
    s_waitcnt vmcnt(9)
    v_mul_f32 v52, s56, v52
    v_mfma_f32_16x16x32_bf16 a[92:95], v[212:215], v[140:143], a[92:95]
    s_waitcnt lgkmcnt(0)
    s_barrier
    v_mfma_f32_16x16x32_bf16 a[96:99], v[216:219], v[80:83], a[96:99]
    v_mul_f32 v53, s56, v53
    v_mul_f32 v54, s56, v54
    v_mfma_f32_16x16x32_bf16 a[96:99], v[220:223], v[84:87], a[96:99]
    ds_read_b64_tr_b16 v[208:209], v230 offset:24576
    v_mul_f32 v55, s56, v55
    v_mfma_f32_16x16x32_bf16 a[100:103], v[216:219], v[88:91], a[100:103]
    s_add_u32 s59, s58, 0
    v_cvt_pk_bf16_f32 v56, v48, v49
    v_mfma_f32_16x16x32_bf16 a[100:103], v[220:223], v[92:95], a[100:103]
    ds_read_b64_tr_b16 v[210:211], v230 offset:25344
    v_cvt_pk_bf16_f32 v57, v50, v51
    v_mfma_f32_16x16x32_bf16 a[104:107], v[216:219], v[96:99], a[104:107]
    v_cvt_pk_bf16_f32 v58, v52, v53
    v_cvt_pk_bf16_f32 v59, v54, v55
    v_mfma_f32_16x16x32_bf16 a[104:107], v[220:223], v[100:103], a[104:107]
    ds_read_b64_tr_b16 v[212:213], v230 offset:36864
    buffer_store_dwordx4 v[56:59], v76, s[28:31], s59 offen sc1
    v_mfma_f32_16x16x32_bf16 a[108:111], v[216:219], v[104:107], a[108:111]
    v_mfma_f32_16x16x32_bf16 a[108:111], v[220:223], v[108:111], a[108:111]
    ds_read_b64_tr_b16 v[214:215], v230 offset:37632
    v_accvgpr_read_b32 v48, a4
    v_mfma_f32_16x16x32_bf16 a[112:115], v[216:219], v[112:115], a[112:115]
    v_accvgpr_read_b32 v49, a5
    v_accvgpr_read_b32 v50, a6
    v_mfma_f32_16x16x32_bf16 a[112:115], v[220:223], v[116:119], a[112:115]
    v_accvgpr_read_b32 v51, a7
    v_accvgpr_read_b32 v52, a36
    v_mfma_f32_16x16x32_bf16 a[116:119], v[216:219], v[120:123], a[116:119]
    v_accvgpr_read_b32 v53, a37
    v_accvgpr_read_b32 v54, a38
    v_mfma_f32_16x16x32_bf16 a[116:119], v[220:223], v[124:127], a[116:119]
    v_accvgpr_read_b32 v55, a39
    v_mul_f32 v48, s56, v48
    v_mfma_f32_16x16x32_bf16 a[120:123], v[216:219], v[128:131], a[120:123]
    v_mul_f32 v49, s56, v49
    v_mul_f32 v50, s56, v50
    v_mfma_f32_16x16x32_bf16 a[120:123], v[220:223], v[132:135], a[120:123]
    v_mul_f32 v51, s56, v51
    v_mul_f32 v52, s56, v52
    v_mfma_f32_16x16x32_bf16 a[124:127], v[216:219], v[136:139], a[124:127]
    v_mul_f32 v53, s56, v53
    v_mul_f32 v54, s56, v54
    v_mfma_f32_16x16x32_bf16 a[124:127], v[220:223], v[140:143], a[124:127]
    s_waitcnt lgkmcnt(0)
    v_mul_f32 v55, s56, v55
    v_mfma_f32_16x16x32_bf16 a[128:131], v[208:211], v[80:83], a[128:131]
    s_add_u32 s59, s58, 0
    v_cvt_pk_bf16_f32 v60, v48, v49
    v_mfma_f32_16x16x32_bf16 a[128:131], v[212:215], v[84:87], a[128:131]
    ds_read_b64_tr_b16 v[216:217], v230 offset:30720
    v_cvt_pk_bf16_f32 v61, v50, v51
    v_mfma_f32_16x16x32_bf16 a[132:135], v[208:211], v[88:91], a[132:135]
    v_cvt_pk_bf16_f32 v62, v52, v53
    v_cvt_pk_bf16_f32 v63, v54, v55
    v_mfma_f32_16x16x32_bf16 a[132:135], v[212:215], v[92:95], a[132:135]
    ds_read_b64_tr_b16 v[218:219], v230 offset:31488
    buffer_store_dwordx4 v[60:63], v77, s[28:31], s59 offen sc1
    v_mfma_f32_16x16x32_bf16 a[136:139], v[208:211], v[96:99], a[136:139]
    v_mfma_f32_16x16x32_bf16 a[136:139], v[212:215], v[100:103], a[136:139]
    ds_read_b64_tr_b16 v[220:221], v230 offset:43008
    v_accvgpr_read_b32 v48, a8
    v_mfma_f32_16x16x32_bf16 a[140:143], v[208:211], v[104:107], a[140:143]
    v_accvgpr_read_b32 v49, a9
    v_accvgpr_read_b32 v50, a10
    v_mfma_f32_16x16x32_bf16 a[140:143], v[212:215], v[108:111], a[140:143]
    ds_read_b64_tr_b16 v[222:223], v230 offset:43776
    v_accvgpr_read_b32 v51, a11
    v_mfma_f32_16x16x32_bf16 a[144:147], v[208:211], v[112:115], a[144:147]
    v_accvgpr_read_b32 v52, a40
    v_accvgpr_read_b32 v53, a41
    v_mfma_f32_16x16x32_bf16 a[144:147], v[212:215], v[116:119], a[144:147]
    v_accvgpr_read_b32 v54, a42
    v_accvgpr_read_b32 v55, a43
    v_mfma_f32_16x16x32_bf16 a[148:151], v[208:211], v[120:123], a[148:151]
    v_mul_f32 v48, s56, v48
    v_mul_f32 v49, s56, v49
    v_mfma_f32_16x16x32_bf16 a[148:151], v[212:215], v[124:127], a[148:151]
    v_mul_f32 v50, s56, v50
    v_mul_f32 v51, s56, v51
    v_mfma_f32_16x16x32_bf16 a[152:155], v[208:211], v[128:131], a[152:155]
    v_mul_f32 v52, s56, v52
    v_mul_f32 v53, s56, v53
    v_mfma_f32_16x16x32_bf16 a[152:155], v[212:215], v[132:135], a[152:155]
    v_mul_f32 v54, s56, v54
    v_mul_f32 v55, s56, v55
    v_mfma_f32_16x16x32_bf16 a[156:159], v[208:211], v[136:139], a[156:159]
    s_add_u32 s59, s58, 2048
    v_cvt_pk_bf16_f32 v64, v48, v49
    v_mfma_f32_16x16x32_bf16 a[156:159], v[212:215], v[140:143], a[156:159]
    s_waitcnt lgkmcnt(0)
    v_cvt_pk_bf16_f32 v65, v50, v51
    v_mfma_f32_16x16x32_bf16 a[160:163], v[216:219], v[80:83], a[160:163]
    v_cvt_pk_bf16_f32 v66, v52, v53
    v_cvt_pk_bf16_f32 v67, v54, v55
    v_mfma_f32_16x16x32_bf16 a[160:163], v[220:223], v[84:87], a[160:163]
    ds_read_b64_tr_b16 v[208:209], v231 offset:24608
    buffer_store_dwordx4 v[64:67], v76, s[28:31], s59 offen sc1
    v_mfma_f32_16x16x32_bf16 a[164:167], v[216:219], v[88:91], a[164:167]
    v_mfma_f32_16x16x32_bf16 a[164:167], v[220:223], v[92:95], a[164:167]
    ds_read_b64_tr_b16 v[210:211], v231 offset:25376
    v_accvgpr_read_b32 v48, a12
    v_mfma_f32_16x16x32_bf16 a[168:171], v[216:219], v[96:99], a[168:171]
    v_accvgpr_read_b32 v49, a13
    v_accvgpr_read_b32 v50, a14
    v_mfma_f32_16x16x32_bf16 a[168:171], v[220:223], v[100:103], a[168:171]
    ds_read_b64_tr_b16 v[212:213], v231 offset:36896
    v_accvgpr_read_b32 v51, a15
    v_mfma_f32_16x16x32_bf16 a[172:175], v[216:219], v[104:107], a[172:175]
    v_accvgpr_read_b32 v52, a44
    v_accvgpr_read_b32 v53, a45
    v_mfma_f32_16x16x32_bf16 a[172:175], v[220:223], v[108:111], a[172:175]
    ds_read_b64_tr_b16 v[214:215], v231 offset:37664
    v_accvgpr_read_b32 v54, a46
    v_mfma_f32_16x16x32_bf16 a[176:179], v[216:219], v[112:115], a[176:179]
    v_accvgpr_read_b32 v55, a47
    v_mul_f32 v48, s56, v48
    v_mfma_f32_16x16x32_bf16 a[176:179], v[220:223], v[116:119], a[176:179]
    v_mul_f32 v49, s56, v49
    v_mul_f32 v50, s56, v50
    v_mfma_f32_16x16x32_bf16 a[180:183], v[216:219], v[120:123], a[180:183]
    v_mul_f32 v51, s56, v51
    v_mul_f32 v52, s56, v52
    v_mfma_f32_16x16x32_bf16 a[180:183], v[220:223], v[124:127], a[180:183]
    v_mul_f32 v53, s56, v53
    v_mul_f32 v54, s56, v54
    v_mfma_f32_16x16x32_bf16 a[184:187], v[216:219], v[128:131], a[184:187]
    v_mul_f32 v55, s56, v55
    s_add_u32 s59, s58, 2048
    v_mfma_f32_16x16x32_bf16 a[184:187], v[220:223], v[132:135], a[184:187]
    v_cvt_pk_bf16_f32 v68, v48, v49
    v_cvt_pk_bf16_f32 v69, v50, v51
    v_mfma_f32_16x16x32_bf16 a[188:191], v[216:219], v[136:139], a[188:191]
    v_cvt_pk_bf16_f32 v70, v52, v53
    v_cvt_pk_bf16_f32 v71, v54, v55
    v_mfma_f32_16x16x32_bf16 a[188:191], v[220:223], v[140:143], a[188:191]
    s_waitcnt lgkmcnt(0)
    buffer_store_dwordx4 v[68:71], v77, s[28:31], s59 offen sc1
    v_mfma_f32_16x16x32_bf16 a[192:195], v[208:211], v[80:83], a[192:195]
    v_mfma_f32_16x16x32_bf16 a[192:195], v[212:215], v[84:87], a[192:195]
    ds_read_b64_tr_b16 v[216:217], v231 offset:30752
    v_accvgpr_read_b32 v48, a16
    v_mfma_f32_16x16x32_bf16 a[196:199], v[208:211], v[88:91], a[196:199]
    v_accvgpr_read_b32 v49, a17
    v_accvgpr_read_b32 v50, a18
    v_mfma_f32_16x16x32_bf16 a[196:199], v[212:215], v[92:95], a[196:199]
    ds_read_b64_tr_b16 v[218:219], v231 offset:31520
    v_accvgpr_read_b32 v51, a19
    v_mfma_f32_16x16x32_bf16 a[200:203], v[208:211], v[96:99], a[200:203]
    v_accvgpr_read_b32 v52, a48
    v_accvgpr_read_b32 v53, a49
    v_mfma_f32_16x16x32_bf16 a[200:203], v[212:215], v[100:103], a[200:203]
    ds_read_b64_tr_b16 v[220:221], v231 offset:43040
    v_accvgpr_read_b32 v54, a50
    v_mfma_f32_16x16x32_bf16 a[204:207], v[208:211], v[104:107], a[204:207]
    v_accvgpr_read_b32 v55, a51
    v_mul_f32 v48, s56, v48
    v_mfma_f32_16x16x32_bf16 a[204:207], v[212:215], v[108:111], a[204:207]
    ds_read_b64_tr_b16 v[222:223], v231 offset:43808
    v_mul_f32 v49, s56, v49
    v_mfma_f32_16x16x32_bf16 a[208:211], v[208:211], v[112:115], a[208:211]
    v_mul_f32 v50, s56, v50
    v_mul_f32 v51, s56, v51
    v_mfma_f32_16x16x32_bf16 a[208:211], v[212:215], v[116:119], a[208:211]
    v_mul_f32 v52, s56, v52
    v_mul_f32 v53, s56, v53
    v_mfma_f32_16x16x32_bf16 a[212:215], v[208:211], v[120:123], a[212:215]
    v_mul_f32 v54, s56, v54
    v_mul_f32 v55, s56, v55
    v_mfma_f32_16x16x32_bf16 a[212:215], v[212:215], v[124:127], a[212:215]
    s_add_u32 s59, s58, 4096
    v_cvt_pk_bf16_f32 v56, v48, v49
    v_mfma_f32_16x16x32_bf16 a[216:219], v[208:211], v[128:131], a[216:219]
    v_cvt_pk_bf16_f32 v57, v50, v51
    v_cvt_pk_bf16_f32 v58, v52, v53
    v_mfma_f32_16x16x32_bf16 a[216:219], v[212:215], v[132:135], a[216:219]
    v_cvt_pk_bf16_f32 v59, v54, v55
    buffer_store_dwordx4 v[56:59], v76, s[28:31], s59 offen sc1
    v_mfma_f32_16x16x32_bf16 a[220:223], v[208:211], v[136:139], a[220:223]
    v_mfma_f32_16x16x32_bf16 a[220:223], v[212:215], v[140:143], a[220:223]
    s_waitcnt lgkmcnt(0)
    v_accvgpr_read_b32 v48, a20
    v_mfma_f32_16x16x32_bf16 a[224:227], v[216:219], v[80:83], a[224:227]
    v_accvgpr_read_b32 v49, a21
    v_accvgpr_read_b32 v50, a22
    v_mfma_f32_16x16x32_bf16 a[224:227], v[220:223], v[84:87], a[224:227]
    ds_read_b64_tr_b16 v[208:209], v230 offset:24640
    v_accvgpr_read_b32 v51, a23
    v_mfma_f32_16x16x32_bf16 a[228:231], v[216:219], v[88:91], a[228:231]
    v_accvgpr_read_b32 v52, a52
    v_accvgpr_read_b32 v53, a53
    v_mfma_f32_16x16x32_bf16 a[228:231], v[220:223], v[92:95], a[228:231]
    ds_read_b64_tr_b16 v[210:211], v230 offset:25408
    v_accvgpr_read_b32 v54, a54
    v_mfma_f32_16x16x32_bf16 a[232:235], v[216:219], v[96:99], a[232:235]
    v_accvgpr_read_b32 v55, a55
    v_mul_f32 v48, s56, v48
    v_mfma_f32_16x16x32_bf16 a[232:235], v[220:223], v[100:103], a[232:235]
    ds_read_b64_tr_b16 v[212:213], v230 offset:36928
    v_mul_f32 v49, s56, v49
    v_mfma_f32_16x16x32_bf16 a[236:239], v[216:219], v[104:107], a[236:239]
    v_mul_f32 v50, s56, v50
    v_mul_f32 v51, s56, v51
    v_mfma_f32_16x16x32_bf16 a[236:239], v[220:223], v[108:111], a[236:239]
    ds_read_b64_tr_b16 v[214:215], v230 offset:37696
    v_mul_f32 v52, s56, v52
    v_mfma_f32_16x16x32_bf16 a[240:243], v[216:219], v[112:115], a[240:243]
    v_mul_f32 v53, s56, v53
    v_mul_f32 v54, s56, v54
    v_mfma_f32_16x16x32_bf16 a[240:243], v[220:223], v[116:119], a[240:243]
    v_mul_f32 v55, s56, v55
    s_add_u32 s59, s58, 4096
    v_mfma_f32_16x16x32_bf16 a[244:247], v[216:219], v[120:123], a[244:247]
    v_cvt_pk_bf16_f32 v60, v48, v49
    v_cvt_pk_bf16_f32 v61, v50, v51
    v_mfma_f32_16x16x32_bf16 a[244:247], v[220:223], v[124:127], a[244:247]
    v_cvt_pk_bf16_f32 v62, v52, v53
    v_cvt_pk_bf16_f32 v63, v54, v55
    v_mfma_f32_16x16x32_bf16 a[248:251], v[216:219], v[128:131], a[248:251]
    buffer_store_dwordx4 v[60:63], v77, s[28:31], s59 offen sc1
    v_mfma_f32_16x16x32_bf16 a[248:251], v[220:223], v[132:135], a[248:251]
    v_accvgpr_read_b32 v48, a24
    v_mfma_f32_16x16x32_bf16 a[252:255], v[216:219], v[136:139], a[252:255]
    v_accvgpr_read_b32 v49, a25
    v_accvgpr_read_b32 v50, a26
    v_mfma_f32_16x16x32_bf16 a[252:255], v[220:223], v[140:143], a[252:255]
    s_waitcnt lgkmcnt(0)
    v_accvgpr_read_b32 v51, a27
    v_mfma_f32_16x16x32_bf16 v[144:147], v[208:211], v[80:83], v[144:147]
    v_accvgpr_read_b32 v52, a56
    v_accvgpr_read_b32 v53, a57
    v_mfma_f32_16x16x32_bf16 v[144:147], v[212:215], v[84:87], v[144:147]
    ds_read_b64_tr_b16 v[216:217], v230 offset:30784
    v_accvgpr_read_b32 v54, a58
    v_mfma_f32_16x16x32_bf16 v[148:151], v[208:211], v[88:91], v[148:151]
    v_accvgpr_read_b32 v55, a59
    v_mul_f32 v48, s56, v48
    v_mfma_f32_16x16x32_bf16 v[148:151], v[212:215], v[92:95], v[148:151]
    ds_read_b64_tr_b16 v[218:219], v230 offset:31552
    v_mul_f32 v49, s56, v49
    v_mfma_f32_16x16x32_bf16 v[152:155], v[208:211], v[96:99], v[152:155]
    v_mul_f32 v50, s56, v50
    v_mul_f32 v51, s56, v51
    v_mfma_f32_16x16x32_bf16 v[152:155], v[212:215], v[100:103], v[152:155]
    ds_read_b64_tr_b16 v[220:221], v230 offset:43072
    v_mul_f32 v52, s56, v52
    v_mfma_f32_16x16x32_bf16 v[156:159], v[208:211], v[104:107], v[156:159]
    v_mul_f32 v53, s56, v53
    v_mul_f32 v54, s56, v54
    v_mfma_f32_16x16x32_bf16 v[156:159], v[212:215], v[108:111], v[156:159]
    ds_read_b64_tr_b16 v[222:223], v230 offset:43840
    v_mul_f32 v55, s56, v55
    v_mfma_f32_16x16x32_bf16 v[160:163], v[208:211], v[112:115], v[160:163]
    s_add_u32 s59, s58, 6144
    v_cvt_pk_bf16_f32 v64, v48, v49
    v_mfma_f32_16x16x32_bf16 v[160:163], v[212:215], v[116:119], v[160:163]
    v_cvt_pk_bf16_f32 v65, v50, v51
    v_cvt_pk_bf16_f32 v66, v52, v53
    v_mfma_f32_16x16x32_bf16 v[164:167], v[208:211], v[120:123], v[164:167]
    v_cvt_pk_bf16_f32 v67, v54, v55
    buffer_store_dwordx4 v[64:67], v76, s[28:31], s59 offen sc1
    v_mfma_f32_16x16x32_bf16 v[164:167], v[212:215], v[124:127], v[164:167]
    v_mfma_f32_16x16x32_bf16 v[168:171], v[208:211], v[128:131], v[168:171]
    v_accvgpr_read_b32 v48, a28
    v_accvgpr_read_b32 v49, a29
    v_mfma_f32_16x16x32_bf16 v[168:171], v[212:215], v[132:135], v[168:171]
    v_accvgpr_read_b32 v50, a30
    v_accvgpr_read_b32 v51, a31
    v_mfma_f32_16x16x32_bf16 v[172:175], v[208:211], v[136:139], v[172:175]
    v_accvgpr_read_b32 v52, a60
    v_accvgpr_read_b32 v53, a61
    v_mfma_f32_16x16x32_bf16 v[172:175], v[212:215], v[140:143], v[172:175]
    s_waitcnt lgkmcnt(0)
    v_accvgpr_read_b32 v54, a62
    v_mfma_f32_16x16x32_bf16 v[176:179], v[216:219], v[80:83], v[176:179]
    v_accvgpr_read_b32 v55, a63
    v_mul_f32 v48, s56, v48
    v_mfma_f32_16x16x32_bf16 v[176:179], v[220:223], v[84:87], v[176:179]
    v_mul_f32 v49, s56, v49
    v_mul_f32 v50, s56, v50
    v_mfma_f32_16x16x32_bf16 v[180:183], v[216:219], v[88:91], v[180:183]
    v_mul_f32 v51, s56, v51
    v_mul_f32 v52, s56, v52
    v_mfma_f32_16x16x32_bf16 v[180:183], v[220:223], v[92:95], v[180:183]
    v_mul_f32 v53, s56, v53
    v_mul_f32 v54, s56, v54
    v_mfma_f32_16x16x32_bf16 v[184:187], v[216:219], v[96:99], v[184:187]
    v_mul_f32 v55, s56, v55
    s_add_u32 s59, s58, 6144
    v_mfma_f32_16x16x32_bf16 v[184:187], v[220:223], v[100:103], v[184:187]
    v_cvt_pk_bf16_f32 v68, v48, v49
    v_cvt_pk_bf16_f32 v69, v50, v51
    v_mfma_f32_16x16x32_bf16 v[188:191], v[216:219], v[104:107], v[188:191]
    v_cvt_pk_bf16_f32 v70, v52, v53
    v_cvt_pk_bf16_f32 v71, v54, v55
    v_mfma_f32_16x16x32_bf16 v[188:191], v[220:223], v[108:111], v[188:191]
    buffer_store_dwordx4 v[68:71], v77, s[28:31], s59 offen sc1
    v_mfma_f32_16x16x32_bf16 v[192:195], v[216:219], v[112:115], v[192:195]
    v_mfma_f32_16x16x32_bf16 v[192:195], v[220:223], v[116:119], v[192:195]
    v_mfma_f32_16x16x32_bf16 v[196:199], v[216:219], v[120:123], v[196:199]
    v_mfma_f32_16x16x32_bf16 v[196:199], v[220:223], v[124:127], v[196:199]
    v_mfma_f32_16x16x32_bf16 v[200:203], v[216:219], v[128:131], v[200:203]
    v_mfma_f32_16x16x32_bf16 v[200:203], v[220:223], v[132:135], v[200:203]
    v_mfma_f32_16x16x32_bf16 v[204:207], v[216:219], v[136:139], v[204:207]
    v_mfma_f32_16x16x32_bf16 v[204:207], v[220:223], v[140:143], v[204:207]
    s_nop 4
    v_accvgpr_read_b32 v48, a64
    v_accvgpr_read_b32 v49, a65
    v_accvgpr_read_b32 v50, a66
    v_accvgpr_read_b32 v51, a67
    v_accvgpr_read_b32 v52, a96
    v_accvgpr_read_b32 v53, a97
    v_accvgpr_read_b32 v54, a98
    v_accvgpr_read_b32 v55, a99
    v_pk_mul_f32 v[48:49], v[48:49], s[56:57]
    v_pk_mul_f32 v[50:51], v[50:51], s[56:57]
    v_pk_mul_f32 v[52:53], v[52:53], s[56:57]
    v_pk_mul_f32 v[54:55], v[54:55], s[56:57]
    s_add_u32 s59, s58, 131072
    v_cvt_pk_bf16_f32 v56, v48, v49
    v_cvt_pk_bf16_f32 v57, v50, v51
    v_cvt_pk_bf16_f32 v58, v52, v53
    v_cvt_pk_bf16_f32 v59, v54, v55
    buffer_store_dwordx4 v[56:59], v76, s[28:31], s59 offen sc1
    v_accvgpr_read_b32 v48, a68
    v_accvgpr_read_b32 v49, a69
    v_accvgpr_read_b32 v50, a70
    v_accvgpr_read_b32 v51, a71
    v_accvgpr_read_b32 v52, a100
    v_accvgpr_read_b32 v53, a101
    v_accvgpr_read_b32 v54, a102
    v_accvgpr_read_b32 v55, a103
    v_pk_mul_f32 v[48:49], v[48:49], s[56:57]
    v_pk_mul_f32 v[50:51], v[50:51], s[56:57]
    v_pk_mul_f32 v[52:53], v[52:53], s[56:57]
    v_pk_mul_f32 v[54:55], v[54:55], s[56:57]
    s_add_u32 s59, s58, 131072
    v_cvt_pk_bf16_f32 v60, v48, v49
    v_cvt_pk_bf16_f32 v61, v50, v51
    v_cvt_pk_bf16_f32 v62, v52, v53
    v_cvt_pk_bf16_f32 v63, v54, v55
    buffer_store_dwordx4 v[60:63], v77, s[28:31], s59 offen sc1
    v_accvgpr_read_b32 v48, a72
    v_accvgpr_read_b32 v49, a73
    v_accvgpr_read_b32 v50, a74
    v_accvgpr_read_b32 v51, a75
    v_accvgpr_read_b32 v52, a104
    v_accvgpr_read_b32 v53, a105
    v_accvgpr_read_b32 v54, a106
    v_accvgpr_read_b32 v55, a107
    v_pk_mul_f32 v[48:49], v[48:49], s[56:57]
    v_pk_mul_f32 v[50:51], v[50:51], s[56:57]
    v_pk_mul_f32 v[52:53], v[52:53], s[56:57]
    v_pk_mul_f32 v[54:55], v[54:55], s[56:57]
    s_add_u32 s59, s58, 133120
    v_cvt_pk_bf16_f32 v64, v48, v49
    v_cvt_pk_bf16_f32 v65, v50, v51
    v_cvt_pk_bf16_f32 v66, v52, v53
    v_cvt_pk_bf16_f32 v67, v54, v55
    buffer_store_dwordx4 v[64:67], v76, s[28:31], s59 offen sc1
    v_accvgpr_read_b32 v48, a76
    v_accvgpr_read_b32 v49, a77
    v_accvgpr_read_b32 v50, a78
    v_accvgpr_read_b32 v51, a79
    v_accvgpr_read_b32 v52, a108
    v_accvgpr_read_b32 v53, a109
    v_accvgpr_read_b32 v54, a110
    v_accvgpr_read_b32 v55, a111
    v_pk_mul_f32 v[48:49], v[48:49], s[56:57]
    v_pk_mul_f32 v[50:51], v[50:51], s[56:57]
    v_pk_mul_f32 v[52:53], v[52:53], s[56:57]
    v_pk_mul_f32 v[54:55], v[54:55], s[56:57]
    s_add_u32 s59, s58, 133120
    v_cvt_pk_bf16_f32 v68, v48, v49
    v_cvt_pk_bf16_f32 v69, v50, v51
    v_cvt_pk_bf16_f32 v70, v52, v53
    v_cvt_pk_bf16_f32 v71, v54, v55
    buffer_store_dwordx4 v[68:71], v77, s[28:31], s59 offen sc1
    v_accvgpr_read_b32 v48, a80
    v_accvgpr_read_b32 v49, a81
    v_accvgpr_read_b32 v50, a82
    v_accvgpr_read_b32 v51, a83
    v_accvgpr_read_b32 v52, a112
    v_accvgpr_read_b32 v53, a113
    v_accvgpr_read_b32 v54, a114
    v_accvgpr_read_b32 v55, a115
    v_pk_mul_f32 v[48:49], v[48:49], s[56:57]
    v_pk_mul_f32 v[50:51], v[50:51], s[56:57]
    v_pk_mul_f32 v[52:53], v[52:53], s[56:57]
    v_pk_mul_f32 v[54:55], v[54:55], s[56:57]
    s_add_u32 s59, s58, 135168
    v_cvt_pk_bf16_f32 v56, v48, v49
    v_cvt_pk_bf16_f32 v57, v50, v51
    v_cvt_pk_bf16_f32 v58, v52, v53
    v_cvt_pk_bf16_f32 v59, v54, v55
    buffer_store_dwordx4 v[56:59], v76, s[28:31], s59 offen sc1
    v_accvgpr_read_b32 v48, a84
    v_accvgpr_read_b32 v49, a85
    v_accvgpr_read_b32 v50, a86
    v_accvgpr_read_b32 v51, a87
    v_accvgpr_read_b32 v52, a116
    v_accvgpr_read_b32 v53, a117
    v_accvgpr_read_b32 v54, a118
    v_accvgpr_read_b32 v55, a119
    v_pk_mul_f32 v[48:49], v[48:49], s[56:57]
    v_pk_mul_f32 v[50:51], v[50:51], s[56:57]
    v_pk_mul_f32 v[52:53], v[52:53], s[56:57]
    v_pk_mul_f32 v[54:55], v[54:55], s[56:57]
    s_add_u32 s59, s58, 135168
    v_cvt_pk_bf16_f32 v60, v48, v49
    v_cvt_pk_bf16_f32 v61, v50, v51
    v_cvt_pk_bf16_f32 v62, v52, v53
    v_cvt_pk_bf16_f32 v63, v54, v55
    buffer_store_dwordx4 v[60:63], v77, s[28:31], s59 offen sc1
    v_accvgpr_read_b32 v48, a88
    v_accvgpr_read_b32 v49, a89
    v_accvgpr_read_b32 v50, a90
    v_accvgpr_read_b32 v51, a91
    v_accvgpr_read_b32 v52, a120
    v_accvgpr_read_b32 v53, a121
    v_accvgpr_read_b32 v54, a122
    v_accvgpr_read_b32 v55, a123
    v_pk_mul_f32 v[48:49], v[48:49], s[56:57]
    v_pk_mul_f32 v[50:51], v[50:51], s[56:57]
    v_pk_mul_f32 v[52:53], v[52:53], s[56:57]
    v_pk_mul_f32 v[54:55], v[54:55], s[56:57]
    s_add_u32 s59, s58, 137216
    v_cvt_pk_bf16_f32 v64, v48, v49
    v_cvt_pk_bf16_f32 v65, v50, v51
    v_cvt_pk_bf16_f32 v66, v52, v53
    v_cvt_pk_bf16_f32 v67, v54, v55
    buffer_store_dwordx4 v[64:67], v76, s[28:31], s59 offen sc1
    v_accvgpr_read_b32 v48, a92
    v_accvgpr_read_b32 v49, a93
    v_accvgpr_read_b32 v50, a94
    v_accvgpr_read_b32 v51, a95
    v_accvgpr_read_b32 v52, a124
    v_accvgpr_read_b32 v53, a125
    v_accvgpr_read_b32 v54, a126
    v_accvgpr_read_b32 v55, a127
    v_pk_mul_f32 v[48:49], v[48:49], s[56:57]
    v_pk_mul_f32 v[50:51], v[50:51], s[56:57]
    v_pk_mul_f32 v[52:53], v[52:53], s[56:57]
    v_pk_mul_f32 v[54:55], v[54:55], s[56:57]
    s_add_u32 s59, s58, 137216
    v_cvt_pk_bf16_f32 v68, v48, v49
    v_cvt_pk_bf16_f32 v69, v50, v51
    v_cvt_pk_bf16_f32 v70, v52, v53
    v_cvt_pk_bf16_f32 v71, v54, v55
    buffer_store_dwordx4 v[68:71], v77, s[28:31], s59 offen sc1
    s_waitcnt vmcnt(16)
    v_mov_b32 v2, 0
    v_mov_b32 v3, 0
    v_dot2_f32_bf16 v2, v16, v32, v2
    v_dot2_f32_bf16 v3, v17, v33, v3
    v_dot2_f32_bf16 v2, v18, v34, v2
    v_dot2_f32_bf16 v3, v19, v35, v3
    v_dot2_f32_bf16 v2, v20, v36, v2
    v_dot2_f32_bf16 v3, v21, v37, v3
    v_dot2_f32_bf16 v2, v22, v38, v2
    v_dot2_f32_bf16 v3, v23, v39, v3
    v_dot2_f32_bf16 v2, v24, v40, v2
    v_dot2_f32_bf16 v3, v25, v41, v3
    v_dot2_f32_bf16 v2, v26, v42, v2
    v_dot2_f32_bf16 v3, v27, v43, v3
    v_dot2_f32_bf16 v2, v28, v44, v2
    v_dot2_f32_bf16 v3, v29, v45, v3
    v_dot2_f32_bf16 v2, v30, v46, v2
    v_dot2_f32_bf16 v3, v31, v47, v3
    v_and_b32 v4, 31, v1
    v_cmp_eq_u32 vcc, 31, v4
    v_lshrrev_b32 v4, 5, v1
    v_add_f32 v2, v2, v3
    v_lshlrev_b32 v4, 2, v4
    v_mov_b32 v3, 0x40000000
    v_add_f32_dpp v2, v2, v2 row_shr:1 row_mask:0xf bank_mask:0xf bound_ctrl:0
    s_nop 1
    v_add_f32_dpp v2, v2, v2 row_shr:2 row_mask:0xf bank_mask:0xf bound_ctrl:0
    s_nop 1
    v_add_f32_dpp v2, v2, v2 row_shr:4 row_mask:0xf bank_mask:0xf bound_ctrl:0
    s_nop 1
    v_add_f32_dpp v2, v2, v2 row_shr:8 row_mask:0xf bank_mask:0xf bound_ctrl:0
    s_nop 1
    v_add_f32_dpp v2, v2, v2 row_bcast:15 row_mask:0xa bank_mask:0xf
    v_mul_f32 v2, 0xbfb8aa3b, v2
    v_exp_f32 v2, v2
    v_cndmask_b32 v3, v3, v4, vcc
    v_add_f32 v2, 1.0, v2
    v_rcp_f32 v2, v2
    s_nop 0
    buffer_store_dword v2, v3, s[28:31], s60 offen sc1
    v_lshlrev_b32 v2, 4, v1
    s_lshr_b32 s20, s80, 2
    s_mul_i32 s20, s20, 4224
    s_add_u32 s20, s20, 34734080
    s_lshl_b32 s21, s81, 2
    s_add_u32 s21, s21, s20
    v_mov_b32 v11, s21
    v_and_b32 v3, 7, v1
    v_lshlrev_b32 v3, 2, v3
    s_lshr_b32 s21, s80, 1
    s_mul_i32 s21, s21, 4224
    s_add_u32 s21, s21, 34801664
    v_add_u32 v4, s21, v3
    v_cmp_gt_u32 vcc, 16, v1
    s_add_u32 s20, s20, 33792
    v_add_u32 v3, s20, v3
    v_cndmask_b32 v11, v11, v4, vcc
    v_cmp_gt_u32 vcc, 8, v1
    s_mov_b32 s35, 0x100000
    v_mov_b32 v32, v2
    v_cndmask_b32 v11, v11, v3, vcc
    v_and_b32 v3, 31, v1
    v_lshlrev_b32 v248, 2, v3
    v_and_b32 v4, 15, v1
    v_lshrrev_b32 v5, 4, v1
    v_lshlrev_b32 v6, 4, v4
    v_lshl_add_u32 v6, v5, 9, v6
    v_lshlrev_b32 v7, 2, v4
    s_add_u32 s21, s36, 0
    s_and_b32 s21, s21, 3
    s_mul_i32 s20, s21, 294912
    v_add_u32 v16, s20, v6
    s_lshl_b32 s21, s21, 7
    v_add_u32 v249, s21, v7
    s_add_u32 s21, s36, 1
    s_and_b32 s21, s21, 3
    s_mul_i32 s20, s21, 294912
    v_add_u32 v17, s20, v6
    s_lshl_b32 s21, s21, 7
    v_add_u32 v250, s21, v7
    s_add_u32 s21, s36, 2
    s_and_b32 s21, s21, 3
    s_mul_i32 s20, s21, 294912
    v_add_u32 v18, s20, v6
    s_lshl_b32 s21, s21, 7
    v_add_u32 v251, s21, v7
    s_add_u32 s21, s36, 3
    s_and_b32 s21, s21, 3
    s_mul_i32 s20, s21, 294912
    v_add_u32 v19, s20, v6
    s_lshl_b32 s21, s21, 7
    v_add_u32 v252, s21, v7
    v_lshrrev_b32 v7, 3, v1
    v_and_b32 v8, 1, v5
    v_lshlrev_b32 v3, 1, v8
    v_and_b32 v6, 7, v1
    v_xor_b32 v3, v3, v6
    v_lshlrev_b32 v3, 4, v3
    v_lshl_add_u32 v20, v7, 11, v3
    v_xor_b32 v21, 64, v20
    v_add_u32 v22, 30720, v20
    v_add_u32 v23, 46080, v21
    v_add_u32 v21, 15360, v21
    v_lshrrev_b32 v3, 2, v4
    v_lshl_add_u32 v3, v5, 3, v3
    v_and_b32 v6, 3, v4
    v_lshlrev_b32 v6, 3, v6
    v_lshl_add_u32 v3, v3, 7, v6
    v_lshrrev_b32 v6, 3, v4
    v_lshl_or_b32 v6, v8, 1, v6
    v_xor_b32 v7, 0, v6
    v_lshl_add_u32 v7, v7, 5, v3
    v_add_u32 v24, s15, v7
    v_add_u32 v28, s40, v7
    v_add_u32 v36, s4, v7
    v_xor_b32 v7, 1, v6
    v_lshl_add_u32 v7, v7, 5, v3
    v_add_u32 v25, s15, v7
    v_add_u32 v29, s40, v7
    v_add_u32 v37, s4, v7
    v_xor_b32 v7, 2, v6
    v_lshl_add_u32 v7, v7, 5, v3
    v_add_u32 v26, s15, v7
    v_add_u32 v30, s40, v7
    v_add_u32 v38, s4, v7
    v_xor_b32 v7, 3, v6
    v_lshl_add_u32 v7, v7, 5, v3
    v_add_u32 v27, s15, v7
    v_add_u32 v31, s40, v7
    v_add_u32 v39, s4, v7
    v_lshlrev_b32 v6, 5, v8
    v_lshrrev_b32 v7, 1, v5
    v_lshl_add_u32 v6, v7, 4, v6
    v_lshl_add_u32 v33, v4, 11, v6
    v_lshrrev_b32 v4, 2, v1
    v_xor_b32 v4, v4, v1
    v_and_b32 v4, 4, v4
    v_cmp_eq_u32 vcc, 0, v4
    v_mov_b32 v5, 0x3f803f80
    s_lshr_b32 s19, s83, 1
    v_cndmask_b32 v13, 0, v5, vcc
    s_mul_i32 s19, s19, 4224
    s_mul_i32 s20, s81, 4224
    v_cmp_gt_u32 vcc, 32, v1
    v_add_u32 v3, s19, v248
    v_add_u32 v4, s20, v248
    v_cndmask_b32 v3, v4, v3, vcc
    v_add_u32 v253, 34668544, v3
    v_pk_mul_f32 v[96:97], v[144:145], v[144:145]
    v_pk_mul_f32 v[98:99], v[146:147], v[146:147]
    v_pk_mul_f32 v[100:101], v[148:149], v[148:149]
    v_pk_mul_f32 v[102:103], v[150:151], v[150:151]
    v_pk_fma_f32 v[96:97], v[96:97], s[54:55], v[72:73]
    v_pk_fma_f32 v[98:99], v[98:99], s[54:55], v[72:73]
    v_pk_fma_f32 v[100:101], v[100:101], s[54:55], v[72:73]
    v_pk_fma_f32 v[102:103], v[102:103], s[54:55], v[72:73]
    v_pk_mul_f32 v[96:97], v[96:97], v[144:145]
    v_pk_mul_f32 v[98:99], v[98:99], v[146:147]
    v_pk_mul_f32 v[100:101], v[100:101], v[148:149]
    v_pk_mul_f32 v[102:103], v[102:103], v[150:151]
    v_exp_f32 v96, v96
    v_exp_f32 v97, v97
    v_exp_f32 v98, v98
    v_exp_f32 v99, v99
    v_exp_f32 v100, v100
    v_exp_f32 v101, v101
    v_exp_f32 v102, v102
    v_exp_f32 v103, v103
    v_pk_add_f32 v[96:97], v[96:97], v[74:75]
    v_pk_add_f32 v[98:99], v[98:99], v[74:75]
    v_pk_add_f32 v[100:101], v[100:101], v[74:75]
    v_pk_add_f32 v[102:103], v[102:103], v[74:75]
    v_rcp_f32 v96, v96
    v_rcp_f32 v97, v97
    v_rcp_f32 v98, v98
    v_rcp_f32 v99, v99
    v_rcp_f32 v100, v100
    v_rcp_f32 v101, v101
    v_rcp_f32 v102, v102
    v_rcp_f32 v103, v103
    v_pk_mul_f32 v[104:105], v[144:145], v[176:177]
    v_pk_mul_f32 v[106:107], v[146:147], v[178:179]
    v_pk_mul_f32 v[108:109], v[148:149], v[180:181]
    v_pk_mul_f32 v[110:111], v[150:151], v[182:183]
    v_pk_mul_f32 v[96:97], v[96:97], v[104:105]
    v_pk_mul_f32 v[98:99], v[98:99], v[106:107]
    v_pk_mul_f32 v[100:101], v[100:101], v[108:109]
    v_pk_mul_f32 v[102:103], v[102:103], v[110:111]
    v_cvt_pk_bf16_f32 v112, v96, v97
    v_cvt_pk_bf16_f32 v113, v98, v99
    v_cvt_pk_bf16_f32 v114, v100, v101
    v_cvt_pk_bf16_f32 v115, v102, v103
    v_pk_mul_f32 v[96:97], v[152:153], v[152:153]
    v_pk_mul_f32 v[98:99], v[154:155], v[154:155]
    v_permlane16_swap_b32 v112, v114
    v_permlane16_swap_b32 v113, v115
    v_pk_mul_f32 v[100:101], v[156:157], v[156:157]
    v_pk_mul_f32 v[102:103], v[158:159], v[158:159]
    v_pk_fma_f32 v[96:97], v[96:97], s[54:55], v[72:73]
    v_pk_fma_f32 v[98:99], v[98:99], s[54:55], v[72:73]
    v_pk_fma_f32 v[100:101], v[100:101], s[54:55], v[72:73]
    v_pk_fma_f32 v[102:103], v[102:103], s[54:55], v[72:73]
    v_pk_mul_f32 v[96:97], v[96:97], v[152:153]
    v_pk_mul_f32 v[98:99], v[98:99], v[154:155]
    v_pk_mul_f32 v[100:101], v[100:101], v[156:157]
    v_pk_mul_f32 v[102:103], v[102:103], v[158:159]
    v_exp_f32 v96, v96
    v_exp_f32 v97, v97
    v_exp_f32 v98, v98
    v_exp_f32 v99, v99
    v_exp_f32 v100, v100
    v_exp_f32 v101, v101
    v_exp_f32 v102, v102
    v_exp_f32 v103, v103
    v_pk_add_f32 v[96:97], v[96:97], v[74:75]
    v_pk_add_f32 v[98:99], v[98:99], v[74:75]
    v_pk_add_f32 v[100:101], v[100:101], v[74:75]
    v_pk_add_f32 v[102:103], v[102:103], v[74:75]
    v_rcp_f32 v96, v96
    v_rcp_f32 v97, v97
    v_rcp_f32 v98, v98
    v_rcp_f32 v99, v99
    v_rcp_f32 v100, v100
    v_rcp_f32 v101, v101
    v_rcp_f32 v102, v102
    v_rcp_f32 v103, v103
    v_pk_mul_f32 v[104:105], v[152:153], v[184:185]
    v_pk_mul_f32 v[106:107], v[154:155], v[186:187]
    v_pk_mul_f32 v[108:109], v[156:157], v[188:189]
    v_pk_mul_f32 v[110:111], v[158:159], v[190:191]
    v_pk_mul_f32 v[96:97], v[96:97], v[104:105]
    v_pk_mul_f32 v[98:99], v[98:99], v[106:107]
    v_pk_mul_f32 v[100:101], v[100:101], v[108:109]
    v_pk_mul_f32 v[102:103], v[102:103], v[110:111]
    v_cvt_pk_bf16_f32 v116, v96, v97
    v_cvt_pk_bf16_f32 v117, v98, v99
    v_cvt_pk_bf16_f32 v118, v100, v101
    v_cvt_pk_bf16_f32 v119, v102, v103
    s_nop 1
    v_permlane16_swap_b32 v116, v118
    v_permlane16_swap_b32 v117, v119
    s_waitcnt vmcnt(1)
    s_barrier
    s_cmp_eq_u32 s36, 0
    s_cbranch_scc0 p1A_f1
    v_mov_b32 v9, 0
    v_mov_b32 v10, 1
    s_mov_b64 exec, 1
    buffer_store_dword v10, v9, s[28:31], s84 offen sc1
    s_mov_b64 exec, -1
p1A_f1:
    buffer_store_dwordx4 v[112:115], v0, s[28:31], s90 offen offset:2048 sc1
    buffer_store_dwordx4 v[116:119], v0, s[28:31], s91 offen offset:2048 sc1
    v_pk_mul_f32 v[96:97], v[160:161], v[160:161]
    v_pk_mul_f32 v[98:99], v[162:163], v[162:163]
    v_pk_mul_f32 v[100:101], v[164:165], v[164:165]
    v_pk_mul_f32 v[102:103], v[166:167], v[166:167]
    v_pk_fma_f32 v[96:97], v[96:97], s[54:55], v[72:73]
    v_pk_fma_f32 v[98:99], v[98:99], s[54:55], v[72:73]
    v_pk_fma_f32 v[100:101], v[100:101], s[54:55], v[72:73]
    v_pk_fma_f32 v[102:103], v[102:103], s[54:55], v[72:73]
    v_pk_mul_f32 v[96:97], v[96:97], v[160:161]
    v_pk_mul_f32 v[98:99], v[98:99], v[162:163]
    v_pk_mul_f32 v[100:101], v[100:101], v[164:165]
    v_pk_mul_f32 v[102:103], v[102:103], v[166:167]
    v_exp_f32 v96, v96
    v_exp_f32 v97, v97
    v_exp_f32 v98, v98
    v_exp_f32 v99, v99
    v_exp_f32 v100, v100
    v_exp_f32 v101, v101
    v_exp_f32 v102, v102
    v_exp_f32 v103, v103
    v_pk_add_f32 v[96:97], v[96:97], v[74:75]
    v_pk_add_f32 v[98:99], v[98:99], v[74:75]
    v_pk_add_f32 v[100:101], v[100:101], v[74:75]
    v_pk_add_f32 v[102:103], v[102:103], v[74:75]
    v_rcp_f32 v96, v96
    v_rcp_f32 v97, v97
    v_rcp_f32 v98, v98
    v_rcp_f32 v99, v99
    v_rcp_f32 v100, v100
    v_rcp_f32 v101, v101
    v_rcp_f32 v102, v102
    v_rcp_f32 v103, v103
    v_pk_mul_f32 v[104:105], v[160:161], v[192:193]
    v_pk_mul_f32 v[106:107], v[162:163], v[194:195]
    v_pk_mul_f32 v[108:109], v[164:165], v[196:197]
    v_pk_mul_f32 v[110:111], v[166:167], v[198:199]
    v_pk_mul_f32 v[96:97], v[96:97], v[104:105]
    v_pk_mul_f32 v[98:99], v[98:99], v[106:107]
    v_pk_mul_f32 v[100:101], v[100:101], v[108:109]
    v_pk_mul_f32 v[102:103], v[102:103], v[110:111]
    v_cvt_pk_bf16_f32 v120, v96, v97
    v_cvt_pk_bf16_f32 v121, v98, v99
    v_cvt_pk_bf16_f32 v122, v100, v101
    v_cvt_pk_bf16_f32 v123, v102, v103
    v_pk_mul_f32 v[96:97], v[168:169], v[168:169]
    v_pk_mul_f32 v[98:99], v[170:171], v[170:171]
    v_permlane16_swap_b32 v120, v122
    v_permlane16_swap_b32 v121, v123
    v_pk_mul_f32 v[100:101], v[172:173], v[172:173]
    v_pk_mul_f32 v[102:103], v[174:175], v[174:175]
    v_pk_fma_f32 v[96:97], v[96:97], s[54:55], v[72:73]
    v_pk_fma_f32 v[98:99], v[98:99], s[54:55], v[72:73]
    v_pk_fma_f32 v[100:101], v[100:101], s[54:55], v[72:73]
    v_pk_fma_f32 v[102:103], v[102:103], s[54:55], v[72:73]
    v_pk_mul_f32 v[96:97], v[96:97], v[168:169]
    v_pk_mul_f32 v[98:99], v[98:99], v[170:171]
    v_pk_mul_f32 v[100:101], v[100:101], v[172:173]
    v_pk_mul_f32 v[102:103], v[102:103], v[174:175]
    v_exp_f32 v96, v96
    v_exp_f32 v97, v97
    v_exp_f32 v98, v98
    v_exp_f32 v99, v99
    v_exp_f32 v100, v100
    v_exp_f32 v101, v101
    v_exp_f32 v102, v102
    v_exp_f32 v103, v103
    v_pk_add_f32 v[96:97], v[96:97], v[74:75]
    v_pk_add_f32 v[98:99], v[98:99], v[74:75]
    v_pk_add_f32 v[100:101], v[100:101], v[74:75]
    v_pk_add_f32 v[102:103], v[102:103], v[74:75]
    v_rcp_f32 v96, v96
    v_rcp_f32 v97, v97
    v_rcp_f32 v98, v98
    v_rcp_f32 v99, v99
    v_rcp_f32 v100, v100
    v_rcp_f32 v101, v101
    v_rcp_f32 v102, v102
    v_rcp_f32 v103, v103
    v_pk_mul_f32 v[104:105], v[168:169], v[200:201]
    v_pk_mul_f32 v[106:107], v[170:171], v[202:203]
    v_pk_mul_f32 v[108:109], v[172:173], v[204:205]
    v_pk_mul_f32 v[110:111], v[174:175], v[206:207]
    v_pk_mul_f32 v[96:97], v[96:97], v[104:105]
    v_pk_mul_f32 v[98:99], v[98:99], v[106:107]
    v_pk_mul_f32 v[100:101], v[100:101], v[108:109]
    v_pk_mul_f32 v[102:103], v[102:103], v[110:111]
    v_cvt_pk_bf16_f32 v124, v96, v97
    v_cvt_pk_bf16_f32 v125, v98, v99
    v_cvt_pk_bf16_f32 v126, v100, v101
    v_cvt_pk_bf16_f32 v127, v102, v103
    buffer_store_dwordx4 v[120:123], v0, s[28:31], s92 offen offset:2048 sc1
    v_accvgpr_read_b32 v80, a128
    v_accvgpr_read_b32 v81, a129
    v_permlane16_swap_b32 v124, v126
    v_permlane16_swap_b32 v125, v127
    v_accvgpr_read_b32 v82, a130
    v_accvgpr_read_b32 v83, a131
    v_accvgpr_read_b32 v84, a132
    v_accvgpr_read_b32 v85, a133
    v_accvgpr_read_b32 v86, a134
    v_accvgpr_read_b32 v87, a135
    v_accvgpr_read_b32 v88, a160
    v_accvgpr_read_b32 v89, a161
    v_accvgpr_read_b32 v90, a162
    v_accvgpr_read_b32 v91, a163
    v_accvgpr_read_b32 v92, a164
    v_accvgpr_read_b32 v93, a165
    v_accvgpr_read_b32 v94, a166
    v_accvgpr_read_b32 v95, a167
    v_pk_mul_f32 v[96:97], v[80:81], v[80:81]
    v_pk_mul_f32 v[98:99], v[82:83], v[82:83]
    v_pk_mul_f32 v[100:101], v[84:85], v[84:85]
    v_pk_mul_f32 v[102:103], v[86:87], v[86:87]
    v_pk_fma_f32 v[96:97], v[96:97], s[54:55], v[72:73]
    v_pk_fma_f32 v[98:99], v[98:99], s[54:55], v[72:73]
    v_pk_fma_f32 v[100:101], v[100:101], s[54:55], v[72:73]
    v_pk_fma_f32 v[102:103], v[102:103], s[54:55], v[72:73]
    v_pk_mul_f32 v[96:97], v[96:97], v[80:81]
    v_pk_mul_f32 v[98:99], v[98:99], v[82:83]
    v_pk_mul_f32 v[100:101], v[100:101], v[84:85]
    v_pk_mul_f32 v[102:103], v[102:103], v[86:87]
    v_exp_f32 v96, v96
    v_exp_f32 v97, v97
    v_exp_f32 v98, v98
    v_exp_f32 v99, v99
    v_exp_f32 v100, v100
    v_exp_f32 v101, v101
    v_exp_f32 v102, v102
    v_exp_f32 v103, v103
    v_pk_add_f32 v[96:97], v[96:97], v[74:75]
    v_pk_add_f32 v[98:99], v[98:99], v[74:75]
    v_pk_add_f32 v[100:101], v[100:101], v[74:75]
    v_pk_add_f32 v[102:103], v[102:103], v[74:75]
    v_rcp_f32 v96, v96
    v_rcp_f32 v97, v97
    v_rcp_f32 v98, v98
    v_rcp_f32 v99, v99
    v_rcp_f32 v100, v100
    v_rcp_f32 v101, v101
    v_rcp_f32 v102, v102
    v_rcp_f32 v103, v103
    v_pk_mul_f32 v[104:105], v[80:81], v[88:89]
    v_pk_mul_f32 v[106:107], v[82:83], v[90:91]
    v_pk_mul_f32 v[108:109], v[84:85], v[92:93]
    v_pk_mul_f32 v[110:111], v[86:87], v[94:95]
    v_pk_mul_f32 v[96:97], v[96:97], v[104:105]
    v_pk_mul_f32 v[98:99], v[98:99], v[106:107]
    v_pk_mul_f32 v[100:101], v[100:101], v[108:109]
    v_pk_mul_f32 v[102:103], v[102:103], v[110:111]
    v_cvt_pk_bf16_f32 v144, v96, v97
    v_cvt_pk_bf16_f32 v145, v98, v99
    v_cvt_pk_bf16_f32 v146, v100, v101
    v_cvt_pk_bf16_f32 v147, v102, v103
    buffer_store_dwordx4 v[124:127], v0, s[28:31], s93 offen offset:2048 sc1
    v_accvgpr_read_b32 v80, a136
    v_accvgpr_read_b32 v81, a137
    v_permlane16_swap_b32 v144, v146
    v_permlane16_swap_b32 v145, v147
    v_accvgpr_read_b32 v82, a138
    v_accvgpr_read_b32 v83, a139
    v_accvgpr_read_b32 v84, a140
    v_accvgpr_read_b32 v85, a141
    v_accvgpr_read_b32 v86, a142
    v_accvgpr_read_b32 v87, a143
    v_accvgpr_read_b32 v88, a168
    v_accvgpr_read_b32 v89, a169
    v_accvgpr_read_b32 v90, a170
    v_accvgpr_read_b32 v91, a171
    v_accvgpr_read_b32 v92, a172
    v_accvgpr_read_b32 v93, a173
    v_accvgpr_read_b32 v94, a174
    v_accvgpr_read_b32 v95, a175
    v_pk_mul_f32 v[96:97], v[80:81], v[80:81]
    v_pk_mul_f32 v[98:99], v[82:83], v[82:83]
    v_pk_mul_f32 v[100:101], v[84:85], v[84:85]
    v_pk_mul_f32 v[102:103], v[86:87], v[86:87]
    v_pk_fma_f32 v[96:97], v[96:97], s[54:55], v[72:73]
    v_pk_fma_f32 v[98:99], v[98:99], s[54:55], v[72:73]
    v_pk_fma_f32 v[100:101], v[100:101], s[54:55], v[72:73]
    v_pk_fma_f32 v[102:103], v[102:103], s[54:55], v[72:73]
    v_pk_mul_f32 v[96:97], v[96:97], v[80:81]
    v_pk_mul_f32 v[98:99], v[98:99], v[82:83]
    v_pk_mul_f32 v[100:101], v[100:101], v[84:85]
    v_pk_mul_f32 v[102:103], v[102:103], v[86:87]
    v_exp_f32 v96, v96
    v_exp_f32 v97, v97
    v_exp_f32 v98, v98
    v_exp_f32 v99, v99
    v_exp_f32 v100, v100
    v_exp_f32 v101, v101
    v_exp_f32 v102, v102
    v_exp_f32 v103, v103
    v_pk_add_f32 v[96:97], v[96:97], v[74:75]
    v_pk_add_f32 v[98:99], v[98:99], v[74:75]
    v_pk_add_f32 v[100:101], v[100:101], v[74:75]
    v_pk_add_f32 v[102:103], v[102:103], v[74:75]
    v_rcp_f32 v96, v96
    v_rcp_f32 v97, v97
    v_rcp_f32 v98, v98
    v_rcp_f32 v99, v99
    v_rcp_f32 v100, v100
    v_rcp_f32 v101, v101
    v_rcp_f32 v102, v102
    v_rcp_f32 v103, v103
    v_pk_mul_f32 v[104:105], v[80:81], v[88:89]
    v_pk_mul_f32 v[106:107], v[82:83], v[90:91]
    v_pk_mul_f32 v[108:109], v[84:85], v[92:93]
    v_pk_mul_f32 v[110:111], v[86:87], v[94:95]
    v_pk_mul_f32 v[96:97], v[96:97], v[104:105]
    v_pk_mul_f32 v[98:99], v[98:99], v[106:107]
    v_pk_mul_f32 v[100:101], v[100:101], v[108:109]
    v_pk_mul_f32 v[102:103], v[102:103], v[110:111]
    v_cvt_pk_bf16_f32 v148, v96, v97
    v_cvt_pk_bf16_f32 v149, v98, v99
    v_cvt_pk_bf16_f32 v150, v100, v101
    v_cvt_pk_bf16_f32 v151, v102, v103
    buffer_store_dwordx4 v[144:147], v0, s[28:31], s90 offen offset:0 sc1
    v_accvgpr_read_b32 v80, a144
    v_accvgpr_read_b32 v81, a145
    v_permlane16_swap_b32 v148, v150
    v_permlane16_swap_b32 v149, v151
    v_accvgpr_read_b32 v82, a146
    v_accvgpr_read_b32 v83, a147
    v_accvgpr_read_b32 v84, a148
    v_accvgpr_read_b32 v85, a149
    v_accvgpr_read_b32 v86, a150
    v_accvgpr_read_b32 v87, a151
    v_accvgpr_read_b32 v88, a176
    v_accvgpr_read_b32 v89, a177
    v_accvgpr_read_b32 v90, a178
    v_accvgpr_read_b32 v91, a179
    v_accvgpr_read_b32 v92, a180
    v_accvgpr_read_b32 v93, a181
    v_accvgpr_read_b32 v94, a182
    v_accvgpr_read_b32 v95, a183
    v_pk_mul_f32 v[96:97], v[80:81], v[80:81]
    v_pk_mul_f32 v[98:99], v[82:83], v[82:83]
    v_pk_mul_f32 v[100:101], v[84:85], v[84:85]
    v_pk_mul_f32 v[102:103], v[86:87], v[86:87]
    v_pk_fma_f32 v[96:97], v[96:97], s[54:55], v[72:73]
    v_pk_fma_f32 v[98:99], v[98:99], s[54:55], v[72:73]
    v_pk_fma_f32 v[100:101], v[100:101], s[54:55], v[72:73]
    v_pk_fma_f32 v[102:103], v[102:103], s[54:55], v[72:73]
    v_pk_mul_f32 v[96:97], v[96:97], v[80:81]
    v_pk_mul_f32 v[98:99], v[98:99], v[82:83]
    v_pk_mul_f32 v[100:101], v[100:101], v[84:85]
    v_pk_mul_f32 v[102:103], v[102:103], v[86:87]
    v_exp_f32 v96, v96
    v_exp_f32 v97, v97
    v_exp_f32 v98, v98
    v_exp_f32 v99, v99
    v_exp_f32 v100, v100
    v_exp_f32 v101, v101
    v_exp_f32 v102, v102
    v_exp_f32 v103, v103
    v_pk_add_f32 v[96:97], v[96:97], v[74:75]
    v_pk_add_f32 v[98:99], v[98:99], v[74:75]
    v_pk_add_f32 v[100:101], v[100:101], v[74:75]
    v_pk_add_f32 v[102:103], v[102:103], v[74:75]
    v_rcp_f32 v96, v96
    v_rcp_f32 v97, v97
    v_rcp_f32 v98, v98
    v_rcp_f32 v99, v99
    v_rcp_f32 v100, v100
    v_rcp_f32 v101, v101
    v_rcp_f32 v102, v102
    v_rcp_f32 v103, v103
    v_pk_mul_f32 v[104:105], v[80:81], v[88:89]
    v_pk_mul_f32 v[106:107], v[82:83], v[90:91]
    v_pk_mul_f32 v[108:109], v[84:85], v[92:93]
    v_pk_mul_f32 v[110:111], v[86:87], v[94:95]
    v_pk_mul_f32 v[96:97], v[96:97], v[104:105]
    v_pk_mul_f32 v[98:99], v[98:99], v[106:107]
    v_pk_mul_f32 v[100:101], v[100:101], v[108:109]
    v_pk_mul_f32 v[102:103], v[102:103], v[110:111]
    v_cvt_pk_bf16_f32 v152, v96, v97
    v_cvt_pk_bf16_f32 v153, v98, v99
    v_cvt_pk_bf16_f32 v154, v100, v101
    v_cvt_pk_bf16_f32 v155, v102, v103
    buffer_store_dwordx4 v[148:151], v0, s[28:31], s91 offen offset:0 sc1
    v_accvgpr_read_b32 v80, a152
    v_accvgpr_read_b32 v81, a153
    v_permlane16_swap_b32 v152, v154
    v_permlane16_swap_b32 v153, v155
    v_accvgpr_read_b32 v82, a154
    v_accvgpr_read_b32 v83, a155
    v_accvgpr_read_b32 v84, a156
    v_accvgpr_read_b32 v85, a157
    v_accvgpr_read_b32 v86, a158
    v_accvgpr_read_b32 v87, a159
    v_accvgpr_read_b32 v88, a184
    v_accvgpr_read_b32 v89, a185
    v_accvgpr_read_b32 v90, a186
    v_accvgpr_read_b32 v91, a187
    v_accvgpr_read_b32 v92, a188
    v_accvgpr_read_b32 v93, a189
    v_accvgpr_read_b32 v94, a190
    v_accvgpr_read_b32 v95, a191
    v_pk_mul_f32 v[96:97], v[80:81], v[80:81]
    v_pk_mul_f32 v[98:99], v[82:83], v[82:83]
    v_pk_mul_f32 v[100:101], v[84:85], v[84:85]
    v_pk_mul_f32 v[102:103], v[86:87], v[86:87]
    v_pk_fma_f32 v[96:97], v[96:97], s[54:55], v[72:73]
    v_pk_fma_f32 v[98:99], v[98:99], s[54:55], v[72:73]
    v_pk_fma_f32 v[100:101], v[100:101], s[54:55], v[72:73]
    v_pk_fma_f32 v[102:103], v[102:103], s[54:55], v[72:73]
    v_pk_mul_f32 v[96:97], v[96:97], v[80:81]
    v_pk_mul_f32 v[98:99], v[98:99], v[82:83]
    v_pk_mul_f32 v[100:101], v[100:101], v[84:85]
    v_pk_mul_f32 v[102:103], v[102:103], v[86:87]
    v_exp_f32 v96, v96
    v_exp_f32 v97, v97
    v_exp_f32 v98, v98
    v_exp_f32 v99, v99
    v_exp_f32 v100, v100
    v_exp_f32 v101, v101
    v_exp_f32 v102, v102
    v_exp_f32 v103, v103
    v_pk_add_f32 v[96:97], v[96:97], v[74:75]
    v_pk_add_f32 v[98:99], v[98:99], v[74:75]
    v_pk_add_f32 v[100:101], v[100:101], v[74:75]
    v_pk_add_f32 v[102:103], v[102:103], v[74:75]
    v_rcp_f32 v96, v96
    v_rcp_f32 v97, v97
    v_rcp_f32 v98, v98
    v_rcp_f32 v99, v99
    v_rcp_f32 v100, v100
    v_rcp_f32 v101, v101
    v_rcp_f32 v102, v102
    v_rcp_f32 v103, v103
    v_pk_mul_f32 v[104:105], v[80:81], v[88:89]
    v_pk_mul_f32 v[106:107], v[82:83], v[90:91]
    v_pk_mul_f32 v[108:109], v[84:85], v[92:93]
    v_pk_mul_f32 v[110:111], v[86:87], v[94:95]
    v_pk_mul_f32 v[96:97], v[96:97], v[104:105]
    v_pk_mul_f32 v[98:99], v[98:99], v[106:107]
    v_pk_mul_f32 v[100:101], v[100:101], v[108:109]
    v_pk_mul_f32 v[102:103], v[102:103], v[110:111]
    v_cvt_pk_bf16_f32 v156, v96, v97
    v_cvt_pk_bf16_f32 v157, v98, v99
    v_cvt_pk_bf16_f32 v158, v100, v101
    v_cvt_pk_bf16_f32 v159, v102, v103
    s_nop 1
    v_permlane16_swap_b32 v156, v158
    v_permlane16_swap_b32 v157, v159
    s_mov_b32 s50, 0x100000
p1A_cnt:
    v_cmp_gt_u32 vcc, 0x100, v14
    s_sub_u32 s50, s50, 1
    s_cbranch_scc1 p1A_cntok
    s_nop 2
    s_cbranch_vccz p1A_cntok
    buffer_load_dword v14, v15, s[76:79], 0 offen sc1
    s_waitcnt vmcnt(0)
    s_branch p1A_cnt
p1A_cntok:
    buffer_load_dword v12, v11, s[28:31], 0 offen sc1
    v_accvgpr_read_b32 v80, a192
    v_accvgpr_read_b32 v81, a193
    v_accvgpr_read_b32 v82, a194
    v_accvgpr_read_b32 v83, a195
    v_accvgpr_read_b32 v84, a196
    v_accvgpr_read_b32 v85, a197
    v_accvgpr_read_b32 v86, a198
    v_accvgpr_read_b32 v87, a199
    v_accvgpr_read_b32 v88, a224
    v_accvgpr_read_b32 v89, a225
    v_accvgpr_read_b32 v90, a226
    v_accvgpr_read_b32 v91, a227
    v_accvgpr_read_b32 v92, a228
    v_accvgpr_read_b32 v93, a229
    v_accvgpr_read_b32 v94, a230
    v_accvgpr_read_b32 v95, a231
    v_pk_mul_f32 v[96:97], v[80:81], v[80:81]
    v_pk_mul_f32 v[98:99], v[82:83], v[82:83]
    v_pk_mul_f32 v[100:101], v[84:85], v[84:85]
    v_pk_mul_f32 v[102:103], v[86:87], v[86:87]
    v_pk_fma_f32 v[96:97], v[96:97], s[54:55], v[72:73]
    v_pk_fma_f32 v[98:99], v[98:99], s[54:55], v[72:73]
    v_pk_fma_f32 v[100:101], v[100:101], s[54:55], v[72:73]
    v_pk_fma_f32 v[102:103], v[102:103], s[54:55], v[72:73]
    v_pk_mul_f32 v[96:97], v[96:97], v[80:81]
    v_pk_mul_f32 v[98:99], v[98:99], v[82:83]
    v_pk_mul_f32 v[100:101], v[100:101], v[84:85]
    v_pk_mul_f32 v[102:103], v[102:103], v[86:87]
    v_exp_f32 v96, v96
    v_exp_f32 v97, v97
    v_exp_f32 v98, v98
    v_exp_f32 v99, v99
    v_exp_f32 v100, v100
    v_exp_f32 v101, v101
    v_exp_f32 v102, v102
    v_exp_f32 v103, v103
    v_pk_add_f32 v[96:97], v[96:97], v[74:75]
    v_pk_add_f32 v[98:99], v[98:99], v[74:75]
    v_pk_add_f32 v[100:101], v[100:101], v[74:75]
    v_pk_add_f32 v[102:103], v[102:103], v[74:75]
    v_rcp_f32 v96, v96
    v_rcp_f32 v97, v97
    v_rcp_f32 v98, v98
    v_rcp_f32 v99, v99
    v_rcp_f32 v100, v100
    v_rcp_f32 v101, v101
    v_rcp_f32 v102, v102
    v_rcp_f32 v103, v103
    v_pk_mul_f32 v[104:105], v[80:81], v[88:89]
    v_pk_mul_f32 v[106:107], v[82:83], v[90:91]
    v_pk_mul_f32 v[108:109], v[84:85], v[92:93]
    v_pk_mul_f32 v[110:111], v[86:87], v[94:95]
    v_pk_mul_f32 v[96:97], v[96:97], v[104:105]
    v_pk_mul_f32 v[98:99], v[98:99], v[106:107]
    v_pk_mul_f32 v[100:101], v[100:101], v[108:109]
    v_pk_mul_f32 v[102:103], v[102:103], v[110:111]
    v_cvt_pk_bf16_f32 v160, v96, v97
    v_cvt_pk_bf16_f32 v161, v98, v99
    v_cvt_pk_bf16_f32 v162, v100, v101
    v_cvt_pk_bf16_f32 v163, v102, v103
    s_nop 1
    v_permlane16_swap_b32 v160, v162
    v_permlane16_swap_b32 v161, v163
    s_waitcnt vmcnt(0)
    v_cmp_ne_u32 vcc, 1, v12
    s_sub_u32 s23, s9, 16384
    s_sub_u32 s24, s10, 16384
    s_cmp_eq_u64 vcc, 0
    s_cselect_b32 s89, 1, 0
    s_cselect_b32 s22, s88, 0x40000000
    s_cselect_b32 s23, s23, 0x40000000
    s_cselect_b32 s24, s24, 0x40000000
    v_accvgpr_read_b32 v80, a200
    v_accvgpr_read_b32 v81, a201
    v_accvgpr_read_b32 v82, a202
    v_accvgpr_read_b32 v83, a203
    buffer_load_dwordx4 a[0:3], v2, s[28:31], s22 offen offset:0 sc1
    v_accvgpr_read_b32 v84, a204
    v_accvgpr_read_b32 v85, a205
    v_accvgpr_read_b32 v86, a206
    v_accvgpr_read_b32 v87, a207
    v_accvgpr_read_b32 v88, a232
    v_accvgpr_read_b32 v89, a233
    v_accvgpr_read_b32 v90, a234
    v_accvgpr_read_b32 v91, a235
    v_accvgpr_read_b32 v92, a236
    v_accvgpr_read_b32 v93, a237
    buffer_load_dwordx4 a[4:7], v2, s[28:31], s22 offen offset:1024 sc1
    v_accvgpr_read_b32 v94, a238
    v_accvgpr_read_b32 v95, a239
    v_pk_mul_f32 v[96:97], v[80:81], v[80:81]
    v_pk_mul_f32 v[98:99], v[82:83], v[82:83]
    v_pk_mul_f32 v[100:101], v[84:85], v[84:85]
    v_pk_mul_f32 v[102:103], v[86:87], v[86:87]
    v_pk_fma_f32 v[96:97], v[96:97], s[54:55], v[72:73]
    v_pk_fma_f32 v[98:99], v[98:99], s[54:55], v[72:73]
    v_pk_fma_f32 v[100:101], v[100:101], s[54:55], v[72:73]
    v_pk_fma_f32 v[102:103], v[102:103], s[54:55], v[72:73]
    buffer_load_dwordx4 a[8:11], v2, s[28:31], s22 offen offset:2048 sc1
    v_pk_mul_f32 v[96:97], v[96:97], v[80:81]
    v_pk_mul_f32 v[98:99], v[98:99], v[82:83]
    v_pk_mul_f32 v[100:101], v[100:101], v[84:85]
    v_pk_mul_f32 v[102:103], v[102:103], v[86:87]
    v_exp_f32 v96, v96
    v_exp_f32 v97, v97
    v_exp_f32 v98, v98
    v_exp_f32 v99, v99
    v_exp_f32 v100, v100
    buffer_load_dwordx4 a[12:15], v2, s[28:31], s22 offen offset:3072 sc1
    s_add_u32 m0, s11, 0
    v_exp_f32 v101, v101
    v_exp_f32 v102, v102
    v_exp_f32 v103, v103
    v_pk_add_f32 v[96:97], v[96:97], v[74:75]
    v_pk_add_f32 v[98:99], v[98:99], v[74:75]
    v_pk_add_f32 v[100:101], v[100:101], v[74:75]
    v_pk_add_f32 v[102:103], v[102:103], v[74:75]
    v_rcp_f32 v96, v96
    v_rcp_f32 v97, v97
    buffer_load_dwordx4 v2, s[28:31], s23 offen offset:0 sc1 lds
    v_rcp_f32 v98, v98
    v_rcp_f32 v99, v99
    v_rcp_f32 v100, v100
    v_rcp_f32 v101, v101
    v_rcp_f32 v102, v102
    v_rcp_f32 v103, v103
    v_pk_mul_f32 v[104:105], v[80:81], v[88:89]
    buffer_load_dwordx4 v2, s[28:31], s23 offen offset:1024 sc1 lds
    s_add_u32 s23, s23, 8192
    s_add_u32 m0, s11, 8192
    v_pk_mul_f32 v[106:107], v[82:83], v[90:91]
    v_pk_mul_f32 v[108:109], v[84:85], v[92:93]
    v_pk_mul_f32 v[110:111], v[86:87], v[94:95]
    v_pk_mul_f32 v[96:97], v[96:97], v[104:105]
    v_pk_mul_f32 v[98:99], v[98:99], v[106:107]
    v_pk_mul_f32 v[100:101], v[100:101], v[108:109]
    v_pk_mul_f32 v[102:103], v[102:103], v[110:111]
    v_cvt_pk_bf16_f32 v164, v96, v97
    v_cvt_pk_bf16_f32 v165, v98, v99
    v_cvt_pk_bf16_f32 v166, v100, v101
    v_cvt_pk_bf16_f32 v167, v102, v103
    v_accvgpr_read_b32 v80, a208
    v_accvgpr_read_b32 v81, a209
    v_permlane16_swap_b32 v164, v166
    v_permlane16_swap_b32 v165, v167
    v_accvgpr_read_b32 v82, a210
    v_accvgpr_read_b32 v83, a211
    buffer_load_dwordx4 v2, s[28:31], s24 offen offset:0 sc1 lds
    v_accvgpr_read_b32 v84, a212
    v_accvgpr_read_b32 v85, a213
    v_accvgpr_read_b32 v86, a214
    v_accvgpr_read_b32 v87, a215
    v_accvgpr_read_b32 v88, a240
    v_accvgpr_read_b32 v89, a241
    v_accvgpr_read_b32 v90, a242
    v_accvgpr_read_b32 v91, a243
    v_accvgpr_read_b32 v92, a244
    v_accvgpr_read_b32 v93, a245
    buffer_load_dwordx4 v2, s[28:31], s24 offen offset:1024 sc1 lds
    s_add_u32 s24, s24, 8192
    s_add_u32 m0, s11, 16384
    v_accvgpr_read_b32 v94, a246
    v_accvgpr_read_b32 v95, a247
    v_pk_mul_f32 v[96:97], v[80:81], v[80:81]
    v_pk_mul_f32 v[98:99], v[82:83], v[82:83]
    v_pk_mul_f32 v[100:101], v[84:85], v[84:85]
    v_pk_mul_f32 v[102:103], v[86:87], v[86:87]
    v_pk_fma_f32 v[96:97], v[96:97], s[54:55], v[72:73]
    v_pk_fma_f32 v[98:99], v[98:99], s[54:55], v[72:73]
    v_pk_fma_f32 v[100:101], v[100:101], s[54:55], v[72:73]
    v_pk_fma_f32 v[102:103], v[102:103], s[54:55], v[72:73]
    buffer_load_dwordx4 v2, s[28:31], s23 offen offset:0 sc1 lds
    v_pk_mul_f32 v[96:97], v[96:97], v[80:81]
    v_pk_mul_f32 v[98:99], v[98:99], v[82:83]
    v_pk_mul_f32 v[100:101], v[100:101], v[84:85]
    v_pk_mul_f32 v[102:103], v[102:103], v[86:87]
    v_exp_f32 v96, v96
    v_exp_f32 v97, v97
    v_exp_f32 v98, v98
    v_exp_f32 v99, v99
    buffer_load_dwordx4 v2, s[28:31], s23 offen offset:1024 sc1 lds
    s_add_u32 s23, s23, 8192
    s_add_u32 m0, s11, 24576
    v_exp_f32 v100, v100
    v_exp_f32 v101, v101
    v_exp_f32 v102, v102
    v_exp_f32 v103, v103
    v_pk_add_f32 v[96:97], v[96:97], v[74:75]
    v_pk_add_f32 v[98:99], v[98:99], v[74:75]
    v_pk_add_f32 v[100:101], v[100:101], v[74:75]
    v_pk_add_f32 v[102:103], v[102:103], v[74:75]
    v_rcp_f32 v96, v96
    buffer_load_dwordx4 v2, s[28:31], s24 offen offset:0 sc1 lds
    v_rcp_f32 v97, v97
    v_rcp_f32 v98, v98
    v_rcp_f32 v99, v99
    v_rcp_f32 v100, v100
    v_rcp_f32 v101, v101
    v_rcp_f32 v102, v102
    v_rcp_f32 v103, v103
    v_pk_mul_f32 v[104:105], v[80:81], v[88:89]
    buffer_load_dwordx4 v2, s[28:31], s24 offen offset:1024 sc1 lds
    s_add_u32 s24, s24, 8192
    v_pk_mul_f32 v[106:107], v[82:83], v[90:91]
    v_pk_mul_f32 v[108:109], v[84:85], v[92:93]
    v_pk_mul_f32 v[110:111], v[86:87], v[94:95]
    v_pk_mul_f32 v[96:97], v[96:97], v[104:105]
    v_pk_mul_f32 v[98:99], v[98:99], v[106:107]
    v_pk_mul_f32 v[100:101], v[100:101], v[108:109]
    v_pk_mul_f32 v[102:103], v[102:103], v[110:111]
    v_cvt_pk_bf16_f32 v168, v96, v97
    v_cvt_pk_bf16_f32 v169, v98, v99
    v_cvt_pk_bf16_f32 v170, v100, v101
    v_cvt_pk_bf16_f32 v171, v102, v103
    v_accvgpr_read_b32 v80, a216
    v_accvgpr_read_b32 v81, a217
    v_permlane16_swap_b32 v168, v170
    v_permlane16_swap_b32 v169, v171
    v_accvgpr_read_b32 v82, a218
    v_accvgpr_read_b32 v83, a219
    v_accvgpr_read_b32 v84, a220
    v_accvgpr_read_b32 v85, a221
    v_accvgpr_read_b32 v86, a222
    v_accvgpr_read_b32 v87, a223
    v_accvgpr_read_b32 v88, a248
    v_accvgpr_read_b32 v89, a249
    v_accvgpr_read_b32 v90, a250
    v_accvgpr_read_b32 v91, a251
    v_accvgpr_read_b32 v92, a252
    v_accvgpr_read_b32 v93, a253
    v_accvgpr_read_b32 v94, a254
    v_accvgpr_read_b32 v95, a255
    v_pk_mul_f32 v[96:97], v[80:81], v[80:81]
    v_pk_mul_f32 v[98:99], v[82:83], v[82:83]
    v_pk_mul_f32 v[100:101], v[84:85], v[84:85]
    v_pk_mul_f32 v[102:103], v[86:87], v[86:87]
    v_pk_fma_f32 v[96:97], v[96:97], s[54:55], v[72:73]
    v_pk_fma_f32 v[98:99], v[98:99], s[54:55], v[72:73]
    v_pk_fma_f32 v[100:101], v[100:101], s[54:55], v[72:73]
    v_pk_fma_f32 v[102:103], v[102:103], s[54:55], v[72:73]
    v_pk_mul_f32 v[96:97], v[96:97], v[80:81]
    v_pk_mul_f32 v[98:99], v[98:99], v[82:83]
    v_pk_mul_f32 v[100:101], v[100:101], v[84:85]
    v_pk_mul_f32 v[102:103], v[102:103], v[86:87]
    v_exp_f32 v96, v96
    v_exp_f32 v97, v97
    v_exp_f32 v98, v98
    v_exp_f32 v99, v99
    v_exp_f32 v100, v100
    v_exp_f32 v101, v101
    v_exp_f32 v102, v102
    v_exp_f32 v103, v103
    v_pk_add_f32 v[96:97], v[96:97], v[74:75]
    v_pk_add_f32 v[98:99], v[98:99], v[74:75]
    v_pk_add_f32 v[100:101], v[100:101], v[74:75]
    v_pk_add_f32 v[102:103], v[102:103], v[74:75]
    v_rcp_f32 v96, v96
    v_rcp_f32 v97, v97
    v_rcp_f32 v98, v98
    v_rcp_f32 v99, v99
    v_rcp_f32 v100, v100
    v_rcp_f32 v101, v101
    v_rcp_f32 v102, v102
    v_rcp_f32 v103, v103
    v_pk_mul_f32 v[104:105], v[80:81], v[88:89]
    v_pk_mul_f32 v[106:107], v[82:83], v[90:91]
    v_pk_mul_f32 v[108:109], v[84:85], v[92:93]
    v_pk_mul_f32 v[110:111], v[86:87], v[94:95]
    v_pk_mul_f32 v[96:97], v[96:97], v[104:105]
    v_pk_mul_f32 v[98:99], v[98:99], v[106:107]
    v_pk_mul_f32 v[100:101], v[100:101], v[108:109]
    v_pk_mul_f32 v[102:103], v[102:103], v[110:111]
    v_cvt_pk_bf16_f32 v172, v96, v97
    v_cvt_pk_bf16_f32 v173, v98, v99
    v_cvt_pk_bf16_f32 v174, v100, v101
    v_cvt_pk_bf16_f32 v175, v102, v103
    s_nop 1
    v_permlane16_swap_b32 v172, v174
    v_permlane16_swap_b32 v173, v175
    s_cmp_eq_u32 s89, 1
    s_cbranch_scc1 p2_have1A
p2_poll1A:
    buffer_load_dword v12, v11, s[28:31], 0 offen sc1
    s_waitcnt vmcnt(0)
    v_cmp_ne_u32 vcc, 1, v12
    s_sub_u32 s35, s35, 1
    s_cbranch_scc1 p2_got1A
    s_nop 2
    s_cbranch_vccz p2_got1A
    s_sleep 6
    s_branch p2_poll1A
p2_got1A:
    s_mov_b32 s22, s88
    s_sub_u32 s23, s9, 16384
    s_sub_u32 s24, s10, 16384
    buffer_load_dwordx4 a[0:3], v2, s[28:31], s22 offen offset:0 sc1
    buffer_load_dwordx4 a[4:7], v2, s[28:31], s22 offen offset:1024 sc1
    buffer_load_dwordx4 a[8:11], v2, s[28:31], s22 offen offset:2048 sc1
    buffer_load_dwordx4 a[12:15], v2, s[28:31], s22 offen offset:3072 sc1
    s_add_u32 m0, s11, 0
    s_nop 0
    buffer_load_dwordx4 v2, s[28:31], s23 offen offset:0 sc1 lds
    buffer_load_dwordx4 v2, s[28:31], s23 offen offset:1024 sc1 lds
    s_add_u32 s23, s23, 8192
    s_add_u32 m0, s11, 8192
    s_nop 0
    buffer_load_dwordx4 v2, s[28:31], s24 offen offset:0 sc1 lds
    buffer_load_dwordx4 v2, s[28:31], s24 offen offset:1024 sc1 lds
    s_add_u32 s24, s24, 8192
    s_add_u32 m0, s11, 16384
    s_nop 0
    buffer_load_dwordx4 v2, s[28:31], s23 offen offset:0 sc1 lds
    buffer_load_dwordx4 v2, s[28:31], s23 offen offset:1024 sc1 lds
    s_add_u32 s23, s23, 8192
    s_add_u32 m0, s11, 24576
    s_nop 0
    buffer_load_dwordx4 v2, s[28:31], s24 offen offset:0 sc1 lds
    buffer_load_dwordx4 v2, s[28:31], s24 offen offset:1024 sc1 lds
    s_add_u32 s24, s24, 8192
p2_have1A:
    s_branch p2_start
p1_typeB:
    v_lshrrev_b32 v2, 3, v1
    v_and_b32 v3, 6, v2
    v_and_b32 v4, 7, v1
    v_xor_b32 v3, v3, v4
    v_lshlrev_b32 v3, 4, v3
    v_lshl_add_u32 v232, v2, 11, v3
    v_add_u32 v233, 16384, v232
    v_add_u32 v234, 32768, v232
    v_add_u32 v235, 49152, v232
    v_add_u32 v236, 65536, v232
    v_add_u32 v237, 81920, v232
    v_add_u32 v238, 98304, v232
    v_add_u32 v239, 114688, v232
    s_lshl_b32 s50, s39, 19
    s_lshl_b32 s51, s36, 17
    s_add_u32 s42, s50, s51
    s_lshl_b32 s45, s36, 13
    s_mov_b32 s52, 6144
    s_mov_b32 s53, 7168
    v_lshrrev_b32 v2, 3, v1
    v_lshrrev_b32 v3, 4, v1
    v_and_b32 v3, 1, v3
    s_lshl_b32 s50, s37, 1
    v_or_b32 v3, s50, v3
    v_lshlrev_b32 v3, 1, v3
    v_and_b32 v4, 7, v1
    v_xor_b32 v3, v3, v4
    v_lshlrev_b32 v3, 4, v3
    s_lshl_b32 s50, s36, 3
    v_add_u32 v2, s50, v2
    v_mul_lo_u32 v2, v2, s52
    v_add_u32 v240, v2, v3
    s_lshl_b32 s43, s41, 7
    s_add_u32 s43, s43, 4096
    s_lshl_b32 s46, s36, 10
    s_add_u32 s46, s46, 65536
    v_lshrrev_b32 v2, 4, v1
    s_lshl_b32 s51, s37, 2
    v_or_b32 v3, s51, v2
    v_lshlrev_b32 v3, 1, v3
    v_and_b32 v4, 15, v1
    v_xor_b32 v3, v3, v4
    v_lshlrev_b32 v3, 4, v3
    s_lshl_b32 s51, s37, 3
    v_add_u32 v2, s51, v2
    v_mul_lo_u32 v2, v2, s53
    v_add_u32 v241, v2, v3
    v_add_u32 v242, 28672, v241
    v_add_u32 v243, 114688, v241
    v_add_u32 v244, 143360, v241
    s_lshl_b32 s44, s41, 8
    s_lshl_b32 s50, s37, 11
    s_lshl_b32 s51, s38, 13
    s_add_u32 s47, s50, s51
    s_add_u32 s47, s47, 81920
    s_waitcnt lgkmcnt(0)
    s_mov_b32 s16, s4
    s_mov_b32 s17, s5
    s_mov_b32 s18, 4194304
    s_mov_b32 s19, 0x20000
    s_add_u32 m0, s45, 0
    s_nop 0
    buffer_load_dwordx4 v232, s[16:19], s42 offen lds
    s_add_u32 m0, s45, 1024
    s_nop 0
    buffer_load_dwordx4 v233, s[16:19], s42 offen lds
    s_add_u32 m0, s45, 2048
    s_nop 0
    buffer_load_dwordx4 v234, s[16:19], s42 offen lds
    s_add_u32 m0, s45, 3072
    s_nop 0
    buffer_load_dwordx4 v235, s[16:19], s42 offen lds
    s_add_u32 m0, s45, 4096
    s_nop 0
    buffer_load_dwordx4 v236, s[16:19], s42 offen lds
    s_add_u32 m0, s45, 5120
    s_nop 0
    buffer_load_dwordx4 v237, s[16:19], s42 offen lds
    s_add_u32 m0, s45, 6144
    s_nop 0
    buffer_load_dwordx4 v238, s[16:19], s42 offen lds
    s_add_u32 m0, s45, 7168
    s_nop 0
    buffer_load_dwordx4 v239, s[16:19], s42 offen lds
    s_add_u32 s42, s42, 128
    s_mov_b32 s20, s6
    s_mov_b32 s21, s7
    s_mov_b32 s22, 6291456
    s_mov_b32 s23, 0x20000
    s_add_u32 m0, s46, 0
    s_nop 0
    buffer_load_dwordx4 v240, s[20:23], s43 offen lds
    s_add_u32 s43, s43, 196608
    s_add_u32 m0, s46, 4096
    s_nop 0
    buffer_load_dwordx4 v240, s[20:23], s43 offen lds
    s_add_u32 s43, s43, 196608
    s_cmp_lt_u32 s36, 2
    s_cselect_b32 s24, s8, s10
    s_cselect_b32 s25, s9, s11
    s_mov_b32 s26, 7340032
    s_mov_b32 s27, 0x20000
    s_add_u32 m0, s47, 0
    s_nop 0
    buffer_load_dwordx4 v241, s[24:27], s44 offen lds
    s_add_u32 m0, s47, 1024
    s_nop 0
    buffer_load_dwordx4 v242, s[24:27], s44 offen lds
    s_add_u32 m0, s47, 4096
    s_nop 0
    buffer_load_dwordx4 v243, s[24:27], s44 offen lds
    s_add_u32 m0, s47, 5120
    s_nop 0
    buffer_load_dwordx4 v244, s[24:27], s44 offen lds
    s_add_u32 s44, s44, 229376
    s_add_u32 m0, s47, 16384
    s_nop 0
    buffer_load_dwordx4 v241, s[24:27], s44 offen lds
    s_add_u32 m0, s47, 17408
    s_nop 0
    buffer_load_dwordx4 v242, s[24:27], s44 offen lds
    s_add_u32 m0, s47, 20480
    s_nop 0
    buffer_load_dwordx4 v243, s[24:27], s44 offen lds
    s_add_u32 m0, s47, 21504
    s_nop 0
    buffer_load_dwordx4 v244, s[24:27], s44 offen lds
    s_add_u32 s44, s44, 229376
    s_mov_b32 s28, s14
    s_mov_b32 s29, s15
    s_mov_b32 s30, 268435456
    s_mov_b32 s31, 0x20000
    s_mov_b32 s32, s12
    s_mov_b32 s33, s13
    s_mov_b32 s34, 2048
    s_mov_b32 s35, 0x20000
    s_mov_b32 s66, 7340032
    s_mov_b32 s67, 0x20000
    s_mov_b32 s70, 2097152
    s_mov_b32 s71, 0x20000
    s_mov_b32 s74, 4194304
    s_mov_b32 s75, 0x20000
    s_mov_b32 s78, 256
    s_mov_b32 s79, 0x20000
    s_lshl_b32 s52, s2, 2
    s_add_u32 s52, s52, s36
    s_lshl_b32 s53, s2, 1
    s_add_u32 s53, s53, s37
    v_lshlrev_b32 v4, 7, v1
    v_mov_b32 v5, 0x40000000
    v_cmp_gt_u32 vcc, 3, v1
    s_mul_i32 s50, s52, 384
    s_add_u32 s50, s50, 393216
    v_cndmask_b32 v6, v5, v4, vcc
    buffer_load_dword v246, v6, s[20:23], s50 offen
    v_cmp_gt_u32 vcc, 8, v1
    s_mul_i32 s50, s53, 896
    s_add_u32 s50, s50, 458752
    v_cndmask_b32 v245, v5, v4, vcc
    buffer_load_dword v246, v245, s[24:27], s50 offen
    v_lshrrev_b32 v6, 2, v1
    v_and_b32 v7, 3, v1
    v_lshlrev_b32 v7, 7, v7
    v_lshl_add_u32 v6, v6, 11, v7
    v_cndmask_b32 v0, v5, v6, vcc
    v_cmp_gt_u32 vcc, 14, v1
    s_lshl_b32 s63, s52, 12
    buffer_load_dword v246, v0, s[16:19], s63 offen
    s_add_u32 s63, s63, 512
    v_cndmask_b32 v247, v5, v4, vcc
    s_lshl_b32 s6, s52, 10
    s_mul_i32 s7, s52, 384
    s_add_u32 s7, s7, 786432
    s_mul_i32 s49, s53, 896
    s_add_u32 s49, s49, 917504
    v_cmp_gt_u32 vcc, 3, v1
    s_mul_i32 s5, s52, 384
    s_nop 0
    v_cndmask_b32 v254, v5, v4, vcc
    s_add_u32 s53, s41, 16
    s_mul_i32 s84, s53, 4224
    s_lshl_b32 s52, s39, 2
    s_add_u32 s84, s84, s52
    s_add_u32 s84, s84, 34734080
    s_mul_i32 s85, s39, 4224
    s_lshl_b32 s52, s53, 2
    s_add_u32 s85, s85, s52
    s_add_u32 s52, s85, 34603008
    s_add_u32 s85, s85, 34668544
    v_mov_b32 v15, 0
    v_mov_b32 v3, 0x40000000
    v_mov_b32 v248, 0x40000000
    v_mov_b32 v249, 1
    s_cmp_eq_u32 s36, 0
    s_cselect_b32 s50, 0, 0x40000000
    v_writelane_b32 v3, s84, 0
    v_writelane_b32 v3, s85, 1
    v_writelane_b32 v3, s52, 2
    v_writelane_b32 v248, s50, 0
    buffer_store_dword v15, v3, s[28:31], s50 offen sc1
    s_lshr_b32 s86, s2, 3
    s_and_b32 s86, s86, 3
    s_add_u32 s86, s86, 2
    v_and_b32 v2, 15, v1
    v_lshrrev_b32 v3, 4, v1
    v_and_b32 v4, 6, v2
    v_xor_b32 v4, v4, v3
    v_lshlrev_b32 v4, 4, v4
    s_lshl_b32 s50, s37, 14
    v_lshl_add_u32 v4, v2, 7, v4
    v_add_u32 v224, s50, v4
    v_xor_b32 v225, 64, v224
    v_lshrrev_b32 v4, 2, v2
    v_lshl_add_u32 v5, v3, 3, v4
    v_and_b32 v8, 3, v2
    v_lshlrev_b32 v8, 3, v8
    v_and_b32 v9, 1, v3
    v_lshrrev_b32 v10, 3, v2
    v_lshl_or_b32 v10, v9, 1, v10
    v_lshl_add_u32 v11, v5, 7, v8
    v_add_u32 v11, 65536, v11
    s_lshl_b32 s50, s38, 1
    s_add_u32 s51, s50, 0
    v_xor_b32 v12, s51, v10
    v_lshl_add_u32 v226, v12, 5, v11
    s_add_u32 s51, s50, 1
    v_xor_b32 v12, s51, v10
    v_lshl_add_u32 v227, v12, 5, v11
    v_lshl_or_b32 v10, v9, 2, v4
    v_lshl_add_u32 v11, v5, 8, v8
    v_add_u32 v11, 81920, v11
    s_lshl_b32 s50, s38, 2
    s_add_u32 s51, s50, 0
    v_xor_b32 v12, s51, v10
    v_lshl_add_u32 v228, v12, 5, v11
    s_add_u32 s51, s50, 1
    v_xor_b32 v12, s51, v10
    v_lshl_add_u32 v229, v12, 5, v11
    s_add_u32 s51, s50, 2
    v_xor_b32 v12, s51, v10
    v_lshl_add_u32 v230, v12, 5, v11
    s_add_u32 s51, s50, 3
    v_xor_b32 v12, s51, v10
    v_lshl_add_u32 v231, v12, 5, v11
    s_mov_b32 s54, 0xbdd2d3e8
    s_mov_b32 s55, 0xbdd2d3e8
    v_and_b32 v2, 31, v1
    v_lshlrev_b32 v252, 6, v2
    v_lshrrev_b32 v3, 5, v1
    v_lshl_add_u32 v253, v3, 11, v252
    s_lshl_b32 s50, s39, 8
    s_lshl_b32 s51, s62, 3
    s_add_u32 s50, s50, s51
    s_lshl_b32 s51, s36, 1
    s_add_u32 s50, s50, s51
    s_lshl_b32 s60, s50, 2
    s_add_u32 s60, s60, 33554432
    s_lshl_b32 s61, s50, 11
    s_lshl_b32 s51, s39, 3
    s_lshl_b32 s52, s37, 2
    s_add_u32 s51, s51, s52
    s_lshl_b32 s50, s41, 1
    s_add_u32 s52, s38, 64
    s_add_u32 s50, s50, s52
    s_lshl_b32 s50, s50, 17
    s_lshl_b32 s52, s51, 11
    s_add_u32 s58, s50, s52
    s_mul_i32 s50, s51, 288
    s_mul_i32 s51, s41, 8
    s_add_u32 s51, s51, 64
    s_mul_i32 s52, s38, 4
    s_add_u32 s50, s50, s51
    s_add_u32 s50, s50, s52
    s_lshl_b32 s50, s50, 10
    s_add_u32 s90, s50, 12582912
    s_add_u32 s91, s50, 12877824
    s_add_u32 s92, s50, 13172736
    s_add_u32 s93, s50, 13467648
    s_and_b32 s50, s2, 7
    s_lshr_b32 s51, s2, 3
    s_and_b32 s81, s51, 7
    s_lshr_b32 s52, s51, 3
    s_lshl_b32 s80, s50, 2
    s_add_u32 s80, s80, s52
    s_lshl_b32 s82, s81, 3
    s_lshl_b32 s52, s36, 1
    s_add_u32 s82, s82, s52
    s_and_b32 s83, s51, 3
    s_lshr_b32 s8, s51, 2
    s_lshr_b32 s52, s50, 1
    s_lshl_b32 s52, s52, 2
    s_add_u32 s83, s83, s52
    s_and_b32 s52, s50, 1
    s_lshl_b32 s52, s52, 3
    s_add_u32 s8, s8, s52
    s_lshl_b32 s11, s36, 11
    s_xor_b32 s12, s11, 0x8000
    s_lshl_b32 s50, s80, 17
    s_add_u32 s9, s50, s11
    s_add_u32 s10, s9, 8404992
    s_add_u32 s9, s9, 4210688
    s_lshl_b32 s51, s82, 11
    s_add_u32 s88, s50, s51
    s_lshl_b32 s41, s82, 7
    s_add_u32 s41, s41, 33554432
    s_lshl_b32 s62, s83, 9
    s_add_u32 s62, s62, 33554432
    s_mul_i32 s94, s83, 1179648
    s_add_u32 s94, s94, 12582912
    s_mul_i32 s52, s36, 57344
    s_add_u32 s13, s94, s52
    s_add_u32 s13, s13, 65536
    s_mul_i32 s52, s36, 16384
    s_add_u32 s94, s94, s52
    s_lshl_b32 s95, s8, 7
    s_mul_i32 s52, s36, 1835008
    s_add_u32 s14, s95, s52
    s_mul_i32 s52, s36, 524288
    s_add_u32 s95, s95, s52
    s_lshl_b32 s40, s36, 14
    s_add_u32 s15, s40, 98304
    s_lshl_b32 s4, s36, 13
    s_add_u32 s4, s4, 65536
    s_mul_i32 s3, s81, 4224
    s_lshl_b32 s50, s80, 2
    s_add_u32 s3, s3, s50
    s_add_u32 s3, s3, 34603008
    s_waitcnt vmcnt(12)
    s_barrier
    ds_read_b64_tr_b16 v[208:209], v226 offset:0
    ds_read_b64_tr_b16 v[210:211], v226 offset:512
    ds_read_b64_tr_b16 v[212:213], v226 offset:4096
    ds_read_b64_tr_b16 v[214:215], v226 offset:4608
    ds_read_b128 v[16:19], v224 offset:0
    ds_read_b128 v[20:23], v225 offset:0
    ds_read_b128 v[24:27], v224 offset:2048
    ds_read_b128 v[28:31], v225 offset:2048
    ds_read_b128 v[32:35], v224 offset:4096
    ds_read_b128 v[36:39], v225 offset:4096
    ds_read_b128 v[40:43], v224 offset:6144
    ds_read_b128 v[44:47], v225 offset:6144
    ds_read_b128 v[48:51], v224 offset:8192
    ds_read_b128 v[52:55], v225 offset:8192
    ds_read_b128 v[56:59], v224 offset:10240
    ds_read_b128 v[60:63], v225 offset:10240
    ds_read_b128 v[64:67], v224 offset:12288
    ds_read_b128 v[68:71], v225 offset:12288
    ds_read_b128 v[72:75], v224 offset:14336
    ds_read_b128 v[76:79], v225 offset:14336
    s_mov_b32 s48, 7
    s_waitcnt lgkmcnt(0)
    s_barrier
    v_mfma_f32_16x16x32_bf16 a[0:3], v[16:19], v[208:211], 0
    s_add_u32 m0, s45, 32768
    v_mfma_f32_16x16x32_bf16 a[0:3], v[20:23], v[212:215], a[0:3]
    ds_read_b64_tr_b16 v[216:217], v227 offset:0
    buffer_load_dwordx4 v232, s[16:19], s42 offen lds
    v_mfma_f32_16x16x32_bf16 a[4:7], v[24:27], v[208:211], 0
    v_mfma_f32_16x16x32_bf16 a[4:7], v[28:31], v[212:215], a[4:7]
    ds_read_b64_tr_b16 v[218:219], v227 offset:512
    v_mfma_f32_16x16x32_bf16 a[8:11], v[32:35], v[208:211], 0
    s_add_u32 m0, s45, 33792
    v_mfma_f32_16x16x32_bf16 a[8:11], v[36:39], v[212:215], a[8:11]
    ds_read_b64_tr_b16 v[220:221], v227 offset:4096
    buffer_load_dwordx4 v233, s[16:19], s42 offen lds
    v_mfma_f32_16x16x32_bf16 a[12:15], v[40:43], v[208:211], 0
    v_mfma_f32_16x16x32_bf16 a[12:15], v[44:47], v[212:215], a[12:15]
    ds_read_b64_tr_b16 v[222:223], v227 offset:4608
    v_mfma_f32_16x16x32_bf16 a[16:19], v[48:51], v[208:211], 0
    s_add_u32 m0, s45, 34816
    v_mfma_f32_16x16x32_bf16 a[16:19], v[52:55], v[212:215], a[16:19]
    buffer_load_dwordx4 v234, s[16:19], s42 offen lds
    v_mfma_f32_16x16x32_bf16 a[20:23], v[56:59], v[208:211], 0
    v_mfma_f32_16x16x32_bf16 a[20:23], v[60:63], v[212:215], a[20:23]
    v_mfma_f32_16x16x32_bf16 a[24:27], v[64:67], v[208:211], 0
    s_add_u32 m0, s45, 35840
    v_mfma_f32_16x16x32_bf16 a[24:27], v[68:71], v[212:215], a[24:27]
    buffer_load_dwordx4 v235, s[16:19], s42 offen lds
    v_mfma_f32_16x16x32_bf16 a[28:31], v[72:75], v[208:211], 0
    s_waitcnt vmcnt(8)
    v_mfma_f32_16x16x32_bf16 a[28:31], v[76:79], v[212:215], a[28:31]
    s_waitcnt lgkmcnt(0)
    s_barrier
    v_mfma_f32_16x16x32_bf16 a[32:35], v[16:19], v[216:219], 0
    s_add_u32 m0, s45, 36864
    v_mfma_f32_16x16x32_bf16 a[32:35], v[20:23], v[220:223], a[32:35]
    ds_read_b64_tr_b16 v[208:209], v228 offset:0
    buffer_load_dwordx4 v236, s[16:19], s42 offen lds
    v_mfma_f32_16x16x32_bf16 a[36:39], v[24:27], v[216:219], 0
    v_mfma_f32_16x16x32_bf16 a[36:39], v[28:31], v[220:223], a[36:39]
    ds_read_b64_tr_b16 v[210:211], v228 offset:1024
    v_mfma_f32_16x16x32_bf16 a[40:43], v[32:35], v[216:219], 0
    s_add_u32 m0, s45, 37888
    v_mfma_f32_16x16x32_bf16 a[40:43], v[36:39], v[220:223], a[40:43]
    ds_read_b64_tr_b16 v[212:213], v228 offset:16384
    buffer_load_dwordx4 v237, s[16:19], s42 offen lds
    v_mfma_f32_16x16x32_bf16 a[44:47], v[40:43], v[216:219], 0
    v_mfma_f32_16x16x32_bf16 a[44:47], v[44:47], v[220:223], a[44:47]
    ds_read_b64_tr_b16 v[214:215], v228 offset:17408
    v_mfma_f32_16x16x32_bf16 a[48:51], v[48:51], v[216:219], 0
    s_add_u32 m0, s45, 38912
    v_mfma_f32_16x16x32_bf16 a[48:51], v[52:55], v[220:223], a[48:51]
    buffer_load_dwordx4 v238, s[16:19], s42 offen lds
    v_mfma_f32_16x16x32_bf16 a[52:55], v[56:59], v[216:219], 0
    v_mfma_f32_16x16x32_bf16 a[52:55], v[60:63], v[220:223], a[52:55]
    v_mfma_f32_16x16x32_bf16 a[56:59], v[64:67], v[216:219], 0
    s_add_u32 m0, s45, 39936
    v_mfma_f32_16x16x32_bf16 a[56:59], v[68:71], v[220:223], a[56:59]
    buffer_load_dwordx4 v239, s[16:19], s42 offen lds
    s_add_u32 s42, s42, 128
    v_mfma_f32_16x16x32_bf16 a[60:63], v[72:75], v[216:219], 0
    v_mfma_f32_16x16x32_bf16 a[60:63], v[76:79], v[220:223], a[60:63]
    s_waitcnt lgkmcnt(0)
    v_mfma_f32_16x16x32_bf16 a[64:67], v[208:211], v[16:19], 0
    s_add_u32 m0, s46, 8192
    v_mfma_f32_16x16x32_bf16 a[64:67], v[212:215], v[20:23], a[64:67]
    ds_read_b64_tr_b16 v[216:217], v228 offset:8192
    buffer_load_dwordx4 v240, s[20:23], s43 offen lds
    s_add_u32 s43, s43, 196608
    v_mfma_f32_16x16x32_bf16 a[68:71], v[208:211], v[24:27], 0
    v_mfma_f32_16x16x32_bf16 a[68:71], v[212:215], v[28:31], a[68:71]
    ds_read_b64_tr_b16 v[218:219], v228 offset:9216
    v_mfma_f32_16x16x32_bf16 a[72:75], v[208:211], v[32:35], 0
    s_add_u32 m0, s46, 12288
    v_mfma_f32_16x16x32_bf16 a[72:75], v[212:215], v[36:39], a[72:75]
    ds_read_b64_tr_b16 v[220:221], v228 offset:24576
    buffer_load_dwordx4 v240, s[20:23], s43 offen lds
    s_add_u32 s43, s43, 196608
    v_mfma_f32_16x16x32_bf16 a[76:79], v[208:211], v[40:43], 0
    v_mfma_f32_16x16x32_bf16 a[76:79], v[212:215], v[44:47], a[76:79]
    ds_read_b64_tr_b16 v[222:223], v228 offset:25600
    v_mfma_f32_16x16x32_bf16 a[80:83], v[208:211], v[48:51], 0
    s_add_u32 m0, s47, 32768
    v_mfma_f32_16x16x32_bf16 a[80:83], v[212:215], v[52:55], a[80:83]
    buffer_load_dwordx4 v241, s[24:27], s44 offen lds
    v_mfma_f32_16x16x32_bf16 a[84:87], v[208:211], v[56:59], 0
    v_mfma_f32_16x16x32_bf16 a[84:87], v[212:215], v[60:63], a[84:87]
    v_mfma_f32_16x16x32_bf16 a[88:91], v[208:211], v[64:67], 0
    s_add_u32 m0, s47, 33792
    v_mfma_f32_16x16x32_bf16 a[88:91], v[212:215], v[68:71], a[88:91]
    buffer_load_dwordx4 v242, s[24:27], s44 offen lds
    v_mfma_f32_16x16x32_bf16 a[92:95], v[208:211], v[72:75], 0
    v_mfma_f32_16x16x32_bf16 a[92:95], v[212:215], v[76:79], a[92:95]
    s_waitcnt lgkmcnt(0)
    v_mfma_f32_16x16x32_bf16 a[96:99], v[216:219], v[16:19], 0
    s_add_u32 m0, s47, 36864
    v_mfma_f32_16x16x32_bf16 a[96:99], v[220:223], v[20:23], a[96:99]
    ds_read_b64_tr_b16 v[208:209], v229 offset:0
    buffer_load_dwordx4 v243, s[24:27], s44 offen lds
    v_mfma_f32_16x16x32_bf16 a[100:103], v[216:219], v[24:27], 0
    v_mfma_f32_16x16x32_bf16 a[100:103], v[220:223], v[28:31], a[100:103]
    ds_read_b64_tr_b16 v[210:211], v229 offset:1024
    v_mfma_f32_16x16x32_bf16 a[104:107], v[216:219], v[32:35], 0
    s_add_u32 m0, s47, 37888
    v_mfma_f32_16x16x32_bf16 a[104:107], v[220:223], v[36:39], a[104:107]
    ds_read_b64_tr_b16 v[212:213], v229 offset:16384
    buffer_load_dwordx4 v244, s[24:27], s44 offen lds
    s_add_u32 s44, s44, 229376
    v_mfma_f32_16x16x32_bf16 a[108:111], v[216:219], v[40:43], 0
    v_mfma_f32_16x16x32_bf16 a[108:111], v[220:223], v[44:47], a[108:111]
    ds_read_b64_tr_b16 v[214:215], v229 offset:17408
    v_mfma_f32_16x16x32_bf16 a[112:115], v[216:219], v[48:51], 0
    s_add_u32 m0, s47, 49152
    v_mfma_f32_16x16x32_bf16 a[112:115], v[220:223], v[52:55], a[112:115]
    buffer_load_dwordx4 v241, s[24:27], s44 offen lds
    v_mfma_f32_16x16x32_bf16 a[116:119], v[216:219], v[56:59], 0
    v_mfma_f32_16x16x32_bf16 a[116:119], v[220:223], v[60:63], a[116:119]
    v_mfma_f32_16x16x32_bf16 a[120:123], v[216:219], v[64:67], 0
    s_add_u32 m0, s47, 50176
    v_mfma_f32_16x16x32_bf16 a[120:123], v[220:223], v[68:71], a[120:123]
    buffer_load_dwordx4 v242, s[24:27], s44 offen lds
    v_mfma_f32_16x16x32_bf16 a[124:127], v[216:219], v[72:75], 0
    v_mfma_f32_16x16x32_bf16 a[124:127], v[220:223], v[76:79], a[124:127]
    s_waitcnt lgkmcnt(0)
    v_mfma_f32_16x16x32_bf16 a[128:131], v[208:211], v[16:19], 0
    s_add_u32 m0, s47, 53248
    v_mfma_f32_16x16x32_bf16 a[128:131], v[212:215], v[20:23], a[128:131]
    ds_read_b64_tr_b16 v[216:217], v229 offset:8192
    buffer_load_dwordx4 v243, s[24:27], s44 offen lds
    v_mfma_f32_16x16x32_bf16 a[132:135], v[208:211], v[24:27], 0
    v_mfma_f32_16x16x32_bf16 a[132:135], v[212:215], v[28:31], a[132:135]
    ds_read_b64_tr_b16 v[218:219], v229 offset:9216
    v_mfma_f32_16x16x32_bf16 a[136:139], v[208:211], v[32:35], 0
    s_add_u32 m0, s47, 54272
    v_mfma_f32_16x16x32_bf16 a[136:139], v[212:215], v[36:39], a[136:139]
    ds_read_b64_tr_b16 v[220:221], v229 offset:24576
    buffer_load_dwordx4 v244, s[24:27], s44 offen lds
    s_add_u32 s44, s44, 229376
    v_mfma_f32_16x16x32_bf16 a[140:143], v[208:211], v[40:43], 0
    v_mfma_f32_16x16x32_bf16 a[140:143], v[212:215], v[44:47], a[140:143]
    ds_read_b64_tr_b16 v[222:223], v229 offset:25600
    v_mfma_f32_16x16x32_bf16 a[144:147], v[208:211], v[48:51], 0
    s_add_u32 m0, s45, 0
    v_mfma_f32_16x16x32_bf16 a[144:147], v[212:215], v[52:55], a[144:147]
    buffer_load_dwordx4 v232, s[16:19], s42 offen lds
    v_mfma_f32_16x16x32_bf16 a[148:151], v[208:211], v[56:59], 0
    v_mfma_f32_16x16x32_bf16 a[148:151], v[212:215], v[60:63], a[148:151]
    v_mfma_f32_16x16x32_bf16 a[152:155], v[208:211], v[64:67], 0
    s_add_u32 m0, s45, 1024
    v_mfma_f32_16x16x32_bf16 a[152:155], v[212:215], v[68:71], a[152:155]
    buffer_load_dwordx4 v233, s[16:19], s42 offen lds
    v_mfma_f32_16x16x32_bf16 a[156:159], v[208:211], v[72:75], 0
    s_waitcnt vmcnt(12)
    v_mfma_f32_16x16x32_bf16 a[156:159], v[212:215], v[76:79], a[156:159]
    s_waitcnt lgkmcnt(0)
    s_barrier
    v_mfma_f32_16x16x32_bf16 a[160:163], v[216:219], v[16:19], 0
    s_add_u32 m0, s45, 2048
    v_mfma_f32_16x16x32_bf16 a[160:163], v[220:223], v[20:23], a[160:163]
    ds_read_b64_tr_b16 v[208:209], v230 offset:0
    buffer_load_dwordx4 v234, s[16:19], s42 offen lds
    v_mfma_f32_16x16x32_bf16 a[164:167], v[216:219], v[24:27], 0
    v_mfma_f32_16x16x32_bf16 a[164:167], v[220:223], v[28:31], a[164:167]
    ds_read_b64_tr_b16 v[210:211], v230 offset:1024
    v_mfma_f32_16x16x32_bf16 a[168:171], v[216:219], v[32:35], 0
    s_add_u32 m0, s45, 3072
    v_mfma_f32_16x16x32_bf16 a[168:171], v[220:223], v[36:39], a[168:171]
    ds_read_b64_tr_b16 v[212:213], v230 offset:16384
    buffer_load_dwordx4 v235, s[16:19], s42 offen lds
    v_mfma_f32_16x16x32_bf16 a[172:175], v[216:219], v[40:43], 0
    v_mfma_f32_16x16x32_bf16 a[172:175], v[220:223], v[44:47], a[172:175]
    ds_read_b64_tr_b16 v[214:215], v230 offset:17408
    v_mfma_f32_16x16x32_bf16 a[176:179], v[216:219], v[48:51], 0
    ds_read_b128 v[80:83], v224 offset:32768
    s_add_u32 m0, s45, 4096
    v_mfma_f32_16x16x32_bf16 a[176:179], v[220:223], v[52:55], a[176:179]
    buffer_load_dwordx4 v236, s[16:19], s42 offen lds
    v_mfma_f32_16x16x32_bf16 a[180:183], v[216:219], v[56:59], 0
    ds_read_b128 v[84:87], v225 offset:32768
    v_mfma_f32_16x16x32_bf16 a[180:183], v[220:223], v[60:63], a[180:183]
    v_mfma_f32_16x16x32_bf16 a[184:187], v[216:219], v[64:67], 0
    ds_read_b128 v[88:91], v224 offset:34816
    s_add_u32 m0, s45, 5120
    v_mfma_f32_16x16x32_bf16 a[184:187], v[220:223], v[68:71], a[184:187]
    buffer_load_dwordx4 v237, s[16:19], s42 offen lds
    v_mfma_f32_16x16x32_bf16 a[188:191], v[216:219], v[72:75], 0
    ds_read_b128 v[92:95], v225 offset:34816
    v_mfma_f32_16x16x32_bf16 a[188:191], v[220:223], v[76:79], a[188:191]
    s_waitcnt lgkmcnt(4)
    v_mfma_f32_16x16x32_bf16 a[192:195], v[208:211], v[16:19], 0
    s_add_u32 m0, s45, 6144
    v_mfma_f32_16x16x32_bf16 a[192:195], v[212:215], v[20:23], a[192:195]
    ds_read_b64_tr_b16 v[216:217], v230 offset:8192
    buffer_load_dwordx4 v238, s[16:19], s42 offen lds
    v_mfma_f32_16x16x32_bf16 a[196:199], v[208:211], v[24:27], 0
    v_mfma_f32_16x16x32_bf16 a[196:199], v[212:215], v[28:31], a[196:199]
    ds_read_b64_tr_b16 v[218:219], v230 offset:9216
    v_mfma_f32_16x16x32_bf16 a[200:203], v[208:211], v[32:35], 0
    s_add_u32 m0, s45, 7168
    v_mfma_f32_16x16x32_bf16 a[200:203], v[212:215], v[36:39], a[200:203]
    ds_read_b64_tr_b16 v[220:221], v230 offset:24576
    buffer_load_dwordx4 v239, s[16:19], s42 offen lds
    s_add_u32 s42, s42, 128
    v_mfma_f32_16x16x32_bf16 a[204:207], v[208:211], v[40:43], 0
    v_mfma_f32_16x16x32_bf16 a[204:207], v[212:215], v[44:47], a[204:207]
    ds_read_b64_tr_b16 v[222:223], v230 offset:25600
    v_mfma_f32_16x16x32_bf16 a[208:211], v[208:211], v[48:51], 0
    ds_read_b128 v[96:99], v224 offset:36864
    v_mfma_f32_16x16x32_bf16 a[208:211], v[212:215], v[52:55], a[208:211]
    v_mfma_f32_16x16x32_bf16 a[212:215], v[208:211], v[56:59], 0
    ds_read_b128 v[100:103], v225 offset:36864
    v_mfma_f32_16x16x32_bf16 a[212:215], v[212:215], v[60:63], a[212:215]
    v_mfma_f32_16x16x32_bf16 a[216:219], v[208:211], v[64:67], 0
    ds_read_b128 v[104:107], v224 offset:38912
    s_add_u32 m0, s46, 0
    v_mfma_f32_16x16x32_bf16 a[216:219], v[212:215], v[68:71], a[216:219]
    buffer_load_dwordx4 v240, s[20:23], s43 offen lds
    s_add_u32 s43, s43, 196608
    v_mfma_f32_16x16x32_bf16 a[220:223], v[208:211], v[72:75], 0
    ds_read_b128 v[108:111], v225 offset:38912
    v_mfma_f32_16x16x32_bf16 a[220:223], v[212:215], v[76:79], a[220:223]
    s_waitcnt lgkmcnt(4)
    v_mfma_f32_16x16x32_bf16 a[224:227], v[216:219], v[16:19], 0
    s_add_u32 m0, s46, 4096
    v_mfma_f32_16x16x32_bf16 a[224:227], v[220:223], v[20:23], a[224:227]
    ds_read_b64_tr_b16 v[208:209], v231 offset:0
    buffer_load_dwordx4 v240, s[20:23], s43 offen lds
    s_add_u32 s43, s43, 196608
    v_mfma_f32_16x16x32_bf16 a[228:231], v[216:219], v[24:27], 0
    v_mfma_f32_16x16x32_bf16 a[228:231], v[220:223], v[28:31], a[228:231]
    ds_read_b64_tr_b16 v[210:211], v231 offset:1024
    v_mfma_f32_16x16x32_bf16 a[232:235], v[216:219], v[32:35], 0
    v_mfma_f32_16x16x32_bf16 a[232:235], v[220:223], v[36:39], a[232:235]
    ds_read_b64_tr_b16 v[212:213], v231 offset:16384
    v_mfma_f32_16x16x32_bf16 a[236:239], v[216:219], v[40:43], 0
    v_mfma_f32_16x16x32_bf16 a[236:239], v[220:223], v[44:47], a[236:239]
    ds_read_b64_tr_b16 v[214:215], v231 offset:17408
    v_mfma_f32_16x16x32_bf16 a[240:243], v[216:219], v[48:51], 0
    ds_read_b128 v[112:115], v224 offset:40960
    v_mfma_f32_16x16x32_bf16 a[240:243], v[220:223], v[52:55], a[240:243]
    v_mfma_f32_16x16x32_bf16 a[244:247], v[216:219], v[56:59], 0
    ds_read_b128 v[116:119], v225 offset:40960
    v_mfma_f32_16x16x32_bf16 a[244:247], v[220:223], v[60:63], a[244:247]
    v_mfma_f32_16x16x32_bf16 a[248:251], v[216:219], v[64:67], 0
    ds_read_b128 v[120:123], v224 offset:43008
    v_mfma_f32_16x16x32_bf16 a[248:251], v[220:223], v[68:71], a[248:251]
    v_mfma_f32_16x16x32_bf16 a[252:255], v[216:219], v[72:75], 0
    ds_read_b128 v[124:127], v225 offset:43008
    v_mfma_f32_16x16x32_bf16 a[252:255], v[220:223], v[76:79], a[252:255]
    s_waitcnt lgkmcnt(4)
    v_mfma_f32_16x16x32_bf16 v[144:147], v[208:211], v[16:19], 0
    buffer_load_dword v246, v254, s[68:71], s5 offen
    v_mfma_f32_16x16x32_bf16 v[144:147], v[212:215], v[20:23], v[144:147]
    ds_read_b64_tr_b16 v[216:217], v231 offset:8192
    s_add_u32 s5, s5, 393216
    v_mfma_f32_16x16x32_bf16 v[148:151], v[208:211], v[24:27], 0
    v_mfma_f32_16x16x32_bf16 v[148:151], v[212:215], v[28:31], v[148:151]
    ds_read_b64_tr_b16 v[218:219], v231 offset:9216
    v_mfma_f32_16x16x32_bf16 v[152:155], v[208:211], v[32:35], 0
    buffer_load_dword v246, v254, s[20:23], s7 offen
    v_mfma_f32_16x16x32_bf16 v[152:155], v[212:215], v[36:39], v[152:155]
    ds_read_b64_tr_b16 v[220:221], v231 offset:24576
    s_add_u32 s7, s7, 393216
    v_mfma_f32_16x16x32_bf16 v[156:159], v[208:211], v[40:43], 0
    buffer_load_dword v246, v245, s[24:27], s49 offen
    v_mfma_f32_16x16x32_bf16 v[156:159], v[212:215], v[44:47], v[156:159]
    ds_read_b64_tr_b16 v[222:223], v231 offset:25600
    s_add_u32 s49, s49, 458752
    v_mfma_f32_16x16x32_bf16 v[160:163], v[208:211], v[48:51], 0
    ds_read_b128 v[128:131], v224 offset:45056
    v_mfma_f32_16x16x32_bf16 v[160:163], v[212:215], v[52:55], v[160:163]
    buffer_load_dword v246, v0, s[16:19], s63 offen
    v_mfma_f32_16x16x32_bf16 v[164:167], v[208:211], v[56:59], 0
    ds_read_b128 v[132:135], v225 offset:45056
    s_add_u32 s63, s63, 512
    v_mfma_f32_16x16x32_bf16 v[164:167], v[212:215], v[60:63], v[164:167]
    v_mfma_f32_16x16x32_bf16 v[168:171], v[208:211], v[64:67], 0
    ds_read_b128 v[136:139], v224 offset:47104
    v_mfma_f32_16x16x32_bf16 v[168:171], v[212:215], v[68:71], v[168:171]
    v_mfma_f32_16x16x32_bf16 v[172:175], v[208:211], v[72:75], 0
    ds_read_b128 v[140:143], v225 offset:47104
    s_waitcnt vmcnt(22)
    v_mfma_f32_16x16x32_bf16 v[172:175], v[212:215], v[76:79], v[172:175]
    s_waitcnt lgkmcnt(0)
    s_barrier
    v_mfma_f32_16x16x32_bf16 v[176:179], v[216:219], v[16:19], 0
    ds_read_b64_tr_b16 v[208:209], v226 offset:8192
    v_mfma_f32_16x16x32_bf16 v[176:179], v[220:223], v[20:23], v[176:179]
    s_add_u32 m0, s47, 0
    v_mfma_f32_16x16x32_bf16 v[180:183], v[216:219], v[24:27], 0
    ds_read_b64_tr_b16 v[210:211], v226 offset:8704
    buffer_load_dwordx4 v241, s[24:27], s44 offen lds
    v_mfma_f32_16x16x32_bf16 v[180:183], v[220:223], v[28:31], v[180:183]
    v_mfma_f32_16x16x32_bf16 v[184:187], v[216:219], v[32:35], 0
    ds_read_b64_tr_b16 v[212:213], v226 offset:12288
    v_mfma_f32_16x16x32_bf16 v[184:187], v[220:223], v[36:39], v[184:187]
    v_mfma_f32_16x16x32_bf16 v[188:191], v[216:219], v[40:43], 0
    ds_read_b64_tr_b16 v[214:215], v226 offset:12800
    v_mfma_f32_16x16x32_bf16 v[188:191], v[220:223], v[44:47], v[188:191]
    v_mfma_f32_16x16x32_bf16 v[192:195], v[216:219], v[48:51], 0
    s_add_u32 m0, s47, 1024
    v_mfma_f32_16x16x32_bf16 v[192:195], v[220:223], v[52:55], v[192:195]
    buffer_load_dwordx4 v242, s[24:27], s44 offen lds
    v_mfma_f32_16x16x32_bf16 v[196:199], v[216:219], v[56:59], 0
    v_mfma_f32_16x16x32_bf16 v[196:199], v[220:223], v[60:63], v[196:199]
    v_mfma_f32_16x16x32_bf16 v[200:203], v[216:219], v[64:67], 0
    v_mfma_f32_16x16x32_bf16 v[200:203], v[220:223], v[68:71], v[200:203]
    v_mfma_f32_16x16x32_bf16 v[204:207], v[216:219], v[72:75], 0
    v_mfma_f32_16x16x32_bf16 v[204:207], v[220:223], v[76:79], v[204:207]
    s_waitcnt lgkmcnt(0)
    v_mfma_f32_16x16x32_bf16 a[0:3], v[80:83], v[208:211], a[0:3]
    s_add_u32 m0, s47, 4096
    v_mfma_f32_16x16x32_bf16 a[0:3], v[84:87], v[212:215], a[0:3]
    ds_read_b64_tr_b16 v[216:217], v227 offset:8192
    buffer_load_dwordx4 v243, s[24:27], s44 offen lds
    v_mfma_f32_16x16x32_bf16 a[4:7], v[88:91], v[208:211], a[4:7]
    v_mfma_f32_16x16x32_bf16 a[4:7], v[92:95], v[212:215], a[4:7]
    ds_read_b64_tr_b16 v[218:219], v227 offset:8704
    v_mfma_f32_16x16x32_bf16 a[8:11], v[96:99], v[208:211], a[8:11]
    v_mfma_f32_16x16x32_bf16 a[8:11], v[100:103], v[212:215], a[8:11]
    ds_read_b64_tr_b16 v[220:221], v227 offset:12288
    v_mfma_f32_16x16x32_bf16 a[12:15], v[104:107], v[208:211], a[12:15]
    v_mfma_f32_16x16x32_bf16 a[12:15], v[108:111], v[212:215], a[12:15]
    ds_read_b64_tr_b16 v[222:223], v227 offset:12800
    s_add_u32 m0, s47, 5120
    v_mfma_f32_16x16x32_bf16 a[16:19], v[112:115], v[208:211], a[16:19]
    buffer_load_dwordx4 v244, s[24:27], s44 offen lds
    s_add_u32 s44, s44, 229376
    v_mfma_f32_16x16x32_bf16 a[16:19], v[116:119], v[212:215], a[16:19]
    v_mfma_f32_16x16x32_bf16 a[20:23], v[120:123], v[208:211], a[20:23]
    v_mfma_f32_16x16x32_bf16 a[20:23], v[124:127], v[212:215], a[20:23]
    v_mfma_f32_16x16x32_bf16 a[24:27], v[128:131], v[208:211], a[24:27]
    v_mfma_f32_16x16x32_bf16 a[24:27], v[132:135], v[212:215], a[24:27]
    v_mfma_f32_16x16x32_bf16 a[28:31], v[136:139], v[208:211], a[28:31]
    s_waitcnt vmcnt(10)
    v_mfma_f32_16x16x32_bf16 a[28:31], v[140:143], v[212:215], a[28:31]
    s_waitcnt lgkmcnt(0)
    s_barrier
    s_add_u32 m0, s47, 16384
    v_mfma_f32_16x16x32_bf16 a[32:35], v[80:83], v[216:219], a[32:35]
    buffer_load_dwordx4 v241, s[24:27], s44 offen lds
    v_mfma_f32_16x16x32_bf16 a[32:35], v[84:87], v[220:223], a[32:35]
    ds_read_b64_tr_b16 v[208:209], v228 offset:32768
    v_mfma_f32_16x16x32_bf16 a[36:39], v[88:91], v[216:219], a[36:39]
    v_mfma_f32_16x16x32_bf16 a[36:39], v[92:95], v[220:223], a[36:39]
    ds_read_b64_tr_b16 v[210:211], v228 offset:33792
    v_mfma_f32_16x16x32_bf16 a[40:43], v[96:99], v[216:219], a[40:43]
    v_mfma_f32_16x16x32_bf16 a[40:43], v[100:103], v[220:223], a[40:43]
    ds_read_b64_tr_b16 v[212:213], v228 offset:49152
    v_mfma_f32_16x16x32_bf16 a[44:47], v[104:107], v[216:219], a[44:47]
    v_mfma_f32_16x16x32_bf16 a[44:47], v[108:111], v[220:223], a[44:47]
    ds_read_b64_tr_b16 v[214:215], v228 offset:50176
    s_add_u32 m0, s47, 17408
    v_mfma_f32_16x16x32_bf16 a[48:51], v[112:115], v[216:219], a[48:51]
    ds_read_b128 v[16:19], v224 offset:0
    buffer_load_dwordx4 v242, s[24:27], s44 offen lds
    v_mfma_f32_16x16x32_bf16 a[48:51], v[116:119], v[220:223], a[48:51]
    v_mfma_f32_16x16x32_bf16 a[52:55], v[120:123], v[216:219], a[52:55]
    v_mfma_f32_16x16x32_bf16 a[52:55], v[124:127], v[220:223], a[52:55]
    v_mfma_f32_16x16x32_bf16 a[56:59], v[128:131], v[216:219], a[56:59]
    ds_read_b128 v[20:23], v225 offset:0
    v_mfma_f32_16x16x32_bf16 a[56:59], v[132:135], v[220:223], a[56:59]
    v_mfma_f32_16x16x32_bf16 a[60:63], v[136:139], v[216:219], a[60:63]
    s_add_u32 m0, s47, 20480
    v_mfma_f32_16x16x32_bf16 a[60:63], v[140:143], v[220:223], a[60:63]
    s_waitcnt lgkmcnt(2)
    buffer_load_dwordx4 v243, s[24:27], s44 offen lds
    v_mfma_f32_16x16x32_bf16 a[64:67], v[208:211], v[80:83], a[64:67]
    v_mfma_f32_16x16x32_bf16 a[64:67], v[212:215], v[84:87], a[64:67]
    ds_read_b64_tr_b16 v[216:217], v228 offset:40960
    v_mfma_f32_16x16x32_bf16 a[68:71], v[208:211], v[88:91], a[68:71]
    v_mfma_f32_16x16x32_bf16 a[68:71], v[212:215], v[92:95], a[68:71]
    ds_read_b64_tr_b16 v[218:219], v228 offset:41984
    v_mfma_f32_16x16x32_bf16 a[72:75], v[208:211], v[96:99], a[72:75]
    v_mfma_f32_16x16x32_bf16 a[72:75], v[212:215], v[100:103], a[72:75]
    ds_read_b64_tr_b16 v[220:221], v228 offset:57344
    v_mfma_f32_16x16x32_bf16 a[76:79], v[208:211], v[104:107], a[76:79]
    s_add_u32 m0, s47, 21504
    v_mfma_f32_16x16x32_bf16 a[76:79], v[212:215], v[108:111], a[76:79]
    ds_read_b64_tr_b16 v[222:223], v228 offset:58368
    buffer_load_dwordx4 v244, s[24:27], s44 offen lds
    s_add_u32 s44, s44, 229376
    v_mfma_f32_16x16x32_bf16 a[80:83], v[208:211], v[112:115], a[80:83]
    ds_read_b128 v[24:27], v224 offset:2048
    v_mfma_f32_16x16x32_bf16 a[80:83], v[212:215], v[116:119], a[80:83]
    v_mfma_f32_16x16x32_bf16 a[84:87], v[208:211], v[120:123], a[84:87]
    v_mfma_f32_16x16x32_bf16 a[84:87], v[212:215], v[124:127], a[84:87]
    v_mfma_f32_16x16x32_bf16 a[88:91], v[208:211], v[128:131], a[88:91]
    ds_read_b128 v[28:31], v225 offset:2048
    v_mfma_f32_16x16x32_bf16 a[88:91], v[212:215], v[132:135], a[88:91]
    v_mfma_f32_16x16x32_bf16 a[92:95], v[208:211], v[136:139], a[92:95]
    s_add_u32 m0, s45, 32768
    v_mfma_f32_16x16x32_bf16 a[92:95], v[212:215], v[140:143], a[92:95]
    s_waitcnt lgkmcnt(2)
    buffer_load_dwordx4 v232, s[16:19], s42 offen lds
    v_mfma_f32_16x16x32_bf16 a[96:99], v[216:219], v[80:83], a[96:99]
    v_mfma_f32_16x16x32_bf16 a[96:99], v[220:223], v[84:87], a[96:99]
    ds_read_b64_tr_b16 v[208:209], v229 offset:32768
    v_mfma_f32_16x16x32_bf16 a[100:103], v[216:219], v[88:91], a[100:103]
    v_mfma_f32_16x16x32_bf16 a[100:103], v[220:223], v[92:95], a[100:103]
    ds_read_b64_tr_b16 v[210:211], v229 offset:33792
    v_mfma_f32_16x16x32_bf16 a[104:107], v[216:219], v[96:99], a[104:107]
    v_mfma_f32_16x16x32_bf16 a[104:107], v[220:223], v[100:103], a[104:107]
    ds_read_b64_tr_b16 v[212:213], v229 offset:49152
    v_mfma_f32_16x16x32_bf16 a[108:111], v[216:219], v[104:107], a[108:111]
    s_add_u32 m0, s45, 33792
    v_mfma_f32_16x16x32_bf16 a[108:111], v[220:223], v[108:111], a[108:111]
    ds_read_b64_tr_b16 v[214:215], v229 offset:50176
    buffer_load_dwordx4 v233, s[16:19], s42 offen lds
    v_mfma_f32_16x16x32_bf16 a[112:115], v[216:219], v[112:115], a[112:115]
    ds_read_b128 v[32:35], v224 offset:4096
    v_mfma_f32_16x16x32_bf16 a[112:115], v[220:223], v[116:119], a[112:115]
    v_mfma_f32_16x16x32_bf16 a[116:119], v[216:219], v[120:123], a[116:119]
    v_mfma_f32_16x16x32_bf16 a[116:119], v[220:223], v[124:127], a[116:119]
    v_mfma_f32_16x16x32_bf16 a[120:123], v[216:219], v[128:131], a[120:123]
    ds_read_b128 v[36:39], v225 offset:4096
    v_mfma_f32_16x16x32_bf16 a[120:123], v[220:223], v[132:135], a[120:123]
    s_add_u32 m0, s45, 34816
    v_mfma_f32_16x16x32_bf16 a[124:127], v[216:219], v[136:139], a[124:127]
    buffer_load_dwordx4 v234, s[16:19], s42 offen lds
    v_mfma_f32_16x16x32_bf16 a[124:127], v[220:223], v[140:143], a[124:127]
    s_waitcnt lgkmcnt(2)
    v_mfma_f32_16x16x32_bf16 a[128:131], v[208:211], v[80:83], a[128:131]
    v_mfma_f32_16x16x32_bf16 a[128:131], v[212:215], v[84:87], a[128:131]
    ds_read_b64_tr_b16 v[216:217], v229 offset:40960
    v_mfma_f32_16x16x32_bf16 a[132:135], v[208:211], v[88:91], a[132:135]
    v_mfma_f32_16x16x32_bf16 a[132:135], v[212:215], v[92:95], a[132:135]
    ds_read_b64_tr_b16 v[218:219], v229 offset:41984
    v_mfma_f32_16x16x32_bf16 a[136:139], v[208:211], v[96:99], a[136:139]
    v_mfma_f32_16x16x32_bf16 a[136:139], v[212:215], v[100:103], a[136:139]
    ds_read_b64_tr_b16 v[220:221], v229 offset:57344
    s_add_u32 m0, s45, 35840
    v_mfma_f32_16x16x32_bf16 a[140:143], v[208:211], v[104:107], a[140:143]
    buffer_load_dwordx4 v235, s[16:19], s42 offen lds
    v_mfma_f32_16x16x32_bf16 a[140:143], v[212:215], v[108:111], a[140:143]
    ds_read_b64_tr_b16 v[222:223], v229 offset:58368
    v_mfma_f32_16x16x32_bf16 a[144:147], v[208:211], v[112:115], a[144:147]
    ds_read_b128 v[40:43], v224 offset:6144
    v_mfma_f32_16x16x32_bf16 a[144:147], v[212:215], v[116:119], a[144:147]
    v_mfma_f32_16x16x32_bf16 a[148:151], v[208:211], v[120:123], a[148:151]
    v_mfma_f32_16x16x32_bf16 a[148:151], v[212:215], v[124:127], a[148:151]
    v_mfma_f32_16x16x32_bf16 a[152:155], v[208:211], v[128:131], a[152:155]
    ds_read_b128 v[44:47], v225 offset:6144
    v_mfma_f32_16x16x32_bf16 a[152:155], v[212:215], v[132:135], a[152:155]
    s_add_u32 m0, s45, 36864
    v_mfma_f32_16x16x32_bf16 a[156:159], v[208:211], v[136:139], a[156:159]
    buffer_load_dwordx4 v236, s[16:19], s42 offen lds
    v_mfma_f32_16x16x32_bf16 a[156:159], v[212:215], v[140:143], a[156:159]
    s_waitcnt lgkmcnt(2)
    v_mfma_f32_16x16x32_bf16 a[160:163], v[216:219], v[80:83], a[160:163]
    v_mfma_f32_16x16x32_bf16 a[160:163], v[220:223], v[84:87], a[160:163]
    ds_read_b64_tr_b16 v[208:209], v230 offset:32768
    v_mfma_f32_16x16x32_bf16 a[164:167], v[216:219], v[88:91], a[164:167]
    v_mfma_f32_16x16x32_bf16 a[164:167], v[220:223], v[92:95], a[164:167]
    ds_read_b64_tr_b16 v[210:211], v230 offset:33792
    v_mfma_f32_16x16x32_bf16 a[168:171], v[216:219], v[96:99], a[168:171]
    s_add_u32 m0, s45, 37888
    v_mfma_f32_16x16x32_bf16 a[168:171], v[220:223], v[100:103], a[168:171]
    ds_read_b64_tr_b16 v[212:213], v230 offset:49152
    buffer_load_dwordx4 v237, s[16:19], s42 offen lds
    v_mfma_f32_16x16x32_bf16 a[172:175], v[216:219], v[104:107], a[172:175]
    v_mfma_f32_16x16x32_bf16 a[172:175], v[220:223], v[108:111], a[172:175]
    ds_read_b64_tr_b16 v[214:215], v230 offset:50176
    v_mfma_f32_16x16x32_bf16 a[176:179], v[216:219], v[112:115], a[176:179]
    ds_read_b128 v[48:51], v224 offset:8192
    v_mfma_f32_16x16x32_bf16 a[176:179], v[220:223], v[116:119], a[176:179]
    v_mfma_f32_16x16x32_bf16 a[180:183], v[216:219], v[120:123], a[180:183]
    v_mfma_f32_16x16x32_bf16 a[180:183], v[220:223], v[124:127], a[180:183]
    v_mfma_f32_16x16x32_bf16 a[184:187], v[216:219], v[128:131], a[184:187]
    ds_read_b128 v[52:55], v225 offset:8192
    s_add_u32 m0, s45, 38912
    v_mfma_f32_16x16x32_bf16 a[184:187], v[220:223], v[132:135], a[184:187]
    buffer_load_dwordx4 v238, s[16:19], s42 offen lds
    v_mfma_f32_16x16x32_bf16 a[188:191], v[216:219], v[136:139], a[188:191]
    v_mfma_f32_16x16x32_bf16 a[188:191], v[220:223], v[140:143], a[188:191]
    s_waitcnt lgkmcnt(2)
    v_mfma_f32_16x16x32_bf16 a[192:195], v[208:211], v[80:83], a[192:195]
    v_mfma_f32_16x16x32_bf16 a[192:195], v[212:215], v[84:87], a[192:195]
    ds_read_b64_tr_b16 v[216:217], v230 offset:40960
    v_mfma_f32_16x16x32_bf16 a[196:199], v[208:211], v[88:91], a[196:199]
    v_mfma_f32_16x16x32_bf16 a[196:199], v[212:215], v[92:95], a[196:199]
    ds_read_b64_tr_b16 v[218:219], v230 offset:41984
    v_mfma_f32_16x16x32_bf16 a[200:203], v[208:211], v[96:99], a[200:203]
    s_add_u32 m0, s45, 39936
    v_mfma_f32_16x16x32_bf16 a[200:203], v[212:215], v[100:103], a[200:203]
    ds_read_b64_tr_b16 v[220:221], v230 offset:57344
    buffer_load_dwordx4 v239, s[16:19], s42 offen lds
    s_add_u32 s42, s42, 128
    v_mfma_f32_16x16x32_bf16 a[204:207], v[208:211], v[104:107], a[204:207]
    v_mfma_f32_16x16x32_bf16 a[204:207], v[212:215], v[108:111], a[204:207]
    ds_read_b64_tr_b16 v[222:223], v230 offset:58368
    v_mfma_f32_16x16x32_bf16 a[208:211], v[208:211], v[112:115], a[208:211]
    ds_read_b128 v[56:59], v224 offset:10240
    v_mfma_f32_16x16x32_bf16 a[208:211], v[212:215], v[116:119], a[208:211]
    v_mfma_f32_16x16x32_bf16 a[212:215], v[208:211], v[120:123], a[212:215]
    v_mfma_f32_16x16x32_bf16 a[212:215], v[212:215], v[124:127], a[212:215]
    v_mfma_f32_16x16x32_bf16 a[216:219], v[208:211], v[128:131], a[216:219]
    ds_read_b128 v[60:63], v225 offset:10240
    s_add_u32 m0, s46, 8192
    v_mfma_f32_16x16x32_bf16 a[216:219], v[212:215], v[132:135], a[216:219]
    buffer_load_dwordx4 v240, s[20:23], s43 offen lds
    s_add_u32 s43, s43, 196608
    v_mfma_f32_16x16x32_bf16 a[220:223], v[208:211], v[136:139], a[220:223]
    v_mfma_f32_16x16x32_bf16 a[220:223], v[212:215], v[140:143], a[220:223]
    s_waitcnt lgkmcnt(2)
    v_mfma_f32_16x16x32_bf16 a[224:227], v[216:219], v[80:83], a[224:227]
    s_add_u32 m0, s46, 12288
    v_mfma_f32_16x16x32_bf16 a[224:227], v[220:223], v[84:87], a[224:227]
    ds_read_b64_tr_b16 v[208:209], v231 offset:32768
    buffer_load_dwordx4 v240, s[20:23], s43 offen lds
    s_add_u32 s43, s43, 196608
    v_mfma_f32_16x16x32_bf16 a[228:231], v[216:219], v[88:91], a[228:231]
    v_mfma_f32_16x16x32_bf16 a[228:231], v[220:223], v[92:95], a[228:231]
    ds_read_b64_tr_b16 v[210:211], v231 offset:33792
    v_mfma_f32_16x16x32_bf16 a[232:235], v[216:219], v[96:99], a[232:235]
    v_mfma_f32_16x16x32_bf16 a[232:235], v[220:223], v[100:103], a[232:235]
    ds_read_b64_tr_b16 v[212:213], v231 offset:49152
    v_mfma_f32_16x16x32_bf16 a[236:239], v[216:219], v[104:107], a[236:239]
    v_mfma_f32_16x16x32_bf16 a[236:239], v[220:223], v[108:111], a[236:239]
    ds_read_b64_tr_b16 v[214:215], v231 offset:50176
    v_mfma_f32_16x16x32_bf16 a[240:243], v[216:219], v[112:115], a[240:243]
    ds_read_b128 v[64:67], v224 offset:12288
    v_mfma_f32_16x16x32_bf16 a[240:243], v[220:223], v[116:119], a[240:243]
    v_mfma_f32_16x16x32_bf16 a[244:247], v[216:219], v[120:123], a[244:247]
    v_mfma_f32_16x16x32_bf16 a[244:247], v[220:223], v[124:127], a[244:247]
    v_mfma_f32_16x16x32_bf16 a[248:251], v[216:219], v[128:131], a[248:251]
    ds_read_b128 v[68:71], v225 offset:12288
    v_mfma_f32_16x16x32_bf16 a[248:251], v[220:223], v[132:135], a[248:251]
    v_mfma_f32_16x16x32_bf16 a[252:255], v[216:219], v[136:139], a[252:255]
    buffer_load_dword v246, v245, s[64:67], s6 offen
    v_mfma_f32_16x16x32_bf16 a[252:255], v[220:223], v[140:143], a[252:255]
    s_waitcnt lgkmcnt(2)
    s_add_u32 s6, s6, 1048576
    v_mfma_f32_16x16x32_bf16 v[144:147], v[208:211], v[80:83], v[144:147]
    s_cmp_eq_u32 s48, s86
    v_mfma_f32_16x16x32_bf16 v[144:147], v[212:215], v[84:87], v[144:147]
    ds_read_b64_tr_b16 v[216:217], v231 offset:40960
    s_cselect_b32 s87, 0, 0x40000000
    v_mfma_f32_16x16x32_bf16 v[148:151], v[208:211], v[88:91], v[148:151]
    buffer_atomic_add v249, v248, s[76:79], s87 offen sc1
    v_mfma_f32_16x16x32_bf16 v[148:151], v[212:215], v[92:95], v[148:151]
    ds_read_b64_tr_b16 v[218:219], v231 offset:41984
    v_mfma_f32_16x16x32_bf16 v[152:155], v[208:211], v[96:99], v[152:155]
    buffer_load_dword v246, v254, s[20:23], s7 offen
    v_mfma_f32_16x16x32_bf16 v[152:155], v[212:215], v[100:103], v[152:155]
    ds_read_b64_tr_b16 v[220:221], v231 offset:57344
    s_add_u32 s7, s7, 393216
    v_mfma_f32_16x16x32_bf16 v[156:159], v[208:211], v[104:107], v[156:159]
    buffer_load_dword v246, v245, s[24:27], s49 offen
    v_mfma_f32_16x16x32_bf16 v[156:159], v[212:215], v[108:111], v[156:159]
    ds_read_b64_tr_b16 v[222:223], v231 offset:58368
    s_add_u32 s49, s49, 458752
    v_mfma_f32_16x16x32_bf16 v[160:163], v[208:211], v[112:115], v[160:163]
    ds_read_b128 v[72:75], v224 offset:14336
    v_mfma_f32_16x16x32_bf16 v[160:163], v[212:215], v[116:119], v[160:163]
    v_mfma_f32_16x16x32_bf16 v[164:167], v[208:211], v[120:123], v[164:167]
    v_mfma_f32_16x16x32_bf16 v[164:167], v[212:215], v[124:127], v[164:167]
    v_mfma_f32_16x16x32_bf16 v[168:171], v[208:211], v[128:131], v[168:171]
    ds_read_b128 v[76:79], v225 offset:14336
    v_mfma_f32_16x16x32_bf16 v[168:171], v[212:215], v[132:135], v[168:171]
    v_mfma_f32_16x16x32_bf16 v[172:175], v[208:211], v[136:139], v[172:175]
    s_waitcnt vmcnt(26)
    v_mfma_f32_16x16x32_bf16 v[172:175], v[212:215], v[140:143], v[172:175]
    s_waitcnt lgkmcnt(0)
    s_barrier
    v_mfma_f32_16x16x32_bf16 v[176:179], v[216:219], v[80:83], v[176:179]
    ds_read_b64_tr_b16 v[208:209], v226 offset:0
    v_mfma_f32_16x16x32_bf16 v[176:179], v[220:223], v[84:87], v[176:179]
    s_add_u32 m0, s47, 32768
    v_mfma_f32_16x16x32_bf16 v[180:183], v[216:219], v[88:91], v[180:183]
    ds_read_b64_tr_b16 v[210:211], v226 offset:512
    buffer_load_dwordx4 v241, s[24:27], s44 offen lds
    v_mfma_f32_16x16x32_bf16 v[180:183], v[220:223], v[92:95], v[180:183]
    v_mfma_f32_16x16x32_bf16 v[184:187], v[216:219], v[96:99], v[184:187]
    ds_read_b64_tr_b16 v[212:213], v226 offset:4096
    v_mfma_f32_16x16x32_bf16 v[184:187], v[220:223], v[100:103], v[184:187]
    v_mfma_f32_16x16x32_bf16 v[188:191], v[216:219], v[104:107], v[188:191]
    ds_read_b64_tr_b16 v[214:215], v226 offset:4608
    v_mfma_f32_16x16x32_bf16 v[188:191], v[220:223], v[108:111], v[188:191]
    v_mfma_f32_16x16x32_bf16 v[192:195], v[216:219], v[112:115], v[192:195]
    s_add_u32 m0, s47, 33792
    v_mfma_f32_16x16x32_bf16 v[192:195], v[220:223], v[116:119], v[192:195]
    buffer_load_dwordx4 v242, s[24:27], s44 offen lds
    v_mfma_f32_16x16x32_bf16 v[196:199], v[216:219], v[120:123], v[196:199]
    v_mfma_f32_16x16x32_bf16 v[196:199], v[220:223], v[124:127], v[196:199]
    v_mfma_f32_16x16x32_bf16 v[200:203], v[216:219], v[128:131], v[200:203]
    v_mfma_f32_16x16x32_bf16 v[200:203], v[220:223], v[132:135], v[200:203]
    v_mfma_f32_16x16x32_bf16 v[204:207], v[216:219], v[136:139], v[204:207]
    v_mfma_f32_16x16x32_bf16 v[204:207], v[220:223], v[140:143], v[204:207]
    s_waitcnt lgkmcnt(0)
    s_mov_b32 s48, 6
.p2align 6
p1B_loop:
    v_mfma_f32_16x16x32_bf16 a[0:3], v[16:19], v[208:211], a[0:3]
    s_add_u32 m0, s47, 36864
    v_mfma_f32_16x16x32_bf16 a[0:3], v[20:23], v[212:215], a[0:3]
    ds_read_b64_tr_b16 v[216:217], v227 offset:0
    buffer_load_dwordx4 v243, s[24:27], s44 offen lds
    v_mfma_f32_16x16x32_bf16 a[4:7], v[24:27], v[208:211], a[4:7]
    v_mfma_f32_16x16x32_bf16 a[4:7], v[28:31], v[212:215], a[4:7]
    ds_read_b64_tr_b16 v[218:219], v227 offset:512
    v_mfma_f32_16x16x32_bf16 a[8:11], v[32:35], v[208:211], a[8:11]
    v_mfma_f32_16x16x32_bf16 a[8:11], v[36:39], v[212:215], a[8:11]
    ds_read_b64_tr_b16 v[220:221], v227 offset:4096
    v_mfma_f32_16x16x32_bf16 a[12:15], v[40:43], v[208:211], a[12:15]
    v_mfma_f32_16x16x32_bf16 a[12:15], v[44:47], v[212:215], a[12:15]
    ds_read_b64_tr_b16 v[222:223], v227 offset:4608
    s_add_u32 m0, s47, 37888
    v_mfma_f32_16x16x32_bf16 a[16:19], v[48:51], v[208:211], a[16:19]
    buffer_load_dwordx4 v244, s[24:27], s44 offen lds
    s_add_u32 s44, s44, 229376
    v_mfma_f32_16x16x32_bf16 a[16:19], v[52:55], v[212:215], a[16:19]
    v_mfma_f32_16x16x32_bf16 a[20:23], v[56:59], v[208:211], a[20:23]
    v_mfma_f32_16x16x32_bf16 a[20:23], v[60:63], v[212:215], a[20:23]
    v_mfma_f32_16x16x32_bf16 a[24:27], v[64:67], v[208:211], a[24:27]
    v_mfma_f32_16x16x32_bf16 a[24:27], v[68:71], v[212:215], a[24:27]
    v_mfma_f32_16x16x32_bf16 a[28:31], v[72:75], v[208:211], a[28:31]
    s_waitcnt vmcnt(10)
    v_mfma_f32_16x16x32_bf16 a[28:31], v[76:79], v[212:215], a[28:31]
    s_waitcnt lgkmcnt(0)
    s_barrier
    s_add_u32 m0, s47, 49152
    v_mfma_f32_16x16x32_bf16 a[32:35], v[16:19], v[216:219], a[32:35]
    buffer_load_dwordx4 v241, s[24:27], s44 offen lds
    v_mfma_f32_16x16x32_bf16 a[32:35], v[20:23], v[220:223], a[32:35]
    ds_read_b64_tr_b16 v[208:209], v228 offset:0
    v_mfma_f32_16x16x32_bf16 a[36:39], v[24:27], v[216:219], a[36:39]
    v_mfma_f32_16x16x32_bf16 a[36:39], v[28:31], v[220:223], a[36:39]
    ds_read_b64_tr_b16 v[210:211], v228 offset:1024
    v_mfma_f32_16x16x32_bf16 a[40:43], v[32:35], v[216:219], a[40:43]
    v_mfma_f32_16x16x32_bf16 a[40:43], v[36:39], v[220:223], a[40:43]
    ds_read_b64_tr_b16 v[212:213], v228 offset:16384
    v_mfma_f32_16x16x32_bf16 a[44:47], v[40:43], v[216:219], a[44:47]
    v_mfma_f32_16x16x32_bf16 a[44:47], v[44:47], v[220:223], a[44:47]
    ds_read_b64_tr_b16 v[214:215], v228 offset:17408
    s_add_u32 m0, s47, 50176
    v_mfma_f32_16x16x32_bf16 a[48:51], v[48:51], v[216:219], a[48:51]
    ds_read_b128 v[80:83], v224 offset:32768
    buffer_load_dwordx4 v242, s[24:27], s44 offen lds
    v_mfma_f32_16x16x32_bf16 a[48:51], v[52:55], v[220:223], a[48:51]
    v_mfma_f32_16x16x32_bf16 a[52:55], v[56:59], v[216:219], a[52:55]
    v_mfma_f32_16x16x32_bf16 a[52:55], v[60:63], v[220:223], a[52:55]
    v_mfma_f32_16x16x32_bf16 a[56:59], v[64:67], v[216:219], a[56:59]
    ds_read_b128 v[84:87], v225 offset:32768
    v_mfma_f32_16x16x32_bf16 a[56:59], v[68:71], v[220:223], a[56:59]
    v_mfma_f32_16x16x32_bf16 a[60:63], v[72:75], v[216:219], a[60:63]
    s_add_u32 m0, s47, 53248
    v_mfma_f32_16x16x32_bf16 a[60:63], v[76:79], v[220:223], a[60:63]
    s_waitcnt lgkmcnt(2)
    buffer_load_dwordx4 v243, s[24:27], s44 offen lds
    v_mfma_f32_16x16x32_bf16 a[64:67], v[208:211], v[16:19], a[64:67]
    v_mfma_f32_16x16x32_bf16 a[64:67], v[212:215], v[20:23], a[64:67]
    ds_read_b64_tr_b16 v[216:217], v228 offset:8192
    v_mfma_f32_16x16x32_bf16 a[68:71], v[208:211], v[24:27], a[68:71]
    v_mfma_f32_16x16x32_bf16 a[68:71], v[212:215], v[28:31], a[68:71]
    ds_read_b64_tr_b16 v[218:219], v228 offset:9216
    v_mfma_f32_16x16x32_bf16 a[72:75], v[208:211], v[32:35], a[72:75]
    v_mfma_f32_16x16x32_bf16 a[72:75], v[212:215], v[36:39], a[72:75]
    ds_read_b64_tr_b16 v[220:221], v228 offset:24576
    v_mfma_f32_16x16x32_bf16 a[76:79], v[208:211], v[40:43], a[76:79]
    s_add_u32 m0, s47, 54272
    v_mfma_f32_16x16x32_bf16 a[76:79], v[212:215], v[44:47], a[76:79]
    ds_read_b64_tr_b16 v[222:223], v228 offset:25600
    buffer_load_dwordx4 v244, s[24:27], s44 offen lds
    s_add_u32 s44, s44, 229376
    v_mfma_f32_16x16x32_bf16 a[80:83], v[208:211], v[48:51], a[80:83]
    ds_read_b128 v[88:91], v224 offset:34816
    v_mfma_f32_16x16x32_bf16 a[80:83], v[212:215], v[52:55], a[80:83]
    v_mfma_f32_16x16x32_bf16 a[84:87], v[208:211], v[56:59], a[84:87]
    v_mfma_f32_16x16x32_bf16 a[84:87], v[212:215], v[60:63], a[84:87]
    v_mfma_f32_16x16x32_bf16 a[88:91], v[208:211], v[64:67], a[88:91]
    ds_read_b128 v[92:95], v225 offset:34816
    v_mfma_f32_16x16x32_bf16 a[88:91], v[212:215], v[68:71], a[88:91]
    v_mfma_f32_16x16x32_bf16 a[92:95], v[208:211], v[72:75], a[92:95]
    s_add_u32 m0, s45, 0
    v_mfma_f32_16x16x32_bf16 a[92:95], v[212:215], v[76:79], a[92:95]
    s_waitcnt lgkmcnt(2)
    buffer_load_dwordx4 v232, s[16:19], s42 offen lds
    v_mfma_f32_16x16x32_bf16 a[96:99], v[216:219], v[16:19], a[96:99]
    v_mfma_f32_16x16x32_bf16 a[96:99], v[220:223], v[20:23], a[96:99]
    ds_read_b64_tr_b16 v[208:209], v229 offset:0
    v_mfma_f32_16x16x32_bf16 a[100:103], v[216:219], v[24:27], a[100:103]
    v_mfma_f32_16x16x32_bf16 a[100:103], v[220:223], v[28:31], a[100:103]
    ds_read_b64_tr_b16 v[210:211], v229 offset:1024
    v_mfma_f32_16x16x32_bf16 a[104:107], v[216:219], v[32:35], a[104:107]
    v_mfma_f32_16x16x32_bf16 a[104:107], v[220:223], v[36:39], a[104:107]
    ds_read_b64_tr_b16 v[212:213], v229 offset:16384
    v_mfma_f32_16x16x32_bf16 a[108:111], v[216:219], v[40:43], a[108:111]
    s_add_u32 m0, s45, 1024
    v_mfma_f32_16x16x32_bf16 a[108:111], v[220:223], v[44:47], a[108:111]
    ds_read_b64_tr_b16 v[214:215], v229 offset:17408
    buffer_load_dwordx4 v233, s[16:19], s42 offen lds
    v_mfma_f32_16x16x32_bf16 a[112:115], v[216:219], v[48:51], a[112:115]
    ds_read_b128 v[96:99], v224 offset:36864
    v_mfma_f32_16x16x32_bf16 a[112:115], v[220:223], v[52:55], a[112:115]
    v_mfma_f32_16x16x32_bf16 a[116:119], v[216:219], v[56:59], a[116:119]
    v_mfma_f32_16x16x32_bf16 a[116:119], v[220:223], v[60:63], a[116:119]
    v_mfma_f32_16x16x32_bf16 a[120:123], v[216:219], v[64:67], a[120:123]
    ds_read_b128 v[100:103], v225 offset:36864
    v_mfma_f32_16x16x32_bf16 a[120:123], v[220:223], v[68:71], a[120:123]
    s_add_u32 m0, s45, 2048
    v_mfma_f32_16x16x32_bf16 a[124:127], v[216:219], v[72:75], a[124:127]
    buffer_load_dwordx4 v234, s[16:19], s42 offen lds
    v_mfma_f32_16x16x32_bf16 a[124:127], v[220:223], v[76:79], a[124:127]
    s_waitcnt lgkmcnt(2)
    v_mfma_f32_16x16x32_bf16 a[128:131], v[208:211], v[16:19], a[128:131]
    v_mfma_f32_16x16x32_bf16 a[128:131], v[212:215], v[20:23], a[128:131]
    ds_read_b64_tr_b16 v[216:217], v229 offset:8192
    v_mfma_f32_16x16x32_bf16 a[132:135], v[208:211], v[24:27], a[132:135]
    v_mfma_f32_16x16x32_bf16 a[132:135], v[212:215], v[28:31], a[132:135]
    ds_read_b64_tr_b16 v[218:219], v229 offset:9216
    v_mfma_f32_16x16x32_bf16 a[136:139], v[208:211], v[32:35], a[136:139]
    v_mfma_f32_16x16x32_bf16 a[136:139], v[212:215], v[36:39], a[136:139]
    ds_read_b64_tr_b16 v[220:221], v229 offset:24576
    s_add_u32 m0, s45, 3072
    v_mfma_f32_16x16x32_bf16 a[140:143], v[208:211], v[40:43], a[140:143]
    buffer_load_dwordx4 v235, s[16:19], s42 offen lds
    v_mfma_f32_16x16x32_bf16 a[140:143], v[212:215], v[44:47], a[140:143]
    ds_read_b64_tr_b16 v[222:223], v229 offset:25600
    v_mfma_f32_16x16x32_bf16 a[144:147], v[208:211], v[48:51], a[144:147]
    ds_read_b128 v[104:107], v224 offset:38912
    v_mfma_f32_16x16x32_bf16 a[144:147], v[212:215], v[52:55], a[144:147]
    v_mfma_f32_16x16x32_bf16 a[148:151], v[208:211], v[56:59], a[148:151]
    v_mfma_f32_16x16x32_bf16 a[148:151], v[212:215], v[60:63], a[148:151]
    v_mfma_f32_16x16x32_bf16 a[152:155], v[208:211], v[64:67], a[152:155]
    ds_read_b128 v[108:111], v225 offset:38912
    v_mfma_f32_16x16x32_bf16 a[152:155], v[212:215], v[68:71], a[152:155]
    s_add_u32 m0, s45, 4096
    v_mfma_f32_16x16x32_bf16 a[156:159], v[208:211], v[72:75], a[156:159]
    buffer_load_dwordx4 v236, s[16:19], s42 offen lds
    v_mfma_f32_16x16x32_bf16 a[156:159], v[212:215], v[76:79], a[156:159]
    s_waitcnt lgkmcnt(2)
    v_mfma_f32_16x16x32_bf16 a[160:163], v[216:219], v[16:19], a[160:163]
    v_mfma_f32_16x16x32_bf16 a[160:163], v[220:223], v[20:23], a[160:163]
    ds_read_b64_tr_b16 v[208:209], v230 offset:0
    v_mfma_f32_16x16x32_bf16 a[164:167], v[216:219], v[24:27], a[164:167]
    v_mfma_f32_16x16x32_bf16 a[164:167], v[220:223], v[28:31], a[164:167]
    ds_read_b64_tr_b16 v[210:211], v230 offset:1024
    v_mfma_f32_16x16x32_bf16 a[168:171], v[216:219], v[32:35], a[168:171]
    s_add_u32 m0, s45, 5120
    v_mfma_f32_16x16x32_bf16 a[168:171], v[220:223], v[36:39], a[168:171]
    ds_read_b64_tr_b16 v[212:213], v230 offset:16384
    buffer_load_dwordx4 v237, s[16:19], s42 offen lds
    v_mfma_f32_16x16x32_bf16 a[172:175], v[216:219], v[40:43], a[172:175]
    v_mfma_f32_16x16x32_bf16 a[172:175], v[220:223], v[44:47], a[172:175]
    ds_read_b64_tr_b16 v[214:215], v230 offset:17408
    v_mfma_f32_16x16x32_bf16 a[176:179], v[216:219], v[48:51], a[176:179]
    ds_read_b128 v[112:115], v224 offset:40960
    v_mfma_f32_16x16x32_bf16 a[176:179], v[220:223], v[52:55], a[176:179]
    v_mfma_f32_16x16x32_bf16 a[180:183], v[216:219], v[56:59], a[180:183]
    v_mfma_f32_16x16x32_bf16 a[180:183], v[220:223], v[60:63], a[180:183]
    v_mfma_f32_16x16x32_bf16 a[184:187], v[216:219], v[64:67], a[184:187]
    ds_read_b128 v[116:119], v225 offset:40960
    s_add_u32 m0, s45, 6144
    v_mfma_f32_16x16x32_bf16 a[184:187], v[220:223], v[68:71], a[184:187]
    buffer_load_dwordx4 v238, s[16:19], s42 offen lds
    v_mfma_f32_16x16x32_bf16 a[188:191], v[216:219], v[72:75], a[188:191]
    v_mfma_f32_16x16x32_bf16 a[188:191], v[220:223], v[76:79], a[188:191]
    s_waitcnt lgkmcnt(2)
    v_mfma_f32_16x16x32_bf16 a[192:195], v[208:211], v[16:19], a[192:195]
    v_mfma_f32_16x16x32_bf16 a[192:195], v[212:215], v[20:23], a[192:195]
    ds_read_b64_tr_b16 v[216:217], v230 offset:8192
    v_mfma_f32_16x16x32_bf16 a[196:199], v[208:211], v[24:27], a[196:199]
    v_mfma_f32_16x16x32_bf16 a[196:199], v[212:215], v[28:31], a[196:199]
    ds_read_b64_tr_b16 v[218:219], v230 offset:9216
    v_mfma_f32_16x16x32_bf16 a[200:203], v[208:211], v[32:35], a[200:203]
    s_add_u32 m0, s45, 7168
    v_mfma_f32_16x16x32_bf16 a[200:203], v[212:215], v[36:39], a[200:203]
    ds_read_b64_tr_b16 v[220:221], v230 offset:24576
    buffer_load_dwordx4 v239, s[16:19], s42 offen lds
    s_add_u32 s42, s42, 128
    v_mfma_f32_16x16x32_bf16 a[204:207], v[208:211], v[40:43], a[204:207]
    v_mfma_f32_16x16x32_bf16 a[204:207], v[212:215], v[44:47], a[204:207]
    ds_read_b64_tr_b16 v[222:223], v230 offset:25600
    v_mfma_f32_16x16x32_bf16 a[208:211], v[208:211], v[48:51], a[208:211]
    ds_read_b128 v[120:123], v224 offset:43008
    v_mfma_f32_16x16x32_bf16 a[208:211], v[212:215], v[52:55], a[208:211]
    v_mfma_f32_16x16x32_bf16 a[212:215], v[208:211], v[56:59], a[212:215]
    v_mfma_f32_16x16x32_bf16 a[212:215], v[212:215], v[60:63], a[212:215]
    v_mfma_f32_16x16x32_bf16 a[216:219], v[208:211], v[64:67], a[216:219]
    ds_read_b128 v[124:127], v225 offset:43008
    s_add_u32 m0, s46, 0
    v_mfma_f32_16x16x32_bf16 a[216:219], v[212:215], v[68:71], a[216:219]
    buffer_load_dwordx4 v240, s[20:23], s43 offen lds
    s_add_u32 s43, s43, 196608
    v_mfma_f32_16x16x32_bf16 a[220:223], v[208:211], v[72:75], a[220:223]
    v_mfma_f32_16x16x32_bf16 a[220:223], v[212:215], v[76:79], a[220:223]
    s_waitcnt lgkmcnt(2)
    v_mfma_f32_16x16x32_bf16 a[224:227], v[216:219], v[16:19], a[224:227]
    s_add_u32 m0, s46, 4096
    v_mfma_f32_16x16x32_bf16 a[224:227], v[220:223], v[20:23], a[224:227]
    ds_read_b64_tr_b16 v[208:209], v231 offset:0
    buffer_load_dwordx4 v240, s[20:23], s43 offen lds
    s_add_u32 s43, s43, 196608
    v_mfma_f32_16x16x32_bf16 a[228:231], v[216:219], v[24:27], a[228:231]
    v_mfma_f32_16x16x32_bf16 a[228:231], v[220:223], v[28:31], a[228:231]
    ds_read_b64_tr_b16 v[210:211], v231 offset:1024
    v_mfma_f32_16x16x32_bf16 a[232:235], v[216:219], v[32:35], a[232:235]
    v_mfma_f32_16x16x32_bf16 a[232:235], v[220:223], v[36:39], a[232:235]
    ds_read_b64_tr_b16 v[212:213], v231 offset:16384
    v_mfma_f32_16x16x32_bf16 a[236:239], v[216:219], v[40:43], a[236:239]
    v_mfma_f32_16x16x32_bf16 a[236:239], v[220:223], v[44:47], a[236:239]
    ds_read_b64_tr_b16 v[214:215], v231 offset:17408
    v_mfma_f32_16x16x32_bf16 a[240:243], v[216:219], v[48:51], a[240:243]
    ds_read_b128 v[128:131], v224 offset:45056
    v_mfma_f32_16x16x32_bf16 a[240:243], v[220:223], v[52:55], a[240:243]
    v_mfma_f32_16x16x32_bf16 a[244:247], v[216:219], v[56:59], a[244:247]
    v_mfma_f32_16x16x32_bf16 a[244:247], v[220:223], v[60:63], a[244:247]
    v_mfma_f32_16x16x32_bf16 a[248:251], v[216:219], v[64:67], a[248:251]
    ds_read_b128 v[132:135], v225 offset:45056
    v_mfma_f32_16x16x32_bf16 a[248:251], v[220:223], v[68:71], a[248:251]
    v_mfma_f32_16x16x32_bf16 a[252:255], v[216:219], v[72:75], a[252:255]
    v_mfma_f32_16x16x32_bf16 a[252:255], v[220:223], v[76:79], a[252:255]
    s_waitcnt lgkmcnt(2)
    v_mfma_f32_16x16x32_bf16 v[144:147], v[208:211], v[16:19], v[144:147]
    buffer_load_dword v246, v254, s[68:71], s5 offen
    v_mfma_f32_16x16x32_bf16 v[144:147], v[212:215], v[20:23], v[144:147]
    ds_read_b64_tr_b16 v[216:217], v231 offset:8192
    s_add_u32 s5, s5, 393216
    v_mfma_f32_16x16x32_bf16 v[148:151], v[208:211], v[24:27], v[148:151]
    v_mfma_f32_16x16x32_bf16 v[148:151], v[212:215], v[28:31], v[148:151]
    ds_read_b64_tr_b16 v[218:219], v231 offset:9216
    v_mfma_f32_16x16x32_bf16 v[152:155], v[208:211], v[32:35], v[152:155]
    buffer_load_dword v246, v254, s[20:23], s7 offen
    v_mfma_f32_16x16x32_bf16 v[152:155], v[212:215], v[36:39], v[152:155]
    ds_read_b64_tr_b16 v[220:221], v231 offset:24576
    s_add_u32 s7, s7, 393216
    v_mfma_f32_16x16x32_bf16 v[156:159], v[208:211], v[40:43], v[156:159]
    buffer_load_dword v246, v245, s[24:27], s49 offen
    v_mfma_f32_16x16x32_bf16 v[156:159], v[212:215], v[44:47], v[156:159]
    ds_read_b64_tr_b16 v[222:223], v231 offset:25600
    s_add_u32 s49, s49, 458752
    v_mfma_f32_16x16x32_bf16 v[160:163], v[208:211], v[48:51], v[160:163]
    ds_read_b128 v[136:139], v224 offset:47104
    v_mfma_f32_16x16x32_bf16 v[160:163], v[212:215], v[52:55], v[160:163]
    buffer_load_dword v246, v0, s[16:19], s63 offen
    v_mfma_f32_16x16x32_bf16 v[164:167], v[208:211], v[56:59], v[164:167]
    s_add_u32 s63, s63, 512
    v_mfma_f32_16x16x32_bf16 v[164:167], v[212:215], v[60:63], v[164:167]
    v_mfma_f32_16x16x32_bf16 v[168:171], v[208:211], v[64:67], v[168:171]
    ds_read_b128 v[140:143], v225 offset:47104
    v_mfma_f32_16x16x32_bf16 v[168:171], v[212:215], v[68:71], v[168:171]
    v_mfma_f32_16x16x32_bf16 v[172:175], v[208:211], v[72:75], v[172:175]
    s_waitcnt vmcnt(26)
    v_mfma_f32_16x16x32_bf16 v[172:175], v[212:215], v[76:79], v[172:175]
    s_waitcnt lgkmcnt(0)
    s_barrier
    v_mfma_f32_16x16x32_bf16 v[176:179], v[216:219], v[16:19], v[176:179]
    ds_read_b64_tr_b16 v[208:209], v226 offset:8192
    v_mfma_f32_16x16x32_bf16 v[176:179], v[220:223], v[20:23], v[176:179]
    s_add_u32 m0, s47, 0
    v_mfma_f32_16x16x32_bf16 v[180:183], v[216:219], v[24:27], v[180:183]
    ds_read_b64_tr_b16 v[210:211], v226 offset:8704
    buffer_load_dwordx4 v241, s[24:27], s44 offen lds
    v_mfma_f32_16x16x32_bf16 v[180:183], v[220:223], v[28:31], v[180:183]
    v_mfma_f32_16x16x32_bf16 v[184:187], v[216:219], v[32:35], v[184:187]
    ds_read_b64_tr_b16 v[212:213], v226 offset:12288
    v_mfma_f32_16x16x32_bf16 v[184:187], v[220:223], v[36:39], v[184:187]
    v_mfma_f32_16x16x32_bf16 v[188:191], v[216:219], v[40:43], v[188:191]
    ds_read_b64_tr_b16 v[214:215], v226 offset:12800
    v_mfma_f32_16x16x32_bf16 v[188:191], v[220:223], v[44:47], v[188:191]
    v_mfma_f32_16x16x32_bf16 v[192:195], v[216:219], v[48:51], v[192:195]
    s_add_u32 m0, s47, 1024
    v_mfma_f32_16x16x32_bf16 v[192:195], v[220:223], v[52:55], v[192:195]
    buffer_load_dwordx4 v242, s[24:27], s44 offen lds
    v_mfma_f32_16x16x32_bf16 v[196:199], v[216:219], v[56:59], v[196:199]
    v_mfma_f32_16x16x32_bf16 v[196:199], v[220:223], v[60:63], v[196:199]
    v_mfma_f32_16x16x32_bf16 v[200:203], v[216:219], v[64:67], v[200:203]
    v_mfma_f32_16x16x32_bf16 v[200:203], v[220:223], v[68:71], v[200:203]
    v_mfma_f32_16x16x32_bf16 v[204:207], v[216:219], v[72:75], v[204:207]
    v_mfma_f32_16x16x32_bf16 v[204:207], v[220:223], v[76:79], v[204:207]
    s_waitcnt lgkmcnt(0)
    v_mfma_f32_16x16x32_bf16 a[0:3], v[80:83], v[208:211], a[0:3]
    s_add_u32 m0, s47, 4096
    v_mfma_f32_16x16x32_bf16 a[0:3], v[84:87], v[212:215], a[0:3]
    ds_read_b64_tr_b16 v[216:217], v227 offset:8192
    buffer_load_dwordx4 v243, s[24:27], s44 offen lds
    v_mfma_f32_16x16x32_bf16 a[4:7], v[88:91], v[208:211], a[4:7]
    v_mfma_f32_16x16x32_bf16 a[4:7], v[92:95], v[212:215], a[4:7]
    ds_read_b64_tr_b16 v[218:219], v227 offset:8704
    v_mfma_f32_16x16x32_bf16 a[8:11], v[96:99], v[208:211], a[8:11]
    v_mfma_f32_16x16x32_bf16 a[8:11], v[100:103], v[212:215], a[8:11]
    ds_read_b64_tr_b16 v[220:221], v227 offset:12288
    v_mfma_f32_16x16x32_bf16 a[12:15], v[104:107], v[208:211], a[12:15]
    v_mfma_f32_16x16x32_bf16 a[12:15], v[108:111], v[212:215], a[12:15]
    ds_read_b64_tr_b16 v[222:223], v227 offset:12800
    s_add_u32 m0, s47, 5120
    v_mfma_f32_16x16x32_bf16 a[16:19], v[112:115], v[208:211], a[16:19]
    buffer_load_dwordx4 v244, s[24:27], s44 offen lds
    s_add_u32 s44, s44, 229376
    v_mfma_f32_16x16x32_bf16 a[16:19], v[116:119], v[212:215], a[16:19]
    v_mfma_f32_16x16x32_bf16 a[20:23], v[120:123], v[208:211], a[20:23]
    v_mfma_f32_16x16x32_bf16 a[20:23], v[124:127], v[212:215], a[20:23]
    v_mfma_f32_16x16x32_bf16 a[24:27], v[128:131], v[208:211], a[24:27]
    v_mfma_f32_16x16x32_bf16 a[24:27], v[132:135], v[212:215], a[24:27]
    v_mfma_f32_16x16x32_bf16 a[28:31], v[136:139], v[208:211], a[28:31]
    s_waitcnt vmcnt(10)
    v_mfma_f32_16x16x32_bf16 a[28:31], v[140:143], v[212:215], a[28:31]
    s_waitcnt lgkmcnt(0)
    s_barrier
    s_add_u32 m0, s47, 16384
    v_mfma_f32_16x16x32_bf16 a[32:35], v[80:83], v[216:219], a[32:35]
    buffer_load_dwordx4 v241, s[24:27], s44 offen lds
    v_mfma_f32_16x16x32_bf16 a[32:35], v[84:87], v[220:223], a[32:35]
    ds_read_b64_tr_b16 v[208:209], v228 offset:32768
    v_mfma_f32_16x16x32_bf16 a[36:39], v[88:91], v[216:219], a[36:39]
    v_mfma_f32_16x16x32_bf16 a[36:39], v[92:95], v[220:223], a[36:39]
    ds_read_b64_tr_b16 v[210:211], v228 offset:33792
    v_mfma_f32_16x16x32_bf16 a[40:43], v[96:99], v[216:219], a[40:43]
    v_mfma_f32_16x16x32_bf16 a[40:43], v[100:103], v[220:223], a[40:43]
    ds_read_b64_tr_b16 v[212:213], v228 offset:49152
    v_mfma_f32_16x16x32_bf16 a[44:47], v[104:107], v[216:219], a[44:47]
    v_mfma_f32_16x16x32_bf16 a[44:47], v[108:111], v[220:223], a[44:47]
    ds_read_b64_tr_b16 v[214:215], v228 offset:50176
    s_add_u32 m0, s47, 17408
    v_mfma_f32_16x16x32_bf16 a[48:51], v[112:115], v[216:219], a[48:51]
    ds_read_b128 v[16:19], v224 offset:0
    buffer_load_dwordx4 v242, s[24:27], s44 offen lds
    v_mfma_f32_16x16x32_bf16 a[48:51], v[116:119], v[220:223], a[48:51]
    v_mfma_f32_16x16x32_bf16 a[52:55], v[120:123], v[216:219], a[52:55]
    v_mfma_f32_16x16x32_bf16 a[52:55], v[124:127], v[220:223], a[52:55]
    v_mfma_f32_16x16x32_bf16 a[56:59], v[128:131], v[216:219], a[56:59]
    ds_read_b128 v[20:23], v225 offset:0
    v_mfma_f32_16x16x32_bf16 a[56:59], v[132:135], v[220:223], a[56:59]
    v_mfma_f32_16x16x32_bf16 a[60:63], v[136:139], v[216:219], a[60:63]
    s_add_u32 m0, s47, 20480
    v_mfma_f32_16x16x32_bf16 a[60:63], v[140:143], v[220:223], a[60:63]
    s_waitcnt lgkmcnt(2)
    buffer_load_dwordx4 v243, s[24:27], s44 offen lds
    v_mfma_f32_16x16x32_bf16 a[64:67], v[208:211], v[80:83], a[64:67]
    v_mfma_f32_16x16x32_bf16 a[64:67], v[212:215], v[84:87], a[64:67]
    ds_read_b64_tr_b16 v[216:217], v228 offset:40960
    v_mfma_f32_16x16x32_bf16 a[68:71], v[208:211], v[88:91], a[68:71]
    v_mfma_f32_16x16x32_bf16 a[68:71], v[212:215], v[92:95], a[68:71]
    ds_read_b64_tr_b16 v[218:219], v228 offset:41984
    v_mfma_f32_16x16x32_bf16 a[72:75], v[208:211], v[96:99], a[72:75]
    v_mfma_f32_16x16x32_bf16 a[72:75], v[212:215], v[100:103], a[72:75]
    ds_read_b64_tr_b16 v[220:221], v228 offset:57344
    v_mfma_f32_16x16x32_bf16 a[76:79], v[208:211], v[104:107], a[76:79]
    s_add_u32 m0, s47, 21504
    v_mfma_f32_16x16x32_bf16 a[76:79], v[212:215], v[108:111], a[76:79]
    ds_read_b64_tr_b16 v[222:223], v228 offset:58368
    buffer_load_dwordx4 v244, s[24:27], s44 offen lds
    s_add_u32 s44, s44, 229376
    v_mfma_f32_16x16x32_bf16 a[80:83], v[208:211], v[112:115], a[80:83]
    ds_read_b128 v[24:27], v224 offset:2048
    v_mfma_f32_16x16x32_bf16 a[80:83], v[212:215], v[116:119], a[80:83]
    v_mfma_f32_16x16x32_bf16 a[84:87], v[208:211], v[120:123], a[84:87]
    v_mfma_f32_16x16x32_bf16 a[84:87], v[212:215], v[124:127], a[84:87]
    v_mfma_f32_16x16x32_bf16 a[88:91], v[208:211], v[128:131], a[88:91]
    ds_read_b128 v[28:31], v225 offset:2048
    v_mfma_f32_16x16x32_bf16 a[88:91], v[212:215], v[132:135], a[88:91]
    v_mfma_f32_16x16x32_bf16 a[92:95], v[208:211], v[136:139], a[92:95]
    s_add_u32 m0, s45, 32768
    v_mfma_f32_16x16x32_bf16 a[92:95], v[212:215], v[140:143], a[92:95]
    s_waitcnt lgkmcnt(2)
    buffer_load_dwordx4 v232, s[16:19], s42 offen lds
    v_mfma_f32_16x16x32_bf16 a[96:99], v[216:219], v[80:83], a[96:99]
    v_mfma_f32_16x16x32_bf16 a[96:99], v[220:223], v[84:87], a[96:99]
    ds_read_b64_tr_b16 v[208:209], v229 offset:32768
    v_mfma_f32_16x16x32_bf16 a[100:103], v[216:219], v[88:91], a[100:103]
    v_mfma_f32_16x16x32_bf16 a[100:103], v[220:223], v[92:95], a[100:103]
    ds_read_b64_tr_b16 v[210:211], v229 offset:33792
    v_mfma_f32_16x16x32_bf16 a[104:107], v[216:219], v[96:99], a[104:107]
    v_mfma_f32_16x16x32_bf16 a[104:107], v[220:223], v[100:103], a[104:107]
    ds_read_b64_tr_b16 v[212:213], v229 offset:49152
    v_mfma_f32_16x16x32_bf16 a[108:111], v[216:219], v[104:107], a[108:111]
    s_add_u32 m0, s45, 33792
    v_mfma_f32_16x16x32_bf16 a[108:111], v[220:223], v[108:111], a[108:111]
    ds_read_b64_tr_b16 v[214:215], v229 offset:50176
    buffer_load_dwordx4 v233, s[16:19], s42 offen lds
    v_mfma_f32_16x16x32_bf16 a[112:115], v[216:219], v[112:115], a[112:115]
    ds_read_b128 v[32:35], v224 offset:4096
    v_mfma_f32_16x16x32_bf16 a[112:115], v[220:223], v[116:119], a[112:115]
    v_mfma_f32_16x16x32_bf16 a[116:119], v[216:219], v[120:123], a[116:119]
    v_mfma_f32_16x16x32_bf16 a[116:119], v[220:223], v[124:127], a[116:119]
    v_mfma_f32_16x16x32_bf16 a[120:123], v[216:219], v[128:131], a[120:123]
    ds_read_b128 v[36:39], v225 offset:4096
    v_mfma_f32_16x16x32_bf16 a[120:123], v[220:223], v[132:135], a[120:123]
    s_add_u32 m0, s45, 34816
    v_mfma_f32_16x16x32_bf16 a[124:127], v[216:219], v[136:139], a[124:127]
    buffer_load_dwordx4 v234, s[16:19], s42 offen lds
    v_mfma_f32_16x16x32_bf16 a[124:127], v[220:223], v[140:143], a[124:127]
    s_waitcnt lgkmcnt(2)
    v_mfma_f32_16x16x32_bf16 a[128:131], v[208:211], v[80:83], a[128:131]
    v_mfma_f32_16x16x32_bf16 a[128:131], v[212:215], v[84:87], a[128:131]
    ds_read_b64_tr_b16 v[216:217], v229 offset:40960
    v_mfma_f32_16x16x32_bf16 a[132:135], v[208:211], v[88:91], a[132:135]
    v_mfma_f32_16x16x32_bf16 a[132:135], v[212:215], v[92:95], a[132:135]
    ds_read_b64_tr_b16 v[218:219], v229 offset:41984
    v_mfma_f32_16x16x32_bf16 a[136:139], v[208:211], v[96:99], a[136:139]
    v_mfma_f32_16x16x32_bf16 a[136:139], v[212:215], v[100:103], a[136:139]
    ds_read_b64_tr_b16 v[220:221], v229 offset:57344
    s_add_u32 m0, s45, 35840
    v_mfma_f32_16x16x32_bf16 a[140:143], v[208:211], v[104:107], a[140:143]
    buffer_load_dwordx4 v235, s[16:19], s42 offen lds
    v_mfma_f32_16x16x32_bf16 a[140:143], v[212:215], v[108:111], a[140:143]
    ds_read_b64_tr_b16 v[222:223], v229 offset:58368
    v_mfma_f32_16x16x32_bf16 a[144:147], v[208:211], v[112:115], a[144:147]
    ds_read_b128 v[40:43], v224 offset:6144
    v_mfma_f32_16x16x32_bf16 a[144:147], v[212:215], v[116:119], a[144:147]
    v_mfma_f32_16x16x32_bf16 a[148:151], v[208:211], v[120:123], a[148:151]
    v_mfma_f32_16x16x32_bf16 a[148:151], v[212:215], v[124:127], a[148:151]
    v_mfma_f32_16x16x32_bf16 a[152:155], v[208:211], v[128:131], a[152:155]
    ds_read_b128 v[44:47], v225 offset:6144
    v_mfma_f32_16x16x32_bf16 a[152:155], v[212:215], v[132:135], a[152:155]
    s_add_u32 m0, s45, 36864
    v_mfma_f32_16x16x32_bf16 a[156:159], v[208:211], v[136:139], a[156:159]
    buffer_load_dwordx4 v236, s[16:19], s42 offen lds
    v_mfma_f32_16x16x32_bf16 a[156:159], v[212:215], v[140:143], a[156:159]
    s_waitcnt lgkmcnt(2)
    v_mfma_f32_16x16x32_bf16 a[160:163], v[216:219], v[80:83], a[160:163]
    v_mfma_f32_16x16x32_bf16 a[160:163], v[220:223], v[84:87], a[160:163]
    ds_read_b64_tr_b16 v[208:209], v230 offset:32768
    v_mfma_f32_16x16x32_bf16 a[164:167], v[216:219], v[88:91], a[164:167]
    v_mfma_f32_16x16x32_bf16 a[164:167], v[220:223], v[92:95], a[164:167]
    ds_read_b64_tr_b16 v[210:211], v230 offset:33792
    v_mfma_f32_16x16x32_bf16 a[168:171], v[216:219], v[96:99], a[168:171]
    s_add_u32 m0, s45, 37888
    v_mfma_f32_16x16x32_bf16 a[168:171], v[220:223], v[100:103], a[168:171]
    ds_read_b64_tr_b16 v[212:213], v230 offset:49152
    buffer_load_dwordx4 v237, s[16:19], s42 offen lds
    v_mfma_f32_16x16x32_bf16 a[172:175], v[216:219], v[104:107], a[172:175]
    v_mfma_f32_16x16x32_bf16 a[172:175], v[220:223], v[108:111], a[172:175]
    ds_read_b64_tr_b16 v[214:215], v230 offset:50176
    v_mfma_f32_16x16x32_bf16 a[176:179], v[216:219], v[112:115], a[176:179]
    ds_read_b128 v[48:51], v224 offset:8192
    v_mfma_f32_16x16x32_bf16 a[176:179], v[220:223], v[116:119], a[176:179]
    v_mfma_f32_16x16x32_bf16 a[180:183], v[216:219], v[120:123], a[180:183]
    v_mfma_f32_16x16x32_bf16 a[180:183], v[220:223], v[124:127], a[180:183]
    v_mfma_f32_16x16x32_bf16 a[184:187], v[216:219], v[128:131], a[184:187]
    ds_read_b128 v[52:55], v225 offset:8192
    s_add_u32 m0, s45, 38912
    v_mfma_f32_16x16x32_bf16 a[184:187], v[220:223], v[132:135], a[184:187]
    buffer_load_dwordx4 v238, s[16:19], s42 offen lds
    v_mfma_f32_16x16x32_bf16 a[188:191], v[216:219], v[136:139], a[188:191]
    v_mfma_f32_16x16x32_bf16 a[188:191], v[220:223], v[140:143], a[188:191]
    s_waitcnt lgkmcnt(2)
    v_mfma_f32_16x16x32_bf16 a[192:195], v[208:211], v[80:83], a[192:195]
    v_mfma_f32_16x16x32_bf16 a[192:195], v[212:215], v[84:87], a[192:195]
    ds_read_b64_tr_b16 v[216:217], v230 offset:40960
    v_mfma_f32_16x16x32_bf16 a[196:199], v[208:211], v[88:91], a[196:199]
    v_mfma_f32_16x16x32_bf16 a[196:199], v[212:215], v[92:95], a[196:199]
    ds_read_b64_tr_b16 v[218:219], v230 offset:41984
    v_mfma_f32_16x16x32_bf16 a[200:203], v[208:211], v[96:99], a[200:203]
    s_add_u32 m0, s45, 39936
    v_mfma_f32_16x16x32_bf16 a[200:203], v[212:215], v[100:103], a[200:203]
    ds_read_b64_tr_b16 v[220:221], v230 offset:57344
    buffer_load_dwordx4 v239, s[16:19], s42 offen lds
    s_add_u32 s42, s42, 128
    v_mfma_f32_16x16x32_bf16 a[204:207], v[208:211], v[104:107], a[204:207]
    v_mfma_f32_16x16x32_bf16 a[204:207], v[212:215], v[108:111], a[204:207]
    ds_read_b64_tr_b16 v[222:223], v230 offset:58368
    v_mfma_f32_16x16x32_bf16 a[208:211], v[208:211], v[112:115], a[208:211]
    ds_read_b128 v[56:59], v224 offset:10240
    v_mfma_f32_16x16x32_bf16 a[208:211], v[212:215], v[116:119], a[208:211]
    v_mfma_f32_16x16x32_bf16 a[212:215], v[208:211], v[120:123], a[212:215]
    v_mfma_f32_16x16x32_bf16 a[212:215], v[212:215], v[124:127], a[212:215]
    v_mfma_f32_16x16x32_bf16 a[216:219], v[208:211], v[128:131], a[216:219]
    ds_read_b128 v[60:63], v225 offset:10240
    s_add_u32 m0, s46, 8192
    v_mfma_f32_16x16x32_bf16 a[216:219], v[212:215], v[132:135], a[216:219]
    buffer_load_dwordx4 v240, s[20:23], s43 offen lds
    s_add_u32 s43, s43, 196608
    v_mfma_f32_16x16x32_bf16 a[220:223], v[208:211], v[136:139], a[220:223]
    v_mfma_f32_16x16x32_bf16 a[220:223], v[212:215], v[140:143], a[220:223]
    s_waitcnt lgkmcnt(2)
    v_mfma_f32_16x16x32_bf16 a[224:227], v[216:219], v[80:83], a[224:227]
    s_add_u32 m0, s46, 12288
    v_mfma_f32_16x16x32_bf16 a[224:227], v[220:223], v[84:87], a[224:227]
    ds_read_b64_tr_b16 v[208:209], v231 offset:32768
    buffer_load_dwordx4 v240, s[20:23], s43 offen lds
    s_add_u32 s43, s43, 196608
    v_mfma_f32_16x16x32_bf16 a[228:231], v[216:219], v[88:91], a[228:231]
    v_mfma_f32_16x16x32_bf16 a[228:231], v[220:223], v[92:95], a[228:231]
    ds_read_b64_tr_b16 v[210:211], v231 offset:33792
    v_mfma_f32_16x16x32_bf16 a[232:235], v[216:219], v[96:99], a[232:235]
    v_mfma_f32_16x16x32_bf16 a[232:235], v[220:223], v[100:103], a[232:235]
    ds_read_b64_tr_b16 v[212:213], v231 offset:49152
    v_mfma_f32_16x16x32_bf16 a[236:239], v[216:219], v[104:107], a[236:239]
    v_mfma_f32_16x16x32_bf16 a[236:239], v[220:223], v[108:111], a[236:239]
    ds_read_b64_tr_b16 v[214:215], v231 offset:50176
    v_mfma_f32_16x16x32_bf16 a[240:243], v[216:219], v[112:115], a[240:243]
    ds_read_b128 v[64:67], v224 offset:12288
    v_mfma_f32_16x16x32_bf16 a[240:243], v[220:223], v[116:119], a[240:243]
    v_mfma_f32_16x16x32_bf16 a[244:247], v[216:219], v[120:123], a[244:247]
    v_mfma_f32_16x16x32_bf16 a[244:247], v[220:223], v[124:127], a[244:247]
    v_mfma_f32_16x16x32_bf16 a[248:251], v[216:219], v[128:131], a[248:251]
    ds_read_b128 v[68:71], v225 offset:12288
    v_mfma_f32_16x16x32_bf16 a[248:251], v[220:223], v[132:135], a[248:251]
    v_mfma_f32_16x16x32_bf16 a[252:255], v[216:219], v[136:139], a[252:255]
    buffer_load_dword v246, v245, s[64:67], s6 offen
    v_mfma_f32_16x16x32_bf16 a[252:255], v[220:223], v[140:143], a[252:255]
    s_waitcnt lgkmcnt(2)
    s_add_u32 s6, s6, 1048576
    v_mfma_f32_16x16x32_bf16 v[144:147], v[208:211], v[80:83], v[144:147]
    s_cmp_eq_u32 s48, s86
    v_mfma_f32_16x16x32_bf16 v[144:147], v[212:215], v[84:87], v[144:147]
    ds_read_b64_tr_b16 v[216:217], v231 offset:40960
    s_cselect_b32 s87, 0, 0x40000000
    v_mfma_f32_16x16x32_bf16 v[148:151], v[208:211], v[88:91], v[148:151]
    buffer_atomic_add v249, v248, s[76:79], s87 offen sc1
    v_mfma_f32_16x16x32_bf16 v[148:151], v[212:215], v[92:95], v[148:151]
    ds_read_b64_tr_b16 v[218:219], v231 offset:41984
    v_mfma_f32_16x16x32_bf16 v[152:155], v[208:211], v[96:99], v[152:155]
    buffer_load_dword v246, v254, s[20:23], s7 offen
    v_mfma_f32_16x16x32_bf16 v[152:155], v[212:215], v[100:103], v[152:155]
    ds_read_b64_tr_b16 v[220:221], v231 offset:57344
    s_add_u32 s7, s7, 393216
    v_mfma_f32_16x16x32_bf16 v[156:159], v[208:211], v[104:107], v[156:159]
    buffer_load_dword v246, v245, s[24:27], s49 offen
    v_mfma_f32_16x16x32_bf16 v[156:159], v[212:215], v[108:111], v[156:159]
    ds_read_b64_tr_b16 v[222:223], v231 offset:58368
    s_add_u32 s49, s49, 458752
    v_mfma_f32_16x16x32_bf16 v[160:163], v[208:211], v[112:115], v[160:163]
    ds_read_b128 v[72:75], v224 offset:14336
    v_mfma_f32_16x16x32_bf16 v[160:163], v[212:215], v[116:119], v[160:163]
    v_mfma_f32_16x16x32_bf16 v[164:167], v[208:211], v[120:123], v[164:167]
    v_mfma_f32_16x16x32_bf16 v[164:167], v[212:215], v[124:127], v[164:167]
    v_mfma_f32_16x16x32_bf16 v[168:171], v[208:211], v[128:131], v[168:171]
    ds_read_b128 v[76:79], v225 offset:14336
    v_mfma_f32_16x16x32_bf16 v[168:171], v[212:215], v[132:135], v[168:171]
    v_mfma_f32_16x16x32_bf16 v[172:175], v[208:211], v[136:139], v[172:175]
    s_waitcnt vmcnt(26)
    v_mfma_f32_16x16x32_bf16 v[172:175], v[212:215], v[140:143], v[172:175]
    s_waitcnt lgkmcnt(0)
    s_barrier
    v_mfma_f32_16x16x32_bf16 v[176:179], v[216:219], v[80:83], v[176:179]
    ds_read_b64_tr_b16 v[208:209], v226 offset:0
    v_mfma_f32_16x16x32_bf16 v[176:179], v[220:223], v[84:87], v[176:179]
    s_add_u32 m0, s47, 32768
    v_mfma_f32_16x16x32_bf16 v[180:183], v[216:219], v[88:91], v[180:183]
    ds_read_b64_tr_b16 v[210:211], v226 offset:512
    buffer_load_dwordx4 v241, s[24:27], s44 offen lds
    v_mfma_f32_16x16x32_bf16 v[180:183], v[220:223], v[92:95], v[180:183]
    v_mfma_f32_16x16x32_bf16 v[184:187], v[216:219], v[96:99], v[184:187]
    ds_read_b64_tr_b16 v[212:213], v226 offset:4096
    v_mfma_f32_16x16x32_bf16 v[184:187], v[220:223], v[100:103], v[184:187]
    v_mfma_f32_16x16x32_bf16 v[188:191], v[216:219], v[104:107], v[188:191]
    ds_read_b64_tr_b16 v[214:215], v226 offset:4608
    v_mfma_f32_16x16x32_bf16 v[188:191], v[220:223], v[108:111], v[188:191]
    v_mfma_f32_16x16x32_bf16 v[192:195], v[216:219], v[112:115], v[192:195]
    s_add_u32 m0, s47, 33792
    v_mfma_f32_16x16x32_bf16 v[192:195], v[220:223], v[116:119], v[192:195]
    buffer_load_dwordx4 v242, s[24:27], s44 offen lds
    v_mfma_f32_16x16x32_bf16 v[196:199], v[216:219], v[120:123], v[196:199]
    v_mfma_f32_16x16x32_bf16 v[196:199], v[220:223], v[124:127], v[196:199]
    v_mfma_f32_16x16x32_bf16 v[200:203], v[216:219], v[128:131], v[200:203]
    v_mfma_f32_16x16x32_bf16 v[200:203], v[220:223], v[132:135], v[200:203]
    v_mfma_f32_16x16x32_bf16 v[204:207], v[216:219], v[136:139], v[204:207]
    v_mfma_f32_16x16x32_bf16 v[204:207], v[220:223], v[140:143], v[204:207]
    s_waitcnt lgkmcnt(0)
    s_sub_u32 s48, s48, 1
    s_cmp_lg_u32 s48, 0
    s_cbranch_scc1 p1B_loop
    v_mfma_f32_16x16x32_bf16 a[0:3], v[16:19], v[208:211], a[0:3]
    s_add_u32 m0, s47, 36864
    v_mfma_f32_16x16x32_bf16 a[0:3], v[20:23], v[212:215], a[0:3]
    ds_read_b64_tr_b16 v[216:217], v227 offset:0
    buffer_load_dwordx4 v243, s[24:27], s44 offen lds
    v_mfma_f32_16x16x32_bf16 a[4:7], v[24:27], v[208:211], a[4:7]
    v_mfma_f32_16x16x32_bf16 a[4:7], v[28:31], v[212:215], a[4:7]
    ds_read_b64_tr_b16 v[218:219], v227 offset:512
    v_mfma_f32_16x16x32_bf16 a[8:11], v[32:35], v[208:211], a[8:11]
    v_mfma_f32_16x16x32_bf16 a[8:11], v[36:39], v[212:215], a[8:11]
    ds_read_b64_tr_b16 v[220:221], v227 offset:4096
    v_mfma_f32_16x16x32_bf16 a[12:15], v[40:43], v[208:211], a[12:15]
    v_mfma_f32_16x16x32_bf16 a[12:15], v[44:47], v[212:215], a[12:15]
    ds_read_b64_tr_b16 v[222:223], v227 offset:4608
    v_mfma_f32_16x16x32_bf16 a[16:19], v[48:51], v[208:211], a[16:19]
    v_mfma_f32_16x16x32_bf16 a[16:19], v[52:55], v[212:215], a[16:19]
    v_mfma_f32_16x16x32_bf16 a[20:23], v[56:59], v[208:211], a[20:23]
    v_mfma_f32_16x16x32_bf16 a[20:23], v[60:63], v[212:215], a[20:23]
    v_mfma_f32_16x16x32_bf16 a[24:27], v[64:67], v[208:211], a[24:27]
    v_mfma_f32_16x16x32_bf16 a[24:27], v[68:71], v[212:215], a[24:27]
    v_mfma_f32_16x16x32_bf16 a[28:31], v[72:75], v[208:211], a[28:31]
    s_waitcnt vmcnt(9)
    v_mfma_f32_16x16x32_bf16 a[28:31], v[76:79], v[212:215], a[28:31]
    s_waitcnt lgkmcnt(0)
    s_barrier
    v_mfma_f32_16x16x32_bf16 a[32:35], v[16:19], v[216:219], a[32:35]
    v_mfma_f32_16x16x32_bf16 a[32:35], v[20:23], v[220:223], a[32:35]
    ds_read_b64_tr_b16 v[208:209], v228 offset:0
    v_mfma_f32_16x16x32_bf16 a[36:39], v[24:27], v[216:219], a[36:39]
    s_add_u32 m0, s47, 37888
    v_mfma_f32_16x16x32_bf16 a[36:39], v[28:31], v[220:223], a[36:39]
    ds_read_b64_tr_b16 v[210:211], v228 offset:1024
    buffer_load_dwordx4 v244, s[24:27], s44 offen lds
    s_add_u32 s44, s44, 229376
    v_mfma_f32_16x16x32_bf16 a[40:43], v[32:35], v[216:219], a[40:43]
    v_mfma_f32_16x16x32_bf16 a[40:43], v[36:39], v[220:223], a[40:43]
    ds_read_b64_tr_b16 v[212:213], v228 offset:16384
    v_mfma_f32_16x16x32_bf16 a[44:47], v[40:43], v[216:219], a[44:47]
    v_mfma_f32_16x16x32_bf16 a[44:47], v[44:47], v[220:223], a[44:47]
    ds_read_b64_tr_b16 v[214:215], v228 offset:17408
    v_mfma_f32_16x16x32_bf16 a[48:51], v[48:51], v[216:219], a[48:51]
    ds_read_b128 v[80:83], v224 offset:32768
    v_mfma_f32_16x16x32_bf16 a[48:51], v[52:55], v[220:223], a[48:51]
    v_mfma_f32_16x16x32_bf16 a[52:55], v[56:59], v[216:219], a[52:55]
    v_mfma_f32_16x16x32_bf16 a[52:55], v[60:63], v[220:223], a[52:55]
    v_mfma_f32_16x16x32_bf16 a[56:59], v[64:67], v[216:219], a[56:59]
    ds_read_b128 v[84:87], v225 offset:32768
    v_mfma_f32_16x16x32_bf16 a[56:59], v[68:71], v[220:223], a[56:59]
    v_mfma_f32_16x16x32_bf16 a[60:63], v[72:75], v[216:219], a[60:63]
    v_mfma_f32_16x16x32_bf16 a[60:63], v[76:79], v[220:223], a[60:63]
    s_waitcnt lgkmcnt(2)
    v_mfma_f32_16x16x32_bf16 a[64:67], v[208:211], v[16:19], a[64:67]
    v_mfma_f32_16x16x32_bf16 a[64:67], v[212:215], v[20:23], a[64:67]
    ds_read_b64_tr_b16 v[216:217], v228 offset:8192
    v_mfma_f32_16x16x32_bf16 a[68:71], v[208:211], v[24:27], a[68:71]
    v_mfma_f32_16x16x32_bf16 a[68:71], v[212:215], v[28:31], a[68:71]
    ds_read_b64_tr_b16 v[218:219], v228 offset:9216
    v_mfma_f32_16x16x32_bf16 a[72:75], v[208:211], v[32:35], a[72:75]
    s_add_u32 m0, s47, 49152
    v_mfma_f32_16x16x32_bf16 a[72:75], v[212:215], v[36:39], a[72:75]
    ds_read_b64_tr_b16 v[220:221], v228 offset:24576
    buffer_load_dwordx4 v241, s[24:27], s44 offen lds
    v_mfma_f32_16x16x32_bf16 a[76:79], v[208:211], v[40:43], a[76:79]
    v_mfma_f32_16x16x32_bf16 a[76:79], v[212:215], v[44:47], a[76:79]
    ds_read_b64_tr_b16 v[222:223], v228 offset:25600
    v_mfma_f32_16x16x32_bf16 a[80:83], v[208:211], v[48:51], a[80:83]
    ds_read_b128 v[88:91], v224 offset:34816
    v_mfma_f32_16x16x32_bf16 a[80:83], v[212:215], v[52:55], a[80:83]
    v_mfma_f32_16x16x32_bf16 a[84:87], v[208:211], v[56:59], a[84:87]
    v_mfma_f32_16x16x32_bf16 a[84:87], v[212:215], v[60:63], a[84:87]
    v_mfma_f32_16x16x32_bf16 a[88:91], v[208:211], v[64:67], a[88:91]
    ds_read_b128 v[92:95], v225 offset:34816
    v_mfma_f32_16x16x32_bf16 a[88:91], v[212:215], v[68:71], a[88:91]
    v_mfma_f32_16x16x32_bf16 a[92:95], v[208:211], v[72:75], a[92:95]
    v_mfma_f32_16x16x32_bf16 a[92:95], v[212:215], v[76:79], a[92:95]
    s_waitcnt lgkmcnt(2)
    v_mfma_f32_16x16x32_bf16 a[96:99], v[216:219], v[16:19], a[96:99]
    v_mfma_f32_16x16x32_bf16 a[96:99], v[220:223], v[20:23], a[96:99]
    ds_read_b64_tr_b16 v[208:209], v229 offset:0
    v_mfma_f32_16x16x32_bf16 a[100:103], v[216:219], v[24:27], a[100:103]
    v_mfma_f32_16x16x32_bf16 a[100:103], v[220:223], v[28:31], a[100:103]
    ds_read_b64_tr_b16 v[210:211], v229 offset:1024
    v_mfma_f32_16x16x32_bf16 a[104:107], v[216:219], v[32:35], a[104:107]
    v_mfma_f32_16x16x32_bf16 a[104:107], v[220:223], v[36:39], a[104:107]
    ds_read_b64_tr_b16 v[212:213], v229 offset:16384
    v_mfma_f32_16x16x32_bf16 a[108:111], v[216:219], v[40:43], a[108:111]
    s_add_u32 m0, s47, 50176
    v_mfma_f32_16x16x32_bf16 a[108:111], v[220:223], v[44:47], a[108:111]
    ds_read_b64_tr_b16 v[214:215], v229 offset:17408
    buffer_load_dwordx4 v242, s[24:27], s44 offen lds
    v_mfma_f32_16x16x32_bf16 a[112:115], v[216:219], v[48:51], a[112:115]
    ds_read_b128 v[96:99], v224 offset:36864
    v_mfma_f32_16x16x32_bf16 a[112:115], v[220:223], v[52:55], a[112:115]
    v_mfma_f32_16x16x32_bf16 a[116:119], v[216:219], v[56:59], a[116:119]
    v_mfma_f32_16x16x32_bf16 a[116:119], v[220:223], v[60:63], a[116:119]
    v_mfma_f32_16x16x32_bf16 a[120:123], v[216:219], v[64:67], a[120:123]
    ds_read_b128 v[100:103], v225 offset:36864
    v_mfma_f32_16x16x32_bf16 a[120:123], v[220:223], v[68:71], a[120:123]
    v_mfma_f32_16x16x32_bf16 a[124:127], v[216:219], v[72:75], a[124:127]
    v_mfma_f32_16x16x32_bf16 a[124:127], v[220:223], v[76:79], a[124:127]
    s_waitcnt lgkmcnt(2)
    v_mfma_f32_16x16x32_bf16 a[128:131], v[208:211], v[16:19], a[128:131]
    v_mfma_f32_16x16x32_bf16 a[128:131], v[212:215], v[20:23], a[128:131]
    ds_read_b64_tr_b16 v[216:217], v229 offset:8192
    v_mfma_f32_16x16x32_bf16 a[132:135], v[208:211], v[24:27], a[132:135]
    v_mfma_f32_16x16x32_bf16 a[132:135], v[212:215], v[28:31], a[132:135]
    ds_read_b64_tr_b16 v[218:219], v229 offset:9216
    v_mfma_f32_16x16x32_bf16 a[136:139], v[208:211], v[32:35], a[136:139]
    v_mfma_f32_16x16x32_bf16 a[136:139], v[212:215], v[36:39], a[136:139]
    ds_read_b64_tr_b16 v[220:221], v229 offset:24576
    v_mfma_f32_16x16x32_bf16 a[140:143], v[208:211], v[40:43], a[140:143]
    v_mfma_f32_16x16x32_bf16 a[140:143], v[212:215], v[44:47], a[140:143]
    ds_read_b64_tr_b16 v[222:223], v229 offset:25600
    v_mfma_f32_16x16x32_bf16 a[144:147], v[208:211], v[48:51], a[144:147]
    ds_read_b128 v[104:107], v224 offset:38912
    s_add_u32 m0, s47, 53248
    v_mfma_f32_16x16x32_bf16 a[144:147], v[212:215], v[52:55], a[144:147]
    buffer_load_dwordx4 v243, s[24:27], s44 offen lds
    v_mfma_f32_16x16x32_bf16 a[148:151], v[208:211], v[56:59], a[148:151]
    v_mfma_f32_16x16x32_bf16 a[148:151], v[212:215], v[60:63], a[148:151]
    v_mfma_f32_16x16x32_bf16 a[152:155], v[208:211], v[64:67], a[152:155]
    ds_read_b128 v[108:111], v225 offset:38912
    v_mfma_f32_16x16x32_bf16 a[152:155], v[212:215], v[68:71], a[152:155]
    v_mfma_f32_16x16x32_bf16 a[156:159], v[208:211], v[72:75], a[156:159]
    v_mfma_f32_16x16x32_bf16 a[156:159], v[212:215], v[76:79], a[156:159]
    s_waitcnt lgkmcnt(2)
    v_mfma_f32_16x16x32_bf16 a[160:163], v[216:219], v[16:19], a[160:163]
    v_mfma_f32_16x16x32_bf16 a[160:163], v[220:223], v[20:23], a[160:163]
    ds_read_b64_tr_b16 v[208:209], v230 offset:0
    v_mfma_f32_16x16x32_bf16 a[164:167], v[216:219], v[24:27], a[164:167]
    v_mfma_f32_16x16x32_bf16 a[164:167], v[220:223], v[28:31], a[164:167]
    ds_read_b64_tr_b16 v[210:211], v230 offset:1024
    v_mfma_f32_16x16x32_bf16 a[168:171], v[216:219], v[32:35], a[168:171]
    v_mfma_f32_16x16x32_bf16 a[168:171], v[220:223], v[36:39], a[168:171]
    ds_read_b64_tr_b16 v[212:213], v230 offset:16384
    v_mfma_f32_16x16x32_bf16 a[172:175], v[216:219], v[40:43], a[172:175]
    v_mfma_f32_16x16x32_bf16 a[172:175], v[220:223], v[44:47], a[172:175]
    ds_read_b64_tr_b16 v[214:215], v230 offset:17408
    v_mfma_f32_16x16x32_bf16 a[176:179], v[216:219], v[48:51], a[176:179]
    ds_read_b128 v[112:115], v224 offset:40960
    v_mfma_f32_16x16x32_bf16 a[176:179], v[220:223], v[52:55], a[176:179]
    v_mfma_f32_16x16x32_bf16 a[180:183], v[216:219], v[56:59], a[180:183]
    s_add_u32 m0, s47, 54272
    v_mfma_f32_16x16x32_bf16 a[180:183], v[220:223], v[60:63], a[180:183]
    buffer_load_dwordx4 v244, s[24:27], s44 offen lds
    s_add_u32 s44, s44, 229376
    v_mfma_f32_16x16x32_bf16 a[184:187], v[216:219], v[64:67], a[184:187]
    ds_read_b128 v[116:119], v225 offset:40960
    v_mfma_f32_16x16x32_bf16 a[184:187], v[220:223], v[68:71], a[184:187]
    v_mfma_f32_16x16x32_bf16 a[188:191], v[216:219], v[72:75], a[188:191]
    v_mfma_f32_16x16x32_bf16 a[188:191], v[220:223], v[76:79], a[188:191]
    s_waitcnt lgkmcnt(2)
    v_mfma_f32_16x16x32_bf16 a[192:195], v[208:211], v[16:19], a[192:195]
    v_mfma_f32_16x16x32_bf16 a[192:195], v[212:215], v[20:23], a[192:195]
    ds_read_b64_tr_b16 v[216:217], v230 offset:8192
    v_mfma_f32_16x16x32_bf16 a[196:199], v[208:211], v[24:27], a[196:199]
    v_mfma_f32_16x16x32_bf16 a[196:199], v[212:215], v[28:31], a[196:199]
    ds_read_b64_tr_b16 v[218:219], v230 offset:9216
    v_mfma_f32_16x16x32_bf16 a[200:203], v[208:211], v[32:35], a[200:203]
    v_mfma_f32_16x16x32_bf16 a[200:203], v[212:215], v[36:39], a[200:203]
    ds_read_b64_tr_b16 v[220:221], v230 offset:24576
    v_mfma_f32_16x16x32_bf16 a[204:207], v[208:211], v[40:43], a[204:207]
    v_mfma_f32_16x16x32_bf16 a[204:207], v[212:215], v[44:47], a[204:207]
    ds_read_b64_tr_b16 v[222:223], v230 offset:25600
    v_mfma_f32_16x16x32_bf16 a[208:211], v[208:211], v[48:51], a[208:211]
    ds_read_b128 v[120:123], v224 offset:43008
    v_mfma_f32_16x16x32_bf16 a[208:211], v[212:215], v[52:55], a[208:211]
    v_mfma_f32_16x16x32_bf16 a[212:215], v[208:211], v[56:59], a[212:215]
    v_mfma_f32_16x16x32_bf16 a[212:215], v[212:215], v[60:63], a[212:215]
    v_mfma_f32_16x16x32_bf16 a[216:219], v[208:211], v[64:67], a[216:219]
    ds_read_b128 v[124:127], v225 offset:43008
    v_mfma_f32_16x16x32_bf16 a[216:219], v[212:215], v[68:71], a[216:219]
    v_mfma_f32_16x16x32_bf16 a[220:223], v[208:211], v[72:75], a[220:223]
    v_mfma_f32_16x16x32_bf16 a[220:223], v[212:215], v[76:79], a[220:223]
    s_waitcnt lgkmcnt(2)
    v_mfma_f32_16x16x32_bf16 a[224:227], v[216:219], v[16:19], a[224:227]
    v_mfma_f32_16x16x32_bf16 a[224:227], v[220:223], v[20:23], a[224:227]
    ds_read_b64_tr_b16 v[208:209], v231 offset:0
    v_mfma_f32_16x16x32_bf16 a[228:231], v[216:219], v[24:27], a[228:231]
    v_mfma_f32_16x16x32_bf16 a[228:231], v[220:223], v[28:31], a[228:231]
    ds_read_b64_tr_b16 v[210:211], v231 offset:1024
    v_mfma_f32_16x16x32_bf16 a[232:235], v[216:219], v[32:35], a[232:235]
    v_mfma_f32_16x16x32_bf16 a[232:235], v[220:223], v[36:39], a[232:235]
    ds_read_b64_tr_b16 v[212:213], v231 offset:16384
    v_mfma_f32_16x16x32_bf16 a[236:239], v[216:219], v[40:43], a[236:239]
    v_mfma_f32_16x16x32_bf16 a[236:239], v[220:223], v[44:47], a[236:239]
    ds_read_b64_tr_b16 v[214:215], v231 offset:17408
    v_mfma_f32_16x16x32_bf16 a[240:243], v[216:219], v[48:51], a[240:243]
    ds_read_b128 v[128:131], v224 offset:45056
    v_mfma_f32_16x16x32_bf16 a[240:243], v[220:223], v[52:55], a[240:243]
    v_mfma_f32_16x16x32_bf16 a[244:247], v[216:219], v[56:59], a[244:247]
    v_mfma_f32_16x16x32_bf16 a[244:247], v[220:223], v[60:63], a[244:247]
    v_mfma_f32_16x16x32_bf16 a[248:251], v[216:219], v[64:67], a[248:251]
    ds_read_b128 v[132:135], v225 offset:45056
    v_mfma_f32_16x16x32_bf16 a[248:251], v[220:223], v[68:71], a[248:251]
    v_mfma_f32_16x16x32_bf16 a[252:255], v[216:219], v[72:75], a[252:255]
    v_mfma_f32_16x16x32_bf16 a[252:255], v[220:223], v[76:79], a[252:255]
    s_waitcnt lgkmcnt(2)
    v_mfma_f32_16x16x32_bf16 v[144:147], v[208:211], v[16:19], v[144:147]
    v_mfma_f32_16x16x32_bf16 v[144:147], v[212:215], v[20:23], v[144:147]
    ds_read_b64_tr_b16 v[216:217], v231 offset:8192
    v_mfma_f32_16x16x32_bf16 v[148:151], v[208:211], v[24:27], v[148:151]
    v_mfma_f32_16x16x32_bf16 v[148:151], v[212:215], v[28:31], v[148:151]
    ds_read_b64_tr_b16 v[218:219], v231 offset:9216
    v_mfma_f32_16x16x32_bf16 v[152:155], v[208:211], v[32:35], v[152:155]
    v_mfma_f32_16x16x32_bf16 v[152:155], v[212:215], v[36:39], v[152:155]
    ds_read_b64_tr_b16 v[220:221], v231 offset:24576
    v_mfma_f32_16x16x32_bf16 v[156:159], v[208:211], v[40:43], v[156:159]
    v_mfma_f32_16x16x32_bf16 v[156:159], v[212:215], v[44:47], v[156:159]
    ds_read_b64_tr_b16 v[222:223], v231 offset:25600
    v_mfma_f32_16x16x32_bf16 v[160:163], v[208:211], v[48:51], v[160:163]
    ds_read_b128 v[136:139], v224 offset:47104
    v_mfma_f32_16x16x32_bf16 v[160:163], v[212:215], v[52:55], v[160:163]
    v_mfma_f32_16x16x32_bf16 v[164:167], v[208:211], v[56:59], v[164:167]
    v_mfma_f32_16x16x32_bf16 v[164:167], v[212:215], v[60:63], v[164:167]
    v_mfma_f32_16x16x32_bf16 v[168:171], v[208:211], v[64:67], v[168:171]
    ds_read_b128 v[140:143], v225 offset:47104
    v_mfma_f32_16x16x32_bf16 v[168:171], v[212:215], v[68:71], v[168:171]
    v_mfma_f32_16x16x32_bf16 v[172:175], v[208:211], v[72:75], v[172:175]
    s_waitcnt vmcnt(12)
    v_mfma_f32_16x16x32_bf16 v[172:175], v[212:215], v[76:79], v[172:175]
    s_waitcnt lgkmcnt(0)
    s_barrier
    v_mfma_f32_16x16x32_bf16 v[176:179], v[216:219], v[16:19], v[176:179]
    ds_read_b64_tr_b16 v[208:209], v226 offset:8192
    v_mfma_f32_16x16x32_bf16 v[176:179], v[220:223], v[20:23], v[176:179]
    v_mfma_f32_16x16x32_bf16 v[180:183], v[216:219], v[24:27], v[180:183]
    ds_read_b64_tr_b16 v[210:211], v226 offset:8704
    v_mfma_f32_16x16x32_bf16 v[180:183], v[220:223], v[28:31], v[180:183]
    v_mfma_f32_16x16x32_bf16 v[184:187], v[216:219], v[32:35], v[184:187]
    ds_read_b64_tr_b16 v[212:213], v226 offset:12288
    v_mfma_f32_16x16x32_bf16 v[184:187], v[220:223], v[36:39], v[184:187]
    v_mfma_f32_16x16x32_bf16 v[188:191], v[216:219], v[40:43], v[188:191]
    ds_read_b64_tr_b16 v[214:215], v226 offset:12800
    v_mfma_f32_16x16x32_bf16 v[188:191], v[220:223], v[44:47], v[188:191]
    v_mfma_f32_16x16x32_bf16 v[192:195], v[216:219], v[48:51], v[192:195]
    v_mfma_f32_16x16x32_bf16 v[192:195], v[220:223], v[52:55], v[192:195]
    v_mfma_f32_16x16x32_bf16 v[196:199], v[216:219], v[56:59], v[196:199]
    v_mfma_f32_16x16x32_bf16 v[196:199], v[220:223], v[60:63], v[196:199]
    v_mfma_f32_16x16x32_bf16 v[200:203], v[216:219], v[64:67], v[200:203]
    v_mfma_f32_16x16x32_bf16 v[200:203], v[220:223], v[68:71], v[200:203]
    v_mfma_f32_16x16x32_bf16 v[204:207], v[216:219], v[72:75], v[204:207]
    v_mfma_f32_16x16x32_bf16 v[204:207], v[220:223], v[76:79], v[204:207]
    s_waitcnt lgkmcnt(0)
    v_mfma_f32_16x16x32_bf16 a[0:3], v[80:83], v[208:211], a[0:3]
    v_mfma_f32_16x16x32_bf16 a[0:3], v[84:87], v[212:215], a[0:3]
    ds_read_b64_tr_b16 v[216:217], v227 offset:8192
    v_mfma_f32_16x16x32_bf16 a[4:7], v[88:91], v[208:211], a[4:7]
    buffer_load_dwordx4 v[16:19], v253, s[16:19], s61 offen offset:0
    v_mfma_f32_16x16x32_bf16 a[4:7], v[92:95], v[212:215], a[4:7]
    ds_read_b64_tr_b16 v[218:219], v227 offset:8704
    v_mfma_f32_16x16x32_bf16 a[8:11], v[96:99], v[208:211], a[8:11]
    v_mfma_f32_16x16x32_bf16 a[8:11], v[100:103], v[212:215], a[8:11]
    ds_read_b64_tr_b16 v[220:221], v227 offset:12288
    buffer_load_dwordx4 v[20:23], v253, s[16:19], s61 offen offset:16
    v_mfma_f32_16x16x32_bf16 a[12:15], v[104:107], v[208:211], a[12:15]
    v_mfma_f32_16x16x32_bf16 a[12:15], v[108:111], v[212:215], a[12:15]
    ds_read_b64_tr_b16 v[222:223], v227 offset:12800
    v_mfma_f32_16x16x32_bf16 a[16:19], v[112:115], v[208:211], a[16:19]
    buffer_load_dwordx4 v[24:27], v253, s[16:19], s61 offen offset:32
    v_mfma_f32_16x16x32_bf16 a[16:19], v[116:119], v[212:215], a[16:19]
    v_mfma_f32_16x16x32_bf16 a[20:23], v[120:123], v[208:211], a[20:23]
    v_mfma_f32_16x16x32_bf16 a[20:23], v[124:127], v[212:215], a[20:23]
    buffer_load_dwordx4 v[28:31], v253, s[16:19], s61 offen offset:48
    v_mfma_f32_16x16x32_bf16 a[24:27], v[128:131], v[208:211], a[24:27]
    v_mfma_f32_16x16x32_bf16 a[24:27], v[132:135], v[212:215], a[24:27]
    v_mfma_f32_16x16x32_bf16 a[28:31], v[136:139], v[208:211], a[28:31]
    s_waitcnt vmcnt(4)
    buffer_load_dwordx4 v[32:35], v252, s[32:35], 0 offen offset:0
    v_mfma_f32_16x16x32_bf16 a[28:31], v[140:143], v[212:215], a[28:31]
    s_waitcnt lgkmcnt(0)
    s_barrier
    v_mfma_f32_16x16x32_bf16 a[32:35], v[80:83], v[216:219], a[32:35]
    v_mfma_f32_16x16x32_bf16 a[32:35], v[84:87], v[220:223], a[32:35]
    ds_read_b64_tr_b16 v[208:209], v228 offset:32768
    buffer_load_dwordx4 v[36:39], v252, s[32:35], 0 offen offset:16
    v_mfma_f32_16x16x32_bf16 a[36:39], v[88:91], v[216:219], a[36:39]
    v_mfma_f32_16x16x32_bf16 a[36:39], v[92:95], v[220:223], a[36:39]
    ds_read_b64_tr_b16 v[210:211], v228 offset:33792
    v_mfma_f32_16x16x32_bf16 a[40:43], v[96:99], v[216:219], a[40:43]
    buffer_load_dwordx4 v[40:43], v252, s[32:35], 0 offen offset:32
    v_mfma_f32_16x16x32_bf16 a[40:43], v[100:103], v[220:223], a[40:43]
    ds_read_b64_tr_b16 v[212:213], v228 offset:49152
    v_mfma_f32_16x16x32_bf16 a[44:47], v[104:107], v[216:219], a[44:47]
    v_mfma_f32_16x16x32_bf16 a[44:47], v[108:111], v[220:223], a[44:47]
    ds_read_b64_tr_b16 v[214:215], v228 offset:50176
    buffer_load_dwordx4 v[44:47], v252, s[32:35], 0 offen offset:48
    v_mfma_f32_16x16x32_bf16 a[48:51], v[112:115], v[216:219], a[48:51]
    v_mfma_f32_16x16x32_bf16 a[48:51], v[116:119], v[220:223], a[48:51]
    v_mfma_f32_16x16x32_bf16 a[52:55], v[120:123], v[216:219], a[52:55]
    buffer_load_dword v14, v15, s[76:79], 0 offen sc1
    v_mfma_f32_16x16x32_bf16 a[52:55], v[124:127], v[220:223], a[52:55]
    v_and_b32 v2, 15, v1
    v_mfma_f32_16x16x32_bf16 a[56:59], v[128:131], v[216:219], a[56:59]
    v_lshrrev_b32 v3, 4, v1
    v_lshlrev_b32 v3, 9, v3
    v_mfma_f32_16x16x32_bf16 a[56:59], v[132:135], v[220:223], a[56:59]
    v_lshl_add_u32 v76, v2, 4, v3
    v_lshlrev_b32 v0, 4, v1
    v_mfma_f32_16x16x32_bf16 a[60:63], v[136:139], v[216:219], a[60:63]
    v_mov_b32 v72, 0xc0135761
    v_mov_b32 v73, 0xc0135761
    v_mfma_f32_16x16x32_bf16 a[60:63], v[140:143], v[220:223], a[60:63]
    s_waitcnt lgkmcnt(0)
    v_mov_b32 v74, 1.0
    v_mfma_f32_16x16x32_bf16 a[64:67], v[208:211], v[80:83], a[64:67]
    v_mov_b32 v75, 1.0
    v_mfma_f32_16x16x32_bf16 a[64:67], v[212:215], v[84:87], a[64:67]
    ds_read_b64_tr_b16 v[216:217], v228 offset:40960
    v_mfma_f32_16x16x32_bf16 a[68:71], v[208:211], v[88:91], a[68:71]
    v_mfma_f32_16x16x32_bf16 a[68:71], v[212:215], v[92:95], a[68:71]
    ds_read_b64_tr_b16 v[218:219], v228 offset:41984
    v_mfma_f32_16x16x32_bf16 a[72:75], v[208:211], v[96:99], a[72:75]
    v_mfma_f32_16x16x32_bf16 a[72:75], v[212:215], v[100:103], a[72:75]
    ds_read_b64_tr_b16 v[220:221], v228 offset:57344
    v_mfma_f32_16x16x32_bf16 a[76:79], v[208:211], v[104:107], a[76:79]
    v_mfma_f32_16x16x32_bf16 a[76:79], v[212:215], v[108:111], a[76:79]
    ds_read_b64_tr_b16 v[222:223], v228 offset:58368
    v_mfma_f32_16x16x32_bf16 a[80:83], v[208:211], v[112:115], a[80:83]
    v_accvgpr_read_b32 v48, a0
    v_accvgpr_read_b32 v49, a1
    v_mfma_f32_16x16x32_bf16 a[80:83], v[212:215], v[116:119], a[80:83]
    v_accvgpr_read_b32 v50, a2
    v_accvgpr_read_b32 v51, a3
    v_mfma_f32_16x16x32_bf16 a[84:87], v[208:211], v[120:123], a[84:87]
    v_accvgpr_read_b32 v52, a4
    v_accvgpr_read_b32 v53, a5
    v_mfma_f32_16x16x32_bf16 a[84:87], v[212:215], v[124:127], a[84:87]
    v_accvgpr_read_b32 v54, a6
    v_accvgpr_read_b32 v55, a7
    v_mfma_f32_16x16x32_bf16 a[88:91], v[208:211], v[128:131], a[88:91]
    s_add_u32 s59, s58, 0
    v_cvt_pk_bf16_f32 v56, v48, v49
    v_mfma_f32_16x16x32_bf16 a[88:91], v[212:215], v[132:135], a[88:91]
    v_cvt_pk_bf16_f32 v57, v50, v51
    v_cvt_pk_bf16_f32 v58, v52, v53
    v_mfma_f32_16x16x32_bf16 a[92:95], v[208:211], v[136:139], a[92:95]
    v_cvt_pk_bf16_f32 v59, v54, v55
    buffer_store_dwordx4 v[56:59], v76, s[28:31], s59 offen offset:0 sc1
    v_mfma_f32_16x16x32_bf16 a[92:95], v[212:215], v[140:143], a[92:95]
    s_waitcnt lgkmcnt(0)
    v_mfma_f32_16x16x32_bf16 a[96:99], v[216:219], v[80:83], a[96:99]
    v_accvgpr_read_b32 v48, a32
    v_mfma_f32_16x16x32_bf16 a[96:99], v[220:223], v[84:87], a[96:99]
    ds_read_b64_tr_b16 v[208:209], v229 offset:32768
    v_accvgpr_read_b32 v49, a33
    v_mfma_f32_16x16x32_bf16 a[100:103], v[216:219], v[88:91], a[100:103]
    v_accvgpr_read_b32 v50, a34
    v_accvgpr_read_b32 v51, a35
    v_mfma_f32_16x16x32_bf16 a[100:103], v[220:223], v[92:95], a[100:103]
    ds_read_b64_tr_b16 v[210:211], v229 offset:33792
    v_accvgpr_read_b32 v52, a36
    v_mfma_f32_16x16x32_bf16 a[104:107], v[216:219], v[96:99], a[104:107]
    v_accvgpr_read_b32 v53, a37
    v_accvgpr_read_b32 v54, a38
    v_mfma_f32_16x16x32_bf16 a[104:107], v[220:223], v[100:103], a[104:107]
    ds_read_b64_tr_b16 v[212:213], v229 offset:49152
    v_accvgpr_read_b32 v55, a39
    v_mfma_f32_16x16x32_bf16 a[108:111], v[216:219], v[104:107], a[108:111]
    s_add_u32 s59, s58, 0
    v_cvt_pk_bf16_f32 v60, v48, v49
    v_mfma_f32_16x16x32_bf16 a[108:111], v[220:223], v[108:111], a[108:111]
    ds_read_b64_tr_b16 v[214:215], v229 offset:50176
    v_cvt_pk_bf16_f32 v61, v50, v51
    v_mfma_f32_16x16x32_bf16 a[112:115], v[216:219], v[112:115], a[112:115]
    v_cvt_pk_bf16_f32 v62, v52, v53
    v_cvt_pk_bf16_f32 v63, v54, v55
    v_mfma_f32_16x16x32_bf16 a[112:115], v[220:223], v[116:119], a[112:115]
    buffer_store_dwordx4 v[60:63], v76, s[28:31], s59 offen offset:256 sc1
    v_mfma_f32_16x16x32_bf16 a[116:119], v[216:219], v[120:123], a[116:119]
    v_accvgpr_read_b32 v48, a8
    v_mfma_f32_16x16x32_bf16 a[116:119], v[220:223], v[124:127], a[116:119]
    v_accvgpr_read_b32 v49, a9
    v_accvgpr_read_b32 v50, a10
    v_mfma_f32_16x16x32_bf16 a[120:123], v[216:219], v[128:131], a[120:123]
    v_accvgpr_read_b32 v51, a11
    v_accvgpr_read_b32 v52, a12
    v_mfma_f32_16x16x32_bf16 a[120:123], v[220:223], v[132:135], a[120:123]
    v_accvgpr_read_b32 v53, a13
    v_accvgpr_read_b32 v54, a14
    v_mfma_f32_16x16x32_bf16 a[124:127], v[216:219], v[136:139], a[124:127]
    v_accvgpr_read_b32 v55, a15
    s_add_u32 s59, s58, 2048
    v_mfma_f32_16x16x32_bf16 a[124:127], v[220:223], v[140:143], a[124:127]
    s_waitcnt lgkmcnt(0)
    v_cvt_pk_bf16_f32 v64, v48, v49
    v_mfma_f32_16x16x32_bf16 a[128:131], v[208:211], v[80:83], a[128:131]
    v_cvt_pk_bf16_f32 v65, v50, v51
    v_cvt_pk_bf16_f32 v66, v52, v53
    v_mfma_f32_16x16x32_bf16 a[128:131], v[212:215], v[84:87], a[128:131]
    ds_read_b64_tr_b16 v[216:217], v229 offset:40960
    v_cvt_pk_bf16_f32 v67, v54, v55
    v_mfma_f32_16x16x32_bf16 a[132:135], v[208:211], v[88:91], a[132:135]
    buffer_store_dwordx4 v[64:67], v76, s[28:31], s59 offen offset:0 sc1
    v_mfma_f32_16x16x32_bf16 a[132:135], v[212:215], v[92:95], a[132:135]
    ds_read_b64_tr_b16 v[218:219], v229 offset:41984
    v_mfma_f32_16x16x32_bf16 a[136:139], v[208:211], v[96:99], a[136:139]
    v_accvgpr_read_b32 v48, a40
    v_accvgpr_read_b32 v49, a41
    v_mfma_f32_16x16x32_bf16 a[136:139], v[212:215], v[100:103], a[136:139]
    ds_read_b64_tr_b16 v[220:221], v229 offset:57344
    v_accvgpr_read_b32 v50, a42
    v_mfma_f32_16x16x32_bf16 a[140:143], v[208:211], v[104:107], a[140:143]
    v_accvgpr_read_b32 v51, a43
    v_accvgpr_read_b32 v52, a44
    v_mfma_f32_16x16x32_bf16 a[140:143], v[212:215], v[108:111], a[140:143]
    ds_read_b64_tr_b16 v[222:223], v229 offset:58368
    v_accvgpr_read_b32 v53, a45
    v_mfma_f32_16x16x32_bf16 a[144:147], v[208:211], v[112:115], a[144:147]
    v_accvgpr_read_b32 v54, a46
    v_accvgpr_read_b32 v55, a47
    v_mfma_f32_16x16x32_bf16 a[144:147], v[212:215], v[116:119], a[144:147]
    s_add_u32 s59, s58, 2048
    v_cvt_pk_bf16_f32 v68, v48, v49
    v_mfma_f32_16x16x32_bf16 a[148:151], v[208:211], v[120:123], a[148:151]
    v_cvt_pk_bf16_f32 v69, v50, v51
    v_cvt_pk_bf16_f32 v70, v52, v53
    v_mfma_f32_16x16x32_bf16 a[148:151], v[212:215], v[124:127], a[148:151]
    v_cvt_pk_bf16_f32 v71, v54, v55
    buffer_store_dwordx4 v[68:71], v76, s[28:31], s59 offen offset:256 sc1
    v_mfma_f32_16x16x32_bf16 a[152:155], v[208:211], v[128:131], a[152:155]
    v_mfma_f32_16x16x32_bf16 a[152:155], v[212:215], v[132:135], a[152:155]
    v_accvgpr_read_b32 v48, a16
    v_accvgpr_read_b32 v49, a17
    v_mfma_f32_16x16x32_bf16 a[156:159], v[208:211], v[136:139], a[156:159]
    v_accvgpr_read_b32 v50, a18
    v_accvgpr_read_b32 v51, a19
    v_mfma_f32_16x16x32_bf16 a[156:159], v[212:215], v[140:143], a[156:159]
    s_waitcnt lgkmcnt(0)
    v_accvgpr_read_b32 v52, a20
    v_mfma_f32_16x16x32_bf16 a[160:163], v[216:219], v[80:83], a[160:163]
    v_accvgpr_read_b32 v53, a21
    v_accvgpr_read_b32 v54, a22
    v_mfma_f32_16x16x32_bf16 a[160:163], v[220:223], v[84:87], a[160:163]
    ds_read_b64_tr_b16 v[208:209], v230 offset:32768
    v_accvgpr_read_b32 v55, a23
    v_mfma_f32_16x16x32_bf16 a[164:167], v[216:219], v[88:91], a[164:167]
    s_add_u32 s59, s58, 4096
    v_cvt_pk_bf16_f32 v56, v48, v49
    v_mfma_f32_16x16x32_bf16 a[164:167], v[220:223], v[92:95], a[164:167]
    ds_read_b64_tr_b16 v[210:211], v230 offset:33792
    v_cvt_pk_bf16_f32 v57, v50, v51
    v_mfma_f32_16x16x32_bf16 a[168:171], v[216:219], v[96:99], a[168:171]
    v_cvt_pk_bf16_f32 v58, v52, v53
    v_cvt_pk_bf16_f32 v59, v54, v55
    v_mfma_f32_16x16x32_bf16 a[168:171], v[220:223], v[100:103], a[168:171]
    ds_read_b64_tr_b16 v[212:213], v230 offset:49152
    buffer_store_dwordx4 v[56:59], v76, s[28:31], s59 offen offset:0 sc1
    v_mfma_f32_16x16x32_bf16 a[172:175], v[216:219], v[104:107], a[172:175]
    v_mfma_f32_16x16x32_bf16 a[172:175], v[220:223], v[108:111], a[172:175]
    ds_read_b64_tr_b16 v[214:215], v230 offset:50176
    v_accvgpr_read_b32 v48, a48
    v_mfma_f32_16x16x32_bf16 a[176:179], v[216:219], v[112:115], a[176:179]
    v_accvgpr_read_b32 v49, a49
    v_accvgpr_read_b32 v50, a50
    v_mfma_f32_16x16x32_bf16 a[176:179], v[220:223], v[116:119], a[176:179]
    v_accvgpr_read_b32 v51, a51
    v_accvgpr_read_b32 v52, a52
    v_mfma_f32_16x16x32_bf16 a[180:183], v[216:219], v[120:123], a[180:183]
    v_accvgpr_read_b32 v53, a53
    v_accvgpr_read_b32 v54, a54
    v_mfma_f32_16x16x32_bf16 a[180:183], v[220:223], v[124:127], a[180:183]
    v_accvgpr_read_b32 v55, a55
    s_add_u32 s59, s58, 4096
    v_mfma_f32_16x16x32_bf16 a[184:187], v[216:219], v[128:131], a[184:187]
    v_cvt_pk_bf16_f32 v60, v48, v49
    v_cvt_pk_bf16_f32 v61, v50, v51
    v_mfma_f32_16x16x32_bf16 a[184:187], v[220:223], v[132:135], a[184:187]
    v_cvt_pk_bf16_f32 v62, v52, v53
    v_cvt_pk_bf16_f32 v63, v54, v55
    v_mfma_f32_16x16x32_bf16 a[188:191], v[216:219], v[136:139], a[188:191]
    buffer_store_dwordx4 v[60:63], v76, s[28:31], s59 offen offset:256 sc1
    v_mfma_f32_16x16x32_bf16 a[188:191], v[220:223], v[140:143], a[188:191]
    s_waitcnt lgkmcnt(0)
    v_mfma_f32_16x16x32_bf16 a[192:195], v[208:211], v[80:83], a[192:195]
    v_accvgpr_read_b32 v48, a24
    v_accvgpr_read_b32 v49, a25
    v_mfma_f32_16x16x32_bf16 a[192:195], v[212:215], v[84:87], a[192:195]
    ds_read_b64_tr_b16 v[216:217], v230 offset:40960
    v_accvgpr_read_b32 v50, a26
    v_mfma_f32_16x16x32_bf16 a[196:199], v[208:211], v[88:91], a[196:199]
    v_accvgpr_read_b32 v51, a27
    v_accvgpr_read_b32 v52, a28
    v_mfma_f32_16x16x32_bf16 a[196:199], v[212:215], v[92:95], a[196:199]
    ds_read_b64_tr_b16 v[218:219], v230 offset:41984
    v_accvgpr_read_b32 v53, a29
    v_mfma_f32_16x16x32_bf16 a[200:203], v[208:211], v[96:99], a[200:203]
    v_accvgpr_read_b32 v54, a30
    v_accvgpr_read_b32 v55, a31
    v_mfma_f32_16x16x32_bf16 a[200:203], v[212:215], v[100:103], a[200:203]
    ds_read_b64_tr_b16 v[220:221], v230 offset:57344
    s_add_u32 s59, s58, 6144
    v_mfma_f32_16x16x32_bf16 a[204:207], v[208:211], v[104:107], a[204:207]
    v_cvt_pk_bf16_f32 v64, v48, v49
    v_cvt_pk_bf16_f32 v65, v50, v51
    v_mfma_f32_16x16x32_bf16 a[204:207], v[212:215], v[108:111], a[204:207]
    ds_read_b64_tr_b16 v[222:223], v230 offset:58368
    v_cvt_pk_bf16_f32 v66, v52, v53
    v_mfma_f32_16x16x32_bf16 a[208:211], v[208:211], v[112:115], a[208:211]
    v_cvt_pk_bf16_f32 v67, v54, v55
    buffer_store_dwordx4 v[64:67], v76, s[28:31], s59 offen offset:0 sc1
    v_mfma_f32_16x16x32_bf16 a[208:211], v[212:215], v[116:119], a[208:211]
    v_mfma_f32_16x16x32_bf16 a[212:215], v[208:211], v[120:123], a[212:215]
    v_accvgpr_read_b32 v48, a56
    v_accvgpr_read_b32 v49, a57
    v_mfma_f32_16x16x32_bf16 a[212:215], v[212:215], v[124:127], a[212:215]
    v_accvgpr_read_b32 v50, a58
    v_accvgpr_read_b32 v51, a59
    v_mfma_f32_16x16x32_bf16 a[216:219], v[208:211], v[128:131], a[216:219]
    v_accvgpr_read_b32 v52, a60
    v_accvgpr_read_b32 v53, a61
    v_mfma_f32_16x16x32_bf16 a[216:219], v[212:215], v[132:135], a[216:219]
    v_accvgpr_read_b32 v54, a62
    v_accvgpr_read_b32 v55, a63
    v_mfma_f32_16x16x32_bf16 a[220:223], v[208:211], v[136:139], a[220:223]
    s_add_u32 s59, s58, 6144
    v_cvt_pk_bf16_f32 v68, v48, v49
    v_mfma_f32_16x16x32_bf16 a[220:223], v[212:215], v[140:143], a[220:223]
    s_waitcnt lgkmcnt(0)
    v_cvt_pk_bf16_f32 v69, v50, v51
    v_mfma_f32_16x16x32_bf16 a[224:227], v[216:219], v[80:83], a[224:227]
    v_cvt_pk_bf16_f32 v70, v52, v53
    v_cvt_pk_bf16_f32 v71, v54, v55
    v_mfma_f32_16x16x32_bf16 a[224:227], v[220:223], v[84:87], a[224:227]
    ds_read_b64_tr_b16 v[208:209], v231 offset:32768
    buffer_store_dwordx4 v[68:71], v76, s[28:31], s59 offen offset:256 sc1
    v_mfma_f32_16x16x32_bf16 a[228:231], v[216:219], v[88:91], a[228:231]
    v_mfma_f32_16x16x32_bf16 a[228:231], v[220:223], v[92:95], a[228:231]
    ds_read_b64_tr_b16 v[210:211], v231 offset:33792
    s_waitcnt vmcnt(8)
    v_mfma_f32_16x16x32_bf16 a[232:235], v[216:219], v[96:99], a[232:235]
    v_mov_b32 v2, 0
    v_mov_b32 v3, 0
    v_mfma_f32_16x16x32_bf16 a[232:235], v[220:223], v[100:103], a[232:235]
    ds_read_b64_tr_b16 v[212:213], v231 offset:49152
    v_dot2_f32_bf16 v2, v16, v32, v2
    v_mfma_f32_16x16x32_bf16 a[236:239], v[216:219], v[104:107], a[236:239]
    v_dot2_f32_bf16 v3, v17, v33, v3
    v_mfma_f32_16x16x32_bf16 a[236:239], v[220:223], v[108:111], a[236:239]
    ds_read_b64_tr_b16 v[214:215], v231 offset:50176
    v_mfma_f32_16x16x32_bf16 a[240:243], v[216:219], v[112:115], a[240:243]
    v_dot2_f32_bf16 v2, v18, v34, v2
    v_mfma_f32_16x16x32_bf16 a[240:243], v[220:223], v[116:119], a[240:243]
    v_dot2_f32_bf16 v3, v19, v35, v3
    v_mfma_f32_16x16x32_bf16 a[244:247], v[216:219], v[120:123], a[244:247]
    v_dot2_f32_bf16 v2, v20, v36, v2
    v_mfma_f32_16x16x32_bf16 a[244:247], v[220:223], v[124:127], a[244:247]
    v_dot2_f32_bf16 v3, v21, v37, v3
    v_mfma_f32_16x16x32_bf16 a[248:251], v[216:219], v[128:131], a[248:251]
    v_dot2_f32_bf16 v2, v22, v38, v2
    v_mfma_f32_16x16x32_bf16 a[248:251], v[220:223], v[132:135], a[248:251]
    v_dot2_f32_bf16 v3, v23, v39, v3
    v_mfma_f32_16x16x32_bf16 a[252:255], v[216:219], v[136:139], a[252:255]
    v_dot2_f32_bf16 v2, v24, v40, v2
    v_mfma_f32_16x16x32_bf16 a[252:255], v[220:223], v[140:143], a[252:255]
    s_waitcnt lgkmcnt(0)
    v_dot2_f32_bf16 v3, v25, v41, v3
    v_mfma_f32_16x16x32_bf16 v[144:147], v[208:211], v[80:83], v[144:147]
    v_dot2_f32_bf16 v2, v26, v42, v2
    v_mfma_f32_16x16x32_bf16 v[144:147], v[212:215], v[84:87], v[144:147]
    ds_read_b64_tr_b16 v[216:217], v231 offset:40960
    v_mfma_f32_16x16x32_bf16 v[148:151], v[208:211], v[88:91], v[148:151]
    v_dot2_f32_bf16 v3, v27, v43, v3
    v_mfma_f32_16x16x32_bf16 v[148:151], v[212:215], v[92:95], v[148:151]
    ds_read_b64_tr_b16 v[218:219], v231 offset:41984
    v_dot2_f32_bf16 v2, v28, v44, v2
    v_mfma_f32_16x16x32_bf16 v[152:155], v[208:211], v[96:99], v[152:155]
    v_dot2_f32_bf16 v3, v29, v45, v3
    v_mfma_f32_16x16x32_bf16 v[152:155], v[212:215], v[100:103], v[152:155]
    ds_read_b64_tr_b16 v[220:221], v231 offset:57344
    v_mfma_f32_16x16x32_bf16 v[156:159], v[208:211], v[104:107], v[156:159]
    v_dot2_f32_bf16 v2, v30, v46, v2
    v_mfma_f32_16x16x32_bf16 v[156:159], v[212:215], v[108:111], v[156:159]
    ds_read_b64_tr_b16 v[222:223], v231 offset:58368
    v_dot2_f32_bf16 v3, v31, v47, v3
    v_mfma_f32_16x16x32_bf16 v[160:163], v[208:211], v[112:115], v[160:163]
    v_and_b32 v4, 31, v1
    v_mfma_f32_16x16x32_bf16 v[160:163], v[212:215], v[116:119], v[160:163]
    v_cmp_eq_u32 vcc, 31, v4
    v_lshrrev_b32 v4, 5, v1
    v_mfma_f32_16x16x32_bf16 v[164:167], v[208:211], v[120:123], v[164:167]
    v_add_f32 v2, v2, v3
    v_lshlrev_b32 v4, 2, v4
    v_mfma_f32_16x16x32_bf16 v[164:167], v[212:215], v[124:127], v[164:167]
    v_mov_b32 v3, 0x40000000
    v_add_f32_dpp v2, v2, v2 row_shr:1 row_mask:0xf bank_mask:0xf bound_ctrl:0
    v_mfma_f32_16x16x32_bf16 v[168:171], v[208:211], v[128:131], v[168:171]
    s_nop 1
    v_add_f32_dpp v2, v2, v2 row_shr:2 row_mask:0xf bank_mask:0xf bound_ctrl:0
    v_mfma_f32_16x16x32_bf16 v[168:171], v[212:215], v[132:135], v[168:171]
    s_nop 1
    v_add_f32_dpp v2, v2, v2 row_shr:4 row_mask:0xf bank_mask:0xf bound_ctrl:0
    v_mfma_f32_16x16x32_bf16 v[172:175], v[208:211], v[136:139], v[172:175]
    s_nop 1
    v_add_f32_dpp v2, v2, v2 row_shr:8 row_mask:0xf bank_mask:0xf bound_ctrl:0
    v_mfma_f32_16x16x32_bf16 v[172:175], v[212:215], v[140:143], v[172:175]
    s_waitcnt lgkmcnt(0)
    s_nop 1
    v_mfma_f32_16x16x32_bf16 v[176:179], v[216:219], v[80:83], v[176:179]
    v_add_f32_dpp v2, v2, v2 row_bcast:15 row_mask:0xa bank_mask:0xf
    v_mul_f32 v2, 0xbfb8aa3b, v2
    v_mfma_f32_16x16x32_bf16 v[176:179], v[220:223], v[84:87], v[176:179]
    v_exp_f32 v2, v2
    v_mfma_f32_16x16x32_bf16 v[180:183], v[216:219], v[88:91], v[180:183]
    v_cndmask_b32 v3, v3, v4, vcc
    v_add_f32 v2, 1.0, v2
    v_mfma_f32_16x16x32_bf16 v[180:183], v[220:223], v[92:95], v[180:183]
    v_rcp_f32 v2, v2
    v_mfma_f32_16x16x32_bf16 v[184:187], v[216:219], v[96:99], v[184:187]
    s_nop 0
    buffer_store_dword v2, v3, s[28:31], s60 offen sc1
    v_mfma_f32_16x16x32_bf16 v[184:187], v[220:223], v[100:103], v[184:187]
    v_mfma_f32_16x16x32_bf16 v[188:191], v[216:219], v[104:107], v[188:191]
    v_lshlrev_b32 v2, 4, v1
    s_lshr_b32 s20, s80, 2
    v_mfma_f32_16x16x32_bf16 v[188:191], v[220:223], v[108:111], v[188:191]
    s_mul_i32 s20, s20, 4224
    s_add_u32 s20, s20, 34734080
    v_mfma_f32_16x16x32_bf16 v[192:195], v[216:219], v[112:115], v[192:195]
    s_lshl_b32 s21, s81, 2
    s_add_u32 s21, s21, s20
    v_mfma_f32_16x16x32_bf16 v[192:195], v[220:223], v[116:119], v[192:195]
    v_mov_b32 v11, s21
    v_and_b32 v3, 7, v1
    v_mfma_f32_16x16x32_bf16 v[196:199], v[216:219], v[120:123], v[196:199]
    v_lshlrev_b32 v3, 2, v3
    s_lshr_b32 s21, s80, 1
    v_mfma_f32_16x16x32_bf16 v[196:199], v[220:223], v[124:127], v[196:199]
    s_mul_i32 s21, s21, 4224
    s_add_u32 s21, s21, 34801664
    v_mfma_f32_16x16x32_bf16 v[200:203], v[216:219], v[128:131], v[200:203]
    v_add_u32 v4, s21, v3
    v_cmp_gt_u32 vcc, 16, v1
    v_mfma_f32_16x16x32_bf16 v[200:203], v[220:223], v[132:135], v[200:203]
    s_add_u32 s20, s20, 33792
    v_add_u32 v3, s20, v3
    v_mfma_f32_16x16x32_bf16 v[204:207], v[216:219], v[136:139], v[204:207]
    v_cndmask_b32 v11, v11, v4, vcc
    v_cmp_gt_u32 vcc, 8, v1
    v_mfma_f32_16x16x32_bf16 v[204:207], v[220:223], v[140:143], v[204:207]
    s_mov_b32 s35, 0x100000
    v_mov_b32 v32, v2
    s_nop 4
    v_cndmask_b32 v11, v11, v3, vcc
    v_and_b32 v3, 31, v1
    v_lshlrev_b32 v248, 2, v3
    v_and_b32 v4, 15, v1
    v_lshrrev_b32 v5, 4, v1
    v_lshlrev_b32 v6, 4, v4
    v_lshl_add_u32 v6, v5, 9, v6
    v_lshlrev_b32 v7, 2, v4
    s_add_u32 s21, s36, 0
    s_and_b32 s21, s21, 3
    s_mul_i32 s20, s21, 294912
    v_add_u32 v16, s20, v6
    s_lshl_b32 s21, s21, 7
    v_add_u32 v249, s21, v7
    s_add_u32 s21, s36, 1
    s_and_b32 s21, s21, 3
    s_mul_i32 s20, s21, 294912
    v_add_u32 v17, s20, v6
    s_lshl_b32 s21, s21, 7
    v_add_u32 v250, s21, v7
    s_add_u32 s21, s36, 2
    s_and_b32 s21, s21, 3
    s_mul_i32 s20, s21, 294912
    v_add_u32 v18, s20, v6
    s_lshl_b32 s21, s21, 7
    v_add_u32 v251, s21, v7
    s_add_u32 s21, s36, 3
    s_and_b32 s21, s21, 3
    s_mul_i32 s20, s21, 294912
    v_add_u32 v19, s20, v6
    s_lshl_b32 s21, s21, 7
    v_add_u32 v252, s21, v7
    v_lshrrev_b32 v7, 3, v1
    v_and_b32 v8, 1, v5
    v_lshlrev_b32 v3, 1, v8
    v_and_b32 v6, 7, v1
    v_xor_b32 v3, v3, v6
    v_lshlrev_b32 v3, 4, v3
    v_lshl_add_u32 v20, v7, 11, v3
    v_xor_b32 v21, 64, v20
    v_add_u32 v22, 30720, v20
    v_add_u32 v23, 46080, v21
    v_add_u32 v21, 15360, v21
    v_lshrrev_b32 v3, 2, v4
    v_lshl_add_u32 v3, v5, 3, v3
    v_and_b32 v6, 3, v4
    v_lshlrev_b32 v6, 3, v6
    v_lshl_add_u32 v3, v3, 7, v6
    v_lshrrev_b32 v6, 3, v4
    v_lshl_or_b32 v6, v8, 1, v6
    v_xor_b32 v7, 0, v6
    v_lshl_add_u32 v7, v7, 5, v3
    v_add_u32 v24, s15, v7
    v_add_u32 v28, s40, v7
    v_add_u32 v36, s4, v7
    v_xor_b32 v7, 1, v6
    v_lshl_add_u32 v7, v7, 5, v3
    v_add_u32 v25, s15, v7
    v_add_u32 v29, s40, v7
    v_add_u32 v37, s4, v7
    v_xor_b32 v7, 2, v6
    v_lshl_add_u32 v7, v7, 5, v3
    v_add_u32 v26, s15, v7
    v_add_u32 v30, s40, v7
    v_add_u32 v38, s4, v7
    v_xor_b32 v7, 3, v6
    v_lshl_add_u32 v7, v7, 5, v3
    v_add_u32 v27, s15, v7
    v_add_u32 v31, s40, v7
    v_add_u32 v39, s4, v7
    v_lshlrev_b32 v6, 5, v8
    v_lshrrev_b32 v7, 1, v5
    v_lshl_add_u32 v6, v7, 4, v6
    v_lshl_add_u32 v33, v4, 11, v6
    v_lshrrev_b32 v4, 2, v1
    v_xor_b32 v4, v4, v1
    v_and_b32 v4, 4, v4
    v_cmp_eq_u32 vcc, 0, v4
    v_mov_b32 v5, 0x3f803f80
    s_lshr_b32 s19, s83, 1
    v_cndmask_b32 v13, 0, v5, vcc
    s_mul_i32 s19, s19, 4224
    s_mul_i32 s20, s81, 4224
    v_cmp_gt_u32 vcc, 32, v1
    v_add_u32 v3, s19, v248
    v_add_u32 v4, s20, v248
    v_cndmask_b32 v3, v4, v3, vcc
    v_add_u32 v253, 34668544, v3
    v_pk_mul_f32 v[96:97], v[144:145], v[144:145]
    v_pk_mul_f32 v[98:99], v[146:147], v[146:147]
    v_pk_mul_f32 v[100:101], v[148:149], v[148:149]
    v_pk_mul_f32 v[102:103], v[150:151], v[150:151]
    v_pk_fma_f32 v[96:97], v[96:97], s[54:55], v[72:73]
    v_pk_fma_f32 v[98:99], v[98:99], s[54:55], v[72:73]
    v_pk_fma_f32 v[100:101], v[100:101], s[54:55], v[72:73]
    v_pk_fma_f32 v[102:103], v[102:103], s[54:55], v[72:73]
    v_pk_mul_f32 v[96:97], v[96:97], v[144:145]
    v_pk_mul_f32 v[98:99], v[98:99], v[146:147]
    v_pk_mul_f32 v[100:101], v[100:101], v[148:149]
    v_pk_mul_f32 v[102:103], v[102:103], v[150:151]
    v_exp_f32 v96, v96
    v_exp_f32 v97, v97
    v_exp_f32 v98, v98
    v_exp_f32 v99, v99
    v_exp_f32 v100, v100
    v_exp_f32 v101, v101
    v_exp_f32 v102, v102
    v_exp_f32 v103, v103
    v_pk_add_f32 v[96:97], v[96:97], v[74:75]
    v_pk_add_f32 v[98:99], v[98:99], v[74:75]
    v_pk_add_f32 v[100:101], v[100:101], v[74:75]
    v_pk_add_f32 v[102:103], v[102:103], v[74:75]
    v_rcp_f32 v96, v96
    v_rcp_f32 v97, v97
    v_rcp_f32 v98, v98
    v_rcp_f32 v99, v99
    v_rcp_f32 v100, v100
    v_rcp_f32 v101, v101
    v_rcp_f32 v102, v102
    v_rcp_f32 v103, v103
    v_pk_mul_f32 v[104:105], v[144:145], v[176:177]
    v_pk_mul_f32 v[106:107], v[146:147], v[178:179]
    v_pk_mul_f32 v[108:109], v[148:149], v[180:181]
    v_pk_mul_f32 v[110:111], v[150:151], v[182:183]
    v_pk_mul_f32 v[96:97], v[96:97], v[104:105]
    v_pk_mul_f32 v[98:99], v[98:99], v[106:107]
    v_pk_mul_f32 v[100:101], v[100:101], v[108:109]
    v_pk_mul_f32 v[102:103], v[102:103], v[110:111]
    v_cvt_pk_bf16_f32 v128, v96, v97
    v_cvt_pk_bf16_f32 v129, v98, v99
    v_cvt_pk_bf16_f32 v130, v100, v101
    v_cvt_pk_bf16_f32 v131, v102, v103
    v_pk_mul_f32 v[96:97], v[152:153], v[152:153]
    v_pk_mul_f32 v[98:99], v[154:155], v[154:155]
    v_permlane16_swap_b32 v128, v130
    v_permlane16_swap_b32 v129, v131
    v_pk_mul_f32 v[100:101], v[156:157], v[156:157]
    v_pk_mul_f32 v[102:103], v[158:159], v[158:159]
    v_pk_fma_f32 v[96:97], v[96:97], s[54:55], v[72:73]
    v_pk_fma_f32 v[98:99], v[98:99], s[54:55], v[72:73]
    v_pk_fma_f32 v[100:101], v[100:101], s[54:55], v[72:73]
    v_pk_fma_f32 v[102:103], v[102:103], s[54:55], v[72:73]
    v_pk_mul_f32 v[96:97], v[96:97], v[152:153]
    v_pk_mul_f32 v[98:99], v[98:99], v[154:155]
    v_pk_mul_f32 v[100:101], v[100:101], v[156:157]
    v_pk_mul_f32 v[102:103], v[102:103], v[158:159]
    v_exp_f32 v96, v96
    v_exp_f32 v97, v97
    v_exp_f32 v98, v98
    v_exp_f32 v99, v99
    v_exp_f32 v100, v100
    v_exp_f32 v101, v101
    v_exp_f32 v102, v102
    v_exp_f32 v103, v103
    v_pk_add_f32 v[96:97], v[96:97], v[74:75]
    v_pk_add_f32 v[98:99], v[98:99], v[74:75]
    v_pk_add_f32 v[100:101], v[100:101], v[74:75]
    v_pk_add_f32 v[102:103], v[102:103], v[74:75]
    v_rcp_f32 v96, v96
    v_rcp_f32 v97, v97
    v_rcp_f32 v98, v98
    v_rcp_f32 v99, v99
    v_rcp_f32 v100, v100
    v_rcp_f32 v101, v101
    v_rcp_f32 v102, v102
    v_rcp_f32 v103, v103
    v_pk_mul_f32 v[104:105], v[152:153], v[184:185]
    v_pk_mul_f32 v[106:107], v[154:155], v[186:187]
    v_pk_mul_f32 v[108:109], v[156:157], v[188:189]
    v_pk_mul_f32 v[110:111], v[158:159], v[190:191]
    v_pk_mul_f32 v[96:97], v[96:97], v[104:105]
    v_pk_mul_f32 v[98:99], v[98:99], v[106:107]
    v_pk_mul_f32 v[100:101], v[100:101], v[108:109]
    v_pk_mul_f32 v[102:103], v[102:103], v[110:111]
    v_cvt_pk_bf16_f32 v132, v96, v97
    v_cvt_pk_bf16_f32 v133, v98, v99
    v_cvt_pk_bf16_f32 v134, v100, v101
    v_cvt_pk_bf16_f32 v135, v102, v103
    buffer_store_dwordx4 v[128:131], v0, s[28:31], s90 offen offset:3072 sc1
    s_nop 1
    v_permlane16_swap_b32 v132, v134
    v_permlane16_swap_b32 v133, v135
    s_waitcnt vmcnt(2)
    s_barrier
    s_cmp_eq_u32 s36, 0
    s_cbranch_scc0 p1B_f1
    v_mov_b32 v9, 0
    v_mov_b32 v10, 1
    s_mov_b64 exec, 1
    buffer_store_dword v10, v9, s[28:31], s84 offen sc1
    s_mov_b64 exec, -1
p1B_f1:
    buffer_store_dwordx4 v[132:135], v0, s[28:31], s91 offen offset:3072 sc1
    v_pk_mul_f32 v[96:97], v[160:161], v[160:161]
    v_pk_mul_f32 v[98:99], v[162:163], v[162:163]
    v_pk_mul_f32 v[100:101], v[164:165], v[164:165]
    v_pk_mul_f32 v[102:103], v[166:167], v[166:167]
    v_pk_fma_f32 v[96:97], v[96:97], s[54:55], v[72:73]
    v_pk_fma_f32 v[98:99], v[98:99], s[54:55], v[72:73]
    v_pk_fma_f32 v[100:101], v[100:101], s[54:55], v[72:73]
    v_pk_fma_f32 v[102:103], v[102:103], s[54:55], v[72:73]
    v_pk_mul_f32 v[96:97], v[96:97], v[160:161]
    v_pk_mul_f32 v[98:99], v[98:99], v[162:163]
    v_pk_mul_f32 v[100:101], v[100:101], v[164:165]
    v_pk_mul_f32 v[102:103], v[102:103], v[166:167]
    v_exp_f32 v96, v96
    v_exp_f32 v97, v97
    v_exp_f32 v98, v98
    v_exp_f32 v99, v99
    v_exp_f32 v100, v100
    v_exp_f32 v101, v101
    v_exp_f32 v102, v102
    v_exp_f32 v103, v103
    v_pk_add_f32 v[96:97], v[96:97], v[74:75]
    v_pk_add_f32 v[98:99], v[98:99], v[74:75]
    v_pk_add_f32 v[100:101], v[100:101], v[74:75]
    v_pk_add_f32 v[102:103], v[102:103], v[74:75]
    v_rcp_f32 v96, v96
    v_rcp_f32 v97, v97
    v_rcp_f32 v98, v98
    v_rcp_f32 v99, v99
    v_rcp_f32 v100, v100
    v_rcp_f32 v101, v101
    v_rcp_f32 v102, v102
    v_rcp_f32 v103, v103
    v_pk_mul_f32 v[104:105], v[160:161], v[192:193]
    v_pk_mul_f32 v[106:107], v[162:163], v[194:195]
    v_pk_mul_f32 v[108:109], v[164:165], v[196:197]
    v_pk_mul_f32 v[110:111], v[166:167], v[198:199]
    v_pk_mul_f32 v[96:97], v[96:97], v[104:105]
    v_pk_mul_f32 v[98:99], v[98:99], v[106:107]
    v_pk_mul_f32 v[100:101], v[100:101], v[108:109]
    v_pk_mul_f32 v[102:103], v[102:103], v[110:111]
    v_cvt_pk_bf16_f32 v136, v96, v97
    v_cvt_pk_bf16_f32 v137, v98, v99
    v_cvt_pk_bf16_f32 v138, v100, v101
    v_cvt_pk_bf16_f32 v139, v102, v103
    v_pk_mul_f32 v[96:97], v[168:169], v[168:169]
    v_pk_mul_f32 v[98:99], v[170:171], v[170:171]
    v_permlane16_swap_b32 v136, v138
    v_permlane16_swap_b32 v137, v139
    v_pk_mul_f32 v[100:101], v[172:173], v[172:173]
    v_pk_mul_f32 v[102:103], v[174:175], v[174:175]
    v_pk_fma_f32 v[96:97], v[96:97], s[54:55], v[72:73]
    v_pk_fma_f32 v[98:99], v[98:99], s[54:55], v[72:73]
    v_pk_fma_f32 v[100:101], v[100:101], s[54:55], v[72:73]
    v_pk_fma_f32 v[102:103], v[102:103], s[54:55], v[72:73]
    v_pk_mul_f32 v[96:97], v[96:97], v[168:169]
    v_pk_mul_f32 v[98:99], v[98:99], v[170:171]
    v_pk_mul_f32 v[100:101], v[100:101], v[172:173]
    v_pk_mul_f32 v[102:103], v[102:103], v[174:175]
    v_exp_f32 v96, v96
    v_exp_f32 v97, v97
    v_exp_f32 v98, v98
    v_exp_f32 v99, v99
    v_exp_f32 v100, v100
    v_exp_f32 v101, v101
    v_exp_f32 v102, v102
    v_exp_f32 v103, v103
    v_pk_add_f32 v[96:97], v[96:97], v[74:75]
    v_pk_add_f32 v[98:99], v[98:99], v[74:75]
    v_pk_add_f32 v[100:101], v[100:101], v[74:75]
    v_pk_add_f32 v[102:103], v[102:103], v[74:75]
    v_rcp_f32 v96, v96
    v_rcp_f32 v97, v97
    v_rcp_f32 v98, v98
    v_rcp_f32 v99, v99
    v_rcp_f32 v100, v100
    v_rcp_f32 v101, v101
    v_rcp_f32 v102, v102
    v_rcp_f32 v103, v103
    v_pk_mul_f32 v[104:105], v[168:169], v[200:201]
    v_pk_mul_f32 v[106:107], v[170:171], v[202:203]
    v_pk_mul_f32 v[108:109], v[172:173], v[204:205]
    v_pk_mul_f32 v[110:111], v[174:175], v[206:207]
    v_pk_mul_f32 v[96:97], v[96:97], v[104:105]
    v_pk_mul_f32 v[98:99], v[98:99], v[106:107]
    v_pk_mul_f32 v[100:101], v[100:101], v[108:109]
    v_pk_mul_f32 v[102:103], v[102:103], v[110:111]
    v_cvt_pk_bf16_f32 v140, v96, v97
    v_cvt_pk_bf16_f32 v141, v98, v99
    v_cvt_pk_bf16_f32 v142, v100, v101
    v_cvt_pk_bf16_f32 v143, v102, v103
    buffer_store_dwordx4 v[136:139], v0, s[28:31], s92 offen offset:3072 sc1
    v_accvgpr_read_b32 v80, a192
    v_accvgpr_read_b32 v81, a193
    v_permlane16_swap_b32 v140, v142
    v_permlane16_swap_b32 v141, v143
    v_accvgpr_read_b32 v82, a194
    v_accvgpr_read_b32 v83, a195
    v_accvgpr_read_b32 v84, a196
    v_accvgpr_read_b32 v85, a197
    v_accvgpr_read_b32 v86, a198
    v_accvgpr_read_b32 v87, a199
    v_accvgpr_read_b32 v88, a224
    v_accvgpr_read_b32 v89, a225
    v_accvgpr_read_b32 v90, a226
    v_accvgpr_read_b32 v91, a227
    v_accvgpr_read_b32 v92, a228
    v_accvgpr_read_b32 v93, a229
    v_accvgpr_read_b32 v94, a230
    v_accvgpr_read_b32 v95, a231
    v_pk_mul_f32 v[96:97], v[80:81], v[80:81]
    v_pk_mul_f32 v[98:99], v[82:83], v[82:83]
    v_pk_mul_f32 v[100:101], v[84:85], v[84:85]
    v_pk_mul_f32 v[102:103], v[86:87], v[86:87]
    v_pk_fma_f32 v[96:97], v[96:97], s[54:55], v[72:73]
    v_pk_fma_f32 v[98:99], v[98:99], s[54:55], v[72:73]
    v_pk_fma_f32 v[100:101], v[100:101], s[54:55], v[72:73]
    v_pk_fma_f32 v[102:103], v[102:103], s[54:55], v[72:73]
    v_pk_mul_f32 v[96:97], v[96:97], v[80:81]
    v_pk_mul_f32 v[98:99], v[98:99], v[82:83]
    v_pk_mul_f32 v[100:101], v[100:101], v[84:85]
    v_pk_mul_f32 v[102:103], v[102:103], v[86:87]
    v_exp_f32 v96, v96
    v_exp_f32 v97, v97
    v_exp_f32 v98, v98
    v_exp_f32 v99, v99
    v_exp_f32 v100, v100
    v_exp_f32 v101, v101
    v_exp_f32 v102, v102
    v_exp_f32 v103, v103
    v_pk_add_f32 v[96:97], v[96:97], v[74:75]
    v_pk_add_f32 v[98:99], v[98:99], v[74:75]
    v_pk_add_f32 v[100:101], v[100:101], v[74:75]
    v_pk_add_f32 v[102:103], v[102:103], v[74:75]
    v_rcp_f32 v96, v96
    v_rcp_f32 v97, v97
    v_rcp_f32 v98, v98
    v_rcp_f32 v99, v99
    v_rcp_f32 v100, v100
    v_rcp_f32 v101, v101
    v_rcp_f32 v102, v102
    v_rcp_f32 v103, v103
    v_pk_mul_f32 v[104:105], v[80:81], v[88:89]
    v_pk_mul_f32 v[106:107], v[82:83], v[90:91]
    v_pk_mul_f32 v[108:109], v[84:85], v[92:93]
    v_pk_mul_f32 v[110:111], v[86:87], v[94:95]
    v_pk_mul_f32 v[96:97], v[96:97], v[104:105]
    v_pk_mul_f32 v[98:99], v[98:99], v[106:107]
    v_pk_mul_f32 v[100:101], v[100:101], v[108:109]
    v_pk_mul_f32 v[102:103], v[102:103], v[110:111]
    v_cvt_pk_bf16_f32 v112, v96, v97
    v_cvt_pk_bf16_f32 v113, v98, v99
    v_cvt_pk_bf16_f32 v114, v100, v101
    v_cvt_pk_bf16_f32 v115, v102, v103
    buffer_store_dwordx4 v[140:143], v0, s[28:31], s93 offen offset:3072 sc1
    v_accvgpr_read_b32 v80, a200
    v_accvgpr_read_b32 v81, a201
    v_permlane16_swap_b32 v112, v114
    v_permlane16_swap_b32 v113, v115
    v_accvgpr_read_b32 v82, a202
    v_accvgpr_read_b32 v83, a203
    v_accvgpr_read_b32 v84, a204
    v_accvgpr_read_b32 v85, a205
    v_accvgpr_read_b32 v86, a206
    v_accvgpr_read_b32 v87, a207
    v_accvgpr_read_b32 v88, a232
    v_accvgpr_read_b32 v89, a233
    v_accvgpr_read_b32 v90, a234
    v_accvgpr_read_b32 v91, a235
    v_accvgpr_read_b32 v92, a236
    v_accvgpr_read_b32 v93, a237
    v_accvgpr_read_b32 v94, a238
    v_accvgpr_read_b32 v95, a239
    v_pk_mul_f32 v[96:97], v[80:81], v[80:81]
    v_pk_mul_f32 v[98:99], v[82:83], v[82:83]
    v_pk_mul_f32 v[100:101], v[84:85], v[84:85]
    v_pk_mul_f32 v[102:103], v[86:87], v[86:87]
    v_pk_fma_f32 v[96:97], v[96:97], s[54:55], v[72:73]
    v_pk_fma_f32 v[98:99], v[98:99], s[54:55], v[72:73]
    v_pk_fma_f32 v[100:101], v[100:101], s[54:55], v[72:73]
    v_pk_fma_f32 v[102:103], v[102:103], s[54:55], v[72:73]
    v_pk_mul_f32 v[96:97], v[96:97], v[80:81]
    v_pk_mul_f32 v[98:99], v[98:99], v[82:83]
    v_pk_mul_f32 v[100:101], v[100:101], v[84:85]
    v_pk_mul_f32 v[102:103], v[102:103], v[86:87]
    v_exp_f32 v96, v96
    v_exp_f32 v97, v97
    v_exp_f32 v98, v98
    v_exp_f32 v99, v99
    v_exp_f32 v100, v100
    v_exp_f32 v101, v101
    v_exp_f32 v102, v102
    v_exp_f32 v103, v103
    v_pk_add_f32 v[96:97], v[96:97], v[74:75]
    v_pk_add_f32 v[98:99], v[98:99], v[74:75]
    v_pk_add_f32 v[100:101], v[100:101], v[74:75]
    v_pk_add_f32 v[102:103], v[102:103], v[74:75]
    v_rcp_f32 v96, v96
    v_rcp_f32 v97, v97
    v_rcp_f32 v98, v98
    v_rcp_f32 v99, v99
    v_rcp_f32 v100, v100
    v_rcp_f32 v101, v101
    v_rcp_f32 v102, v102
    v_rcp_f32 v103, v103
    v_pk_mul_f32 v[104:105], v[80:81], v[88:89]
    v_pk_mul_f32 v[106:107], v[82:83], v[90:91]
    v_pk_mul_f32 v[108:109], v[84:85], v[92:93]
    v_pk_mul_f32 v[110:111], v[86:87], v[94:95]
    v_pk_mul_f32 v[96:97], v[96:97], v[104:105]
    v_pk_mul_f32 v[98:99], v[98:99], v[106:107]
    v_pk_mul_f32 v[100:101], v[100:101], v[108:109]
    v_pk_mul_f32 v[102:103], v[102:103], v[110:111]
    v_cvt_pk_bf16_f32 v116, v96, v97
    v_cvt_pk_bf16_f32 v117, v98, v99
    v_cvt_pk_bf16_f32 v118, v100, v101
    v_cvt_pk_bf16_f32 v119, v102, v103
    buffer_store_dwordx4 v[112:115], v0, s[28:31], s90 offen offset:2048 sc1
    v_accvgpr_read_b32 v80, a208
    v_accvgpr_read_b32 v81, a209
    v_permlane16_swap_b32 v116, v118
    v_permlane16_swap_b32 v117, v119
    v_accvgpr_read_b32 v82, a210
    v_accvgpr_read_b32 v83, a211
    v_accvgpr_read_b32 v84, a212
    v_accvgpr_read_b32 v85, a213
    v_accvgpr_read_b32 v86, a214
    v_accvgpr_read_b32 v87, a215
    v_accvgpr_read_b32 v88, a240
    v_accvgpr_read_b32 v89, a241
    v_accvgpr_read_b32 v90, a242
    v_accvgpr_read_b32 v91, a243
    v_accvgpr_read_b32 v92, a244
    v_accvgpr_read_b32 v93, a245
    v_accvgpr_read_b32 v94, a246
    v_accvgpr_read_b32 v95, a247
    v_pk_mul_f32 v[96:97], v[80:81], v[80:81]
    v_pk_mul_f32 v[98:99], v[82:83], v[82:83]
    v_pk_mul_f32 v[100:101], v[84:85], v[84:85]
    v_pk_mul_f32 v[102:103], v[86:87], v[86:87]
    v_pk_fma_f32 v[96:97], v[96:97], s[54:55], v[72:73]
    v_pk_fma_f32 v[98:99], v[98:99], s[54:55], v[72:73]
    v_pk_fma_f32 v[100:101], v[100:101], s[54:55], v[72:73]
    v_pk_fma_f32 v[102:103], v[102:103], s[54:55], v[72:73]
    v_pk_mul_f32 v[96:97], v[96:97], v[80:81]
    v_pk_mul_f32 v[98:99], v[98:99], v[82:83]
    v_pk_mul_f32 v[100:101], v[100:101], v[84:85]
    v_pk_mul_f32 v[102:103], v[102:103], v[86:87]
    v_exp_f32 v96, v96
    v_exp_f32 v97, v97
    v_exp_f32 v98, v98
    v_exp_f32 v99, v99
    v_exp_f32 v100, v100
    v_exp_f32 v101, v101
    v_exp_f32 v102, v102
    v_exp_f32 v103, v103
    v_pk_add_f32 v[96:97], v[96:97], v[74:75]
    v_pk_add_f32 v[98:99], v[98:99], v[74:75]
    v_pk_add_f32 v[100:101], v[100:101], v[74:75]
    v_pk_add_f32 v[102:103], v[102:103], v[74:75]
    v_rcp_f32 v96, v96
    v_rcp_f32 v97, v97
    v_rcp_f32 v98, v98
    v_rcp_f32 v99, v99
    v_rcp_f32 v100, v100
    v_rcp_f32 v101, v101
    v_rcp_f32 v102, v102
    v_rcp_f32 v103, v103
    v_pk_mul_f32 v[104:105], v[80:81], v[88:89]
    v_pk_mul_f32 v[106:107], v[82:83], v[90:91]
    v_pk_mul_f32 v[108:109], v[84:85], v[92:93]
    v_pk_mul_f32 v[110:111], v[86:87], v[94:95]
    v_pk_mul_f32 v[96:97], v[96:97], v[104:105]
    v_pk_mul_f32 v[98:99], v[98:99], v[106:107]
    v_pk_mul_f32 v[100:101], v[100:101], v[108:109]
    v_pk_mul_f32 v[102:103], v[102:103], v[110:111]
    v_cvt_pk_bf16_f32 v120, v96, v97
    v_cvt_pk_bf16_f32 v121, v98, v99
    v_cvt_pk_bf16_f32 v122, v100, v101
    v_cvt_pk_bf16_f32 v123, v102, v103
    buffer_store_dwordx4 v[116:119], v0, s[28:31], s91 offen offset:2048 sc1
    v_accvgpr_read_b32 v80, a216
    v_accvgpr_read_b32 v81, a217
    v_permlane16_swap_b32 v120, v122
    v_permlane16_swap_b32 v121, v123
    v_accvgpr_read_b32 v82, a218
    v_accvgpr_read_b32 v83, a219
    v_accvgpr_read_b32 v84, a220
    v_accvgpr_read_b32 v85, a221
    v_accvgpr_read_b32 v86, a222
    v_accvgpr_read_b32 v87, a223
    v_accvgpr_read_b32 v88, a248
    v_accvgpr_read_b32 v89, a249
    v_accvgpr_read_b32 v90, a250
    v_accvgpr_read_b32 v91, a251
    v_accvgpr_read_b32 v92, a252
    v_accvgpr_read_b32 v93, a253
    v_accvgpr_read_b32 v94, a254
    v_accvgpr_read_b32 v95, a255
    v_pk_mul_f32 v[96:97], v[80:81], v[80:81]
    v_pk_mul_f32 v[98:99], v[82:83], v[82:83]
    v_pk_mul_f32 v[100:101], v[84:85], v[84:85]
    v_pk_mul_f32 v[102:103], v[86:87], v[86:87]
    v_pk_fma_f32 v[96:97], v[96:97], s[54:55], v[72:73]
    v_pk_fma_f32 v[98:99], v[98:99], s[54:55], v[72:73]
    v_pk_fma_f32 v[100:101], v[100:101], s[54:55], v[72:73]
    v_pk_fma_f32 v[102:103], v[102:103], s[54:55], v[72:73]
    v_pk_mul_f32 v[96:97], v[96:97], v[80:81]
    v_pk_mul_f32 v[98:99], v[98:99], v[82:83]
    v_pk_mul_f32 v[100:101], v[100:101], v[84:85]
    v_pk_mul_f32 v[102:103], v[102:103], v[86:87]
    v_exp_f32 v96, v96
    v_exp_f32 v97, v97
    v_exp_f32 v98, v98
    v_exp_f32 v99, v99
    v_exp_f32 v100, v100
    v_exp_f32 v101, v101
    v_exp_f32 v102, v102
    v_exp_f32 v103, v103
    v_pk_add_f32 v[96:97], v[96:97], v[74:75]
    v_pk_add_f32 v[98:99], v[98:99], v[74:75]
    v_pk_add_f32 v[100:101], v[100:101], v[74:75]
    v_pk_add_f32 v[102:103], v[102:103], v[74:75]
    v_rcp_f32 v96, v96
    v_rcp_f32 v97, v97
    v_rcp_f32 v98, v98
    v_rcp_f32 v99, v99
    v_rcp_f32 v100, v100
    v_rcp_f32 v101, v101
    v_rcp_f32 v102, v102
    v_rcp_f32 v103, v103
    v_pk_mul_f32 v[104:105], v[80:81], v[88:89]
    v_pk_mul_f32 v[106:107], v[82:83], v[90:91]
    v_pk_mul_f32 v[108:109], v[84:85], v[92:93]
    v_pk_mul_f32 v[110:111], v[86:87], v[94:95]
    v_pk_mul_f32 v[96:97], v[96:97], v[104:105]
    v_pk_mul_f32 v[98:99], v[98:99], v[106:107]
    v_pk_mul_f32 v[100:101], v[100:101], v[108:109]
    v_pk_mul_f32 v[102:103], v[102:103], v[110:111]
    v_cvt_pk_bf16_f32 v124, v96, v97
    v_cvt_pk_bf16_f32 v125, v98, v99
    v_cvt_pk_bf16_f32 v126, v100, v101
    v_cvt_pk_bf16_f32 v127, v102, v103
    buffer_store_dwordx4 v[120:123], v0, s[28:31], s92 offen offset:2048 sc1
    v_accvgpr_read_b32 v80, a64
    v_accvgpr_read_b32 v81, a65
    v_permlane16_swap_b32 v124, v126
    v_permlane16_swap_b32 v125, v127
    v_accvgpr_read_b32 v82, a66
    v_accvgpr_read_b32 v83, a67
    v_accvgpr_read_b32 v84, a68
    v_accvgpr_read_b32 v85, a69
    v_accvgpr_read_b32 v86, a70
    v_accvgpr_read_b32 v87, a71
    v_accvgpr_read_b32 v88, a96
    v_accvgpr_read_b32 v89, a97
    v_accvgpr_read_b32 v90, a98
    v_accvgpr_read_b32 v91, a99
    v_accvgpr_read_b32 v92, a100
    v_accvgpr_read_b32 v93, a101
    v_accvgpr_read_b32 v94, a102
    v_accvgpr_read_b32 v95, a103
    v_pk_mul_f32 v[96:97], v[80:81], v[80:81]
    v_pk_mul_f32 v[98:99], v[82:83], v[82:83]
    v_pk_mul_f32 v[100:101], v[84:85], v[84:85]
    v_pk_mul_f32 v[102:103], v[86:87], v[86:87]
    v_pk_fma_f32 v[96:97], v[96:97], s[54:55], v[72:73]
    v_pk_fma_f32 v[98:99], v[98:99], s[54:55], v[72:73]
    v_pk_fma_f32 v[100:101], v[100:101], s[54:55], v[72:73]
    v_pk_fma_f32 v[102:103], v[102:103], s[54:55], v[72:73]
    v_pk_mul_f32 v[96:97], v[96:97], v[80:81]
    v_pk_mul_f32 v[98:99], v[98:99], v[82:83]
    v_pk_mul_f32 v[100:101], v[100:101], v[84:85]
    v_pk_mul_f32 v[102:103], v[102:103], v[86:87]
    v_exp_f32 v96, v96
    v_exp_f32 v97, v97
    v_exp_f32 v98, v98
    v_exp_f32 v99, v99
    v_exp_f32 v100, v100
    v_exp_f32 v101, v101
    v_exp_f32 v102, v102
    v_exp_f32 v103, v103
    v_pk_add_f32 v[96:97], v[96:97], v[74:75]
    v_pk_add_f32 v[98:99], v[98:99], v[74:75]
    v_pk_add_f32 v[100:101], v[100:101], v[74:75]
    v_pk_add_f32 v[102:103], v[102:103], v[74:75]
    v_rcp_f32 v96, v96
    v_rcp_f32 v97, v97
    v_rcp_f32 v98, v98
    v_rcp_f32 v99, v99
    v_rcp_f32 v100, v100
    v_rcp_f32 v101, v101
    v_rcp_f32 v102, v102
    v_rcp_f32 v103, v103
    v_pk_mul_f32 v[104:105], v[80:81], v[88:89]
    v_pk_mul_f32 v[106:107], v[82:83], v[90:91]
    v_pk_mul_f32 v[108:109], v[84:85], v[92:93]
    v_pk_mul_f32 v[110:111], v[86:87], v[94:95]
    v_pk_mul_f32 v[96:97], v[96:97], v[104:105]
    v_pk_mul_f32 v[98:99], v[98:99], v[106:107]
    v_pk_mul_f32 v[100:101], v[100:101], v[108:109]
    v_pk_mul_f32 v[102:103], v[102:103], v[110:111]
    v_cvt_pk_bf16_f32 v144, v96, v97
    v_cvt_pk_bf16_f32 v145, v98, v99
    v_cvt_pk_bf16_f32 v146, v100, v101
    v_cvt_pk_bf16_f32 v147, v102, v103
    buffer_store_dwordx4 v[124:127], v0, s[28:31], s93 offen offset:2048 sc1
    v_accvgpr_read_b32 v80, a72
    v_accvgpr_read_b32 v81, a73
    v_permlane16_swap_b32 v144, v146
    v_permlane16_swap_b32 v145, v147
    v_accvgpr_read_b32 v82, a74
    v_accvgpr_read_b32 v83, a75
    v_accvgpr_read_b32 v84, a76
    v_accvgpr_read_b32 v85, a77
    v_accvgpr_read_b32 v86, a78
    v_accvgpr_read_b32 v87, a79
    v_accvgpr_read_b32 v88, a104
    v_accvgpr_read_b32 v89, a105
    v_accvgpr_read_b32 v90, a106
    v_accvgpr_read_b32 v91, a107
    v_accvgpr_read_b32 v92, a108
    v_accvgpr_read_b32 v93, a109
    v_accvgpr_read_b32 v94, a110
    v_accvgpr_read_b32 v95, a111
    v_pk_mul_f32 v[96:97], v[80:81], v[80:81]
    v_pk_mul_f32 v[98:99], v[82:83], v[82:83]
    v_pk_mul_f32 v[100:101], v[84:85], v[84:85]
    v_pk_mul_f32 v[102:103], v[86:87], v[86:87]
    v_pk_fma_f32 v[96:97], v[96:97], s[54:55], v[72:73]
    v_pk_fma_f32 v[98:99], v[98:99], s[54:55], v[72:73]
    v_pk_fma_f32 v[100:101], v[100:101], s[54:55], v[72:73]
    v_pk_fma_f32 v[102:103], v[102:103], s[54:55], v[72:73]
    v_pk_mul_f32 v[96:97], v[96:97], v[80:81]
    v_pk_mul_f32 v[98:99], v[98:99], v[82:83]
    v_pk_mul_f32 v[100:101], v[100:101], v[84:85]
    v_pk_mul_f32 v[102:103], v[102:103], v[86:87]
    v_exp_f32 v96, v96
    v_exp_f32 v97, v97
    v_exp_f32 v98, v98
    v_exp_f32 v99, v99
    v_exp_f32 v100, v100
    v_exp_f32 v101, v101
    v_exp_f32 v102, v102
    v_exp_f32 v103, v103
    v_pk_add_f32 v[96:97], v[96:97], v[74:75]
    v_pk_add_f32 v[98:99], v[98:99], v[74:75]
    v_pk_add_f32 v[100:101], v[100:101], v[74:75]
    v_pk_add_f32 v[102:103], v[102:103], v[74:75]
    v_rcp_f32 v96, v96
    v_rcp_f32 v97, v97
    v_rcp_f32 v98, v98
    v_rcp_f32 v99, v99
    v_rcp_f32 v100, v100
    v_rcp_f32 v101, v101
    v_rcp_f32 v102, v102
    v_rcp_f32 v103, v103
    v_pk_mul_f32 v[104:105], v[80:81], v[88:89]
    v_pk_mul_f32 v[106:107], v[82:83], v[90:91]
    v_pk_mul_f32 v[108:109], v[84:85], v[92:93]
    v_pk_mul_f32 v[110:111], v[86:87], v[94:95]
    v_pk_mul_f32 v[96:97], v[96:97], v[104:105]
    v_pk_mul_f32 v[98:99], v[98:99], v[106:107]
    v_pk_mul_f32 v[100:101], v[100:101], v[108:109]
    v_pk_mul_f32 v[102:103], v[102:103], v[110:111]
    v_cvt_pk_bf16_f32 v148, v96, v97
    v_cvt_pk_bf16_f32 v149, v98, v99
    v_cvt_pk_bf16_f32 v150, v100, v101
    v_cvt_pk_bf16_f32 v151, v102, v103
    buffer_store_dwordx4 v[144:147], v0, s[28:31], s90 offen offset:0 sc1
    v_accvgpr_read_b32 v80, a80
    v_accvgpr_read_b32 v81, a81
    v_permlane16_swap_b32 v148, v150
    v_permlane16_swap_b32 v149, v151
    v_accvgpr_read_b32 v82, a82
    v_accvgpr_read_b32 v83, a83
    v_accvgpr_read_b32 v84, a84
    v_accvgpr_read_b32 v85, a85
    v_accvgpr_read_b32 v86, a86
    v_accvgpr_read_b32 v87, a87
    v_accvgpr_read_b32 v88, a112
    v_accvgpr_read_b32 v89, a113
    v_accvgpr_read_b32 v90, a114
    v_accvgpr_read_b32 v91, a115
    v_accvgpr_read_b32 v92, a116
    v_accvgpr_read_b32 v93, a117
    v_accvgpr_read_b32 v94, a118
    v_accvgpr_read_b32 v95, a119
    v_pk_mul_f32 v[96:97], v[80:81], v[80:81]
    v_pk_mul_f32 v[98:99], v[82:83], v[82:83]
    v_pk_mul_f32 v[100:101], v[84:85], v[84:85]
    v_pk_mul_f32 v[102:103], v[86:87], v[86:87]
    v_pk_fma_f32 v[96:97], v[96:97], s[54:55], v[72:73]
    v_pk_fma_f32 v[98:99], v[98:99], s[54:55], v[72:73]
    v_pk_fma_f32 v[100:101], v[100:101], s[54:55], v[72:73]
    v_pk_fma_f32 v[102:103], v[102:103], s[54:55], v[72:73]
    v_pk_mul_f32 v[96:97], v[96:97], v[80:81]
    v_pk_mul_f32 v[98:99], v[98:99], v[82:83]
    v_pk_mul_f32 v[100:101], v[100:101], v[84:85]
    v_pk_mul_f32 v[102:103], v[102:103], v[86:87]
    v_exp_f32 v96, v96
    v_exp_f32 v97, v97
    v_exp_f32 v98, v98
    v_exp_f32 v99, v99
    v_exp_f32 v100, v100
    v_exp_f32 v101, v101
    v_exp_f32 v102, v102
    v_exp_f32 v103, v103
    v_pk_add_f32 v[96:97], v[96:97], v[74:75]
    v_pk_add_f32 v[98:99], v[98:99], v[74:75]
    v_pk_add_f32 v[100:101], v[100:101], v[74:75]
    v_pk_add_f32 v[102:103], v[102:103], v[74:75]
    v_rcp_f32 v96, v96
    v_rcp_f32 v97, v97
    v_rcp_f32 v98, v98
    v_rcp_f32 v99, v99
    v_rcp_f32 v100, v100
    v_rcp_f32 v101, v101
    v_rcp_f32 v102, v102
    v_rcp_f32 v103, v103
    v_pk_mul_f32 v[104:105], v[80:81], v[88:89]
    v_pk_mul_f32 v[106:107], v[82:83], v[90:91]
    v_pk_mul_f32 v[108:109], v[84:85], v[92:93]
    v_pk_mul_f32 v[110:111], v[86:87], v[94:95]
    v_pk_mul_f32 v[96:97], v[96:97], v[104:105]
    v_pk_mul_f32 v[98:99], v[98:99], v[106:107]
    v_pk_mul_f32 v[100:101], v[100:101], v[108:109]
    v_pk_mul_f32 v[102:103], v[102:103], v[110:111]
    v_cvt_pk_bf16_f32 v152, v96, v97
    v_cvt_pk_bf16_f32 v153, v98, v99
    v_cvt_pk_bf16_f32 v154, v100, v101
    v_cvt_pk_bf16_f32 v155, v102, v103
    buffer_store_dwordx4 v[148:151], v0, s[28:31], s91 offen offset:0 sc1
    v_accvgpr_read_b32 v80, a88
    v_accvgpr_read_b32 v81, a89
    v_permlane16_swap_b32 v152, v154
    v_permlane16_swap_b32 v153, v155
    v_accvgpr_read_b32 v82, a90
    v_accvgpr_read_b32 v83, a91
    v_accvgpr_read_b32 v84, a92
    v_accvgpr_read_b32 v85, a93
    v_accvgpr_read_b32 v86, a94
    v_accvgpr_read_b32 v87, a95
    v_accvgpr_read_b32 v88, a120
    v_accvgpr_read_b32 v89, a121
    v_accvgpr_read_b32 v90, a122
    v_accvgpr_read_b32 v91, a123
    v_accvgpr_read_b32 v92, a124
    v_accvgpr_read_b32 v93, a125
    v_accvgpr_read_b32 v94, a126
    v_accvgpr_read_b32 v95, a127
    v_pk_mul_f32 v[96:97], v[80:81], v[80:81]
    v_pk_mul_f32 v[98:99], v[82:83], v[82:83]
    v_pk_mul_f32 v[100:101], v[84:85], v[84:85]
    v_pk_mul_f32 v[102:103], v[86:87], v[86:87]
    v_pk_fma_f32 v[96:97], v[96:97], s[54:55], v[72:73]
    v_pk_fma_f32 v[98:99], v[98:99], s[54:55], v[72:73]
    v_pk_fma_f32 v[100:101], v[100:101], s[54:55], v[72:73]
    v_pk_fma_f32 v[102:103], v[102:103], s[54:55], v[72:73]
    v_pk_mul_f32 v[96:97], v[96:97], v[80:81]
    v_pk_mul_f32 v[98:99], v[98:99], v[82:83]
    v_pk_mul_f32 v[100:101], v[100:101], v[84:85]
    v_pk_mul_f32 v[102:103], v[102:103], v[86:87]
    v_exp_f32 v96, v96
    v_exp_f32 v97, v97
    v_exp_f32 v98, v98
    v_exp_f32 v99, v99
    v_exp_f32 v100, v100
    v_exp_f32 v101, v101
    v_exp_f32 v102, v102
    v_exp_f32 v103, v103
    v_pk_add_f32 v[96:97], v[96:97], v[74:75]
    v_pk_add_f32 v[98:99], v[98:99], v[74:75]
    v_pk_add_f32 v[100:101], v[100:101], v[74:75]
    v_pk_add_f32 v[102:103], v[102:103], v[74:75]
    v_rcp_f32 v96, v96
    v_rcp_f32 v97, v97
    v_rcp_f32 v98, v98
    v_rcp_f32 v99, v99
    v_rcp_f32 v100, v100
    v_rcp_f32 v101, v101
    v_rcp_f32 v102, v102
    v_rcp_f32 v103, v103
    v_pk_mul_f32 v[104:105], v[80:81], v[88:89]
    v_pk_mul_f32 v[106:107], v[82:83], v[90:91]
    v_pk_mul_f32 v[108:109], v[84:85], v[92:93]
    v_pk_mul_f32 v[110:111], v[86:87], v[94:95]
    v_pk_mul_f32 v[96:97], v[96:97], v[104:105]
    v_pk_mul_f32 v[98:99], v[98:99], v[106:107]
    v_pk_mul_f32 v[100:101], v[100:101], v[108:109]
    v_pk_mul_f32 v[102:103], v[102:103], v[110:111]
    v_cvt_pk_bf16_f32 v156, v96, v97
    v_cvt_pk_bf16_f32 v157, v98, v99
    v_cvt_pk_bf16_f32 v158, v100, v101
    v_cvt_pk_bf16_f32 v159, v102, v103
    s_nop 1
    v_permlane16_swap_b32 v156, v158
    v_permlane16_swap_b32 v157, v159
    s_mov_b32 s50, 0x100000
p1B_cnt:
    v_cmp_gt_u32 vcc, 0x100, v14
    s_sub_u32 s50, s50, 1
    s_cbranch_scc1 p1B_cntok
    s_nop 2
    s_cbranch_vccz p1B_cntok
    buffer_load_dword v14, v15, s[76:79], 0 offen sc1
    s_waitcnt vmcnt(0)
    s_branch p1B_cnt
p1B_cntok:
    buffer_load_dword v12, v11, s[28:31], 0 offen sc1
    v_accvgpr_read_b32 v80, a128
    v_accvgpr_read_b32 v81, a129
    v_accvgpr_read_b32 v82, a130
    v_accvgpr_read_b32 v83, a131
    v_accvgpr_read_b32 v84, a132
    v_accvgpr_read_b32 v85, a133
    v_accvgpr_read_b32 v86, a134
    v_accvgpr_read_b32 v87, a135
    v_accvgpr_read_b32 v88, a160
    v_accvgpr_read_b32 v89, a161
    v_accvgpr_read_b32 v90, a162
    v_accvgpr_read_b32 v91, a163
    v_accvgpr_read_b32 v92, a164
    v_accvgpr_read_b32 v93, a165
    v_accvgpr_read_b32 v94, a166
    v_accvgpr_read_b32 v95, a167
    v_pk_mul_f32 v[96:97], v[80:81], v[80:81]
    v_pk_mul_f32 v[98:99], v[82:83], v[82:83]
    v_pk_mul_f32 v[100:101], v[84:85], v[84:85]
    v_pk_mul_f32 v[102:103], v[86:87], v[86:87]
    v_pk_fma_f32 v[96:97], v[96:97], s[54:55], v[72:73]
    v_pk_fma_f32 v[98:99], v[98:99], s[54:55], v[72:73]
    v_pk_fma_f32 v[100:101], v[100:101], s[54:55], v[72:73]
    v_pk_fma_f32 v[102:103], v[102:103], s[54:55], v[72:73]
    v_pk_mul_f32 v[96:97], v[96:97], v[80:81]
    v_pk_mul_f32 v[98:99], v[98:99], v[82:83]
    v_pk_mul_f32 v[100:101], v[100:101], v[84:85]
    v_pk_mul_f32 v[102:103], v[102:103], v[86:87]
    v_exp_f32 v96, v96
    v_exp_f32 v97, v97
    v_exp_f32 v98, v98
    v_exp_f32 v99, v99
    v_exp_f32 v100, v100
    v_exp_f32 v101, v101
    v_exp_f32 v102, v102
    v_exp_f32 v103, v103
    v_pk_add_f32 v[96:97], v[96:97], v[74:75]
    v_pk_add_f32 v[98:99], v[98:99], v[74:75]
    v_pk_add_f32 v[100:101], v[100:101], v[74:75]
    v_pk_add_f32 v[102:103], v[102:103], v[74:75]
    v_rcp_f32 v96, v96
    v_rcp_f32 v97, v97
    v_rcp_f32 v98, v98
    v_rcp_f32 v99, v99
    v_rcp_f32 v100, v100
    v_rcp_f32 v101, v101
    v_rcp_f32 v102, v102
    v_rcp_f32 v103, v103
    v_pk_mul_f32 v[104:105], v[80:81], v[88:89]
    v_pk_mul_f32 v[106:107], v[82:83], v[90:91]
    v_pk_mul_f32 v[108:109], v[84:85], v[92:93]
    v_pk_mul_f32 v[110:111], v[86:87], v[94:95]
    v_pk_mul_f32 v[96:97], v[96:97], v[104:105]
    v_pk_mul_f32 v[98:99], v[98:99], v[106:107]
    v_pk_mul_f32 v[100:101], v[100:101], v[108:109]
    v_pk_mul_f32 v[102:103], v[102:103], v[110:111]
    v_cvt_pk_bf16_f32 v160, v96, v97
    v_cvt_pk_bf16_f32 v161, v98, v99
    v_cvt_pk_bf16_f32 v162, v100, v101
    v_cvt_pk_bf16_f32 v163, v102, v103
    s_nop 1
    v_permlane16_swap_b32 v160, v162
    v_permlane16_swap_b32 v161, v163
    s_waitcnt vmcnt(0)
    v_cmp_ne_u32 vcc, 1, v12
    s_sub_u32 s23, s9, 16384
    s_sub_u32 s24, s10, 16384
    s_cmp_eq_u64 vcc, 0
    s_cselect_b32 s89, 1, 0
    s_cselect_b32 s22, s88, 0x40000000
    s_cselect_b32 s23, s23, 0x40000000
    s_cselect_b32 s24, s24, 0x40000000
    v_accvgpr_read_b32 v80, a136
    v_accvgpr_read_b32 v81, a137
    v_accvgpr_read_b32 v82, a138
    v_accvgpr_read_b32 v83, a139
    buffer_load_dwordx4 a[0:3], v2, s[28:31], s22 offen offset:0 sc1
    v_accvgpr_read_b32 v84, a140
    v_accvgpr_read_b32 v85, a141
    v_accvgpr_read_b32 v86, a142
    v_accvgpr_read_b32 v87, a143
    v_accvgpr_read_b32 v88, a168
    v_accvgpr_read_b32 v89, a169
    v_accvgpr_read_b32 v90, a170
    v_accvgpr_read_b32 v91, a171
    v_accvgpr_read_b32 v92, a172
    v_accvgpr_read_b32 v93, a173
    buffer_load_dwordx4 a[4:7], v2, s[28:31], s22 offen offset:1024 sc1
    v_accvgpr_read_b32 v94, a174
    v_accvgpr_read_b32 v95, a175
    v_pk_mul_f32 v[96:97], v[80:81], v[80:81]
    v_pk_mul_f32 v[98:99], v[82:83], v[82:83]
    v_pk_mul_f32 v[100:101], v[84:85], v[84:85]
    v_pk_mul_f32 v[102:103], v[86:87], v[86:87]
    v_pk_fma_f32 v[96:97], v[96:97], s[54:55], v[72:73]
    v_pk_fma_f32 v[98:99], v[98:99], s[54:55], v[72:73]
    v_pk_fma_f32 v[100:101], v[100:101], s[54:55], v[72:73]
    v_pk_fma_f32 v[102:103], v[102:103], s[54:55], v[72:73]
    buffer_load_dwordx4 a[8:11], v2, s[28:31], s22 offen offset:2048 sc1
    v_pk_mul_f32 v[96:97], v[96:97], v[80:81]
    v_pk_mul_f32 v[98:99], v[98:99], v[82:83]
    v_pk_mul_f32 v[100:101], v[100:101], v[84:85]
    v_pk_mul_f32 v[102:103], v[102:103], v[86:87]
    v_exp_f32 v96, v96
    v_exp_f32 v97, v97
    v_exp_f32 v98, v98
    v_exp_f32 v99, v99
    v_exp_f32 v100, v100
    buffer_load_dwordx4 a[12:15], v2, s[28:31], s22 offen offset:3072 sc1
    s_add_u32 m0, s11, 0
    v_exp_f32 v101, v101
    v_exp_f32 v102, v102
    v_exp_f32 v103, v103
    v_pk_add_f32 v[96:97], v[96:97], v[74:75]
    v_pk_add_f32 v[98:99], v[98:99], v[74:75]
    v_pk_add_f32 v[100:101], v[100:101], v[74:75]
    v_pk_add_f32 v[102:103], v[102:103], v[74:75]
    v_rcp_f32 v96, v96
    v_rcp_f32 v97, v97
    buffer_load_dwordx4 v2, s[28:31], s23 offen offset:0 sc1 lds
    v_rcp_f32 v98, v98
    v_rcp_f32 v99, v99
    v_rcp_f32 v100, v100
    v_rcp_f32 v101, v101
    v_rcp_f32 v102, v102
    v_rcp_f32 v103, v103
    v_pk_mul_f32 v[104:105], v[80:81], v[88:89]
    buffer_load_dwordx4 v2, s[28:31], s23 offen offset:1024 sc1 lds
    s_add_u32 s23, s23, 8192
    s_add_u32 m0, s11, 8192
    v_pk_mul_f32 v[106:107], v[82:83], v[90:91]
    v_pk_mul_f32 v[108:109], v[84:85], v[92:93]
    v_pk_mul_f32 v[110:111], v[86:87], v[94:95]
    v_pk_mul_f32 v[96:97], v[96:97], v[104:105]
    v_pk_mul_f32 v[98:99], v[98:99], v[106:107]
    v_pk_mul_f32 v[100:101], v[100:101], v[108:109]
    v_pk_mul_f32 v[102:103], v[102:103], v[110:111]
    v_cvt_pk_bf16_f32 v164, v96, v97
    v_cvt_pk_bf16_f32 v165, v98, v99
    v_cvt_pk_bf16_f32 v166, v100, v101
    v_cvt_pk_bf16_f32 v167, v102, v103
    v_accvgpr_read_b32 v80, a144
    v_accvgpr_read_b32 v81, a145
    v_permlane16_swap_b32 v164, v166
    v_permlane16_swap_b32 v165, v167
    v_accvgpr_read_b32 v82, a146
    v_accvgpr_read_b32 v83, a147
    buffer_load_dwordx4 v2, s[28:31], s24 offen offset:0 sc1 lds
    v_accvgpr_read_b32 v84, a148
    v_accvgpr_read_b32 v85, a149
    v_accvgpr_read_b32 v86, a150
    v_accvgpr_read_b32 v87, a151
    v_accvgpr_read_b32 v88, a176
    v_accvgpr_read_b32 v89, a177
    v_accvgpr_read_b32 v90, a178
    v_accvgpr_read_b32 v91, a179
    v_accvgpr_read_b32 v92, a180
    v_accvgpr_read_b32 v93, a181
    buffer_load_dwordx4 v2, s[28:31], s24 offen offset:1024 sc1 lds
    s_add_u32 s24, s24, 8192
    s_add_u32 m0, s11, 16384
    v_accvgpr_read_b32 v94, a182
    v_accvgpr_read_b32 v95, a183
    v_pk_mul_f32 v[96:97], v[80:81], v[80:81]
    v_pk_mul_f32 v[98:99], v[82:83], v[82:83]
    v_pk_mul_f32 v[100:101], v[84:85], v[84:85]
    v_pk_mul_f32 v[102:103], v[86:87], v[86:87]
    v_pk_fma_f32 v[96:97], v[96:97], s[54:55], v[72:73]
    v_pk_fma_f32 v[98:99], v[98:99], s[54:55], v[72:73]
    v_pk_fma_f32 v[100:101], v[100:101], s[54:55], v[72:73]
    v_pk_fma_f32 v[102:103], v[102:103], s[54:55], v[72:73]
    buffer_load_dwordx4 v2, s[28:31], s23 offen offset:0 sc1 lds
    v_pk_mul_f32 v[96:97], v[96:97], v[80:81]
    v_pk_mul_f32 v[98:99], v[98:99], v[82:83]
    v_pk_mul_f32 v[100:101], v[100:101], v[84:85]
    v_pk_mul_f32 v[102:103], v[102:103], v[86:87]
    v_exp_f32 v96, v96
    v_exp_f32 v97, v97
    v_exp_f32 v98, v98
    v_exp_f32 v99, v99
    buffer_load_dwordx4 v2, s[28:31], s23 offen offset:1024 sc1 lds
    s_add_u32 s23, s23, 8192
    s_add_u32 m0, s11, 24576
    v_exp_f32 v100, v100
    v_exp_f32 v101, v101
    v_exp_f32 v102, v102
    v_exp_f32 v103, v103
    v_pk_add_f32 v[96:97], v[96:97], v[74:75]
    v_pk_add_f32 v[98:99], v[98:99], v[74:75]
    v_pk_add_f32 v[100:101], v[100:101], v[74:75]
    v_pk_add_f32 v[102:103], v[102:103], v[74:75]
    v_rcp_f32 v96, v96
    buffer_load_dwordx4 v2, s[28:31], s24 offen offset:0 sc1 lds
    v_rcp_f32 v97, v97
    v_rcp_f32 v98, v98
    v_rcp_f32 v99, v99
    v_rcp_f32 v100, v100
    v_rcp_f32 v101, v101
    v_rcp_f32 v102, v102
    v_rcp_f32 v103, v103
    v_pk_mul_f32 v[104:105], v[80:81], v[88:89]
    buffer_load_dwordx4 v2, s[28:31], s24 offen offset:1024 sc1 lds
    s_add_u32 s24, s24, 8192
    v_pk_mul_f32 v[106:107], v[82:83], v[90:91]
    v_pk_mul_f32 v[108:109], v[84:85], v[92:93]
    v_pk_mul_f32 v[110:111], v[86:87], v[94:95]
    v_pk_mul_f32 v[96:97], v[96:97], v[104:105]
    v_pk_mul_f32 v[98:99], v[98:99], v[106:107]
    v_pk_mul_f32 v[100:101], v[100:101], v[108:109]
    v_pk_mul_f32 v[102:103], v[102:103], v[110:111]
    v_cvt_pk_bf16_f32 v168, v96, v97
    v_cvt_pk_bf16_f32 v169, v98, v99
    v_cvt_pk_bf16_f32 v170, v100, v101
    v_cvt_pk_bf16_f32 v171, v102, v103
    v_accvgpr_read_b32 v80, a152
    v_accvgpr_read_b32 v81, a153
    v_permlane16_swap_b32 v168, v170
    v_permlane16_swap_b32 v169, v171
    v_accvgpr_read_b32 v82, a154
    v_accvgpr_read_b32 v83, a155
    v_accvgpr_read_b32 v84, a156
    v_accvgpr_read_b32 v85, a157
    v_accvgpr_read_b32 v86, a158
    v_accvgpr_read_b32 v87, a159
    v_accvgpr_read_b32 v88, a184
    v_accvgpr_read_b32 v89, a185
    v_accvgpr_read_b32 v90, a186
    v_accvgpr_read_b32 v91, a187
    v_accvgpr_read_b32 v92, a188
    v_accvgpr_read_b32 v93, a189
    v_accvgpr_read_b32 v94, a190
    v_accvgpr_read_b32 v95, a191
    v_pk_mul_f32 v[96:97], v[80:81], v[80:81]
    v_pk_mul_f32 v[98:99], v[82:83], v[82:83]
    v_pk_mul_f32 v[100:101], v[84:85], v[84:85]
    v_pk_mul_f32 v[102:103], v[86:87], v[86:87]
    v_pk_fma_f32 v[96:97], v[96:97], s[54:55], v[72:73]
    v_pk_fma_f32 v[98:99], v[98:99], s[54:55], v[72:73]
    v_pk_fma_f32 v[100:101], v[100:101], s[54:55], v[72:73]
    v_pk_fma_f32 v[102:103], v[102:103], s[54:55], v[72:73]
    v_pk_mul_f32 v[96:97], v[96:97], v[80:81]
    v_pk_mul_f32 v[98:99], v[98:99], v[82:83]
    v_pk_mul_f32 v[100:101], v[100:101], v[84:85]
    v_pk_mul_f32 v[102:103], v[102:103], v[86:87]
    v_exp_f32 v96, v96
    v_exp_f32 v97, v97
    v_exp_f32 v98, v98
    v_exp_f32 v99, v99
    v_exp_f32 v100, v100
    v_exp_f32 v101, v101
    v_exp_f32 v102, v102
    v_exp_f32 v103, v103
    v_pk_add_f32 v[96:97], v[96:97], v[74:75]
    v_pk_add_f32 v[98:99], v[98:99], v[74:75]
    v_pk_add_f32 v[100:101], v[100:101], v[74:75]
    v_pk_add_f32 v[102:103], v[102:103], v[74:75]
    v_rcp_f32 v96, v96
    v_rcp_f32 v97, v97
    v_rcp_f32 v98, v98
    v_rcp_f32 v99, v99
    v_rcp_f32 v100, v100
    v_rcp_f32 v101, v101
    v_rcp_f32 v102, v102
    v_rcp_f32 v103, v103
    v_pk_mul_f32 v[104:105], v[80:81], v[88:89]
    v_pk_mul_f32 v[106:107], v[82:83], v[90:91]
    v_pk_mul_f32 v[108:109], v[84:85], v[92:93]
    v_pk_mul_f32 v[110:111], v[86:87], v[94:95]
    v_pk_mul_f32 v[96:97], v[96:97], v[104:105]
    v_pk_mul_f32 v[98:99], v[98:99], v[106:107]
    v_pk_mul_f32 v[100:101], v[100:101], v[108:109]
    v_pk_mul_f32 v[102:103], v[102:103], v[110:111]
    v_cvt_pk_bf16_f32 v172, v96, v97
    v_cvt_pk_bf16_f32 v173, v98, v99
    v_cvt_pk_bf16_f32 v174, v100, v101
    v_cvt_pk_bf16_f32 v175, v102, v103
    s_nop 1
    v_permlane16_swap_b32 v172, v174
    v_permlane16_swap_b32 v173, v175
    s_cmp_eq_u32 s89, 1
    s_cbranch_scc1 p2_have1B
p2_poll1B:
    buffer_load_dword v12, v11, s[28:31], 0 offen sc1
    s_waitcnt vmcnt(0)
    v_cmp_ne_u32 vcc, 1, v12
    s_sub_u32 s35, s35, 1
    s_cbranch_scc1 p2_got1B
    s_nop 2
    s_cbranch_vccz p2_got1B
    s_sleep 6
    s_branch p2_poll1B
p2_got1B:
    s_mov_b32 s22, s88
    s_sub_u32 s23, s9, 16384
    s_sub_u32 s24, s10, 16384
    buffer_load_dwordx4 a[0:3], v2, s[28:31], s22 offen offset:0 sc1
    buffer_load_dwordx4 a[4:7], v2, s[28:31], s22 offen offset:1024 sc1
    buffer_load_dwordx4 a[8:11], v2, s[28:31], s22 offen offset:2048 sc1
    buffer_load_dwordx4 a[12:15], v2, s[28:31], s22 offen offset:3072 sc1
    s_add_u32 m0, s11, 0
    s_nop 0
    buffer_load_dwordx4 v2, s[28:31], s23 offen offset:0 sc1 lds
    buffer_load_dwordx4 v2, s[28:31], s23 offen offset:1024 sc1 lds
    s_add_u32 s23, s23, 8192
    s_add_u32 m0, s11, 8192
    s_nop 0
    buffer_load_dwordx4 v2, s[28:31], s24 offen offset:0 sc1 lds
    buffer_load_dwordx4 v2, s[28:31], s24 offen offset:1024 sc1 lds
    s_add_u32 s24, s24, 8192
    s_add_u32 m0, s11, 16384
    s_nop 0
    buffer_load_dwordx4 v2, s[28:31], s23 offen offset:0 sc1 lds
    buffer_load_dwordx4 v2, s[28:31], s23 offen offset:1024 sc1 lds
    s_add_u32 s23, s23, 8192
    s_add_u32 m0, s11, 24576
    s_nop 0
    buffer_load_dwordx4 v2, s[28:31], s24 offen offset:0 sc1 lds
    buffer_load_dwordx4 v2, s[28:31], s24 offen offset:1024 sc1 lds
    s_add_u32 s24, s24, 8192
p2_have1B:
p2_start:
    v_accvgpr_write_b32 a248, v13
    v_accvgpr_write_b32 a249, v13
    v_accvgpr_write_b32 a250, v13
    v_accvgpr_write_b32 a251, v13
    s_mov_b32 s18, 6
    s_mov_b32 s35, 0x100000
    s_waitcnt vmcnt(4)
    s_barrier
    ds_read_b128 a[176:179], v32 offset:0
    ds_read_b128 a[180:183], v32 offset:1024
    ds_read_b128 a[192:195], v32 offset:8192
    ds_read_b128 a[196:199], v32 offset:9216
    s_waitcnt lgkmcnt(0)
    v_mfma_f32_32x32x16_bf16 v[40:55], a[176:179], a[0:3], 0
    v_mfma_f32_32x32x16_bf16 v[40:55], a[180:183], a[4:7], v[40:55]
    s_nop 11
    v_mfma_f32_32x32x16_bf16 v[56:71], a[176:179], a[8:11], 0
    buffer_store_dwordx4 v[152:155], v0, s[28:31], s92 offen offset:0 sc1
    v_exp_f32 v40, v40
    v_exp_f32 v41, v41
    v_exp_f32 v42, v42
    v_mfma_f32_32x32x16_bf16 v[56:71], a[180:183], a[12:15], v[56:71]
    ds_read_b128 a[184:187], v32 offset:2048
    v_exp_f32 v43, v43
    v_cvt_pk_bf16_f32 v72, v40, v41
    v_exp_f32 v44, v44
    v_exp_f32 v45, v45
    v_cvt_pk_bf16_f32 v73, v42, v43
    v_exp_f32 v46, v46
    s_nop 0
    ds_read_b128 a[188:191], v32 offset:3072
    v_exp_f32 v47, v47
    v_cvt_pk_bf16_f32 v74, v44, v45
    v_exp_f32 v48, v48
    s_nop 0
    v_exp_f32 v49, v49
    v_cvt_pk_bf16_f32 v75, v46, v47
    v_exp_f32 v50, v50
    v_exp_f32 v51, v51
    s_nop 0
    v_cvt_pk_bf16_f32 v76, v48, v49
    v_exp_f32 v52, v52
    v_exp_f32 v53, v53
    v_cvt_pk_bf16_f32 v77, v50, v51
    s_nop 0
    s_waitcnt lgkmcnt(0)
    v_exp_f32 v54, v54
    v_exp_f32 v55, v55
    v_cvt_pk_bf16_f32 v78, v52, v53
    v_cvt_pk_bf16_f32 v79, v54, v55
    v_mfma_f32_32x32x16_bf16 v[40:55], a[184:187], a[0:3], 0
    buffer_store_dwordx4 v[156:159], v0, s[28:31], s93 offen offset:0 sc1
    v_exp_f32 v56, v56
    v_exp_f32 v57, v57
    v_exp_f32 v58, v58
    v_mfma_f32_32x32x16_bf16 v[40:55], a[188:191], a[4:7], v[40:55]
    buffer_store_dwordx4 v[160:163], v0, s[28:31], s90 offen offset:1024 sc1
    v_exp_f32 v59, v59
    v_cvt_pk_bf16_f32 v80, v56, v57
    v_exp_f32 v60, v60
    v_exp_f32 v61, v61
    v_mfma_f32_32x32x16_bf16 a[208:223], a[192:195], v[72:75], 0
    ds_read_b128 a[200:203], v32 offset:10240
    v_cvt_pk_bf16_f32 v81, v58, v59
    v_exp_f32 v62, v62
    v_exp_f32 v63, v63
    v_cvt_pk_bf16_f32 v82, v60, v61
    v_exp_f32 v64, v64
    v_mfma_f32_32x32x16_bf16 a[208:223], a[196:199], v[76:79], a[208:223]
    ds_read_b128 a[204:207], v32 offset:11264
    v_exp_f32 v65, v65
    v_cvt_pk_bf16_f32 v83, v62, v63
    v_exp_f32 v66, v66
    v_exp_f32 v67, v67
    v_cvt_pk_bf16_f32 v84, v64, v65
    v_mfma_f32_16x16x32_bf16 a[240:243], a[248:251], v[72:75], 0
    v_exp_f32 v68, v68
    v_exp_f32 v69, v69
    v_cvt_pk_bf16_f32 v85, v66, v67
    v_mfma_f32_16x16x32_bf16 a[240:243], a[248:251], v[76:79], a[240:243]
    v_exp_f32 v70, v70
    v_exp_f32 v71, v71
    v_cvt_pk_bf16_f32 v86, v68, v69
    v_cvt_pk_bf16_f32 v87, v70, v71
    v_mfma_f32_32x32x16_bf16 v[56:71], a[184:187], a[8:11], 0
    buffer_store_dwordx4 v[164:167], v0, s[28:31], s91 offen offset:1024 sc1
    v_exp_f32 v40, v40
    v_exp_f32 v41, v41
    v_exp_f32 v42, v42
    v_mfma_f32_32x32x16_bf16 v[56:71], a[188:191], a[12:15], v[56:71]
    buffer_store_dwordx4 v[168:171], v0, s[28:31], s92 offen offset:1024 sc1
    v_exp_f32 v43, v43
    v_cvt_pk_bf16_f32 v72, v40, v41
    v_exp_f32 v44, v44
    v_mfma_f32_32x32x16_bf16 a[224:239], a[192:195], v[80:83], 0
    ds_read_b128 a[176:179], v32 offset:4096
    ds_read_b128 a[180:183], v32 offset:5120
    v_exp_f32 v45, v45
    v_cvt_pk_bf16_f32 v73, v42, v43
    v_exp_f32 v46, v46
    v_exp_f32 v47, v47
    v_mfma_f32_32x32x16_bf16 a[224:239], a[196:199], v[84:87], a[224:239]
    v_cvt_pk_bf16_f32 v74, v44, v45
    v_exp_f32 v48, v48
    v_exp_f32 v49, v49
    v_cvt_pk_bf16_f32 v75, v46, v47
    v_exp_f32 v50, v50
    v_exp_f32 v51, v51
    v_mfma_f32_16x16x32_bf16 a[244:247], a[248:251], v[80:83], 0
    v_cvt_pk_bf16_f32 v76, v48, v49
    v_exp_f32 v52, v52
    v_exp_f32 v53, v53
    v_cvt_pk_bf16_f32 v77, v50, v51
    v_mfma_f32_16x16x32_bf16 a[244:247], a[248:251], v[84:87], a[244:247]
    s_waitcnt lgkmcnt(0)
    v_exp_f32 v54, v54
    v_exp_f32 v55, v55
    v_cvt_pk_bf16_f32 v78, v52, v53
    v_cvt_pk_bf16_f32 v79, v54, v55
    v_mfma_f32_32x32x16_bf16 v[40:55], a[176:179], a[0:3], 0
    s_add_u32 m0, s12, 0
    buffer_store_dwordx4 v[172:175], v0, s[28:31], s93 offen offset:1024 sc1
    v_exp_f32 v56, v56
    v_exp_f32 v57, v57
    v_exp_f32 v58, v58
    v_mfma_f32_32x32x16_bf16 v[40:55], a[180:183], a[4:7], v[40:55]
    buffer_load_dwordx4 v2, s[28:31], s9 offen sc1 lds
    buffer_load_dwordx4 v2, s[28:31], s9 offen offset:1024 sc1 lds
    v_exp_f32 v59, v59
    v_cvt_pk_bf16_f32 v80, v56, v57
    v_exp_f32 v60, v60
    v_mfma_f32_32x32x16_bf16 a[208:223], a[200:203], v[72:75], a[208:223]
    s_add_u32 m0, s12, 8192
    s_add_u32 s9, s9, 8192
    ds_read_b128 a[192:195], v32 offset:12288
    v_exp_f32 v61, v61
    v_cvt_pk_bf16_f32 v81, v58, v59
    v_exp_f32 v62, v62
    v_exp_f32 v63, v63
    v_cvt_pk_bf16_f32 v82, v60, v61
    v_mfma_f32_32x32x16_bf16 a[208:223], a[204:207], v[76:79], a[208:223]
    buffer_load_dwordx4 v2, s[28:31], s10 offen sc1 lds
    buffer_load_dwordx4 v2, s[28:31], s10 offen offset:1024 sc1 lds
    v_exp_f32 v64, v64
    v_exp_f32 v65, v65
    v_cvt_pk_bf16_f32 v83, v62, v63
    v_exp_f32 v66, v66
    v_mfma_f32_16x16x32_bf16 a[240:243], a[248:251], v[72:75], a[240:243]
    s_add_u32 s10, s10, 8192
    ds_read_b128 a[196:199], v32 offset:13312
    v_exp_f32 v67, v67
    v_cvt_pk_bf16_f32 v84, v64, v65
    v_exp_f32 v68, v68
    v_exp_f32 v69, v69
    v_mfma_f32_16x16x32_bf16 a[240:243], a[248:251], v[76:79], a[240:243]
    v_cvt_pk_bf16_f32 v85, v66, v67
    v_exp_f32 v70, v70
    v_exp_f32 v71, v71
    v_cvt_pk_bf16_f32 v86, v68, v69
    v_cvt_pk_bf16_f32 v87, v70, v71
    v_mfma_f32_32x32x16_bf16 v[56:71], a[176:179], a[8:11], 0
    ds_read_b128 a[184:187], v32 offset:6144
    v_mov_b64 v[88:89], 0
    v_mov_b64 v[90:91], 0
    v_mov_b64 v[92:93], 0
    v_mov_b64 v[94:95], 0
    v_exp_f32 v40, v40
    v_exp_f32 v41, v41
    v_mfma_f32_32x32x16_bf16 v[56:71], a[180:183], a[12:15], v[56:71]
    ds_read_b128 a[188:191], v32 offset:7168
    v_exp_f32 v42, v42
    v_exp_f32 v43, v43
    v_cvt_pk_bf16_f32 v72, v40, v41
    v_exp_f32 v44, v44
    v_exp_f32 v45, v45
    v_mfma_f32_32x32x16_bf16 a[224:239], a[200:203], v[80:83], a[224:239]
    v_cvt_pk_bf16_f32 v73, v42, v43
    v_exp_f32 v46, v46
    v_exp_f32 v47, v47
    v_cvt_pk_bf16_f32 v74, v44, v45
    v_exp_f32 v48, v48
    v_exp_f32 v49, v49
    v_mfma_f32_32x32x16_bf16 a[224:239], a[204:207], v[84:87], a[224:239]
    v_mov_b64 v[96:97], 0
    v_mov_b64 v[98:99], 0
    v_mov_b64 v[100:101], 0
    v_mov_b64 v[102:103], 0
    v_cvt_pk_bf16_f32 v75, v46, v47
    v_exp_f32 v50, v50
    v_exp_f32 v51, v51
    v_cvt_pk_bf16_f32 v76, v48, v49
    v_mfma_f32_16x16x32_bf16 a[244:247], a[248:251], v[80:83], a[244:247]
    v_exp_f32 v52, v52
    v_exp_f32 v53, v53
    v_cvt_pk_bf16_f32 v77, v50, v51
    v_mfma_f32_16x16x32_bf16 a[244:247], a[248:251], v[84:87], a[244:247]
    s_waitcnt lgkmcnt(0)
    v_exp_f32 v54, v54
    v_exp_f32 v55, v55
    v_cvt_pk_bf16_f32 v78, v52, v53
    v_cvt_pk_bf16_f32 v79, v54, v55
    v_mfma_f32_32x32x16_bf16 v[40:55], a[184:187], a[0:3], 0
    ds_read_b128 a[200:203], v32 offset:14336
    v_mov_b64 v[104:105], 0
    v_mov_b64 v[106:107], 0
    v_mov_b64 v[108:109], 0
    v_mov_b64 v[110:111], 0
    v_exp_f32 v56, v56
    v_exp_f32 v57, v57
    v_exp_f32 v58, v58
    v_mfma_f32_32x32x16_bf16 v[40:55], a[188:191], a[4:7], v[40:55]
    ds_read_b128 a[204:207], v32 offset:15360
    v_exp_f32 v59, v59
    v_cvt_pk_bf16_f32 v80, v56, v57
    v_exp_f32 v60, v60
    v_exp_f32 v61, v61
    v_cvt_pk_bf16_f32 v81, v58, v59
    v_exp_f32 v62, v62
    v_mfma_f32_32x32x16_bf16 a[208:223], a[192:195], v[72:75], a[208:223]
    v_exp_f32 v63, v63
    v_cvt_pk_bf16_f32 v82, v60, v61
    v_exp_f32 v64, v64
    v_exp_f32 v65, v65
    v_cvt_pk_bf16_f32 v83, v62, v63
    v_exp_f32 v66, v66
    v_mfma_f32_32x32x16_bf16 a[208:223], a[196:199], v[76:79], a[208:223]
    v_mov_b64 v[112:113], 0
    v_mov_b64 v[114:115], 0
    v_mov_b64 v[116:117], 0
    v_mov_b64 v[118:119], 0
    v_exp_f32 v67, v67
    v_cvt_pk_bf16_f32 v84, v64, v65
    v_exp_f32 v68, v68
    v_exp_f32 v69, v69
    v_mfma_f32_16x16x32_bf16 a[240:243], a[248:251], v[72:75], a[240:243]
    v_cvt_pk_bf16_f32 v85, v66, v67
    v_exp_f32 v70, v70
    v_exp_f32 v71, v71
    v_cvt_pk_bf16_f32 v86, v68, v69
    v_cvt_pk_bf16_f32 v87, v70, v71
    v_mfma_f32_16x16x32_bf16 a[240:243], a[248:251], v[76:79], a[240:243]
    s_waitcnt vmcnt(4)
    s_barrier
    s_cmp_eq_u32 s36, 0
    s_cbranch_scc0 p2_nof2
    v_mov_b32 v9, 0
    v_mov_b32 v10, 1
    s_mov_b64 exec, 1
    buffer_store_dword v10, v9, s[28:31], s85 offen sc1
    s_mov_b64 exec, -1
p2_nof2:
    s_barrier
    v_mfma_f32_32x32x16_bf16 v[56:71], a[184:187], a[8:11], 0
    s_add_u32 m0, s12, 16384
    ds_read_b128 a[176:179], v32 offset:16384
    v_mov_b64 v[120:121], 0
    v_mov_b64 v[122:123], 0
    v_mov_b64 v[124:125], 0
    v_mov_b64 v[126:127], 0
    v_exp_f32 v40, v40
    v_exp_f32 v41, v41
    v_exp_f32 v42, v42
    v_mfma_f32_32x32x16_bf16 v[56:71], a[188:191], a[12:15], v[56:71]
    buffer_load_dwordx4 v2, s[28:31], s9 offen sc1 lds
    buffer_load_dwordx4 v2, s[28:31], s9 offen offset:1024 sc1 lds
    v_exp_f32 v43, v43
    v_cvt_pk_bf16_f32 v72, v40, v41
    v_exp_f32 v44, v44
    v_mfma_f32_32x32x16_bf16 a[224:239], a[192:195], v[80:83], a[224:239]
    s_add_u32 s9, s9, 8192
    ds_read_b128 a[180:183], v32 offset:17408
    v_exp_f32 v45, v45
    v_cvt_pk_bf16_f32 v73, v42, v43
    v_exp_f32 v46, v46
    v_exp_f32 v47, v47
    v_cvt_pk_bf16_f32 v74, v44, v45
    v_exp_f32 v48, v48
    v_mfma_f32_32x32x16_bf16 a[224:239], a[196:199], v[84:87], a[224:239]
    v_mov_b64 v[128:129], 0
    v_mov_b64 v[130:131], 0
    v_mov_b64 v[132:133], 0
    v_mov_b64 v[134:135], 0
    v_exp_f32 v49, v49
    v_cvt_pk_bf16_f32 v75, v46, v47
    v_exp_f32 v50, v50
    v_exp_f32 v51, v51
    v_mfma_f32_16x16x32_bf16 a[244:247], a[248:251], v[80:83], a[244:247]
    v_cvt_pk_bf16_f32 v76, v48, v49
    v_exp_f32 v52, v52
    v_exp_f32 v53, v53
    v_cvt_pk_bf16_f32 v77, v50, v51
    v_mfma_f32_16x16x32_bf16 a[244:247], a[248:251], v[84:87], a[244:247]
    s_waitcnt lgkmcnt(0)
    s_add_u32 m0, s12, 24576
    v_exp_f32 v54, v54
    v_exp_f32 v55, v55
    v_cvt_pk_bf16_f32 v78, v52, v53
    v_cvt_pk_bf16_f32 v79, v54, v55
    v_mfma_f32_32x32x16_bf16 v[40:55], a[176:179], a[0:3], 0
    buffer_load_dwordx4 v2, s[28:31], s10 offen sc1 lds
    buffer_load_dwordx4 v2, s[28:31], s10 offen offset:1024 sc1 lds
    v_mov_b64 v[136:137], 0
    v_mov_b64 v[138:139], 0
    v_mov_b64 v[140:141], 0
    v_mov_b64 v[142:143], 0
    v_exp_f32 v56, v56
    v_mfma_f32_32x32x16_bf16 v[40:55], a[180:183], a[4:7], v[40:55]
    s_add_u32 s10, s10, 8192
    ds_read_b128 a[192:195], v32 offset:24576
    v_exp_f32 v57, v57
    v_exp_f32 v58, v58
    v_exp_f32 v59, v59
    v_cvt_pk_bf16_f32 v80, v56, v57
    v_exp_f32 v60, v60
    v_mfma_f32_32x32x16_bf16 a[208:223], a[200:203], v[72:75], a[208:223]
    ds_read_b128 a[196:199], v32 offset:25600
    v_exp_f32 v61, v61
    v_cvt_pk_bf16_f32 v81, v58, v59
    v_exp_f32 v62, v62
    v_exp_f32 v63, v63
    v_cvt_pk_bf16_f32 v82, v60, v61
    v_exp_f32 v64, v64
    v_mfma_f32_32x32x16_bf16 a[208:223], a[204:207], v[76:79], a[208:223]
    v_mov_b64 v[144:145], 0
    v_mov_b64 v[146:147], 0
    v_mov_b64 v[148:149], 0
    v_mov_b64 v[150:151], 0
    v_exp_f32 v65, v65
    v_cvt_pk_bf16_f32 v83, v62, v63
    v_exp_f32 v66, v66
    v_exp_f32 v67, v67
    v_mfma_f32_16x16x32_bf16 a[240:243], a[248:251], v[72:75], a[240:243]
    v_cvt_pk_bf16_f32 v84, v64, v65
    v_exp_f32 v68, v68
    v_exp_f32 v69, v69
    v_cvt_pk_bf16_f32 v85, v66, v67
    v_mfma_f32_16x16x32_bf16 a[240:243], a[248:251], v[76:79], a[240:243]
    v_exp_f32 v70, v70
    v_exp_f32 v71, v71
    v_cvt_pk_bf16_f32 v86, v68, v69
    v_cvt_pk_bf16_f32 v87, v70, v71
    v_mfma_f32_32x32x16_bf16 v[56:71], a[176:179], a[8:11], 0
    ds_read_b128 a[184:187], v32 offset:18432
    v_mov_b64 v[152:153], 0
    v_mov_b64 v[154:155], 0
    v_mov_b64 v[156:157], 0
    v_mov_b64 v[158:159], 0
    v_exp_f32 v40, v40
    v_exp_f32 v41, v41
    v_mfma_f32_32x32x16_bf16 v[56:71], a[180:183], a[12:15], v[56:71]
    ds_read_b128 a[188:191], v32 offset:19456
    v_exp_f32 v42, v42
    v_exp_f32 v43, v43
    v_cvt_pk_bf16_f32 v72, v40, v41
    v_exp_f32 v44, v44
    v_exp_f32 v45, v45
    v_mfma_f32_32x32x16_bf16 a[224:239], a[200:203], v[80:83], a[224:239]
    v_cvt_pk_bf16_f32 v73, v42, v43
    v_exp_f32 v46, v46
    v_exp_f32 v47, v47
    v_cvt_pk_bf16_f32 v74, v44, v45
    v_exp_f32 v48, v48
    v_exp_f32 v49, v49
    v_mfma_f32_32x32x16_bf16 a[224:239], a[204:207], v[84:87], a[224:239]
    v_mov_b64 v[160:161], 0
    v_mov_b64 v[162:163], 0
    v_mov_b64 v[164:165], 0
    v_mov_b64 v[166:167], 0
    v_cvt_pk_bf16_f32 v75, v46, v47
    v_exp_f32 v50, v50
    v_exp_f32 v51, v51
    v_cvt_pk_bf16_f32 v76, v48, v49
    v_mfma_f32_16x16x32_bf16 a[244:247], a[248:251], v[80:83], a[244:247]
    v_exp_f32 v52, v52
    v_exp_f32 v53, v53
    v_cvt_pk_bf16_f32 v77, v50, v51
    v_mfma_f32_16x16x32_bf16 a[244:247], a[248:251], v[84:87], a[244:247]
    s_waitcnt lgkmcnt(0)
    v_exp_f32 v54, v54
    v_exp_f32 v55, v55
    v_cvt_pk_bf16_f32 v78, v52, v53
    v_cvt_pk_bf16_f32 v79, v54, v55
    v_mfma_f32_32x32x16_bf16 v[40:55], a[184:187], a[0:3], 0
    ds_read_b128 a[200:203], v32 offset:26624
    v_mov_b64 v[168:169], 0
    v_mov_b64 v[170:171], 0
    v_mov_b64 v[172:173], 0
    v_mov_b64 v[174:175], 0
    v_exp_f32 v56, v56
    v_exp_f32 v57, v57
    v_mfma_f32_32x32x16_bf16 v[40:55], a[188:191], a[4:7], v[40:55]
    ds_read_b128 a[204:207], v32 offset:27648
    v_exp_f32 v58, v58
    v_exp_f32 v59, v59
    v_cvt_pk_bf16_f32 v80, v56, v57
    v_exp_f32 v60, v60
    v_exp_f32 v61, v61
    v_mfma_f32_32x32x16_bf16 a[208:223], a[192:195], v[72:75], a[208:223]
    v_cvt_pk_bf16_f32 v81, v58, v59
    v_exp_f32 v62, v62
    v_exp_f32 v63, v63
    v_cvt_pk_bf16_f32 v82, v60, v61
    v_exp_f32 v64, v64
    v_exp_f32 v65, v65
    v_mfma_f32_32x32x16_bf16 a[208:223], a[196:199], v[76:79], a[208:223]
    v_mov_b64 v[176:177], 0
    v_mov_b64 v[178:179], 0
    v_mov_b64 v[180:181], 0
    v_mov_b64 v[182:183], 0
    v_cvt_pk_bf16_f32 v83, v62, v63
    v_exp_f32 v66, v66
    v_exp_f32 v67, v67
    v_cvt_pk_bf16_f32 v84, v64, v65
    v_mfma_f32_16x16x32_bf16 a[240:243], a[248:251], v[72:75], a[240:243]
    v_exp_f32 v68, v68
    v_exp_f32 v69, v69
    v_cvt_pk_bf16_f32 v85, v66, v67
    v_mfma_f32_16x16x32_bf16 a[240:243], a[248:251], v[76:79], a[240:243]
    v_exp_f32 v70, v70
    v_exp_f32 v71, v71
    v_cvt_pk_bf16_f32 v86, v68, v69
    v_cvt_pk_bf16_f32 v87, v70, v71
    v_mfma_f32_32x32x16_bf16 v[56:71], a[184:187], a[8:11], 0
    s_add_u32 m0, s15, 0
    ds_read_b128 a[176:179], v32 offset:20480
    v_mov_b64 v[184:185], 0
    v_mov_b64 v[186:187], 0
    v_mov_b64 v[188:189], 0
    v_mov_b64 v[190:191], 0
    v_exp_f32 v40, v40
    v_exp_f32 v41, v41
    v_exp_f32 v42, v42
    v_mfma_f32_32x32x16_bf16 v[56:71], a[188:191], a[12:15], v[56:71]
    buffer_load_dwordx4 v20, s[64:67], s14 offen offset:0 lds
    buffer_load_dwordx4 v21, s[64:67], s14 offen offset:1024 lds
    v_exp_f32 v43, v43
    v_cvt_pk_bf16_f32 v72, v40, v41
    v_exp_f32 v44, v44
    v_mfma_f32_32x32x16_bf16 a[224:239], a[192:195], v[80:83], a[224:239]
    ds_read_b128 a[180:183], v32 offset:21504
    v_exp_f32 v45, v45
    v_cvt_pk_bf16_f32 v73, v42, v43
    v_exp_f32 v46, v46
    v_exp_f32 v47, v47
    v_cvt_pk_bf16_f32 v74, v44, v45
    v_exp_f32 v48, v48
    v_mfma_f32_32x32x16_bf16 a[224:239], a[196:199], v[84:87], a[224:239]
    v_mov_b64 v[192:193], 0
    v_mov_b64 v[194:195], 0
    v_mov_b64 v[196:197], 0
    v_mov_b64 v[198:199], 0
    v_exp_f32 v49, v49
    v_cvt_pk_bf16_f32 v75, v46, v47
    v_exp_f32 v50, v50
    v_exp_f32 v51, v51
    v_mfma_f32_16x16x32_bf16 a[244:247], a[248:251], v[80:83], a[244:247]
    v_cvt_pk_bf16_f32 v76, v48, v49
    v_exp_f32 v52, v52
    v_exp_f32 v53, v53
    v_cvt_pk_bf16_f32 v77, v50, v51
    v_mfma_f32_16x16x32_bf16 a[244:247], a[248:251], v[84:87], a[244:247]
    s_waitcnt lgkmcnt(0)
    v_exp_f32 v54, v54
    v_exp_f32 v55, v55
    v_cvt_pk_bf16_f32 v78, v52, v53
    v_cvt_pk_bf16_f32 v79, v54, v55
    v_mfma_f32_32x32x16_bf16 v[40:55], a[176:179], a[0:3], 0
    buffer_load_dwordx4 v22, s[64:67], s14 offen offset:2048 lds
    buffer_load_dwordx4 v23, s[64:67], s14 offen offset:3072 lds
    v_mov_b64 v[200:201], 0
    v_mov_b64 v[202:203], 0
    v_mov_b64 v[204:205], 0
    v_mov_b64 v[206:207], 0
    v_exp_f32 v56, v56
    v_mfma_f32_32x32x16_bf16 v[40:55], a[180:183], a[4:7], v[40:55]
    s_add_u32 s14, s14, 65536
    ds_read_b128 a[192:195], v32 offset:28672
    v_exp_f32 v57, v57
    v_exp_f32 v58, v58
    v_exp_f32 v59, v59
    v_cvt_pk_bf16_f32 v80, v56, v57
    v_exp_f32 v60, v60
    v_mfma_f32_32x32x16_bf16 a[208:223], a[200:203], v[72:75], a[208:223]
    ds_read_b128 a[196:199], v32 offset:29696
    v_exp_f32 v61, v61
    v_cvt_pk_bf16_f32 v81, v58, v59
    v_exp_f32 v62, v62
    v_exp_f32 v63, v63
    v_cvt_pk_bf16_f32 v82, v60, v61
    v_exp_f32 v64, v64
    v_mfma_f32_32x32x16_bf16 a[208:223], a[204:207], v[76:79], a[208:223]
    v_mov_b64 v[208:209], 0
    v_mov_b64 v[210:211], 0
    v_mov_b64 v[212:213], 0
    v_mov_b64 v[214:215], 0
    v_exp_f32 v65, v65
    v_cvt_pk_bf16_f32 v83, v62, v63
    v_exp_f32 v66, v66
    v_exp_f32 v67, v67
    v_mfma_f32_16x16x32_bf16 a[240:243], a[248:251], v[72:75], a[240:243]
    v_cvt_pk_bf16_f32 v84, v64, v65
    v_exp_f32 v68, v68
    v_exp_f32 v69, v69
    v_cvt_pk_bf16_f32 v85, v66, v67
    v_mfma_f32_16x16x32_bf16 a[240:243], a[248:251], v[76:79], a[240:243]
    s_add_u32 m0, s15, 4096
    v_exp_f32 v70, v70
    v_exp_f32 v71, v71
    v_cvt_pk_bf16_f32 v86, v68, v69
    v_cvt_pk_bf16_f32 v87, v70, v71
    v_mfma_f32_32x32x16_bf16 v[56:71], a[176:179], a[8:11], 0
    buffer_load_dwordx4 v20, s[64:67], s14 offen offset:0 lds
    buffer_load_dwordx4 v21, s[64:67], s14 offen offset:1024 lds
    v_exp_f32 v40, v40
    v_exp_f32 v41, v41
    v_mfma_f32_32x32x16_bf16 v[56:71], a[180:183], a[12:15], v[56:71]
    ds_read_b128 a[184:187], v32 offset:22528
    v_exp_f32 v42, v42
    v_exp_f32 v43, v43
    v_cvt_pk_bf16_f32 v72, v40, v41
    v_exp_f32 v44, v44
    v_exp_f32 v45, v45
    v_mfma_f32_32x32x16_bf16 a[224:239], a[200:203], v[80:83], a[224:239]
    ds_read_b128 a[188:191], v32 offset:23552
    v_cvt_pk_bf16_f32 v73, v42, v43
    v_exp_f32 v46, v46
    v_exp_f32 v47, v47
    v_cvt_pk_bf16_f32 v74, v44, v45
    v_exp_f32 v48, v48
    v_exp_f32 v49, v49
    v_mfma_f32_32x32x16_bf16 a[224:239], a[204:207], v[84:87], a[224:239]
    buffer_load_dwordx4 v22, s[64:67], s14 offen offset:2048 lds
    buffer_load_dwordx4 v23, s[64:67], s14 offen offset:3072 lds
    v_cvt_pk_bf16_f32 v75, v46, v47
    v_exp_f32 v50, v50
    v_exp_f32 v51, v51
    v_mfma_f32_16x16x32_bf16 a[244:247], a[248:251], v[80:83], a[244:247]
    s_add_u32 s14, s14, 65536
    v_cvt_pk_bf16_f32 v76, v48, v49
    v_exp_f32 v52, v52
    v_exp_f32 v53, v53
    v_cvt_pk_bf16_f32 v77, v50, v51
    v_mfma_f32_16x16x32_bf16 a[244:247], a[248:251], v[84:87], a[244:247]
    s_waitcnt lgkmcnt(0)
    v_exp_f32 v54, v54
    v_exp_f32 v55, v55
    v_cvt_pk_bf16_f32 v78, v52, v53
    v_cvt_pk_bf16_f32 v79, v54, v55
    v_mfma_f32_32x32x16_bf16 v[40:55], a[184:187], a[0:3], 0
    ds_read_b128 a[200:203], v32 offset:30720
    v_exp_f32 v56, v56
    v_exp_f32 v57, v57
    v_exp_f32 v58, v58
    v_exp_f32 v59, v59
    v_mfma_f32_32x32x16_bf16 v[40:55], a[188:191], a[4:7], v[40:55]
    ds_read_b128 a[204:207], v32 offset:31744
    v_cvt_pk_bf16_f32 v80, v56, v57
    v_exp_f32 v60, v60
    v_exp_f32 v61, v61
    v_cvt_pk_bf16_f32 v81, v58, v59
    v_exp_f32 v62, v62
    v_mfma_f32_32x32x16_bf16 a[208:223], a[192:195], v[72:75], a[208:223]
    v_exp_f32 v63, v63
    v_cvt_pk_bf16_f32 v82, v60, v61
    v_exp_f32 v64, v64
    v_exp_f32 v65, v65
    v_cvt_pk_bf16_f32 v83, v62, v63
    v_mfma_f32_32x32x16_bf16 a[208:223], a[196:199], v[76:79], a[208:223]
    v_exp_f32 v66, v66
    v_exp_f32 v67, v67
    v_cvt_pk_bf16_f32 v84, v64, v65
    v_exp_f32 v68, v68
    v_exp_f32 v69, v69
    v_cvt_pk_bf16_f32 v85, v66, v67
    v_mfma_f32_16x16x32_bf16 a[240:243], a[248:251], v[72:75], a[240:243]
    v_exp_f32 v70, v70
    v_exp_f32 v71, v71
    v_cvt_pk_bf16_f32 v86, v68, v69
    v_cvt_pk_bf16_f32 v87, v70, v71
    v_mfma_f32_16x16x32_bf16 a[240:243], a[248:251], v[76:79], a[240:243]
    s_waitcnt vmcnt(12)
    s_add_u32 m0, s15, 8192
    s_barrier
    v_xor_b32 v32, 0x8000, v32
    v_mfma_f32_32x32x16_bf16 v[56:71], a[184:187], a[8:11], 0
    buffer_load_dwordx4 v20, s[64:67], s14 offen offset:0 lds
    buffer_load_dwordx4 v21, s[64:67], s14 offen offset:1024 lds
    v_exp_f32 v40, v40
    v_exp_f32 v41, v41
    v_mfma_f32_32x32x16_bf16 v[56:71], a[188:191], a[12:15], v[56:71]
    buffer_load_dwordx4 v22, s[64:67], s14 offen offset:2048 lds
    buffer_load_dwordx4 v23, s[64:67], s14 offen offset:3072 lds
    v_exp_f32 v42, v42
    v_exp_f32 v43, v43
    v_cvt_pk_bf16_f32 v72, v40, v41
    v_mfma_f32_32x32x16_bf16 a[224:239], a[192:195], v[80:83], a[224:239]
    s_add_u32 s14, s14, 65536
    ds_read_b128 a[176:179], v32 offset:0
    ds_read_b128 a[180:183], v32 offset:1024
    v_exp_f32 v44, v44
    v_exp_f32 v45, v45
    v_cvt_pk_bf16_f32 v73, v42, v43
    v_exp_f32 v46, v46
    v_exp_f32 v47, v47
    v_mfma_f32_32x32x16_bf16 a[224:239], a[196:199], v[84:87], a[224:239]
    v_cvt_pk_bf16_f32 v74, v44, v45
    v_exp_f32 v48, v48
    v_exp_f32 v49, v49
    v_cvt_pk_bf16_f32 v75, v46, v47
    v_exp_f32 v50, v50
    v_exp_f32 v51, v51
    v_mfma_f32_16x16x32_bf16 a[244:247], a[248:251], v[80:83], a[244:247]
    v_cvt_pk_bf16_f32 v76, v48, v49
    v_exp_f32 v52, v52
    v_exp_f32 v53, v53
    v_cvt_pk_bf16_f32 v77, v50, v51
    v_mfma_f32_16x16x32_bf16 a[244:247], a[248:251], v[84:87], a[244:247]
    s_waitcnt lgkmcnt(0)
    s_add_u32 m0, s11, 0
    v_exp_f32 v54, v54
    v_exp_f32 v55, v55
    v_cvt_pk_bf16_f32 v78, v52, v53
    v_cvt_pk_bf16_f32 v79, v54, v55
    v_mfma_f32_32x32x16_bf16 v[40:55], a[176:179], a[0:3], 0
    buffer_load_dwordx4 v2, s[28:31], s9 offen sc1 lds
    buffer_load_dwordx4 v2, s[28:31], s9 offen offset:1024 sc1 lds
    v_exp_f32 v56, v56
    v_exp_f32 v57, v57
    v_mfma_f32_32x32x16_bf16 v[40:55], a[180:183], a[4:7], v[40:55]
    s_add_u32 s9, s9, 8192
    ds_read_b128 a[192:195], v32 offset:8192
    v_exp_f32 v58, v58
    v_exp_f32 v59, v59
    v_cvt_pk_bf16_f32 v80, v56, v57
    v_exp_f32 v60, v60
    v_mfma_f32_32x32x16_bf16 a[208:223], a[200:203], v[72:75], a[208:223]
    ds_read_b128 a[196:199], v32 offset:9216
    v_exp_f32 v61, v61
    v_cvt_pk_bf16_f32 v81, v58, v59
    v_exp_f32 v62, v62
    v_exp_f32 v63, v63
    v_cvt_pk_bf16_f32 v82, v60, v61
    v_mfma_f32_32x32x16_bf16 a[208:223], a[204:207], v[76:79], a[208:223]
    v_exp_f32 v64, v64
    v_exp_f32 v65, v65
    v_cvt_pk_bf16_f32 v83, v62, v63
    v_exp_f32 v66, v66
    v_exp_f32 v67, v67
    v_mfma_f32_16x16x32_bf16 a[240:243], a[248:251], v[72:75], a[240:243]
    v_cvt_pk_bf16_f32 v84, v64, v65
    v_exp_f32 v68, v68
    v_exp_f32 v69, v69
    v_cvt_pk_bf16_f32 v85, v66, v67
    v_mfma_f32_16x16x32_bf16 a[240:243], a[248:251], v[76:79], a[240:243]
    s_add_u32 m0, s11, 8192
    v_exp_f32 v70, v70
    v_exp_f32 v71, v71
    v_cvt_pk_bf16_f32 v86, v68, v69
    v_cvt_pk_bf16_f32 v87, v70, v71
    v_mfma_f32_32x32x16_bf16 v[56:71], a[176:179], a[8:11], 0
    buffer_load_dwordx4 v2, s[28:31], s10 offen sc1 lds
    buffer_load_dwordx4 v2, s[28:31], s10 offen offset:1024 sc1 lds
    v_exp_f32 v40, v40
    v_exp_f32 v41, v41
    v_exp_f32 v42, v42
    v_mfma_f32_32x32x16_bf16 v[56:71], a[180:183], a[12:15], v[56:71]
    s_add_u32 m0, s4, 0
    s_add_u32 s10, s10, 8192
    ds_read_b128 a[184:187], v32 offset:2048
    ds_read_b128 a[188:191], v32 offset:3072
    v_exp_f32 v43, v43
    v_cvt_pk_bf16_f32 v72, v40, v41
    v_exp_f32 v44, v44
    v_exp_f32 v45, v45
    v_cvt_pk_bf16_f32 v73, v42, v43
    v_mfma_f32_32x32x16_bf16 a[224:239], a[200:203], v[80:83], a[224:239]
    s_xor_b32 s11, s11, 0x8000
    buffer_load_dwordx4 v20, s[68:71], s95 offen offset:0 lds
    buffer_load_dwordx4 v21, s[68:71], s95 offen offset:1024 lds
    v_exp_f32 v46, v46
    v_exp_f32 v47, v47
    v_mfma_f32_32x32x16_bf16 a[224:239], a[204:207], v[84:87], a[224:239]
    s_xor_b32 s12, s12, 0x8000
    v_cvt_pk_bf16_f32 v74, v44, v45
    v_exp_f32 v48, v48
    v_exp_f32 v49, v49
    v_cvt_pk_bf16_f32 v75, v46, v47
    v_exp_f32 v50, v50
    v_exp_f32 v51, v51
    v_mfma_f32_16x16x32_bf16 a[244:247], a[248:251], v[80:83], a[244:247]
    v_cvt_pk_bf16_f32 v76, v48, v49
    v_exp_f32 v52, v52
    v_exp_f32 v53, v53
    v_cvt_pk_bf16_f32 v77, v50, v51
    v_mfma_f32_16x16x32_bf16 a[244:247], a[248:251], v[84:87], a[244:247]
    s_waitcnt lgkmcnt(0)
    v_exp_f32 v54, v54
    v_exp_f32 v55, v55
    v_cvt_pk_bf16_f32 v78, v52, v53
    v_cvt_pk_bf16_f32 v79, v54, v55
    v_mfma_f32_32x32x16_bf16 v[40:55], a[184:187], a[0:3], 0
    buffer_load_dwordx4 v22, s[68:71], s95 offen offset:2048 lds
    buffer_load_dwordx4 v23, s[68:71], s95 offen offset:3072 lds
    v_exp_f32 v56, v56
    v_exp_f32 v57, v57
    v_exp_f32 v58, v58
    v_mfma_f32_32x32x16_bf16 v[40:55], a[188:191], a[4:7], v[40:55]
    s_add_u32 m0, s4, 4096
    s_add_u32 s95, s95, 65536
    ds_read_b128 a[200:203], v32 offset:10240
    v_exp_f32 v59, v59
    v_cvt_pk_bf16_f32 v80, v56, v57
    v_exp_f32 v60, v60
    v_exp_f32 v61, v61
    v_cvt_pk_bf16_f32 v81, v58, v59
    v_mfma_f32_32x32x16_bf16 a[208:223], a[192:195], v[72:75], a[208:223]
    buffer_load_dwordx4 v20, s[68:71], s95 offen offset:0 lds
    buffer_load_dwordx4 v21, s[68:71], s95 offen offset:1024 lds
    v_exp_f32 v62, v62
    v_exp_f32 v63, v63
    v_cvt_pk_bf16_f32 v82, v60, v61
    v_mfma_f32_32x32x16_bf16 a[208:223], a[196:199], v[76:79], a[208:223]
    ds_read_b128 a[204:207], v32 offset:11264
    v_exp_f32 v64, v64
    v_exp_f32 v65, v65
    v_cvt_pk_bf16_f32 v83, v62, v63
    v_exp_f32 v66, v66
    v_exp_f32 v67, v67
    v_mfma_f32_16x16x32_bf16 a[240:243], a[248:251], v[72:75], a[240:243]
    v_cvt_pk_bf16_f32 v84, v64, v65
    v_exp_f32 v68, v68
    v_exp_f32 v69, v69
    v_cvt_pk_bf16_f32 v85, v66, v67
    v_mfma_f32_16x16x32_bf16 a[240:243], a[248:251], v[76:79], a[240:243]
    v_exp_f32 v70, v70
    v_exp_f32 v71, v71
    v_cvt_pk_bf16_f32 v86, v68, v69
    v_cvt_pk_bf16_f32 v87, v70, v71
    v_mfma_f32_32x32x16_bf16 v[56:71], a[184:187], a[8:11], 0
    buffer_load_dwordx4 v22, s[68:71], s95 offen offset:2048 lds
    buffer_load_dwordx4 v23, s[68:71], s95 offen offset:3072 lds
    v_exp_f32 v40, v40
    v_exp_f32 v41, v41
    v_mfma_f32_32x32x16_bf16 v[56:71], a[188:191], a[12:15], v[56:71]
    s_add_u32 s95, s95, 65536
    ds_read_b128 a[176:179], v32 offset:4096
    v_exp_f32 v42, v42
    v_exp_f32 v43, v43
    v_cvt_pk_bf16_f32 v72, v40, v41
    v_exp_f32 v44, v44
    v_mfma_f32_32x32x16_bf16 a[224:239], a[192:195], v[80:83], a[224:239]
    ds_read_b128 a[180:183], v32 offset:5120
    v_exp_f32 v45, v45
    v_cvt_pk_bf16_f32 v73, v42, v43
    v_exp_f32 v46, v46
    v_exp_f32 v47, v47
    v_cvt_pk_bf16_f32 v74, v44, v45
    v_mfma_f32_32x32x16_bf16 a[224:239], a[196:199], v[84:87], a[224:239]
    v_exp_f32 v48, v48
    v_exp_f32 v49, v49
    v_cvt_pk_bf16_f32 v75, v46, v47
    v_exp_f32 v50, v50
    v_exp_f32 v51, v51
    v_mfma_f32_16x16x32_bf16 a[244:247], a[248:251], v[80:83], a[244:247]
    v_cvt_pk_bf16_f32 v76, v48, v49
    v_exp_f32 v52, v52
    v_exp_f32 v53, v53
    v_cvt_pk_bf16_f32 v77, v50, v51
    v_mfma_f32_16x16x32_bf16 a[244:247], a[248:251], v[84:87], a[244:247]
    s_waitcnt lgkmcnt(0)
    v_exp_f32 v54, v54
    v_exp_f32 v55, v55
    v_cvt_pk_bf16_f32 v78, v52, v53
    v_cvt_pk_bf16_f32 v79, v54, v55
    v_mfma_f32_32x32x16_bf16 v[40:55], a[176:179], a[0:3], 0
    ds_read_b128 a[192:195], v32 offset:12288
    v_exp_f32 v56, v56
    v_exp_f32 v57, v57
    v_exp_f32 v58, v58
    v_mfma_f32_32x32x16_bf16 v[40:55], a[180:183], a[4:7], v[40:55]
    ds_read_b128 a[196:199], v32 offset:13312
    v_exp_f32 v59, v59
    v_cvt_pk_bf16_f32 v80, v56, v57
    v_exp_f32 v60, v60
    v_exp_f32 v61, v61
    v_cvt_pk_bf16_f32 v81, v58, v59
    v_mfma_f32_32x32x16_bf16 a[208:223], a[200:203], v[72:75], a[208:223]
    v_exp_f32 v62, v62
    v_exp_f32 v63, v63
    v_cvt_pk_bf16_f32 v82, v60, v61
    v_exp_f32 v64, v64
    v_exp_f32 v65, v65
    v_mfma_f32_32x32x16_bf16 a[208:223], a[204:207], v[76:79], a[208:223]
    v_cvt_pk_bf16_f32 v83, v62, v63
    v_exp_f32 v66, v66
    v_exp_f32 v67, v67
    v_cvt_pk_bf16_f32 v84, v64, v65
    v_exp_f32 v68, v68
    v_mfma_f32_16x16x32_bf16 a[240:243], a[248:251], v[72:75], a[240:243]
    v_exp_f32 v69, v69
    v_cvt_pk_bf16_f32 v85, v66, v67
    v_exp_f32 v70, v70
    v_mfma_f32_16x16x32_bf16 a[240:243], a[248:251], v[76:79], a[240:243]
    v_exp_f32 v71, v71
    v_cvt_pk_bf16_f32 v86, v68, v69
    v_cvt_pk_bf16_f32 v87, v70, v71
    v_mfma_f32_32x32x16_bf16 v[56:71], a[176:179], a[8:11], 0
    buffer_load_dword v5, v253, s[28:31], 0 offen sc1
    v_exp_f32 v40, v40
    v_exp_f32 v41, v41
    v_exp_f32 v42, v42
    v_mfma_f32_32x32x16_bf16 v[56:71], a[180:183], a[12:15], v[56:71]
    ds_read_b128 a[184:187], v32 offset:6144
    v_exp_f32 v43, v43
    v_cvt_pk_bf16_f32 v72, v40, v41
    v_exp_f32 v44, v44
    v_exp_f32 v45, v45
    v_mfma_f32_32x32x16_bf16 a[224:239], a[200:203], v[80:83], a[224:239]
    ds_read_b128 a[188:191], v32 offset:7168
    v_cvt_pk_bf16_f32 v73, v42, v43
    v_exp_f32 v46, v46
    v_exp_f32 v47, v47
    v_cvt_pk_bf16_f32 v74, v44, v45
    v_exp_f32 v48, v48
    v_mfma_f32_32x32x16_bf16 a[224:239], a[204:207], v[84:87], a[224:239]
    v_exp_f32 v49, v49
    v_cvt_pk_bf16_f32 v75, v46, v47
    v_exp_f32 v50, v50
    v_exp_f32 v51, v51
    v_cvt_pk_bf16_f32 v76, v48, v49
    v_mfma_f32_16x16x32_bf16 a[244:247], a[248:251], v[80:83], a[244:247]
    v_exp_f32 v52, v52
    v_exp_f32 v53, v53
    v_cvt_pk_bf16_f32 v77, v50, v51
    v_mfma_f32_16x16x32_bf16 a[244:247], a[248:251], v[84:87], a[244:247]
    s_waitcnt lgkmcnt(0)
    v_exp_f32 v54, v54
    v_exp_f32 v55, v55
    v_cvt_pk_bf16_f32 v78, v52, v53
    v_cvt_pk_bf16_f32 v79, v54, v55
    v_mfma_f32_32x32x16_bf16 v[40:55], a[184:187], a[0:3], 0
    ds_read_b128 a[200:203], v32 offset:14336
    v_exp_f32 v56, v56
    v_exp_f32 v57, v57
    v_exp_f32 v58, v58
    v_exp_f32 v59, v59
    v_mfma_f32_32x32x16_bf16 v[40:55], a[188:191], a[4:7], v[40:55]
    ds_read_b128 a[204:207], v32 offset:15360
    v_cvt_pk_bf16_f32 v80, v56, v57
    v_exp_f32 v60, v60
    v_exp_f32 v61, v61
    v_cvt_pk_bf16_f32 v81, v58, v59
    v_exp_f32 v62, v62
    v_mfma_f32_32x32x16_bf16 a[208:223], a[192:195], v[72:75], a[208:223]
    v_exp_f32 v63, v63
    v_cvt_pk_bf16_f32 v82, v60, v61
    v_exp_f32 v64, v64
    v_exp_f32 v65, v65
    v_cvt_pk_bf16_f32 v83, v62, v63
    v_mfma_f32_32x32x16_bf16 a[208:223], a[196:199], v[76:79], a[208:223]
    v_exp_f32 v66, v66
    v_exp_f32 v67, v67
    v_cvt_pk_bf16_f32 v84, v64, v65
    v_exp_f32 v68, v68
    v_exp_f32 v69, v69
    v_cvt_pk_bf16_f32 v85, v66, v67
    v_mfma_f32_16x16x32_bf16 a[240:243], a[248:251], v[72:75], a[240:243]
    v_exp_f32 v70, v70
    v_exp_f32 v71, v71
    v_cvt_pk_bf16_f32 v86, v68, v69
    v_cvt_pk_bf16_f32 v87, v70, v71
    v_mfma_f32_16x16x32_bf16 a[240:243], a[248:251], v[76:79], a[240:243]
    s_waitcnt vmcnt(0)
p2_poll2:
    v_cmp_ne_u32 vcc, 1, v5
    s_sub_u32 s35, s35, 1
    s_cbranch_scc1 p2_got2
    s_nop 2
    s_cbranch_vccz p2_got2
    s_sleep 6
    buffer_load_dword v5, v253, s[28:31], 0 offen sc1
    s_waitcnt vmcnt(0)
    s_branch p2_poll2
p2_got2:
    s_barrier
    v_mfma_f32_32x32x16_bf16 v[56:71], a[184:187], a[8:11], 0
    buffer_load_dwordx4 a[16:19], v16, s[28:31], s13 offen offset:0 sc1
    buffer_load_dwordx4 a[20:23], v16, s[28:31], s13 offen offset:256 sc1
    v_exp_f32 v40, v40
    v_exp_f32 v41, v41
    v_mfma_f32_32x32x16_bf16 v[56:71], a[188:191], a[12:15], v[56:71]
    ds_read_b128 a[176:179], v32 offset:16384
    v_exp_f32 v42, v42
    v_exp_f32 v43, v43
    v_cvt_pk_bf16_f32 v72, v40, v41
    v_exp_f32 v44, v44
    v_exp_f32 v45, v45
    v_mfma_f32_32x32x16_bf16 a[224:239], a[192:195], v[80:83], a[224:239]
    ds_read_b128 a[180:183], v32 offset:17408
    v_cvt_pk_bf16_f32 v73, v42, v43
    v_exp_f32 v46, v46
    v_exp_f32 v47, v47
    v_cvt_pk_bf16_f32 v74, v44, v45
    v_exp_f32 v48, v48
    v_mfma_f32_32x32x16_bf16 a[224:239], a[196:199], v[84:87], a[224:239]
    v_exp_f32 v49, v49
    v_cvt_pk_bf16_f32 v75, v46, v47
    v_exp_f32 v50, v50
    v_exp_f32 v51, v51
    v_cvt_pk_bf16_f32 v76, v48, v49
    v_exp_f32 v52, v52
    v_mfma_f32_16x16x32_bf16 a[244:247], a[248:251], v[80:83], a[244:247]
    v_exp_f32 v53, v53
    v_cvt_pk_bf16_f32 v77, v50, v51
    v_exp_f32 v54, v54
    v_mfma_f32_16x16x32_bf16 a[244:247], a[248:251], v[84:87], a[244:247]
    s_waitcnt lgkmcnt(0)
    s_add_u32 m0, s12, 16384
    v_exp_f32 v55, v55
    v_cvt_pk_bf16_f32 v78, v52, v53
    v_cvt_pk_bf16_f32 v79, v54, v55
    v_mfma_f32_32x32x16_bf16 v[40:55], a[176:179], a[0:3], 0
    buffer_load_dwordx4 v2, s[28:31], s9 offen sc1 lds
    buffer_load_dwordx4 v2, s[28:31], s9 offen offset:1024 sc1 lds
    v_exp_f32 v56, v56
    v_exp_f32 v57, v57
    v_exp_f32 v58, v58
    v_mfma_f32_32x32x16_bf16 v[40:55], a[180:183], a[4:7], v[40:55]
    s_add_u32 s9, s9, 8192
    buffer_load_dwordx4 a[24:27], v17, s[28:31], s13 offen offset:0 sc1
    buffer_load_dwordx4 a[28:31], v17, s[28:31], s13 offen offset:256 sc1
    v_exp_f32 v59, v59
    v_cvt_pk_bf16_f32 v80, v56, v57
    v_exp_f32 v60, v60
    v_mfma_f32_32x32x16_bf16 a[208:223], a[200:203], v[72:75], a[208:223]
    ds_read_b128 a[192:195], v32 offset:24576
    v_exp_f32 v61, v61
    v_cvt_pk_bf16_f32 v81, v58, v59
    v_exp_f32 v62, v62
    v_exp_f32 v63, v63
    v_cvt_pk_bf16_f32 v82, v60, v61
    v_exp_f32 v64, v64
    v_mfma_f32_32x32x16_bf16 a[208:223], a[204:207], v[76:79], a[208:223]
    buffer_load_dwordx4 a[32:35], v18, s[28:31], s13 offen offset:0 sc1
    buffer_load_dwordx4 a[36:39], v18, s[28:31], s13 offen offset:256 sc1
    v_exp_f32 v65, v65
    v_cvt_pk_bf16_f32 v83, v62, v63
    v_exp_f32 v66, v66
    v_mfma_f32_16x16x32_bf16 a[240:243], a[248:251], v[72:75], a[240:243]
    ds_read_b128 a[196:199], v32 offset:25600
    v_exp_f32 v67, v67
    v_cvt_pk_bf16_f32 v84, v64, v65
    v_exp_f32 v68, v68
    v_exp_f32 v69, v69
    v_mfma_f32_16x16x32_bf16 a[240:243], a[248:251], v[76:79], a[240:243]
    s_add_u32 m0, s12, 24576
    v_cvt_pk_bf16_f32 v85, v66, v67
    v_exp_f32 v70, v70
    v_exp_f32 v71, v71
    v_cvt_pk_bf16_f32 v86, v68, v69
    v_cvt_pk_bf16_f32 v87, v70, v71
    v_mfma_f32_32x32x16_bf16 v[56:71], a[176:179], a[8:11], 0
    buffer_load_dwordx4 v2, s[28:31], s10 offen sc1 lds
    buffer_load_dwordx4 v2, s[28:31], s10 offen offset:1024 sc1 lds
    v_exp_f32 v40, v40
    v_exp_f32 v41, v41
    v_mfma_f32_32x32x16_bf16 v[56:71], a[180:183], a[12:15], v[56:71]
    s_add_u32 s10, s10, 8192
    ds_read_b128 a[184:187], v32 offset:18432
    ds_read_b128 a[188:191], v32 offset:19456
    v_exp_f32 v42, v42
    v_exp_f32 v43, v43
    v_cvt_pk_bf16_f32 v72, v40, v41
    v_exp_f32 v44, v44
    v_exp_f32 v45, v45
    v_mfma_f32_32x32x16_bf16 a[224:239], a[200:203], v[80:83], a[224:239]
    buffer_load_dwordx4 a[40:43], v19, s[28:31], s13 offen offset:0 sc1
    buffer_load_dwordx4 a[44:47], v19, s[28:31], s13 offen offset:256 sc1
    v_cvt_pk_bf16_f32 v73, v42, v43
    v_exp_f32 v46, v46
    v_exp_f32 v47, v47
    v_mfma_f32_32x32x16_bf16 a[224:239], a[204:207], v[84:87], a[224:239]
    s_add_u32 s13, s13, 2048
    v_cvt_pk_bf16_f32 v74, v44, v45
    v_exp_f32 v48, v48
    v_exp_f32 v49, v49
    v_cvt_pk_bf16_f32 v75, v46, v47
    v_exp_f32 v50, v50
    v_exp_f32 v51, v51
    v_mfma_f32_16x16x32_bf16 a[244:247], a[248:251], v[80:83], a[244:247]
    v_cvt_pk_bf16_f32 v76, v48, v49
    v_exp_f32 v52, v52
    v_exp_f32 v53, v53
    v_cvt_pk_bf16_f32 v77, v50, v51
    v_mfma_f32_16x16x32_bf16 a[244:247], a[248:251], v[84:87], a[244:247]
    s_waitcnt lgkmcnt(0)
    v_exp_f32 v54, v54
    v_exp_f32 v55, v55
    v_cvt_pk_bf16_f32 v78, v52, v53
    v_cvt_pk_bf16_f32 v79, v54, v55
    v_mfma_f32_32x32x16_bf16 v[40:55], a[184:187], a[0:3], 0
    buffer_load_dwordx4 a[48:51], v16, s[28:31], s13 offen offset:0 sc1
    buffer_load_dwordx4 a[52:55], v16, s[28:31], s13 offen offset:256 sc1
    v_exp_f32 v56, v56
    v_exp_f32 v57, v57
    v_mfma_f32_32x32x16_bf16 v[40:55], a[188:191], a[4:7], v[40:55]
    ds_read_b128 a[200:203], v32 offset:26624
    v_exp_f32 v58, v58
    v_exp_f32 v59, v59
    v_cvt_pk_bf16_f32 v80, v56, v57
    v_exp_f32 v60, v60
    v_mfma_f32_32x32x16_bf16 a[208:223], a[192:195], v[72:75], a[208:223]
    ds_read_b128 a[204:207], v32 offset:27648
    v_exp_f32 v61, v61
    v_cvt_pk_bf16_f32 v81, v58, v59
    v_exp_f32 v62, v62
    v_exp_f32 v63, v63
    v_cvt_pk_bf16_f32 v82, v60, v61
    v_mfma_f32_32x32x16_bf16 a[208:223], a[196:199], v[76:79], a[208:223]
    v_exp_f32 v64, v64
    v_exp_f32 v65, v65
    v_cvt_pk_bf16_f32 v83, v62, v63
    v_exp_f32 v66, v66
    v_exp_f32 v67, v67
    v_mfma_f32_16x16x32_bf16 a[240:243], a[248:251], v[72:75], a[240:243]
    v_cvt_pk_bf16_f32 v84, v64, v65
    v_exp_f32 v68, v68
    v_exp_f32 v69, v69
    v_cvt_pk_bf16_f32 v85, v66, v67
    v_mfma_f32_16x16x32_bf16 a[240:243], a[248:251], v[76:79], a[240:243]
    v_exp_f32 v70, v70
    v_exp_f32 v71, v71
    v_cvt_pk_bf16_f32 v86, v68, v69
    v_cvt_pk_bf16_f32 v87, v70, v71
    v_mfma_f32_32x32x16_bf16 v[56:71], a[184:187], a[8:11], 0
    buffer_load_dwordx4 a[56:59], v17, s[28:31], s13 offen offset:0 sc1
    buffer_load_dwordx4 a[60:63], v17, s[28:31], s13 offen offset:256 sc1
    v_exp_f32 v40, v40
    v_exp_f32 v41, v41
    v_mfma_f32_32x32x16_bf16 v[56:71], a[188:191], a[12:15], v[56:71]
    ds_read_b128 a[176:179], v32 offset:20480
    v_exp_f32 v42, v42
    v_exp_f32 v43, v43
    v_cvt_pk_bf16_f32 v72, v40, v41
    v_exp_f32 v44, v44
    v_mfma_f32_32x32x16_bf16 a[224:239], a[192:195], v[80:83], a[224:239]
    ds_read_b128 a[180:183], v32 offset:21504
    v_exp_f32 v45, v45
    v_cvt_pk_bf16_f32 v73, v42, v43
    v_exp_f32 v46, v46
    v_exp_f32 v47, v47
    v_cvt_pk_bf16_f32 v74, v44, v45
    v_mfma_f32_32x32x16_bf16 a[224:239], a[196:199], v[84:87], a[224:239]
    v_exp_f32 v48, v48
    v_exp_f32 v49, v49
    v_cvt_pk_bf16_f32 v75, v46, v47
    v_exp_f32 v50, v50
    v_exp_f32 v51, v51
    v_mfma_f32_16x16x32_bf16 a[244:247], a[248:251], v[80:83], a[244:247]
    v_cvt_pk_bf16_f32 v76, v48, v49
    v_exp_f32 v52, v52
    v_exp_f32 v53, v53
    v_cvt_pk_bf16_f32 v77, v50, v51
    v_mfma_f32_16x16x32_bf16 a[244:247], a[248:251], v[84:87], a[244:247]
    s_waitcnt lgkmcnt(0)
    v_exp_f32 v54, v54
    v_exp_f32 v55, v55
    v_cvt_pk_bf16_f32 v78, v52, v53
    v_cvt_pk_bf16_f32 v79, v54, v55
    v_mfma_f32_32x32x16_bf16 v[40:55], a[176:179], a[0:3], 0
    buffer_load_dwordx4 a[64:67], v18, s[28:31], s13 offen offset:0 sc1
    buffer_load_dwordx4 a[68:71], v18, s[28:31], s13 offen offset:256 sc1
    v_exp_f32 v56, v56
    v_exp_f32 v57, v57
    v_mfma_f32_32x32x16_bf16 v[40:55], a[180:183], a[4:7], v[40:55]
    buffer_load_dwordx4 a[72:75], v19, s[28:31], s13 offen offset:0 sc1
    buffer_load_dwordx4 a[76:79], v19, s[28:31], s13 offen offset:256 sc1
    v_exp_f32 v58, v58
    v_exp_f32 v59, v59
    v_cvt_pk_bf16_f32 v80, v56, v57
    v_mfma_f32_32x32x16_bf16 a[208:223], a[200:203], v[72:75], a[208:223]
    s_add_u32 s13, s13, 2048
    ds_read_b128 a[192:195], v32 offset:28672
    v_exp_f32 v60, v60
    v_exp_f32 v61, v61
    v_cvt_pk_bf16_f32 v81, v58, v59
    v_exp_f32 v62, v62
    v_exp_f32 v63, v63
    v_mfma_f32_32x32x16_bf16 a[208:223], a[204:207], v[76:79], a[208:223]
    ds_read_b128 a[196:199], v32 offset:29696
    v_cvt_pk_bf16_f32 v82, v60, v61
    v_exp_f32 v64, v64
    v_exp_f32 v65, v65
    v_cvt_pk_bf16_f32 v83, v62, v63
    v_exp_f32 v66, v66
    v_exp_f32 v67, v67
    v_mfma_f32_16x16x32_bf16 a[240:243], a[248:251], v[72:75], a[240:243]
    v_cvt_pk_bf16_f32 v84, v64, v65
    v_exp_f32 v68, v68
    v_exp_f32 v69, v69
    v_cvt_pk_bf16_f32 v85, v66, v67
    v_mfma_f32_16x16x32_bf16 a[240:243], a[248:251], v[76:79], a[240:243]
    v_exp_f32 v70, v70
    v_exp_f32 v71, v71
    v_cvt_pk_bf16_f32 v86, v68, v69
    v_cvt_pk_bf16_f32 v87, v70, v71
    v_mfma_f32_32x32x16_bf16 v[56:71], a[176:179], a[8:11], 0
    buffer_load_dwordx4 a[80:83], v16, s[28:31], s13 offen offset:0 sc1
    buffer_load_dwordx4 a[84:87], v16, s[28:31], s13 offen offset:256 sc1
    v_exp_f32 v40, v40
    v_exp_f32 v41, v41
    v_mfma_f32_32x32x16_bf16 v[56:71], a[180:183], a[12:15], v[56:71]
    ds_read_b128 a[184:187], v32 offset:22528
    v_exp_f32 v42, v42
    v_exp_f32 v43, v43
    v_cvt_pk_bf16_f32 v72, v40, v41
    v_exp_f32 v44, v44
    v_mfma_f32_32x32x16_bf16 a[224:239], a[200:203], v[80:83], a[224:239]
    ds_read_b128 a[188:191], v32 offset:23552
    v_exp_f32 v45, v45
    v_cvt_pk_bf16_f32 v73, v42, v43
    v_exp_f32 v46, v46
    v_exp_f32 v47, v47
    v_cvt_pk_bf16_f32 v74, v44, v45
    v_mfma_f32_32x32x16_bf16 a[224:239], a[204:207], v[84:87], a[224:239]
    v_exp_f32 v48, v48
    v_exp_f32 v49, v49
    v_cvt_pk_bf16_f32 v75, v46, v47
    v_exp_f32 v50, v50
    v_exp_f32 v51, v51
    v_mfma_f32_16x16x32_bf16 a[244:247], a[248:251], v[80:83], a[244:247]
    v_cvt_pk_bf16_f32 v76, v48, v49
    v_exp_f32 v52, v52
    v_exp_f32 v53, v53
    v_cvt_pk_bf16_f32 v77, v50, v51
    v_mfma_f32_16x16x32_bf16 a[244:247], a[248:251], v[84:87], a[244:247]
    s_waitcnt lgkmcnt(0)
    v_exp_f32 v54, v54
    v_exp_f32 v55, v55
    v_cvt_pk_bf16_f32 v78, v52, v53
    v_cvt_pk_bf16_f32 v79, v54, v55
    v_mfma_f32_32x32x16_bf16 v[40:55], a[184:187], a[0:3], 0
    buffer_load_dwordx4 a[88:91], v17, s[28:31], s13 offen offset:0 sc1
    buffer_load_dwordx4 a[92:95], v17, s[28:31], s13 offen offset:256 sc1
    v_exp_f32 v56, v56
    v_exp_f32 v57, v57
    v_mfma_f32_32x32x16_bf16 v[40:55], a[188:191], a[4:7], v[40:55]
    ds_read_b128 a[200:203], v32 offset:30720
    v_exp_f32 v58, v58
    v_exp_f32 v59, v59
    v_cvt_pk_bf16_f32 v80, v56, v57
    v_exp_f32 v60, v60
    v_exp_f32 v61, v61
    v_mfma_f32_32x32x16_bf16 a[208:223], a[192:195], v[72:75], a[208:223]
    ds_read_b128 a[204:207], v32 offset:31744
    v_cvt_pk_bf16_f32 v81, v58, v59
    v_exp_f32 v62, v62
    v_exp_f32 v63, v63
    v_cvt_pk_bf16_f32 v82, v60, v61
    v_exp_f32 v64, v64
    v_exp_f32 v65, v65
    v_mfma_f32_32x32x16_bf16 a[208:223], a[196:199], v[76:79], a[208:223]
    v_cvt_pk_bf16_f32 v83, v62, v63
    v_exp_f32 v66, v66
    v_exp_f32 v67, v67
    v_cvt_pk_bf16_f32 v84, v64, v65
    v_exp_f32 v68, v68
    v_exp_f32 v69, v69
    v_mfma_f32_16x16x32_bf16 a[240:243], a[248:251], v[72:75], a[240:243]
    v_cvt_pk_bf16_f32 v85, v66, v67
    v_exp_f32 v70, v70
    v_exp_f32 v71, v71
    v_cvt_pk_bf16_f32 v86, v68, v69
    v_mfma_f32_16x16x32_bf16 a[240:243], a[248:251], v[76:79], a[240:243]
    s_waitcnt vmcnt(33)
    s_barrier
    v_cvt_pk_bf16_f32 v87, v70, v71
    v_xor_b32 v32, 0x8000, v32
    v_mfma_f32_32x32x16_bf16 v[56:71], a[184:187], a[8:11], 0
    buffer_load_dwordx4 a[96:99], v18, s[28:31], s13 offen offset:0 sc1
    buffer_load_dwordx4 a[100:103], v18, s[28:31], s13 offen offset:256 sc1
    v_exp_f32 v40, v40
    v_exp_f32 v41, v41
    v_mfma_f32_32x32x16_bf16 v[56:71], a[188:191], a[12:15], v[56:71]
    buffer_load_dwordx4 a[104:107], v19, s[28:31], s13 offen offset:0 sc1
    buffer_load_dwordx4 a[108:111], v19, s[28:31], s13 offen offset:256 sc1
    v_exp_f32 v42, v42
    v_exp_f32 v43, v43
    v_cvt_pk_bf16_f32 v72, v40, v41
    v_mfma_f32_32x32x16_bf16 a[224:239], a[192:195], v[80:83], a[224:239]
    s_add_u32 s13, s13, 2048
    ds_read_b128 a[176:179], v32 offset:0
    ds_read_b128 a[180:183], v32 offset:1024
    v_exp_f32 v44, v44
    v_exp_f32 v45, v45
    v_cvt_pk_bf16_f32 v73, v42, v43
    v_exp_f32 v46, v46
    v_exp_f32 v47, v47
    v_mfma_f32_32x32x16_bf16 a[224:239], a[196:199], v[84:87], a[224:239]
    v_cvt_pk_bf16_f32 v74, v44, v45
    v_exp_f32 v48, v48
    v_exp_f32 v49, v49
    v_cvt_pk_bf16_f32 v75, v46, v47
    v_exp_f32 v50, v50
    v_exp_f32 v51, v51
    v_mfma_f32_16x16x32_bf16 a[244:247], a[248:251], v[80:83], a[244:247]
    v_cvt_pk_bf16_f32 v76, v48, v49
    v_exp_f32 v52, v52
    v_exp_f32 v53, v53
    v_cvt_pk_bf16_f32 v77, v50, v51
    v_mfma_f32_16x16x32_bf16 a[244:247], a[248:251], v[84:87], a[244:247]
    s_waitcnt lgkmcnt(0)
    v_exp_f32 v54, v54
    v_exp_f32 v55, v55
    v_cvt_pk_bf16_f32 v78, v52, v53
    v_cvt_pk_bf16_f32 v79, v54, v55
    v_mfma_f32_32x32x16_bf16 v[40:55], a[176:179], a[0:3], 0
    ds_read_b128 a[192:195], v32 offset:8192
    v_exp_f32 v56, v56
    v_exp_f32 v57, v57
    v_exp_f32 v58, v58
    v_mfma_f32_32x32x16_bf16 v[40:55], a[180:183], a[4:7], v[40:55]
    ds_read_b128 a[196:199], v32 offset:9216
    v_exp_f32 v59, v59
    v_cvt_pk_bf16_f32 v80, v56, v57
    v_exp_f32 v60, v60
    v_exp_f32 v61, v61
    v_cvt_pk_bf16_f32 v81, v58, v59
    v_mfma_f32_32x32x16_bf16 a[208:223], a[200:203], v[72:75], a[208:223]
    v_exp_f32 v62, v62
    v_exp_f32 v63, v63
    v_cvt_pk_bf16_f32 v82, v60, v61
    v_exp_f32 v64, v64
    v_exp_f32 v65, v65
    v_mfma_f32_32x32x16_bf16 a[208:223], a[204:207], v[76:79], a[208:223]
    v_cvt_pk_bf16_f32 v83, v62, v63
    v_exp_f32 v66, v66
    v_exp_f32 v67, v67
    v_cvt_pk_bf16_f32 v84, v64, v65
    v_exp_f32 v68, v68
    v_mfma_f32_16x16x32_bf16 a[240:243], a[248:251], v[72:75], a[240:243]
    v_exp_f32 v69, v69
    v_cvt_pk_bf16_f32 v85, v66, v67
    v_exp_f32 v70, v70
    v_mfma_f32_16x16x32_bf16 a[240:243], a[248:251], v[76:79], a[240:243]
    v_exp_f32 v71, v71
    v_cvt_pk_bf16_f32 v86, v68, v69
    v_cvt_pk_bf16_f32 v87, v70, v71
    buffer_load_dword v34, v248, s[28:31], s41 offen offset:0 sc1
    buffer_load_dword v35, v248, s[28:31], s41 offen offset:128 sc1
    buffer_load_dword v240, v249, s[28:31], s62 offen offset:0 sc1
    buffer_load_dword v241, v249, s[28:31], s62 offen offset:64 sc1
    buffer_load_dword v242, v250, s[28:31], s62 offen offset:0 sc1
    buffer_load_dword v243, v250, s[28:31], s62 offen offset:64 sc1
    buffer_load_dword v244, v251, s[28:31], s62 offen offset:0 sc1
    buffer_load_dword v245, v251, s[28:31], s62 offen offset:64 sc1
    buffer_load_dword v246, v252, s[28:31], s62 offen offset:0 sc1
    buffer_load_dword v247, v252, s[28:31], s62 offen offset:64 sc1
    s_waitcnt vmcnt(59)
    ds_read_b64_tr_b16 a[144:145], v24 offset:0
    ds_read_b64_tr_b16 a[146:147], v24 offset:512
    ds_read_b64_tr_b16 a[148:149], v25 offset:0
    ds_read_b64_tr_b16 a[150:151], v25 offset:512
    ds_read_b64_tr_b16 a[152:153], v26 offset:0
    ds_read_b64_tr_b16 a[154:155], v26 offset:512
    ds_read_b64_tr_b16 a[156:157], v27 offset:0
    ds_read_b64_tr_b16 a[158:159], v27 offset:512
.p2align 6
k5_loop:
    v_mfma_f32_32x32x16_bf16 v[56:71], a[176:179], a[8:11], 0
    s_waitcnt vmcnt(20) lgkmcnt(0)
    ds_read_b128 a[184:187], v32 offset:2048
    v_exp_f32 v40, v40
    v_exp_f32 v41, v41
    v_exp_f32 v42, v42
    v_mfma_f32_16x16x32_bf16 v[88:91], a[144:147], a[16:19], v[88:91]
    ds_read_b128 a[188:191], v32 offset:3072
    v_exp_f32 v43, v43
    v_mfma_f32_16x16x32_bf16 v[92:95], a[148:151], a[16:19], v[92:95]
    s_add_u32 m0, s11, 0
    ds_read_b64_tr_b16 a[160:161], v24 offset:4096
    v_cvt_pk_bf16_f32 v72, v40, v41
    v_mfma_f32_32x32x16_bf16 v[56:71], a[180:183], a[12:15], v[56:71]
    buffer_load_dwordx4 v2, s[28:31], s9 offen sc1 lds
    buffer_load_dwordx4 v2, s[28:31], s9 offen offset:1024 sc1 lds
    v_exp_f32 v44, v44
    v_mfma_f32_16x16x32_bf16 v[96:99], a[152:155], a[16:19], v[96:99]
    s_add_u32 s9, s9, 8192
    v_exp_f32 v45, v45
    v_cvt_pk_bf16_f32 v73, v42, v43
    v_mfma_f32_16x16x32_bf16 v[100:103], a[156:159], a[16:19], v[100:103]
    ds_read_b64_tr_b16 a[162:163], v24 offset:4608
    v_exp_f32 v46, v46
    v_mfma_f32_16x16x32_bf16 a[244:247], a[248:251], v[80:83], a[244:247]
    s_add_u32 m0, s15, 12288
    v_exp_f32 v47, v47
    v_cvt_pk_bf16_f32 v74, v44, v45
    v_mfma_f32_32x32x16_bf16 a[224:239], a[200:203], v[80:83], a[224:239]
    buffer_load_dwordx4 v20, s[64:67], s14 offen offset:0 lds
    buffer_load_dwordx4 v21, s[64:67], s14 offen offset:1024 lds
    v_exp_f32 v48, v48
    v_mfma_f32_16x16x32_bf16 v[104:107], a[144:147], a[20:23], v[104:107]
    v_exp_f32 v49, v49
    v_mfma_f32_16x16x32_bf16 v[108:111], a[148:151], a[20:23], v[108:111]
    v_cvt_pk_bf16_f32 v75, v46, v47
    v_exp_f32 v50, v50
    v_mfma_f32_32x32x16_bf16 a[224:239], a[204:207], v[84:87], a[224:239]
    v_exp_f32 v51, v51
    v_cvt_pk_bf16_f32 v76, v48, v49
    v_exp_f32 v52, v52
    v_exp_f32 v53, v53
    v_mfma_f32_16x16x32_bf16 v[112:115], a[152:155], a[20:23], v[112:115]
    v_cvt_pk_bf16_f32 v77, v50, v51
    v_exp_f32 v54, v54
    v_mfma_f32_16x16x32_bf16 v[116:119], a[156:159], a[20:23], v[116:119]
    v_exp_f32 v55, v55
    v_mfma_f32_16x16x32_bf16 a[244:247], a[248:251], v[84:87], a[244:247]
    s_waitcnt lgkmcnt(2)
    v_cvt_pk_bf16_f32 v78, v52, v53
    v_cvt_pk_bf16_f32 v79, v54, v55
    v_mfma_f32_32x32x16_bf16 v[40:55], a[184:187], a[0:3], 0
    buffer_load_dwordx4 v22, s[64:67], s14 offen offset:2048 lds
    buffer_load_dwordx4 v23, s[64:67], s14 offen offset:3072 lds
    v_exp_f32 v56, v56
    v_mfma_f32_16x16x32_bf16 v[120:123], a[144:147], a[24:27], v[120:123]
    s_add_u32 s14, s14, 65536
    ds_read_b128 a[200:203], v32 offset:10240
    v_exp_f32 v57, v57
    v_mfma_f32_16x16x32_bf16 v[124:127], a[148:151], a[24:27], v[124:127]
    ds_read_b128 a[204:207], v32 offset:11264
    v_exp_f32 v58, v58
    v_mfma_f32_32x32x16_bf16 v[40:55], a[188:191], a[4:7], v[40:55]
    buffer_load_dwordx4 a[112:115], v16, s[28:31], s13 offen offset:0 sc1
    buffer_load_dwordx4 a[116:119], v16, s[28:31], s13 offen offset:256 sc1
    v_exp_f32 v59, v59
    v_mfma_f32_16x16x32_bf16 v[128:131], a[152:155], a[24:27], v[128:131]
    ds_read_b64_tr_b16 a[164:165], v25 offset:4096
    v_cvt_pk_bf16_f32 v80, v56, v57
    v_mfma_f32_16x16x32_bf16 v[132:135], a[156:159], a[24:27], v[132:135]
    ds_read_b64_tr_b16 a[166:167], v25 offset:4608
    v_exp_f32 v60, v60
    v_mfma_f32_16x16x32_bf16 a[240:243], a[248:251], v[72:75], a[240:243]
    v_exp_f32 v61, v61
    v_cvt_pk_bf16_f32 v81, v58, v59
    v_mfma_f32_32x32x16_bf16 a[208:223], a[192:195], v[72:75], a[208:223]
    v_exp_f32 v62, v62
    v_exp_f32 v63, v63
    v_cvt_pk_bf16_f32 v82, v60, v61
    v_exp_f32 v64, v64
    v_mfma_f32_16x16x32_bf16 v[136:139], a[144:147], a[28:31], v[136:139]
    ds_read_b64_tr_b16 a[168:169], v26 offset:4096
    v_exp_f32 v65, v65
    v_mfma_f32_16x16x32_bf16 v[140:143], a[148:151], a[28:31], v[140:143]
    v_cvt_pk_bf16_f32 v83, v62, v63
    v_exp_f32 v66, v66
    v_mfma_f32_32x32x16_bf16 a[208:223], a[196:199], v[76:79], a[208:223]
    v_exp_f32 v67, v67
    v_cvt_pk_bf16_f32 v84, v64, v65
    v_exp_f32 v68, v68
    v_exp_f32 v69, v69
    v_mfma_f32_16x16x32_bf16 v[144:147], a[152:155], a[28:31], v[144:147]
    v_cvt_pk_bf16_f32 v85, v66, v67
    v_exp_f32 v70, v70
    v_mfma_f32_16x16x32_bf16 v[148:151], a[156:159], a[28:31], v[148:151]
    v_exp_f32 v71, v71
    v_mfma_f32_16x16x32_bf16 a[240:243], a[248:251], v[76:79], a[240:243]
    s_add_u32 m0, s11, 8192
    v_cvt_pk_bf16_f32 v86, v68, v69
    v_cvt_pk_bf16_f32 v87, v70, v71
    v_mfma_f32_32x32x16_bf16 v[56:71], a[184:187], a[8:11], 0
    buffer_load_dwordx4 v2, s[28:31], s10 offen sc1 lds
    buffer_load_dwordx4 v2, s[28:31], s10 offen offset:1024 sc1 lds
    v_exp_f32 v40, v40
    v_mfma_f32_16x16x32_bf16 v[152:155], a[144:147], a[32:35], v[152:155]
    s_add_u32 s10, s10, 8192
    ds_read_b128 a[176:179], v32 offset:4096
    v_exp_f32 v41, v41
    v_mfma_f32_16x16x32_bf16 v[156:159], a[148:151], a[32:35], v[156:159]
    s_xor_b32 s11, s11, 0x8000
    ds_read_b128 a[180:183], v32 offset:5120
    v_exp_f32 v42, v42
    v_mfma_f32_32x32x16_bf16 v[56:71], a[188:191], a[12:15], v[56:71]
    s_xor_b32 s12, s12, 0x8000
    ds_read_b64_tr_b16 a[170:171], v26 offset:4608
    v_exp_f32 v43, v43
    v_cvt_pk_bf16_f32 v72, v40, v41
    v_exp_f32 v44, v44
    v_mfma_f32_16x16x32_bf16 v[160:163], a[152:155], a[32:35], v[160:163]
    ds_read_b64_tr_b16 a[172:173], v27 offset:4096
    v_exp_f32 v45, v45
    v_mfma_f32_16x16x32_bf16 v[164:167], a[156:159], a[32:35], v[164:167]
    v_cvt_pk_bf16_f32 v73, v42, v43
    v_exp_f32 v46, v46
    v_mfma_f32_16x16x32_bf16 a[244:247], a[248:251], v[80:83], a[244:247]
    v_exp_f32 v47, v47
    v_cvt_pk_bf16_f32 v74, v44, v45
    v_mfma_f32_32x32x16_bf16 a[224:239], a[192:195], v[80:83], a[224:239]
    buffer_load_dwordx4 a[120:123], v17, s[28:31], s13 offen offset:0 sc1
    buffer_load_dwordx4 a[124:127], v17, s[28:31], s13 offen offset:256 sc1
    v_exp_f32 v48, v48
    v_mfma_f32_16x16x32_bf16 v[168:171], a[144:147], a[36:39], v[168:171]
    v_exp_f32 v49, v49
    v_mfma_f32_16x16x32_bf16 v[172:175], a[148:151], a[36:39], v[172:175]
    v_cvt_pk_bf16_f32 v75, v46, v47
    v_exp_f32 v50, v50
    v_mfma_f32_32x32x16_bf16 a[224:239], a[196:199], v[84:87], a[224:239]
    v_exp_f32 v51, v51
    v_cvt_pk_bf16_f32 v76, v48, v49
    v_exp_f32 v52, v52
    v_exp_f32 v53, v53
    v_mfma_f32_16x16x32_bf16 v[176:179], a[152:155], a[36:39], v[176:179]
    v_cvt_pk_bf16_f32 v77, v50, v51
    v_exp_f32 v54, v54
    v_mfma_f32_16x16x32_bf16 v[180:183], a[156:159], a[36:39], v[180:183]
    v_exp_f32 v55, v55
    v_mfma_f32_16x16x32_bf16 a[244:247], a[248:251], v[84:87], a[244:247]
    s_waitcnt lgkmcnt(2)
    v_cvt_pk_bf16_f32 v78, v52, v53
    v_cvt_pk_bf16_f32 v79, v54, v55
    v_mfma_f32_32x32x16_bf16 v[40:55], a[176:179], a[0:3], 0
    buffer_load_dwordx4 a[128:131], v18, s[28:31], s13 offen offset:0 sc1
    buffer_load_dwordx4 a[132:135], v18, s[28:31], s13 offen offset:256 sc1
    v_exp_f32 v56, v56
    v_mfma_f32_16x16x32_bf16 v[184:187], a[144:147], a[40:43], v[184:187]
    ds_read_b128 a[192:195], v32 offset:12288
    v_exp_f32 v57, v57
    v_mfma_f32_16x16x32_bf16 v[188:191], a[148:151], a[40:43], v[188:191]
    ds_read_b128 a[196:199], v32 offset:13312
    v_exp_f32 v58, v58
    v_mfma_f32_32x32x16_bf16 v[40:55], a[180:183], a[4:7], v[40:55]
    buffer_load_dwordx4 a[136:139], v19, s[28:31], s13 offen offset:0 sc1
    buffer_load_dwordx4 a[140:143], v19, s[28:31], s13 offen offset:256 sc1
    v_exp_f32 v59, v59
    v_mfma_f32_16x16x32_bf16 v[192:195], a[152:155], a[40:43], v[192:195]
    s_add_u32 s13, s13, 2048
    ds_read_b64_tr_b16 a[174:175], v27 offset:4608
    v_cvt_pk_bf16_f32 v80, v56, v57
    v_mfma_f32_16x16x32_bf16 v[196:199], a[156:159], a[40:43], v[196:199]
    v_exp_f32 v60, v60
    v_mfma_f32_16x16x32_bf16 a[240:243], a[248:251], v[72:75], a[240:243]
    v_exp_f32 v61, v61
    v_cvt_pk_bf16_f32 v81, v58, v59
    v_mfma_f32_32x32x16_bf16 a[208:223], a[200:203], v[72:75], a[208:223]
    v_exp_f32 v62, v62
    v_exp_f32 v63, v63
    v_cvt_pk_bf16_f32 v82, v60, v61
    v_exp_f32 v64, v64
    v_mfma_f32_16x16x32_bf16 v[200:203], a[144:147], a[44:47], v[200:203]
    v_exp_f32 v65, v65
    v_mfma_f32_16x16x32_bf16 v[204:207], a[148:151], a[44:47], v[204:207]
    v_cvt_pk_bf16_f32 v83, v62, v63
    v_exp_f32 v66, v66
    v_mfma_f32_32x32x16_bf16 a[208:223], a[204:207], v[76:79], a[208:223]
    v_exp_f32 v67, v67
    v_cvt_pk_bf16_f32 v84, v64, v65
    v_exp_f32 v68, v68
    v_exp_f32 v69, v69
    v_mfma_f32_16x16x32_bf16 v[208:211], a[152:155], a[44:47], v[208:211]
    v_cvt_pk_bf16_f32 v85, v66, v67
    v_exp_f32 v70, v70
    v_mfma_f32_16x16x32_bf16 v[212:215], a[156:159], a[44:47], v[212:215]
    v_exp_f32 v71, v71
    v_mfma_f32_16x16x32_bf16 a[240:243], a[248:251], v[76:79], a[240:243]
    v_cvt_pk_bf16_f32 v86, v68, v69
    v_cvt_pk_bf16_f32 v87, v70, v71
    v_mfma_f32_32x32x16_bf16 v[56:71], a[176:179], a[8:11], 0
    s_waitcnt vmcnt(24) lgkmcnt(0)
    ds_read_b128 a[184:187], v32 offset:6144
    v_exp_f32 v40, v40
    v_exp_f32 v41, v41
    v_exp_f32 v42, v42
    v_mfma_f32_16x16x32_bf16 v[88:91], a[160:163], a[48:51], v[88:91]
    ds_read_b128 a[188:191], v32 offset:7168
    v_exp_f32 v43, v43
    v_mfma_f32_16x16x32_bf16 v[92:95], a[164:167], a[48:51], v[92:95]
    s_add_u32 m0, s15, 0
    ds_read_b64_tr_b16 a[144:145], v24 offset:8192
    v_cvt_pk_bf16_f32 v72, v40, v41
    v_mfma_f32_32x32x16_bf16 v[56:71], a[180:183], a[12:15], v[56:71]
    buffer_load_dwordx4 v20, s[64:67], s14 offen offset:0 lds
    buffer_load_dwordx4 v21, s[64:67], s14 offen offset:1024 lds
    v_exp_f32 v44, v44
    v_mfma_f32_16x16x32_bf16 v[96:99], a[168:171], a[48:51], v[96:99]
    v_exp_f32 v45, v45
    v_cvt_pk_bf16_f32 v73, v42, v43
    v_mfma_f32_16x16x32_bf16 v[100:103], a[172:175], a[48:51], v[100:103]
    ds_read_b64_tr_b16 a[146:147], v24 offset:8704
    v_exp_f32 v46, v46
    v_mfma_f32_16x16x32_bf16 a[244:247], a[248:251], v[80:83], a[244:247]
    v_exp_f32 v47, v47
    v_cvt_pk_bf16_f32 v74, v44, v45
    v_mfma_f32_32x32x16_bf16 a[224:239], a[200:203], v[80:83], a[224:239]
    v_exp_f32 v48, v48
    v_exp_f32 v49, v49
    v_cvt_pk_bf16_f32 v75, v46, v47
    v_exp_f32 v50, v50
    v_mfma_f32_16x16x32_bf16 v[104:107], a[160:163], a[52:55], v[104:107]
    v_exp_f32 v51, v51
    v_mfma_f32_16x16x32_bf16 v[108:111], a[164:167], a[52:55], v[108:111]
    v_cvt_pk_bf16_f32 v76, v48, v49
    v_exp_f32 v52, v52
    v_mfma_f32_32x32x16_bf16 a[224:239], a[204:207], v[84:87], a[224:239]
    buffer_load_dwordx4 v22, s[64:67], s14 offen offset:2048 lds
    buffer_load_dwordx4 v23, s[64:67], s14 offen offset:3072 lds
    v_exp_f32 v53, v53
    v_mfma_f32_16x16x32_bf16 v[112:115], a[168:171], a[52:55], v[112:115]
    s_add_u32 s14, s14, 65536
    v_cvt_pk_bf16_f32 v77, v50, v51
    v_exp_f32 v54, v54
    v_mfma_f32_16x16x32_bf16 v[116:119], a[172:175], a[52:55], v[116:119]
    v_exp_f32 v55, v55
    v_mfma_f32_16x16x32_bf16 a[244:247], a[248:251], v[84:87], a[244:247]
    s_waitcnt lgkmcnt(2)
    v_cvt_pk_bf16_f32 v78, v52, v53
    v_cvt_pk_bf16_f32 v79, v54, v55
    v_mfma_f32_32x32x16_bf16 v[40:55], a[184:187], a[0:3], 0
    ds_read_b128 a[200:203], v32 offset:14336
    v_exp_f32 v56, v56
    v_exp_f32 v57, v57
    v_exp_f32 v58, v58
    v_mfma_f32_16x16x32_bf16 v[120:123], a[160:163], a[56:59], v[120:123]
    ds_read_b128 a[204:207], v32 offset:15360
    v_exp_f32 v59, v59
    v_mfma_f32_16x16x32_bf16 v[124:127], a[164:167], a[56:59], v[124:127]
    ds_read_b64_tr_b16 a[148:149], v25 offset:8192
    v_cvt_pk_bf16_f32 v80, v56, v57
    v_mfma_f32_32x32x16_bf16 v[40:55], a[188:191], a[4:7], v[40:55]
    buffer_load_dwordx4 a[16:19], v16, s[28:31], s13 offen offset:0 sc1
    buffer_load_dwordx4 a[20:23], v16, s[28:31], s13 offen offset:256 sc1
    v_exp_f32 v60, v60
    v_mfma_f32_16x16x32_bf16 v[128:131], a[168:171], a[56:59], v[128:131]
    ds_read_b64_tr_b16 a[150:151], v25 offset:8704
    v_exp_f32 v61, v61
    v_mfma_f32_16x16x32_bf16 v[132:135], a[172:175], a[56:59], v[132:135]
    v_cvt_pk_bf16_f32 v81, v58, v59
    v_exp_f32 v62, v62
    v_mfma_f32_16x16x32_bf16 a[240:243], a[248:251], v[72:75], a[240:243]
    v_exp_f32 v63, v63
    v_mfma_f32_32x32x16_bf16 a[208:223], a[192:195], v[72:75], a[208:223]
    v_cvt_pk_bf16_f32 v82, v60, v61
    v_exp_f32 v64, v64
    v_exp_f32 v65, v65
    v_cvt_pk_bf16_f32 v83, v62, v63
    v_mfma_f32_16x16x32_bf16 v[136:139], a[160:163], a[60:63], v[136:139]
    ds_read_b64_tr_b16 a[152:153], v26 offset:8192
    v_exp_f32 v66, v66
    v_mfma_f32_16x16x32_bf16 v[140:143], a[164:167], a[60:63], v[140:143]
    v_exp_f32 v67, v67
    v_cvt_pk_bf16_f32 v84, v64, v65
    v_mfma_f32_32x32x16_bf16 a[208:223], a[196:199], v[76:79], a[208:223]
    v_exp_f32 v68, v68
    v_exp_f32 v69, v69
    v_cvt_pk_bf16_f32 v85, v66, v67
    v_exp_f32 v70, v70
    v_mfma_f32_16x16x32_bf16 v[144:147], a[168:171], a[60:63], v[144:147]
    v_exp_f32 v71, v71
    v_mfma_f32_16x16x32_bf16 v[148:151], a[172:175], a[60:63], v[148:151]
    v_cvt_pk_bf16_f32 v86, v68, v69
    v_cvt_pk_bf16_f32 v87, v70, v71
    v_mfma_f32_16x16x32_bf16 a[240:243], a[248:251], v[76:79], a[240:243]
    s_waitcnt vmcnt(46)
    s_barrier
    v_mfma_f32_32x32x16_bf16 v[56:71], a[184:187], a[8:11], 0
    buffer_load_dwordx4 a[24:27], v17, s[28:31], s13 offen offset:0 sc1
    buffer_load_dwordx4 a[28:31], v17, s[28:31], s13 offen offset:256 sc1
    v_exp_f32 v40, v40
    v_mfma_f32_16x16x32_bf16 v[152:155], a[160:163], a[64:67], v[152:155]
    ds_read_b128 a[176:179], v32 offset:16384
    v_exp_f32 v41, v41
    v_mfma_f32_16x16x32_bf16 v[156:159], a[164:167], a[64:67], v[156:159]
    ds_read_b128 a[180:183], v32 offset:17408
    v_exp_f32 v42, v42
    v_mfma_f32_32x32x16_bf16 v[56:71], a[188:191], a[12:15], v[56:71]
    ds_read_b64_tr_b16 a[154:155], v26 offset:8704
    v_exp_f32 v43, v43
    v_cvt_pk_bf16_f32 v72, v40, v41
    v_exp_f32 v44, v44
    v_mfma_f32_16x16x32_bf16 v[160:163], a[168:171], a[64:67], v[160:163]
    ds_read_b64_tr_b16 a[156:157], v27 offset:8192
    v_exp_f32 v45, v45
    v_mfma_f32_16x16x32_bf16 v[164:167], a[172:175], a[64:67], v[164:167]
    v_cvt_pk_bf16_f32 v73, v42, v43
    v_exp_f32 v46, v46
    v_mfma_f32_16x16x32_bf16 a[244:247], a[248:251], v[80:83], a[244:247]
    v_exp_f32 v47, v47
    v_cvt_pk_bf16_f32 v74, v44, v45
    v_mfma_f32_32x32x16_bf16 a[224:239], a[192:195], v[80:83], a[224:239]
    buffer_load_dwordx4 a[32:35], v18, s[28:31], s13 offen offset:0 sc1
    buffer_load_dwordx4 a[36:39], v18, s[28:31], s13 offen offset:256 sc1
    v_exp_f32 v48, v48
    v_mfma_f32_16x16x32_bf16 v[168:171], a[160:163], a[68:71], v[168:171]
    v_exp_f32 v49, v49
    v_mfma_f32_16x16x32_bf16 v[172:175], a[164:167], a[68:71], v[172:175]
    v_cvt_pk_bf16_f32 v75, v46, v47
    v_exp_f32 v50, v50
    v_mfma_f32_32x32x16_bf16 a[224:239], a[196:199], v[84:87], a[224:239]
    v_exp_f32 v51, v51
    v_cvt_pk_bf16_f32 v76, v48, v49
    v_exp_f32 v52, v52
    v_exp_f32 v53, v53
    v_mfma_f32_16x16x32_bf16 v[176:179], a[168:171], a[68:71], v[176:179]
    v_cvt_pk_bf16_f32 v77, v50, v51
    v_exp_f32 v54, v54
    v_mfma_f32_16x16x32_bf16 v[180:183], a[172:175], a[68:71], v[180:183]
    v_exp_f32 v55, v55
    v_mfma_f32_16x16x32_bf16 a[244:247], a[248:251], v[84:87], a[244:247]
    s_waitcnt lgkmcnt(2)
    s_add_u32 m0, s12, 16384
    v_cvt_pk_bf16_f32 v78, v52, v53
    v_cvt_pk_bf16_f32 v79, v54, v55
    v_mfma_f32_32x32x16_bf16 v[40:55], a[176:179], a[0:3], 0
    buffer_load_dwordx4 v2, s[28:31], s9 offen sc1 lds
    buffer_load_dwordx4 v2, s[28:31], s9 offen offset:1024 sc1 lds
    v_exp_f32 v56, v56
    v_mfma_f32_16x16x32_bf16 v[184:187], a[160:163], a[72:75], v[184:187]
    s_add_u32 s9, s9, 8192
    ds_read_b128 a[192:195], v32 offset:24576
    v_exp_f32 v57, v57
    v_mfma_f32_16x16x32_bf16 v[188:191], a[164:167], a[72:75], v[188:191]
    ds_read_b128 a[196:199], v32 offset:25600
    v_exp_f32 v58, v58
    v_mfma_f32_32x32x16_bf16 v[40:55], a[180:183], a[4:7], v[40:55]
    buffer_load_dwordx4 a[40:43], v19, s[28:31], s13 offen offset:0 sc1
    buffer_load_dwordx4 a[44:47], v19, s[28:31], s13 offen offset:256 sc1
    v_exp_f32 v59, v59
    v_mfma_f32_16x16x32_bf16 v[192:195], a[168:171], a[72:75], v[192:195]
    s_add_u32 s13, s13, 2048
    ds_read_b64_tr_b16 a[158:159], v27 offset:8704
    v_cvt_pk_bf16_f32 v80, v56, v57
    v_mfma_f32_16x16x32_bf16 v[196:199], a[172:175], a[72:75], v[196:199]
    v_exp_f32 v60, v60
    v_mfma_f32_16x16x32_bf16 a[240:243], a[248:251], v[72:75], a[240:243]
    v_exp_f32 v61, v61
    v_cvt_pk_bf16_f32 v81, v58, v59
    v_mfma_f32_32x32x16_bf16 a[208:223], a[200:203], v[72:75], a[208:223]
    v_exp_f32 v62, v62
    v_exp_f32 v63, v63
    v_cvt_pk_bf16_f32 v82, v60, v61
    v_exp_f32 v64, v64
    v_mfma_f32_16x16x32_bf16 v[200:203], a[160:163], a[76:79], v[200:203]
    v_exp_f32 v65, v65
    v_mfma_f32_16x16x32_bf16 v[204:207], a[164:167], a[76:79], v[204:207]
    v_cvt_pk_bf16_f32 v83, v62, v63
    v_exp_f32 v66, v66
    v_mfma_f32_32x32x16_bf16 a[208:223], a[204:207], v[76:79], a[208:223]
    v_exp_f32 v67, v67
    v_cvt_pk_bf16_f32 v84, v64, v65
    v_exp_f32 v68, v68
    v_exp_f32 v69, v69
    v_mfma_f32_16x16x32_bf16 v[208:211], a[168:171], a[76:79], v[208:211]
    v_cvt_pk_bf16_f32 v85, v66, v67
    v_exp_f32 v70, v70
    v_mfma_f32_16x16x32_bf16 v[212:215], a[172:175], a[76:79], v[212:215]
    v_exp_f32 v71, v71
    v_mfma_f32_16x16x32_bf16 a[240:243], a[248:251], v[76:79], a[240:243]
    v_cvt_pk_bf16_f32 v86, v68, v69
    v_cvt_pk_bf16_f32 v87, v70, v71
    v_mfma_f32_32x32x16_bf16 v[56:71], a[176:179], a[8:11], 0
    s_waitcnt vmcnt(24) lgkmcnt(0)
    ds_read_b128 a[184:187], v32 offset:18432
    v_exp_f32 v40, v40
    v_exp_f32 v41, v41
    v_exp_f32 v42, v42
    v_mfma_f32_16x16x32_bf16 v[88:91], a[144:147], a[80:83], v[88:91]
    ds_read_b128 a[188:191], v32 offset:19456
    v_exp_f32 v43, v43
    v_mfma_f32_16x16x32_bf16 v[92:95], a[148:151], a[80:83], v[92:95]
    s_add_u32 m0, s12, 24576
    ds_read_b64_tr_b16 a[160:161], v24 offset:12288
    v_cvt_pk_bf16_f32 v72, v40, v41
    v_mfma_f32_32x32x16_bf16 v[56:71], a[180:183], a[12:15], v[56:71]
    buffer_load_dwordx4 v2, s[28:31], s10 offen sc1 lds
    buffer_load_dwordx4 v2, s[28:31], s10 offen offset:1024 sc1 lds
    v_exp_f32 v44, v44
    v_mfma_f32_16x16x32_bf16 v[96:99], a[152:155], a[80:83], v[96:99]
    s_add_u32 s10, s10, 8192
    v_exp_f32 v45, v45
    v_cvt_pk_bf16_f32 v73, v42, v43
    v_mfma_f32_16x16x32_bf16 v[100:103], a[156:159], a[80:83], v[100:103]
    ds_read_b64_tr_b16 a[162:163], v24 offset:12800
    v_exp_f32 v46, v46
    v_mfma_f32_16x16x32_bf16 a[244:247], a[248:251], v[80:83], a[244:247]
    s_add_u32 m0, s15, 4096
    v_exp_f32 v47, v47
    v_cvt_pk_bf16_f32 v74, v44, v45
    v_mfma_f32_32x32x16_bf16 a[224:239], a[200:203], v[80:83], a[224:239]
    buffer_load_dwordx4 v20, s[64:67], s14 offen offset:0 lds
    buffer_load_dwordx4 v21, s[64:67], s14 offen offset:1024 lds
    v_exp_f32 v48, v48
    v_mfma_f32_16x16x32_bf16 v[104:107], a[144:147], a[84:87], v[104:107]
    v_exp_f32 v49, v49
    v_mfma_f32_16x16x32_bf16 v[108:111], a[148:151], a[84:87], v[108:111]
    v_cvt_pk_bf16_f32 v75, v46, v47
    v_exp_f32 v50, v50
    v_mfma_f32_32x32x16_bf16 a[224:239], a[204:207], v[84:87], a[224:239]
    v_exp_f32 v51, v51
    v_cvt_pk_bf16_f32 v76, v48, v49
    v_exp_f32 v52, v52
    v_exp_f32 v53, v53
    v_mfma_f32_16x16x32_bf16 v[112:115], a[152:155], a[84:87], v[112:115]
    v_cvt_pk_bf16_f32 v77, v50, v51
    v_exp_f32 v54, v54
    v_mfma_f32_16x16x32_bf16 v[116:119], a[156:159], a[84:87], v[116:119]
    v_exp_f32 v55, v55
    v_mfma_f32_16x16x32_bf16 a[244:247], a[248:251], v[84:87], a[244:247]
    s_waitcnt lgkmcnt(2)
    v_cvt_pk_bf16_f32 v78, v52, v53
    v_cvt_pk_bf16_f32 v79, v54, v55
    v_mfma_f32_32x32x16_bf16 v[40:55], a[184:187], a[0:3], 0
    buffer_load_dwordx4 v22, s[64:67], s14 offen offset:2048 lds
    buffer_load_dwordx4 v23, s[64:67], s14 offen offset:3072 lds
    v_exp_f32 v56, v56
    v_mfma_f32_16x16x32_bf16 v[120:123], a[144:147], a[88:91], v[120:123]
    s_add_u32 s14, s14, 65536
    ds_read_b128 a[200:203], v32 offset:26624
    v_exp_f32 v57, v57
    v_mfma_f32_16x16x32_bf16 v[124:127], a[148:151], a[88:91], v[124:127]
    ds_read_b128 a[204:207], v32 offset:27648
    v_exp_f32 v58, v58
    v_mfma_f32_32x32x16_bf16 v[40:55], a[188:191], a[4:7], v[40:55]
    buffer_load_dwordx4 a[48:51], v16, s[28:31], s13 offen offset:0 sc1
    buffer_load_dwordx4 a[52:55], v16, s[28:31], s13 offen offset:256 sc1
    v_exp_f32 v59, v59
    v_mfma_f32_16x16x32_bf16 v[128:131], a[152:155], a[88:91], v[128:131]
    ds_read_b64_tr_b16 a[164:165], v25 offset:12288
    v_cvt_pk_bf16_f32 v80, v56, v57
    v_mfma_f32_16x16x32_bf16 v[132:135], a[156:159], a[88:91], v[132:135]
    ds_read_b64_tr_b16 a[166:167], v25 offset:12800
    v_exp_f32 v60, v60
    v_mfma_f32_16x16x32_bf16 a[240:243], a[248:251], v[72:75], a[240:243]
    v_exp_f32 v61, v61
    v_cvt_pk_bf16_f32 v81, v58, v59
    v_mfma_f32_32x32x16_bf16 a[208:223], a[192:195], v[72:75], a[208:223]
    v_exp_f32 v62, v62
    v_exp_f32 v63, v63
    v_cvt_pk_bf16_f32 v82, v60, v61
    v_exp_f32 v64, v64
    v_mfma_f32_16x16x32_bf16 v[136:139], a[144:147], a[92:95], v[136:139]
    ds_read_b64_tr_b16 a[168:169], v26 offset:12288
    v_exp_f32 v65, v65
    v_mfma_f32_16x16x32_bf16 v[140:143], a[148:151], a[92:95], v[140:143]
    v_cvt_pk_bf16_f32 v83, v62, v63
    v_exp_f32 v66, v66
    v_mfma_f32_32x32x16_bf16 a[208:223], a[196:199], v[76:79], a[208:223]
    v_exp_f32 v67, v67
    v_cvt_pk_bf16_f32 v84, v64, v65
    v_exp_f32 v68, v68
    v_exp_f32 v69, v69
    v_mfma_f32_16x16x32_bf16 v[144:147], a[152:155], a[92:95], v[144:147]
    v_cvt_pk_bf16_f32 v85, v66, v67
    v_exp_f32 v70, v70
    v_mfma_f32_16x16x32_bf16 v[148:151], a[156:159], a[92:95], v[148:151]
    v_exp_f32 v71, v71
    v_mfma_f32_16x16x32_bf16 a[240:243], a[248:251], v[76:79], a[240:243]
    v_cvt_pk_bf16_f32 v86, v68, v69
    v_cvt_pk_bf16_f32 v87, v70, v71
    v_mfma_f32_32x32x16_bf16 v[56:71], a[184:187], a[8:11], 0
    buffer_load_dwordx4 a[56:59], v17, s[28:31], s13 offen offset:0 sc1
    buffer_load_dwordx4 a[60:63], v17, s[28:31], s13 offen offset:256 sc1
    v_exp_f32 v40, v40
    v_mfma_f32_16x16x32_bf16 v[152:155], a[144:147], a[96:99], v[152:155]
    ds_read_b128 a[176:179], v32 offset:20480
    v_exp_f32 v41, v41
    v_mfma_f32_16x16x32_bf16 v[156:159], a[148:151], a[96:99], v[156:159]
    ds_read_b128 a[180:183], v32 offset:21504
    v_exp_f32 v42, v42
    v_mfma_f32_32x32x16_bf16 v[56:71], a[188:191], a[12:15], v[56:71]
    ds_read_b64_tr_b16 a[170:171], v26 offset:12800
    v_exp_f32 v43, v43
    v_cvt_pk_bf16_f32 v72, v40, v41
    v_exp_f32 v44, v44
    v_mfma_f32_16x16x32_bf16 v[160:163], a[152:155], a[96:99], v[160:163]
    ds_read_b64_tr_b16 a[172:173], v27 offset:12288
    v_exp_f32 v45, v45
    v_mfma_f32_16x16x32_bf16 v[164:167], a[156:159], a[96:99], v[164:167]
    v_cvt_pk_bf16_f32 v73, v42, v43
    v_exp_f32 v46, v46
    v_mfma_f32_16x16x32_bf16 a[244:247], a[248:251], v[80:83], a[244:247]
    v_exp_f32 v47, v47
    v_mfma_f32_32x32x16_bf16 a[224:239], a[192:195], v[80:83], a[224:239]
    v_cvt_pk_bf16_f32 v74, v44, v45
    v_exp_f32 v48, v48
    v_exp_f32 v49, v49
    v_cvt_pk_bf16_f32 v75, v46, v47
    v_mfma_f32_16x16x32_bf16 v[168:171], a[144:147], a[100:103], v[168:171]
    v_exp_f32 v50, v50
    v_mfma_f32_16x16x32_bf16 v[172:175], a[148:151], a[100:103], v[172:175]
    ds_read_b64_tr_b16 a[174:175], v27 offset:12800
    v_exp_f32 v51, v51
    v_mfma_f32_32x32x16_bf16 a[224:239], a[196:199], v[84:87], a[224:239]
    v_cvt_pk_bf16_f32 v76, v48, v49
    v_exp_f32 v52, v52
    v_exp_f32 v53, v53
    v_cvt_pk_bf16_f32 v77, v50, v51
    v_mfma_f32_16x16x32_bf16 v[176:179], a[152:155], a[100:103], v[176:179]
    v_exp_f32 v54, v54
    v_mfma_f32_16x16x32_bf16 v[180:183], a[156:159], a[100:103], v[180:183]
    v_exp_f32 v55, v55
    v_mfma_f32_16x16x32_bf16 a[244:247], a[248:251], v[84:87], a[244:247]
    s_waitcnt lgkmcnt(3)
    v_cvt_pk_bf16_f32 v78, v52, v53
    v_cvt_pk_bf16_f32 v79, v54, v55
    v_mfma_f32_32x32x16_bf16 v[40:55], a[176:179], a[0:3], 0
    buffer_load_dwordx4 a[64:67], v18, s[28:31], s13 offen offset:0 sc1
    buffer_load_dwordx4 a[68:71], v18, s[28:31], s13 offen offset:256 sc1
    v_exp_f32 v56, v56
    v_mfma_f32_16x16x32_bf16 v[184:187], a[144:147], a[104:107], v[184:187]
    ds_read_b128 a[192:195], v32 offset:28672
    v_exp_f32 v57, v57
    v_mfma_f32_16x16x32_bf16 v[188:191], a[148:151], a[104:107], v[188:191]
    ds_read_b128 a[196:199], v32 offset:29696
    v_exp_f32 v58, v58
    v_mfma_f32_32x32x16_bf16 v[40:55], a[180:183], a[4:7], v[40:55]
    buffer_load_dwordx4 a[72:75], v19, s[28:31], s13 offen offset:0 sc1
    buffer_load_dwordx4 a[76:79], v19, s[28:31], s13 offen offset:256 sc1
    v_exp_f32 v59, v59
    v_mfma_f32_16x16x32_bf16 v[192:195], a[152:155], a[104:107], v[192:195]
    s_add_u32 s13, s13, 2048
    v_cvt_pk_bf16_f32 v80, v56, v57
    v_exp_f32 v60, v60
    v_mfma_f32_16x16x32_bf16 v[196:199], a[156:159], a[104:107], v[196:199]
    v_exp_f32 v61, v61
    v_mfma_f32_16x16x32_bf16 a[240:243], a[248:251], v[72:75], a[240:243]
    v_cvt_pk_bf16_f32 v81, v58, v59
    v_exp_f32 v62, v62
    v_mfma_f32_32x32x16_bf16 a[208:223], a[200:203], v[72:75], a[208:223]
    v_exp_f32 v63, v63
    v_cvt_pk_bf16_f32 v82, v60, v61
    v_exp_f32 v64, v64
    v_exp_f32 v65, v65
    v_mfma_f32_16x16x32_bf16 v[200:203], a[144:147], a[108:111], v[200:203]
    v_cvt_pk_bf16_f32 v83, v62, v63
    v_exp_f32 v66, v66
    v_mfma_f32_16x16x32_bf16 v[204:207], a[148:151], a[108:111], v[204:207]
    v_exp_f32 v67, v67
    v_mfma_f32_32x32x16_bf16 a[208:223], a[204:207], v[76:79], a[208:223]
    v_cvt_pk_bf16_f32 v84, v64, v65
    v_exp_f32 v68, v68
    v_exp_f32 v69, v69
    v_cvt_pk_bf16_f32 v85, v66, v67
    v_mfma_f32_16x16x32_bf16 v[208:211], a[152:155], a[108:111], v[208:211]
    v_exp_f32 v70, v70
    v_mfma_f32_16x16x32_bf16 v[212:215], a[156:159], a[108:111], v[212:215]
    v_exp_f32 v71, v71
    v_mfma_f32_16x16x32_bf16 a[240:243], a[248:251], v[76:79], a[240:243]
    v_cvt_pk_bf16_f32 v86, v68, v69
    v_cvt_pk_bf16_f32 v87, v70, v71
    v_mfma_f32_32x32x16_bf16 v[56:71], a[176:179], a[8:11], 0
    s_waitcnt vmcnt(24) lgkmcnt(2)
    ds_read_b128 a[184:187], v32 offset:22528
    v_exp_f32 v40, v40
    v_exp_f32 v41, v41
    v_exp_f32 v42, v42
    v_mfma_f32_16x16x32_bf16 v[88:91], a[160:163], a[112:115], v[88:91]
    ds_read_b128 a[188:191], v32 offset:23552
    v_exp_f32 v43, v43
    v_mfma_f32_16x16x32_bf16 v[92:95], a[164:167], a[112:115], v[92:95]
    s_add_u32 m0, s15, 8192
    ds_read_b64_tr_b16 a[144:145], v24 offset:0
    v_cvt_pk_bf16_f32 v72, v40, v41
    v_mfma_f32_32x32x16_bf16 v[56:71], a[180:183], a[12:15], v[56:71]
    buffer_load_dwordx4 v20, s[64:67], s14 offen offset:0 lds
    buffer_load_dwordx4 v21, s[64:67], s14 offen offset:1024 lds
    v_exp_f32 v44, v44
    v_mfma_f32_16x16x32_bf16 v[96:99], a[168:171], a[112:115], v[96:99]
    v_exp_f32 v45, v45
    v_cvt_pk_bf16_f32 v73, v42, v43
    v_mfma_f32_16x16x32_bf16 v[100:103], a[172:175], a[112:115], v[100:103]
    ds_read_b64_tr_b16 a[146:147], v24 offset:512
    v_exp_f32 v46, v46
    v_mfma_f32_16x16x32_bf16 a[244:247], a[248:251], v[80:83], a[244:247]
    v_exp_f32 v47, v47
    v_cvt_pk_bf16_f32 v74, v44, v45
    v_mfma_f32_32x32x16_bf16 a[224:239], a[200:203], v[80:83], a[224:239]
    v_exp_f32 v48, v48
    v_exp_f32 v49, v49
    v_cvt_pk_bf16_f32 v75, v46, v47
    v_exp_f32 v50, v50
    v_mfma_f32_16x16x32_bf16 v[104:107], a[160:163], a[116:119], v[104:107]
    v_exp_f32 v51, v51
    v_mfma_f32_16x16x32_bf16 v[108:111], a[164:167], a[116:119], v[108:111]
    v_cvt_pk_bf16_f32 v76, v48, v49
    v_exp_f32 v52, v52
    v_mfma_f32_32x32x16_bf16 a[224:239], a[204:207], v[84:87], a[224:239]
    buffer_load_dwordx4 v22, s[64:67], s14 offen offset:2048 lds
    buffer_load_dwordx4 v23, s[64:67], s14 offen offset:3072 lds
    v_exp_f32 v53, v53
    v_mfma_f32_16x16x32_bf16 v[112:115], a[168:171], a[116:119], v[112:115]
    s_add_u32 s14, s14, 65536
    v_cvt_pk_bf16_f32 v77, v50, v51
    v_exp_f32 v54, v54
    v_mfma_f32_16x16x32_bf16 v[116:119], a[172:175], a[116:119], v[116:119]
    v_exp_f32 v55, v55
    v_mfma_f32_16x16x32_bf16 a[244:247], a[248:251], v[84:87], a[244:247]
    s_waitcnt lgkmcnt(2)
    v_cvt_pk_bf16_f32 v78, v52, v53
    v_cvt_pk_bf16_f32 v79, v54, v55
    v_mfma_f32_32x32x16_bf16 v[40:55], a[184:187], a[0:3], 0
    ds_read_b128 a[200:203], v32 offset:30720
    v_exp_f32 v56, v56
    v_exp_f32 v57, v57
    v_exp_f32 v58, v58
    v_mfma_f32_16x16x32_bf16 v[120:123], a[160:163], a[120:123], v[120:123]
    ds_read_b128 a[204:207], v32 offset:31744
    v_exp_f32 v59, v59
    v_mfma_f32_16x16x32_bf16 v[124:127], a[164:167], a[120:123], v[124:127]
    ds_read_b64_tr_b16 a[148:149], v25 offset:0
    v_cvt_pk_bf16_f32 v80, v56, v57
    v_mfma_f32_32x32x16_bf16 v[40:55], a[188:191], a[4:7], v[40:55]
    buffer_load_dwordx4 a[80:83], v16, s[28:31], s13 offen offset:0 sc1
    buffer_load_dwordx4 a[84:87], v16, s[28:31], s13 offen offset:256 sc1
    v_exp_f32 v60, v60
    v_mfma_f32_16x16x32_bf16 v[128:131], a[168:171], a[120:123], v[128:131]
    ds_read_b64_tr_b16 a[150:151], v25 offset:512
    v_exp_f32 v61, v61
    v_mfma_f32_16x16x32_bf16 v[132:135], a[172:175], a[120:123], v[132:135]
    v_cvt_pk_bf16_f32 v81, v58, v59
    v_exp_f32 v62, v62
    v_mfma_f32_16x16x32_bf16 a[240:243], a[248:251], v[72:75], a[240:243]
    v_exp_f32 v63, v63
    v_mfma_f32_32x32x16_bf16 a[208:223], a[192:195], v[72:75], a[208:223]
    v_cvt_pk_bf16_f32 v82, v60, v61
    v_exp_f32 v64, v64
    v_exp_f32 v65, v65
    v_cvt_pk_bf16_f32 v83, v62, v63
    v_mfma_f32_16x16x32_bf16 v[136:139], a[160:163], a[124:127], v[136:139]
    ds_read_b64_tr_b16 a[152:153], v26 offset:0
    v_exp_f32 v66, v66
    v_mfma_f32_16x16x32_bf16 v[140:143], a[164:167], a[124:127], v[140:143]
    v_exp_f32 v67, v67
    v_cvt_pk_bf16_f32 v84, v64, v65
    v_mfma_f32_32x32x16_bf16 a[208:223], a[196:199], v[76:79], a[208:223]
    v_exp_f32 v68, v68
    v_exp_f32 v69, v69
    v_cvt_pk_bf16_f32 v85, v66, v67
    v_exp_f32 v70, v70
    v_mfma_f32_16x16x32_bf16 v[144:147], a[168:171], a[124:127], v[144:147]
    v_exp_f32 v71, v71
    v_mfma_f32_16x16x32_bf16 v[148:151], a[172:175], a[124:127], v[148:151]
    v_cvt_pk_bf16_f32 v86, v68, v69
    v_cvt_pk_bf16_f32 v87, v70, v71
    v_mfma_f32_16x16x32_bf16 a[240:243], a[248:251], v[76:79], a[240:243]
    s_waitcnt vmcnt(40)
    s_barrier
    v_xor_b32 v32, 0x8000, v32
    v_mfma_f32_32x32x16_bf16 v[56:71], a[184:187], a[8:11], 0
    buffer_load_dwordx4 a[88:91], v17, s[28:31], s13 offen offset:0 sc1
    buffer_load_dwordx4 a[92:95], v17, s[28:31], s13 offen offset:256 sc1
    v_exp_f32 v40, v40
    v_mfma_f32_16x16x32_bf16 v[152:155], a[160:163], a[128:131], v[152:155]
    ds_read_b128 a[176:179], v32 offset:0
    v_exp_f32 v41, v41
    v_mfma_f32_16x16x32_bf16 v[156:159], a[164:167], a[128:131], v[156:159]
    ds_read_b128 a[180:183], v32 offset:1024
    v_exp_f32 v42, v42
    v_mfma_f32_32x32x16_bf16 v[56:71], a[188:191], a[12:15], v[56:71]
    ds_read_b64_tr_b16 a[154:155], v26 offset:512
    v_exp_f32 v43, v43
    v_cvt_pk_bf16_f32 v72, v40, v41
    v_exp_f32 v44, v44
    v_mfma_f32_16x16x32_bf16 v[160:163], a[168:171], a[128:131], v[160:163]
    ds_read_b64_tr_b16 a[156:157], v27 offset:0
    v_exp_f32 v45, v45
    v_mfma_f32_16x16x32_bf16 v[164:167], a[172:175], a[128:131], v[164:167]
    v_cvt_pk_bf16_f32 v73, v42, v43
    v_exp_f32 v46, v46
    v_mfma_f32_16x16x32_bf16 a[244:247], a[248:251], v[80:83], a[244:247]
    v_exp_f32 v47, v47
    v_mfma_f32_32x32x16_bf16 a[224:239], a[192:195], v[80:83], a[224:239]
    v_cvt_pk_bf16_f32 v74, v44, v45
    v_exp_f32 v48, v48
    v_exp_f32 v49, v49
    v_cvt_pk_bf16_f32 v75, v46, v47
    v_mfma_f32_16x16x32_bf16 v[168:171], a[160:163], a[132:135], v[168:171]
    v_exp_f32 v50, v50
    v_mfma_f32_16x16x32_bf16 v[172:175], a[164:167], a[132:135], v[172:175]
    ds_read_b64_tr_b16 a[158:159], v27 offset:512
    v_exp_f32 v51, v51
    v_mfma_f32_32x32x16_bf16 a[224:239], a[196:199], v[84:87], a[224:239]
    v_cvt_pk_bf16_f32 v76, v48, v49
    v_exp_f32 v52, v52
    v_exp_f32 v53, v53
    v_cvt_pk_bf16_f32 v77, v50, v51
    v_mfma_f32_16x16x32_bf16 v[176:179], a[168:171], a[132:135], v[176:179]
    v_exp_f32 v54, v54
    v_mfma_f32_16x16x32_bf16 v[180:183], a[172:175], a[132:135], v[180:183]
    v_exp_f32 v55, v55
    v_mfma_f32_16x16x32_bf16 a[244:247], a[248:251], v[84:87], a[244:247]
    s_waitcnt lgkmcnt(3)
    v_cvt_pk_bf16_f32 v78, v52, v53
    v_cvt_pk_bf16_f32 v79, v54, v55
    v_mfma_f32_32x32x16_bf16 v[40:55], a[176:179], a[0:3], 0
    buffer_load_dwordx4 a[96:99], v18, s[28:31], s13 offen offset:0 sc1
    buffer_load_dwordx4 a[100:103], v18, s[28:31], s13 offen offset:256 sc1
    v_exp_f32 v56, v56
    v_mfma_f32_16x16x32_bf16 v[184:187], a[160:163], a[136:139], v[184:187]
    ds_read_b128 a[192:195], v32 offset:8192
    v_exp_f32 v57, v57
    v_mfma_f32_16x16x32_bf16 v[188:191], a[164:167], a[136:139], v[188:191]
    ds_read_b128 a[196:199], v32 offset:9216
    v_exp_f32 v58, v58
    v_mfma_f32_32x32x16_bf16 v[40:55], a[180:183], a[4:7], v[40:55]
    buffer_load_dwordx4 a[104:107], v19, s[28:31], s13 offen offset:0 sc1
    buffer_load_dwordx4 a[108:111], v19, s[28:31], s13 offen offset:256 sc1
    v_exp_f32 v59, v59
    v_mfma_f32_16x16x32_bf16 v[192:195], a[168:171], a[136:139], v[192:195]
    s_add_u32 s13, s13, 2048
    v_cvt_pk_bf16_f32 v80, v56, v57
    v_exp_f32 v60, v60
    v_mfma_f32_16x16x32_bf16 v[196:199], a[172:175], a[136:139], v[196:199]
    v_exp_f32 v61, v61
    v_mfma_f32_16x16x32_bf16 a[240:243], a[248:251], v[72:75], a[240:243]
    v_cvt_pk_bf16_f32 v81, v58, v59
    v_exp_f32 v62, v62
    v_mfma_f32_32x32x16_bf16 a[208:223], a[200:203], v[72:75], a[208:223]
    v_exp_f32 v63, v63
    v_cvt_pk_bf16_f32 v82, v60, v61
    v_exp_f32 v64, v64
    v_exp_f32 v65, v65
    v_mfma_f32_16x16x32_bf16 v[200:203], a[160:163], a[140:143], v[200:203]
    v_cvt_pk_bf16_f32 v83, v62, v63
    v_exp_f32 v66, v66
    v_mfma_f32_16x16x32_bf16 v[204:207], a[164:167], a[140:143], v[204:207]
    v_exp_f32 v67, v67
    v_mfma_f32_32x32x16_bf16 a[208:223], a[204:207], v[76:79], a[208:223]
    v_cvt_pk_bf16_f32 v84, v64, v65
    v_exp_f32 v68, v68
    v_exp_f32 v69, v69
    v_cvt_pk_bf16_f32 v85, v66, v67
    v_mfma_f32_16x16x32_bf16 v[208:211], a[168:171], a[140:143], v[208:211]
    v_exp_f32 v70, v70
    v_mfma_f32_16x16x32_bf16 v[212:215], a[172:175], a[140:143], v[212:215]
    v_exp_f32 v71, v71
    v_mfma_f32_16x16x32_bf16 a[240:243], a[248:251], v[76:79], a[240:243]
    v_cvt_pk_bf16_f32 v86, v68, v69
    v_cvt_pk_bf16_f32 v87, v70, v71
    s_sub_u32 s18, s18, 1
    s_cmp_lg_u32 s18, 0
    s_cbranch_scc1 k5_loop
    s_nop 1
    v_mfma_f32_32x32x16_bf16 a[224:239], a[200:203], v[80:83], a[224:239]
    v_mfma_f32_32x32x16_bf16 a[224:239], a[204:207], v[84:87], a[224:239]
    v_mfma_f32_16x16x32_bf16 a[244:247], a[248:251], v[80:83], a[244:247]
    v_mfma_f32_16x16x32_bf16 a[244:247], a[248:251], v[84:87], a[244:247]
    s_mul_i32 s19, s82, 288
    s_lshl_b32 s20, s80, 1
    s_add_u32 s19, s19, s20
    s_lshl_b32 s19, s19, 10
    s_add_u32 s19, s19, 12582912
    s_mov_b32 s20, 0x2b800000
    s_mov_b32 s21, 0x53800000
    s_nop 1
    v_accvgpr_read_b32 v3, a240
    v_accvgpr_read_b32 v4, a244
    v_cmp_le_f32 s[22:23], s20, v3
    v_cmp_ge_f32 s[24:25], s21, v3
    s_nop 1
    s_and_b64 s[22:23], s[22:23], s[24:25]
    v_cmp_le_f32 vcc, s20, v4
    v_cmp_ge_f32 s[24:25], s21, v4
    s_nop 1
    s_and_b64 s[22:23], s[22:23], vcc
    s_and_b64 s[22:23], s[22:23], s[24:25]
    s_cmp_eq_u64 s[22:23], -1
    s_cbranch_scc0 k5_slow
k5_store:
    s_waitcnt vmcnt(63)
    v_accvgpr_read_b32 v3, a240
    v_accvgpr_read_b32 v40, a208
    v_accvgpr_read_b32 v41, a209
    v_accvgpr_read_b32 v42, a210
    v_accvgpr_read_b32 v43, a211
    v_accvgpr_read_b32 v44, a212
    v_accvgpr_read_b32 v45, a213
    v_accvgpr_read_b32 v46, a214
    v_accvgpr_read_b32 v47, a215
    v_accvgpr_read_b32 v48, a216
    v_accvgpr_read_b32 v49, a217
    v_accvgpr_read_b32 v50, a218
    v_accvgpr_read_b32 v51, a219
    v_accvgpr_read_b32 v52, a220
    v_accvgpr_read_b32 v53, a221
    v_accvgpr_read_b32 v54, a222
    v_accvgpr_read_b32 v55, a223
    v_rcp_f32 v3, v3
    s_nop 0
    v_mul_f32 v3, v3, v34
    v_mul_f32 v40, v40, v3
    v_mul_f32 v41, v41, v3
    v_mul_f32 v42, v42, v3
    v_mul_f32 v43, v43, v3
    v_mul_f32 v44, v44, v3
    v_mul_f32 v45, v45, v3
    v_mul_f32 v46, v46, v3
    v_mul_f32 v47, v47, v3
    v_mul_f32 v48, v48, v3
    v_mul_f32 v49, v49, v3
    v_mul_f32 v50, v50, v3
    v_mul_f32 v51, v51, v3
    v_mul_f32 v52, v52, v3
    v_mul_f32 v53, v53, v3
    v_mul_f32 v54, v54, v3
    v_mul_f32 v55, v55, v3
    v_cvt_pk_bf16_f32 v72, v40, v41
    v_cvt_pk_bf16_f32 v73, v42, v43
    v_cvt_pk_bf16_f32 v74, v44, v45
    v_cvt_pk_bf16_f32 v75, v46, v47
    v_cvt_pk_bf16_f32 v76, v48, v49
    v_cvt_pk_bf16_f32 v77, v50, v51
    v_cvt_pk_bf16_f32 v78, v52, v53
    v_cvt_pk_bf16_f32 v79, v54, v55
    s_nop 1
    v_permlane32_swap_b32 v72, v74
    v_permlane32_swap_b32 v73, v75
    v_permlane32_swap_b32 v76, v78
    v_permlane32_swap_b32 v77, v79
    buffer_store_dwordx4 v[72:75], v2, s[28:31], s19 offen offset:0 sc1
    buffer_store_dwordx4 v[76:79], v2, s[28:31], s19 offen offset:1024 sc1
    v_accvgpr_read_b32 v3, a244
    v_accvgpr_read_b32 v56, a224
    v_accvgpr_read_b32 v57, a225
    v_accvgpr_read_b32 v58, a226
    v_accvgpr_read_b32 v59, a227
    v_accvgpr_read_b32 v60, a228
    v_accvgpr_read_b32 v61, a229
    v_accvgpr_read_b32 v62, a230
    v_accvgpr_read_b32 v63, a231
    v_accvgpr_read_b32 v64, a232
    v_accvgpr_read_b32 v65, a233
    v_accvgpr_read_b32 v66, a234
    v_accvgpr_read_b32 v67, a235
    v_accvgpr_read_b32 v68, a236
    v_accvgpr_read_b32 v69, a237
    v_accvgpr_read_b32 v70, a238
    v_accvgpr_read_b32 v71, a239
    v_rcp_f32 v3, v3
    s_nop 0
    v_mul_f32 v3, v3, v35
    v_mul_f32 v56, v56, v3
    v_mul_f32 v57, v57, v3
    v_mul_f32 v58, v58, v3
    v_mul_f32 v59, v59, v3
    v_mul_f32 v60, v60, v3
    v_mul_f32 v61, v61, v3
    v_mul_f32 v62, v62, v3
    v_mul_f32 v63, v63, v3
    v_mul_f32 v64, v64, v3
    v_mul_f32 v65, v65, v3
    v_mul_f32 v66, v66, v3
    v_mul_f32 v67, v67, v3
    v_mul_f32 v68, v68, v3
    v_mul_f32 v69, v69, v3
    v_mul_f32 v70, v70, v3
    v_mul_f32 v71, v71, v3
    v_cvt_pk_bf16_f32 v80, v56, v57
    v_cvt_pk_bf16_f32 v81, v58, v59
    v_cvt_pk_bf16_f32 v82, v60, v61
    v_cvt_pk_bf16_f32 v83, v62, v63
    v_cvt_pk_bf16_f32 v84, v64, v65
    v_cvt_pk_bf16_f32 v85, v66, v67
    v_cvt_pk_bf16_f32 v86, v68, v69
    v_cvt_pk_bf16_f32 v87, v70, v71
    s_add_u32 s19, s19, 294912
    s_nop 1
    v_permlane32_swap_b32 v80, v82
    v_permlane32_swap_b32 v81, v83
    v_permlane32_swap_b32 v84, v86
    v_permlane32_swap_b32 v85, v87
    buffer_store_dwordx4 v[80:83], v2, s[28:31], s19 offen offset:0 sc1
    buffer_store_dwordx4 v[84:87], v2, s[28:31], s19 offen offset:1024 sc1
    s_waitcnt vmcnt(24) lgkmcnt(2)
    v_mfma_f32_16x16x32_bf16 v[88:91], a[144:147], a[16:19], v[88:91]
    ds_read_b64_tr_b16 a[160:161], v24 offset:4096
    v_mfma_f32_16x16x32_bf16 v[92:95], a[148:151], a[16:19], v[92:95]
    s_add_u32 m0, s15, 12288
    buffer_load_dwordx4 a[112:115], v16, s[28:31], s13 offen offset:0 sc1
    v_mfma_f32_16x16x32_bf16 v[96:99], a[152:155], a[16:19], v[96:99]
    ds_read_b64_tr_b16 a[162:163], v24 offset:4608
    v_mfma_f32_16x16x32_bf16 v[100:103], a[156:159], a[16:19], v[100:103]
    buffer_load_dwordx4 v20, s[64:67], s14 offen offset:0 lds
    v_mfma_f32_16x16x32_bf16 v[104:107], a[144:147], a[20:23], v[104:107]
    ds_read_b64_tr_b16 a[164:165], v25 offset:4096
    buffer_load_dwordx4 a[116:119], v16, s[28:31], s13 offen offset:256 sc1
    v_mfma_f32_16x16x32_bf16 v[108:111], a[148:151], a[20:23], v[108:111]
    buffer_load_dwordx4 v21, s[64:67], s14 offen offset:1024 lds
    v_mfma_f32_16x16x32_bf16 v[112:115], a[152:155], a[20:23], v[112:115]
    ds_read_b64_tr_b16 a[166:167], v25 offset:4608
    v_mfma_f32_16x16x32_bf16 v[116:119], a[156:159], a[20:23], v[116:119]
    buffer_load_dwordx4 v22, s[64:67], s14 offen offset:2048 lds
    buffer_load_dwordx4 a[120:123], v17, s[28:31], s13 offen offset:0 sc1
    v_mfma_f32_16x16x32_bf16 v[120:123], a[144:147], a[24:27], v[120:123]
    ds_read_b64_tr_b16 a[168:169], v26 offset:4096
    v_mfma_f32_16x16x32_bf16 v[124:127], a[148:151], a[24:27], v[124:127]
    buffer_load_dwordx4 v23, s[64:67], s14 offen offset:3072 lds
    v_mfma_f32_16x16x32_bf16 v[128:131], a[152:155], a[24:27], v[128:131]
    ds_read_b64_tr_b16 a[170:171], v26 offset:4608
    s_add_u32 s14, s14, 65536
    buffer_load_dwordx4 a[124:127], v17, s[28:31], s13 offen offset:256 sc1
    v_mfma_f32_16x16x32_bf16 v[132:135], a[156:159], a[24:27], v[132:135]
    v_mfma_f32_16x16x32_bf16 v[136:139], a[144:147], a[28:31], v[136:139]
    ds_read_b64_tr_b16 a[172:173], v27 offset:4096
    v_mfma_f32_16x16x32_bf16 v[140:143], a[148:151], a[28:31], v[140:143]
    buffer_load_dwordx4 a[128:131], v18, s[28:31], s13 offen offset:0 sc1
    v_mfma_f32_16x16x32_bf16 v[144:147], a[152:155], a[28:31], v[144:147]
    ds_read_b64_tr_b16 a[174:175], v27 offset:4608
    v_mfma_f32_16x16x32_bf16 v[148:151], a[156:159], a[28:31], v[148:151]
    v_mfma_f32_16x16x32_bf16 v[152:155], a[144:147], a[32:35], v[152:155]
    buffer_load_dwordx4 a[132:135], v18, s[28:31], s13 offen offset:256 sc1
    v_mfma_f32_16x16x32_bf16 v[156:159], a[148:151], a[32:35], v[156:159]
    v_mfma_f32_16x16x32_bf16 v[160:163], a[152:155], a[32:35], v[160:163]
    v_mfma_f32_16x16x32_bf16 v[164:167], a[156:159], a[32:35], v[164:167]
    buffer_load_dwordx4 a[136:139], v19, s[28:31], s13 offen offset:0 sc1
    v_mfma_f32_16x16x32_bf16 v[168:171], a[144:147], a[36:39], v[168:171]
    v_mfma_f32_16x16x32_bf16 v[172:175], a[148:151], a[36:39], v[172:175]
    v_mfma_f32_16x16x32_bf16 v[176:179], a[152:155], a[36:39], v[176:179]
    buffer_load_dwordx4 a[140:143], v19, s[28:31], s13 offen offset:256 sc1
    v_mfma_f32_16x16x32_bf16 v[180:183], a[156:159], a[36:39], v[180:183]
    v_mfma_f32_16x16x32_bf16 v[184:187], a[144:147], a[40:43], v[184:187]
    v_mfma_f32_16x16x32_bf16 v[188:191], a[148:151], a[40:43], v[188:191]
    v_mfma_f32_16x16x32_bf16 v[192:195], a[152:155], a[40:43], v[192:195]
    v_mfma_f32_16x16x32_bf16 v[196:199], a[156:159], a[40:43], v[196:199]
    v_mfma_f32_16x16x32_bf16 v[200:203], a[144:147], a[44:47], v[200:203]
    v_mfma_f32_16x16x32_bf16 v[204:207], a[148:151], a[44:47], v[204:207]
    v_mfma_f32_16x16x32_bf16 v[208:211], a[152:155], a[44:47], v[208:211]
    v_mfma_f32_16x16x32_bf16 v[212:215], a[156:159], a[44:47], v[212:215]
    s_add_u32 s13, s13, 2048
    s_waitcnt vmcnt(12)
    s_barrier
    s_cmp_eq_u32 s36, 0
    s_cbranch_scc0 k5_noflag
    v_mov_b32 v3, 0
    v_mov_b32 v4, 1
    s_mov_b64 exec, 1
    buffer_store_dword v4, v3, s[28:31], s3 offen sc1
    s_mov_b64 exec, -1
k5_noflag:
    s_lshr_b32 s19, s83, 1
    s_mul_i32 s19, s19, 4224
    s_add_u32 s19, s19, 34603008
    v_and_b32 v3, 31, v1
    v_lshlrev_b32 v3, 2, v3
    s_mov_b32 s35, 0x100000
    s_waitcnt vmcnt(24) lgkmcnt(0)
    v_mfma_f32_16x16x32_bf16 v[88:91], a[160:163], a[48:51], v[88:91]
    ds_read_b64_tr_b16 a[144:145], v24 offset:8192
    v_mfma_f32_16x16x32_bf16 v[92:95], a[164:167], a[48:51], v[92:95]
    s_add_u32 m0, s40, 0
    v_mfma_f32_16x16x32_bf16 v[96:99], a[168:171], a[48:51], v[96:99]
    ds_read_b64_tr_b16 a[146:147], v24 offset:8704
    v_sub_f32 v240, 1.0, v240
    v_mfma_f32_16x16x32_bf16 v[100:103], a[172:175], a[48:51], v[100:103]
    buffer_load_dwordx4 v20, s[68:71], s95 offen offset:0 lds
    v_mfma_f32_16x16x32_bf16 v[104:107], a[160:163], a[52:55], v[104:107]
    ds_read_b64_tr_b16 a[148:149], v25 offset:8192
    v_mfma_f32_16x16x32_bf16 v[108:111], a[164:167], a[52:55], v[108:111]
    buffer_load_dwordx4 v21, s[68:71], s95 offen offset:1024 lds
    v_sub_f32 v241, 1.0, v241
    v_mfma_f32_16x16x32_bf16 v[112:115], a[168:171], a[52:55], v[112:115]
    ds_read_b64_tr_b16 a[150:151], v25 offset:8704
    v_mfma_f32_16x16x32_bf16 v[116:119], a[172:175], a[52:55], v[116:119]
    buffer_load_dwordx4 v22, s[68:71], s95 offen offset:2048 lds
    v_mfma_f32_16x16x32_bf16 v[120:123], a[160:163], a[56:59], v[120:123]
    ds_read_b64_tr_b16 a[152:153], v26 offset:8192
    v_sub_f32 v242, 1.0, v242
    v_mfma_f32_16x16x32_bf16 v[124:127], a[164:167], a[56:59], v[124:127]
    buffer_load_dwordx4 v23, s[68:71], s95 offen offset:3072 lds
    v_mfma_f32_16x16x32_bf16 v[128:131], a[168:171], a[56:59], v[128:131]
    ds_read_b64_tr_b16 a[154:155], v26 offset:8704
    s_add_u32 s95, s95, 65536
    v_mfma_f32_16x16x32_bf16 v[132:135], a[172:175], a[56:59], v[132:135]
    s_add_u32 m0, s40, 4096
    v_sub_f32 v243, 1.0, v243
    v_mfma_f32_16x16x32_bf16 v[136:139], a[160:163], a[60:63], v[136:139]
    ds_read_b64_tr_b16 a[156:157], v27 offset:8192
    v_mfma_f32_16x16x32_bf16 v[140:143], a[164:167], a[60:63], v[140:143]
    buffer_load_dwordx4 v20, s[68:71], s95 offen offset:0 lds
    v_mfma_f32_16x16x32_bf16 v[144:147], a[168:171], a[60:63], v[144:147]
    ds_read_b64_tr_b16 a[158:159], v27 offset:8704
    v_sub_f32 v244, 1.0, v244
    v_mfma_f32_16x16x32_bf16 v[148:151], a[172:175], a[60:63], v[148:151]
    buffer_load_dwordx4 v21, s[68:71], s95 offen offset:1024 lds
    v_mfma_f32_16x16x32_bf16 v[152:155], a[160:163], a[64:67], v[152:155]
    v_mfma_f32_16x16x32_bf16 v[156:159], a[164:167], a[64:67], v[156:159]
    buffer_load_dwordx4 v22, s[68:71], s95 offen offset:2048 lds
    v_sub_f32 v245, 1.0, v245
    v_mfma_f32_16x16x32_bf16 v[160:163], a[168:171], a[64:67], v[160:163]
    v_mfma_f32_16x16x32_bf16 v[164:167], a[172:175], a[64:67], v[164:167]
    buffer_load_dwordx4 v23, s[68:71], s95 offen offset:3072 lds
    v_mfma_f32_16x16x32_bf16 v[168:171], a[160:163], a[68:71], v[168:171]
    s_add_u32 s95, s95, 65536
    v_sub_f32 v246, 1.0, v246
    v_mfma_f32_16x16x32_bf16 v[172:175], a[164:167], a[68:71], v[172:175]
    s_add_u32 m0, s40, 8192
    v_mfma_f32_16x16x32_bf16 v[176:179], a[168:171], a[68:71], v[176:179]
    v_mfma_f32_16x16x32_bf16 v[180:183], a[172:175], a[68:71], v[180:183]
    buffer_load_dwordx4 v20, s[68:71], s95 offen offset:0 lds
    v_sub_f32 v247, 1.0, v247
    v_mfma_f32_16x16x32_bf16 v[184:187], a[160:163], a[72:75], v[184:187]
    v_mfma_f32_16x16x32_bf16 v[188:191], a[164:167], a[72:75], v[188:191]
    buffer_load_dwordx4 v21, s[68:71], s95 offen offset:1024 lds
    v_mfma_f32_16x16x32_bf16 v[192:195], a[168:171], a[72:75], v[192:195]
    v_mfma_f32_16x16x32_bf16 v[196:199], a[172:175], a[72:75], v[196:199]
    buffer_load_dwordx4 v22, s[68:71], s95 offen offset:2048 lds
    v_mfma_f32_16x16x32_bf16 v[200:203], a[160:163], a[76:79], v[200:203]
    v_mfma_f32_16x16x32_bf16 v[204:207], a[164:167], a[76:79], v[204:207]
    buffer_load_dwordx4 v23, s[68:71], s95 offen offset:3072 lds
    v_mfma_f32_16x16x32_bf16 v[208:211], a[168:171], a[76:79], v[208:211]
    s_add_u32 s95, s95, 65536
    v_mfma_f32_16x16x32_bf16 v[212:215], a[172:175], a[76:79], v[212:215]
    s_waitcnt vmcnt(17) lgkmcnt(0)
    v_mfma_f32_16x16x32_bf16 v[88:91], a[144:147], a[80:83], v[88:91]
    ds_read_b64_tr_b16 a[160:161], v24 offset:12288
    v_mfma_f32_16x16x32_bf16 v[92:95], a[148:151], a[80:83], v[92:95]
    s_add_u32 m0, s40, 12288
    v_mfma_f32_16x16x32_bf16 v[96:99], a[152:155], a[80:83], v[96:99]
    ds_read_b64_tr_b16 a[162:163], v24 offset:12800
    v_mfma_f32_16x16x32_bf16 v[100:103], a[156:159], a[80:83], v[100:103]
    buffer_load_dwordx4 v20, s[68:71], s95 offen offset:0 lds
    v_mfma_f32_16x16x32_bf16 v[104:107], a[144:147], a[84:87], v[104:107]
    ds_read_b64_tr_b16 a[164:165], v25 offset:12288
    v_mfma_f32_16x16x32_bf16 v[108:111], a[148:151], a[84:87], v[108:111]
    buffer_load_dwordx4 v21, s[68:71], s95 offen offset:1024 lds
    v_mfma_f32_16x16x32_bf16 v[112:115], a[152:155], a[84:87], v[112:115]
    ds_read_b64_tr_b16 a[166:167], v25 offset:12800
    v_mfma_f32_16x16x32_bf16 v[116:119], a[156:159], a[84:87], v[116:119]
    buffer_load_dwordx4 v22, s[68:71], s95 offen offset:2048 lds
    v_mfma_f32_16x16x32_bf16 v[120:123], a[144:147], a[88:91], v[120:123]
    ds_read_b64_tr_b16 a[168:169], v26 offset:12288
    v_mfma_f32_16x16x32_bf16 v[124:127], a[148:151], a[88:91], v[124:127]
    buffer_load_dwordx4 v23, s[68:71], s95 offen offset:3072 lds
    v_mfma_f32_16x16x32_bf16 v[128:131], a[152:155], a[88:91], v[128:131]
    ds_read_b64_tr_b16 a[170:171], v26 offset:12800
    s_add_u32 s95, s95, 65536
    v_mfma_f32_16x16x32_bf16 v[132:135], a[156:159], a[88:91], v[132:135]
    s_add_u32 m0, s15, 0
    v_mfma_f32_16x16x32_bf16 v[136:139], a[144:147], a[92:95], v[136:139]
    ds_read_b64_tr_b16 a[172:173], v27 offset:12288
    v_mfma_f32_16x16x32_bf16 v[140:143], a[148:151], a[92:95], v[140:143]
    buffer_load_dwordx4 v20, s[68:71], s95 offen offset:0 lds
    v_mfma_f32_16x16x32_bf16 v[144:147], a[152:155], a[92:95], v[144:147]
    ds_read_b64_tr_b16 a[174:175], v27 offset:12800
    v_mfma_f32_16x16x32_bf16 v[148:151], a[156:159], a[92:95], v[148:151]
    buffer_load_dwordx4 v21, s[68:71], s95 offen offset:1024 lds
    v_mfma_f32_16x16x32_bf16 v[152:155], a[144:147], a[96:99], v[152:155]
    v_mfma_f32_16x16x32_bf16 v[156:159], a[148:151], a[96:99], v[156:159]
    buffer_load_dwordx4 v22, s[68:71], s95 offen offset:2048 lds
    v_mfma_f32_16x16x32_bf16 v[160:163], a[152:155], a[96:99], v[160:163]
    v_mfma_f32_16x16x32_bf16 v[164:167], a[156:159], a[96:99], v[164:167]
    buffer_load_dwordx4 v23, s[68:71], s95 offen offset:3072 lds
    v_mfma_f32_16x16x32_bf16 v[168:171], a[144:147], a[100:103], v[168:171]
    s_add_u32 s95, s95, 65536
    v_mfma_f32_16x16x32_bf16 v[172:175], a[148:151], a[100:103], v[172:175]
    s_add_u32 m0, s15, 4096
    v_mfma_f32_16x16x32_bf16 v[176:179], a[152:155], a[100:103], v[176:179]
    v_mfma_f32_16x16x32_bf16 v[180:183], a[156:159], a[100:103], v[180:183]
    buffer_load_dwordx4 v20, s[68:71], s95 offen offset:0 lds
    v_mfma_f32_16x16x32_bf16 v[184:187], a[144:147], a[104:107], v[184:187]
    v_mfma_f32_16x16x32_bf16 v[188:191], a[148:151], a[104:107], v[188:191]
    buffer_load_dwordx4 v21, s[68:71], s95 offen offset:1024 lds
    v_mfma_f32_16x16x32_bf16 v[192:195], a[152:155], a[104:107], v[192:195]
    v_mfma_f32_16x16x32_bf16 v[196:199], a[156:159], a[104:107], v[196:199]
    buffer_load_dwordx4 v22, s[68:71], s95 offen offset:2048 lds
    v_mfma_f32_16x16x32_bf16 v[200:203], a[144:147], a[108:111], v[200:203]
    v_mfma_f32_16x16x32_bf16 v[204:207], a[148:151], a[108:111], v[204:207]
    buffer_load_dwordx4 v23, s[68:71], s95 offen offset:3072 lds
    v_mfma_f32_16x16x32_bf16 v[208:211], a[152:155], a[108:111], v[208:211]
    s_add_u32 s95, s95, 65536
    v_mfma_f32_16x16x32_bf16 v[212:215], a[156:159], a[108:111], v[212:215]
    s_waitcnt vmcnt(24) lgkmcnt(0)
    v_mfma_f32_16x16x32_bf16 v[88:91], a[160:163], a[112:115], v[88:91]
    ds_read_b64_tr_b16 a[144:145], v36 offset:0
    v_mfma_f32_16x16x32_bf16 v[92:95], a[164:167], a[112:115], v[92:95]
    v_mfma_f32_16x16x32_bf16 v[96:99], a[168:171], a[112:115], v[96:99]
    ds_read_b64_tr_b16 a[146:147], v36 offset:512
    v_mfma_f32_16x16x32_bf16 v[100:103], a[172:175], a[112:115], v[100:103]
    v_mfma_f32_16x16x32_bf16 v[104:107], a[160:163], a[116:119], v[104:107]
    ds_read_b64_tr_b16 a[148:149], v37 offset:0
    v_mfma_f32_16x16x32_bf16 v[108:111], a[164:167], a[116:119], v[108:111]
    v_mfma_f32_16x16x32_bf16 v[112:115], a[168:171], a[116:119], v[112:115]
    ds_read_b64_tr_b16 a[150:151], v37 offset:512
    v_mfma_f32_16x16x32_bf16 v[116:119], a[172:175], a[116:119], v[116:119]
    v_mfma_f32_16x16x32_bf16 v[120:123], a[160:163], a[120:123], v[120:123]
    ds_read_b64_tr_b16 a[152:153], v38 offset:0
    v_mfma_f32_16x16x32_bf16 v[124:127], a[164:167], a[120:123], v[124:127]
    v_mfma_f32_16x16x32_bf16 v[128:131], a[168:171], a[120:123], v[128:131]
    ds_read_b64_tr_b16 a[154:155], v38 offset:512
    v_mfma_f32_16x16x32_bf16 v[132:135], a[172:175], a[120:123], v[132:135]
    v_mfma_f32_16x16x32_bf16 v[136:139], a[160:163], a[124:127], v[136:139]
    ds_read_b64_tr_b16 a[156:157], v39 offset:0
    v_mfma_f32_16x16x32_bf16 v[140:143], a[164:167], a[124:127], v[140:143]
    v_mfma_f32_16x16x32_bf16 v[144:147], a[168:171], a[124:127], v[144:147]
    ds_read_b64_tr_b16 a[158:159], v39 offset:512
    v_mfma_f32_16x16x32_bf16 v[148:151], a[172:175], a[124:127], v[148:151]
    v_mfma_f32_16x16x32_bf16 v[152:155], a[160:163], a[128:131], v[152:155]
    v_mfma_f32_16x16x32_bf16 v[156:159], a[164:167], a[128:131], v[156:159]
    v_mfma_f32_16x16x32_bf16 v[160:163], a[168:171], a[128:131], v[160:163]
    v_mfma_f32_16x16x32_bf16 v[164:167], a[172:175], a[128:131], v[164:167]
    v_mfma_f32_16x16x32_bf16 v[168:171], a[160:163], a[132:135], v[168:171]
    buffer_load_dword v4, v3, s[28:31], s19 offen sc1
    v_mfma_f32_16x16x32_bf16 v[172:175], a[164:167], a[132:135], v[172:175]
    v_mfma_f32_16x16x32_bf16 v[176:179], a[168:171], a[132:135], v[176:179]
    v_mfma_f32_16x16x32_bf16 v[180:183], a[172:175], a[132:135], v[180:183]
    v_mfma_f32_16x16x32_bf16 v[184:187], a[160:163], a[136:139], v[184:187]
    v_mfma_f32_16x16x32_bf16 v[188:191], a[164:167], a[136:139], v[188:191]
    v_mfma_f32_16x16x32_bf16 v[192:195], a[168:171], a[136:139], v[192:195]
    v_mfma_f32_16x16x32_bf16 v[196:199], a[172:175], a[136:139], v[196:199]
    v_mfma_f32_16x16x32_bf16 v[200:203], a[160:163], a[140:143], v[200:203]
    v_mfma_f32_16x16x32_bf16 v[204:207], a[164:167], a[140:143], v[204:207]
    v_mfma_f32_16x16x32_bf16 v[208:211], a[168:171], a[140:143], v[208:211]
    v_mfma_f32_16x16x32_bf16 v[212:215], a[172:175], a[140:143], v[212:215]
    s_waitcnt vmcnt(0)
k5_poll:
    v_cmp_ne_u32 vcc, 1, v4
    s_sub_u32 s35, s35, 1
    s_cbranch_scc1 k5_got
    s_nop 2
    s_cbranch_vccz k5_got
    s_sleep 6
    buffer_load_dword v4, v3, s[28:31], s19 offen sc1
    s_waitcnt vmcnt(0)
    s_branch k5_poll
k5_got:
    s_mov_b32 s13, s94
    buffer_load_dwordx4 a[16:19], v16, s[28:31], s13 offen offset:0 sc1
    buffer_load_dwordx4 a[20:23], v16, s[28:31], s13 offen offset:256 sc1
    buffer_load_dwordx4 a[24:27], v17, s[28:31], s13 offen offset:0 sc1
    buffer_load_dwordx4 a[28:31], v17, s[28:31], s13 offen offset:256 sc1
    buffer_load_dwordx4 a[32:35], v18, s[28:31], s13 offen offset:0 sc1
    buffer_load_dwordx4 a[36:39], v18, s[28:31], s13 offen offset:256 sc1
    buffer_load_dwordx4 a[40:43], v19, s[28:31], s13 offen offset:0 sc1
    buffer_load_dwordx4 a[44:47], v19, s[28:31], s13 offen offset:256 sc1
    s_add_u32 s13, s13, 2048
    buffer_load_dwordx4 a[48:51], v16, s[28:31], s13 offen offset:0 sc1
    buffer_load_dwordx4 a[52:55], v16, s[28:31], s13 offen offset:256 sc1
    buffer_load_dwordx4 a[56:59], v17, s[28:31], s13 offen offset:0 sc1
    buffer_load_dwordx4 a[60:63], v17, s[28:31], s13 offen offset:256 sc1
    buffer_load_dwordx4 a[64:67], v18, s[28:31], s13 offen offset:0 sc1
    buffer_load_dwordx4 a[68:71], v18, s[28:31], s13 offen offset:256 sc1
    buffer_load_dwordx4 a[72:75], v19, s[28:31], s13 offen offset:0 sc1
    buffer_load_dwordx4 a[76:79], v19, s[28:31], s13 offen offset:256 sc1
    s_add_u32 s13, s13, 2048
    buffer_load_dwordx4 a[80:83], v16, s[28:31], s13 offen offset:0 sc1
    buffer_load_dwordx4 a[84:87], v16, s[28:31], s13 offen offset:256 sc1
    buffer_load_dwordx4 a[88:91], v17, s[28:31], s13 offen offset:0 sc1
    buffer_load_dwordx4 a[92:95], v17, s[28:31], s13 offen offset:256 sc1
    buffer_load_dwordx4 a[96:99], v18, s[28:31], s13 offen offset:0 sc1
    buffer_load_dwordx4 a[100:103], v18, s[28:31], s13 offen offset:256 sc1
    buffer_load_dwordx4 a[104:107], v19, s[28:31], s13 offen offset:0 sc1
    buffer_load_dwordx4 a[108:111], v19, s[28:31], s13 offen offset:256 sc1
    s_add_u32 s13, s13, 2048
    s_nop 7
    v_pk_mul_f32 v[88:89], v[88:89], v[240:241] op_sel_hi:[1,0]
    v_pk_mul_f32 v[90:91], v[90:91], v[240:241] op_sel_hi:[1,0]
    v_pk_mul_f32 v[92:93], v[92:93], v[240:241] op_sel_hi:[1,0]
    v_pk_mul_f32 v[94:95], v[94:95], v[240:241] op_sel_hi:[1,0]
    v_pk_mul_f32 v[96:97], v[96:97], v[240:241] op_sel_hi:[1,0]
    v_pk_mul_f32 v[98:99], v[98:99], v[240:241] op_sel_hi:[1,0]
    v_pk_mul_f32 v[100:101], v[100:101], v[240:241] op_sel_hi:[1,0]
    v_pk_mul_f32 v[102:103], v[102:103], v[240:241] op_sel_hi:[1,0]
    v_pk_mul_f32 v[104:105], v[104:105], v[240:241] op_sel:[0,1]
    v_pk_mul_f32 v[106:107], v[106:107], v[240:241] op_sel:[0,1]
    v_pk_mul_f32 v[108:109], v[108:109], v[240:241] op_sel:[0,1]
    v_pk_mul_f32 v[110:111], v[110:111], v[240:241] op_sel:[0,1]
    v_pk_mul_f32 v[112:113], v[112:113], v[240:241] op_sel:[0,1]
    v_pk_mul_f32 v[114:115], v[114:115], v[240:241] op_sel:[0,1]
    v_pk_mul_f32 v[116:117], v[116:117], v[240:241] op_sel:[0,1]
    v_pk_mul_f32 v[118:119], v[118:119], v[240:241] op_sel:[0,1]
    v_pk_mul_f32 v[120:121], v[120:121], v[242:243] op_sel_hi:[1,0]
    v_pk_mul_f32 v[122:123], v[122:123], v[242:243] op_sel_hi:[1,0]
    v_pk_mul_f32 v[124:125], v[124:125], v[242:243] op_sel_hi:[1,0]
    v_pk_mul_f32 v[126:127], v[126:127], v[242:243] op_sel_hi:[1,0]
    v_pk_mul_f32 v[128:129], v[128:129], v[242:243] op_sel_hi:[1,0]
    v_pk_mul_f32 v[130:131], v[130:131], v[242:243] op_sel_hi:[1,0]
    v_pk_mul_f32 v[132:133], v[132:133], v[242:243] op_sel_hi:[1,0]
    v_pk_mul_f32 v[134:135], v[134:135], v[242:243] op_sel_hi:[1,0]
    v_pk_mul_f32 v[136:137], v[136:137], v[242:243] op_sel:[0,1]
    v_pk_mul_f32 v[138:139], v[138:139], v[242:243] op_sel:[0,1]
    v_pk_mul_f32 v[140:141], v[140:141], v[242:243] op_sel:[0,1]
    v_pk_mul_f32 v[142:143], v[142:143], v[242:243] op_sel:[0,1]
    v_pk_mul_f32 v[144:145], v[144:145], v[242:243] op_sel:[0,1]
    v_pk_mul_f32 v[146:147], v[146:147], v[242:243] op_sel:[0,1]
    v_pk_mul_f32 v[148:149], v[148:149], v[242:243] op_sel:[0,1]
    v_pk_mul_f32 v[150:151], v[150:151], v[242:243] op_sel:[0,1]
    v_pk_mul_f32 v[152:153], v[152:153], v[244:245] op_sel_hi:[1,0]
    v_pk_mul_f32 v[154:155], v[154:155], v[244:245] op_sel_hi:[1,0]
    v_pk_mul_f32 v[156:157], v[156:157], v[244:245] op_sel_hi:[1,0]
    v_pk_mul_f32 v[158:159], v[158:159], v[244:245] op_sel_hi:[1,0]
    v_pk_mul_f32 v[160:161], v[160:161], v[244:245] op_sel_hi:[1,0]
    v_pk_mul_f32 v[162:163], v[162:163], v[244:245] op_sel_hi:[1,0]
    v_pk_mul_f32 v[164:165], v[164:165], v[244:245] op_sel_hi:[1,0]
    v_pk_mul_f32 v[166:167], v[166:167], v[244:245] op_sel_hi:[1,0]
    v_pk_mul_f32 v[168:169], v[168:169], v[244:245] op_sel:[0,1]
    v_pk_mul_f32 v[170:171], v[170:171], v[244:245] op_sel:[0,1]
    v_pk_mul_f32 v[172:173], v[172:173], v[244:245] op_sel:[0,1]
    v_pk_mul_f32 v[174:175], v[174:175], v[244:245] op_sel:[0,1]
    v_pk_mul_f32 v[176:177], v[176:177], v[244:245] op_sel:[0,1]
    v_pk_mul_f32 v[178:179], v[178:179], v[244:245] op_sel:[0,1]
    v_pk_mul_f32 v[180:181], v[180:181], v[244:245] op_sel:[0,1]
    v_pk_mul_f32 v[182:183], v[182:183], v[244:245] op_sel:[0,1]
    v_pk_mul_f32 v[184:185], v[184:185], v[246:247] op_sel_hi:[1,0]
    v_pk_mul_f32 v[186:187], v[186:187], v[246:247] op_sel_hi:[1,0]
    v_pk_mul_f32 v[188:189], v[188:189], v[246:247] op_sel_hi:[1,0]
    v_pk_mul_f32 v[190:191], v[190:191], v[246:247] op_sel_hi:[1,0]
    v_pk_mul_f32 v[192:193], v[192:193], v[246:247] op_sel_hi:[1,0]
    v_pk_mul_f32 v[194:195], v[194:195], v[246:247] op_sel_hi:[1,0]
    v_pk_mul_f32 v[196:197], v[196:197], v[246:247] op_sel_hi:[1,0]
    v_pk_mul_f32 v[198:199], v[198:199], v[246:247] op_sel_hi:[1,0]
    v_pk_mul_f32 v[200:201], v[200:201], v[246:247] op_sel:[0,1]
    v_pk_mul_f32 v[202:203], v[202:203], v[246:247] op_sel:[0,1]
    v_pk_mul_f32 v[204:205], v[204:205], v[246:247] op_sel:[0,1]
    v_pk_mul_f32 v[206:207], v[206:207], v[246:247] op_sel:[0,1]
    v_pk_mul_f32 v[208:209], v[208:209], v[246:247] op_sel:[0,1]
    v_pk_mul_f32 v[210:211], v[210:211], v[246:247] op_sel:[0,1]
    v_pk_mul_f32 v[212:213], v[212:213], v[246:247] op_sel:[0,1]
    v_pk_mul_f32 v[214:215], v[214:215], v[246:247] op_sel:[0,1]
    s_nop 0
    s_waitcnt vmcnt(16) lgkmcnt(0)
    v_mfma_f32_16x16x32_bf16 v[88:91], a[144:147], a[16:19], v[88:91]
    ds_read_b64_tr_b16 a[160:161], v36 offset:4096
    v_mfma_f32_16x16x32_bf16 v[92:95], a[148:151], a[16:19], v[92:95]
    buffer_load_dwordx4 a[112:115], v16, s[28:31], s13 offen offset:0 sc1
    v_mfma_f32_16x16x32_bf16 v[96:99], a[152:155], a[16:19], v[96:99]
    ds_read_b64_tr_b16 a[162:163], v36 offset:4608
    v_mfma_f32_16x16x32_bf16 v[100:103], a[156:159], a[16:19], v[100:103]
    v_mfma_f32_16x16x32_bf16 v[104:107], a[144:147], a[20:23], v[104:107]
    ds_read_b64_tr_b16 a[164:165], v37 offset:4096
    buffer_load_dwordx4 a[116:119], v16, s[28:31], s13 offen offset:256 sc1
    v_mfma_f32_16x16x32_bf16 v[108:111], a[148:151], a[20:23], v[108:111]
    v_mfma_f32_16x16x32_bf16 v[112:115], a[152:155], a[20:23], v[112:115]
    ds_read_b64_tr_b16 a[166:167], v37 offset:4608
    v_mfma_f32_16x16x32_bf16 v[116:119], a[156:159], a[20:23], v[116:119]
    buffer_load_dwordx4 a[120:123], v17, s[28:31], s13 offen offset:0 sc1
    v_mfma_f32_16x16x32_bf16 v[120:123], a[144:147], a[24:27], v[120:123]
    ds_read_b64_tr_b16 a[168:169], v38 offset:4096
    v_mfma_f32_16x16x32_bf16 v[124:127], a[148:151], a[24:27], v[124:127]
    v_mfma_f32_16x16x32_bf16 v[128:131], a[152:155], a[24:27], v[128:131]
    ds_read_b64_tr_b16 a[170:171], v38 offset:4608
    buffer_load_dwordx4 a[124:127], v17, s[28:31], s13 offen offset:256 sc1
    v_mfma_f32_16x16x32_bf16 v[132:135], a[156:159], a[24:27], v[132:135]
    v_mfma_f32_16x16x32_bf16 v[136:139], a[144:147], a[28:31], v[136:139]
    ds_read_b64_tr_b16 a[172:173], v39 offset:4096
    v_mfma_f32_16x16x32_bf16 v[140:143], a[148:151], a[28:31], v[140:143]
    buffer_load_dwordx4 a[128:131], v18, s[28:31], s13 offen offset:0 sc1
    v_mfma_f32_16x16x32_bf16 v[144:147], a[152:155], a[28:31], v[144:147]
    ds_read_b64_tr_b16 a[174:175], v39 offset:4608
    v_mfma_f32_16x16x32_bf16 v[148:151], a[156:159], a[28:31], v[148:151]
    v_mfma_f32_16x16x32_bf16 v[152:155], a[144:147], a[32:35], v[152:155]
    buffer_load_dwordx4 a[132:135], v18, s[28:31], s13 offen offset:256 sc1
    v_mfma_f32_16x16x32_bf16 v[156:159], a[148:151], a[32:35], v[156:159]
    v_mfma_f32_16x16x32_bf16 v[160:163], a[152:155], a[32:35], v[160:163]
    v_mfma_f32_16x16x32_bf16 v[164:167], a[156:159], a[32:35], v[164:167]
    buffer_load_dwordx4 a[136:139], v19, s[28:31], s13 offen offset:0 sc1
    v_mfma_f32_16x16x32_bf16 v[168:171], a[144:147], a[36:39], v[168:171]
    v_mfma_f32_16x16x32_bf16 v[172:175], a[148:151], a[36:39], v[172:175]
    v_mfma_f32_16x16x32_bf16 v[176:179], a[152:155], a[36:39], v[176:179]
    buffer_load_dwordx4 a[140:143], v19, s[28:31], s13 offen offset:256 sc1
    v_mfma_f32_16x16x32_bf16 v[180:183], a[156:159], a[36:39], v[180:183]
    v_mfma_f32_16x16x32_bf16 v[184:187], a[144:147], a[40:43], v[184:187]
    v_mfma_f32_16x16x32_bf16 v[188:191], a[148:151], a[40:43], v[188:191]
    v_mfma_f32_16x16x32_bf16 v[192:195], a[152:155], a[40:43], v[192:195]
    v_mfma_f32_16x16x32_bf16 v[196:199], a[156:159], a[40:43], v[196:199]
    v_mfma_f32_16x16x32_bf16 v[200:203], a[144:147], a[44:47], v[200:203]
    v_mfma_f32_16x16x32_bf16 v[204:207], a[148:151], a[44:47], v[204:207]
    v_mfma_f32_16x16x32_bf16 v[208:211], a[152:155], a[44:47], v[208:211]
    v_mfma_f32_16x16x32_bf16 v[212:215], a[156:159], a[44:47], v[212:215]
    s_add_u32 s13, s13, 2048
    s_waitcnt vmcnt(16) lgkmcnt(0)
    v_mfma_f32_16x16x32_bf16 v[88:91], a[160:163], a[48:51], v[88:91]
    ds_read_b64_tr_b16 a[144:145], v28 offset:0
    v_mfma_f32_16x16x32_bf16 v[92:95], a[164:167], a[48:51], v[92:95]
    buffer_load_dwordx4 a[16:19], v16, s[28:31], s13 offen offset:0 sc1
    v_mfma_f32_16x16x32_bf16 v[96:99], a[168:171], a[48:51], v[96:99]
    ds_read_b64_tr_b16 a[146:147], v28 offset:512
    v_mfma_f32_16x16x32_bf16 v[100:103], a[172:175], a[48:51], v[100:103]
    v_mfma_f32_16x16x32_bf16 v[104:107], a[160:163], a[52:55], v[104:107]
    ds_read_b64_tr_b16 a[148:149], v29 offset:0
    buffer_load_dwordx4 a[20:23], v16, s[28:31], s13 offen offset:256 sc1
    v_mfma_f32_16x16x32_bf16 v[108:111], a[164:167], a[52:55], v[108:111]
    v_mfma_f32_16x16x32_bf16 v[112:115], a[168:171], a[52:55], v[112:115]
    ds_read_b64_tr_b16 a[150:151], v29 offset:512
    v_mfma_f32_16x16x32_bf16 v[116:119], a[172:175], a[52:55], v[116:119]
    buffer_load_dwordx4 a[24:27], v17, s[28:31], s13 offen offset:0 sc1
    v_mfma_f32_16x16x32_bf16 v[120:123], a[160:163], a[56:59], v[120:123]
    ds_read_b64_tr_b16 a[152:153], v30 offset:0
    v_mfma_f32_16x16x32_bf16 v[124:127], a[164:167], a[56:59], v[124:127]
    v_mfma_f32_16x16x32_bf16 v[128:131], a[168:171], a[56:59], v[128:131]
    ds_read_b64_tr_b16 a[154:155], v30 offset:512
    buffer_load_dwordx4 a[28:31], v17, s[28:31], s13 offen offset:256 sc1
    v_mfma_f32_16x16x32_bf16 v[132:135], a[172:175], a[56:59], v[132:135]
    v_mfma_f32_16x16x32_bf16 v[136:139], a[160:163], a[60:63], v[136:139]
    ds_read_b64_tr_b16 a[156:157], v31 offset:0
    v_mfma_f32_16x16x32_bf16 v[140:143], a[164:167], a[60:63], v[140:143]
    buffer_load_dwordx4 a[32:35], v18, s[28:31], s13 offen offset:0 sc1
    v_mfma_f32_16x16x32_bf16 v[144:147], a[168:171], a[60:63], v[144:147]
    ds_read_b64_tr_b16 a[158:159], v31 offset:512
    v_mfma_f32_16x16x32_bf16 v[148:151], a[172:175], a[60:63], v[148:151]
    v_mfma_f32_16x16x32_bf16 v[152:155], a[160:163], a[64:67], v[152:155]
    buffer_load_dwordx4 a[36:39], v18, s[28:31], s13 offen offset:256 sc1
    v_mfma_f32_16x16x32_bf16 v[156:159], a[164:167], a[64:67], v[156:159]
    v_mfma_f32_16x16x32_bf16 v[160:163], a[168:171], a[64:67], v[160:163]
    v_mfma_f32_16x16x32_bf16 v[164:167], a[172:175], a[64:67], v[164:167]
    buffer_load_dwordx4 a[40:43], v19, s[28:31], s13 offen offset:0 sc1
    v_mfma_f32_16x16x32_bf16 v[168:171], a[160:163], a[68:71], v[168:171]
    v_mfma_f32_16x16x32_bf16 v[172:175], a[164:167], a[68:71], v[172:175]
    v_mfma_f32_16x16x32_bf16 v[176:179], a[168:171], a[68:71], v[176:179]
    buffer_load_dwordx4 a[44:47], v19, s[28:31], s13 offen offset:256 sc1
    v_mfma_f32_16x16x32_bf16 v[180:183], a[172:175], a[68:71], v[180:183]
    v_mfma_f32_16x16x32_bf16 v[184:187], a[160:163], a[72:75], v[184:187]
    v_mfma_f32_16x16x32_bf16 v[188:191], a[164:167], a[72:75], v[188:191]
    v_mfma_f32_16x16x32_bf16 v[192:195], a[168:171], a[72:75], v[192:195]
    v_mfma_f32_16x16x32_bf16 v[196:199], a[172:175], a[72:75], v[196:199]
    v_mfma_f32_16x16x32_bf16 v[200:203], a[160:163], a[76:79], v[200:203]
    v_mfma_f32_16x16x32_bf16 v[204:207], a[164:167], a[76:79], v[204:207]
    v_mfma_f32_16x16x32_bf16 v[208:211], a[168:171], a[76:79], v[208:211]
    v_mfma_f32_16x16x32_bf16 v[212:215], a[172:175], a[76:79], v[212:215]
    s_add_u32 s13, s13, 2048
    s_waitcnt vmcnt(16) lgkmcnt(0)
    v_mfma_f32_16x16x32_bf16 v[88:91], a[144:147], a[80:83], v[88:91]
    ds_read_b64_tr_b16 a[160:161], v28 offset:4096
    v_mfma_f32_16x16x32_bf16 v[92:95], a[148:151], a[80:83], v[92:95]
    buffer_load_dwordx4 a[48:51], v16, s[28:31], s13 offen offset:0 sc1
    v_mfma_f32_16x16x32_bf16 v[96:99], a[152:155], a[80:83], v[96:99]
    ds_read_b64_tr_b16 a[162:163], v28 offset:4608
    v_mfma_f32_16x16x32_bf16 v[100:103], a[156:159], a[80:83], v[100:103]
    v_mfma_f32_16x16x32_bf16 v[104:107], a[144:147], a[84:87], v[104:107]
    ds_read_b64_tr_b16 a[164:165], v29 offset:4096
    buffer_load_dwordx4 a[52:55], v16, s[28:31], s13 offen offset:256 sc1
    v_mfma_f32_16x16x32_bf16 v[108:111], a[148:151], a[84:87], v[108:111]
    v_mfma_f32_16x16x32_bf16 v[112:115], a[152:155], a[84:87], v[112:115]
    ds_read_b64_tr_b16 a[166:167], v29 offset:4608
    v_mfma_f32_16x16x32_bf16 v[116:119], a[156:159], a[84:87], v[116:119]
    buffer_load_dwordx4 a[56:59], v17, s[28:31], s13 offen offset:0 sc1
    v_mfma_f32_16x16x32_bf16 v[120:123], a[144:147], a[88:91], v[120:123]
    ds_read_b64_tr_b16 a[168:169], v30 offset:4096
    v_mfma_f32_16x16x32_bf16 v[124:127], a[148:151], a[88:91], v[124:127]
    v_mfma_f32_16x16x32_bf16 v[128:131], a[152:155], a[88:91], v[128:131]
    ds_read_b64_tr_b16 a[170:171], v30 offset:4608
    buffer_load_dwordx4 a[60:63], v17, s[28:31], s13 offen offset:256 sc1
    v_mfma_f32_16x16x32_bf16 v[132:135], a[156:159], a[88:91], v[132:135]
    v_mfma_f32_16x16x32_bf16 v[136:139], a[144:147], a[92:95], v[136:139]
    ds_read_b64_tr_b16 a[172:173], v31 offset:4096
    v_mfma_f32_16x16x32_bf16 v[140:143], a[148:151], a[92:95], v[140:143]
    buffer_load_dwordx4 a[64:67], v18, s[28:31], s13 offen offset:0 sc1
    v_mfma_f32_16x16x32_bf16 v[144:147], a[152:155], a[92:95], v[144:147]
    ds_read_b64_tr_b16 a[174:175], v31 offset:4608
    v_mfma_f32_16x16x32_bf16 v[148:151], a[156:159], a[92:95], v[148:151]
    v_mfma_f32_16x16x32_bf16 v[152:155], a[144:147], a[96:99], v[152:155]
    buffer_load_dwordx4 a[68:71], v18, s[28:31], s13 offen offset:256 sc1
    v_mfma_f32_16x16x32_bf16 v[156:159], a[148:151], a[96:99], v[156:159]
    v_mfma_f32_16x16x32_bf16 v[160:163], a[152:155], a[96:99], v[160:163]
    v_mfma_f32_16x16x32_bf16 v[164:167], a[156:159], a[96:99], v[164:167]
    buffer_load_dwordx4 a[72:75], v19, s[28:31], s13 offen offset:0 sc1
    v_mfma_f32_16x16x32_bf16 v[168:171], a[144:147], a[100:103], v[168:171]
    v_mfma_f32_16x16x32_bf16 v[172:175], a[148:151], a[100:103], v[172:175]
    v_mfma_f32_16x16x32_bf16 v[176:179], a[152:155], a[100:103], v[176:179]
    buffer_load_dwordx4 a[76:79], v19, s[28:31], s13 offen offset:256 sc1
    v_mfma_f32_16x16x32_bf16 v[180:183], a[156:159], a[100:103], v[180:183]
    v_mfma_f32_16x16x32_bf16 v[184:187], a[144:147], a[104:107], v[184:187]
    v_mfma_f32_16x16x32_bf16 v[188:191], a[148:151], a[104:107], v[188:191]
    v_mfma_f32_16x16x32_bf16 v[192:195], a[152:155], a[104:107], v[192:195]
    v_mfma_f32_16x16x32_bf16 v[196:199], a[156:159], a[104:107], v[196:199]
    v_mfma_f32_16x16x32_bf16 v[200:203], a[144:147], a[108:111], v[200:203]
    v_mfma_f32_16x16x32_bf16 v[204:207], a[148:151], a[108:111], v[204:207]
    v_mfma_f32_16x16x32_bf16 v[208:211], a[152:155], a[108:111], v[208:211]
    v_mfma_f32_16x16x32_bf16 v[212:215], a[156:159], a[108:111], v[212:215]
    s_add_u32 s13, s13, 2048
    s_waitcnt vmcnt(16) lgkmcnt(0)
    v_mfma_f32_16x16x32_bf16 v[88:91], a[160:163], a[112:115], v[88:91]
    ds_read_b64_tr_b16 a[144:145], v28 offset:8192
    v_mfma_f32_16x16x32_bf16 v[92:95], a[164:167], a[112:115], v[92:95]
    buffer_load_dwordx4 a[80:83], v16, s[28:31], s13 offen offset:0 sc1
    v_mfma_f32_16x16x32_bf16 v[96:99], a[168:171], a[112:115], v[96:99]
    ds_read_b64_tr_b16 a[146:147], v28 offset:8704
    v_mfma_f32_16x16x32_bf16 v[100:103], a[172:175], a[112:115], v[100:103]
    v_mfma_f32_16x16x32_bf16 v[104:107], a[160:163], a[116:119], v[104:107]
    ds_read_b64_tr_b16 a[148:149], v29 offset:8192
    buffer_load_dwordx4 a[84:87], v16, s[28:31], s13 offen offset:256 sc1
    v_mfma_f32_16x16x32_bf16 v[108:111], a[164:167], a[116:119], v[108:111]
    v_mfma_f32_16x16x32_bf16 v[112:115], a[168:171], a[116:119], v[112:115]
    ds_read_b64_tr_b16 a[150:151], v29 offset:8704
    v_mfma_f32_16x16x32_bf16 v[116:119], a[172:175], a[116:119], v[116:119]
    buffer_load_dwordx4 a[88:91], v17, s[28:31], s13 offen offset:0 sc1
    v_mfma_f32_16x16x32_bf16 v[120:123], a[160:163], a[120:123], v[120:123]
    ds_read_b64_tr_b16 a[152:153], v30 offset:8192
    v_mfma_f32_16x16x32_bf16 v[124:127], a[164:167], a[120:123], v[124:127]
    v_mfma_f32_16x16x32_bf16 v[128:131], a[168:171], a[120:123], v[128:131]
    ds_read_b64_tr_b16 a[154:155], v30 offset:8704
    buffer_load_dwordx4 a[92:95], v17, s[28:31], s13 offen offset:256 sc1
    v_mfma_f32_16x16x32_bf16 v[132:135], a[172:175], a[120:123], v[132:135]
    v_mfma_f32_16x16x32_bf16 v[136:139], a[160:163], a[124:127], v[136:139]
    ds_read_b64_tr_b16 a[156:157], v31 offset:8192
    v_mfma_f32_16x16x32_bf16 v[140:143], a[164:167], a[124:127], v[140:143]
    buffer_load_dwordx4 a[96:99], v18, s[28:31], s13 offen offset:0 sc1
    v_mfma_f32_16x16x32_bf16 v[144:147], a[168:171], a[124:127], v[144:147]
    ds_read_b64_tr_b16 a[158:159], v31 offset:8704
    v_mfma_f32_16x16x32_bf16 v[148:151], a[172:175], a[124:127], v[148:151]
    v_mfma_f32_16x16x32_bf16 v[152:155], a[160:163], a[128:131], v[152:155]
    buffer_load_dwordx4 a[100:103], v18, s[28:31], s13 offen offset:256 sc1
    v_mfma_f32_16x16x32_bf16 v[156:159], a[164:167], a[128:131], v[156:159]
    v_mfma_f32_16x16x32_bf16 v[160:163], a[168:171], a[128:131], v[160:163]
    v_mfma_f32_16x16x32_bf16 v[164:167], a[172:175], a[128:131], v[164:167]
    buffer_load_dwordx4 a[104:107], v19, s[28:31], s13 offen offset:0 sc1
    v_mfma_f32_16x16x32_bf16 v[168:171], a[160:163], a[132:135], v[168:171]
    v_mfma_f32_16x16x32_bf16 v[172:175], a[164:167], a[132:135], v[172:175]
    v_mfma_f32_16x16x32_bf16 v[176:179], a[168:171], a[132:135], v[176:179]
    buffer_load_dwordx4 a[108:111], v19, s[28:31], s13 offen offset:256 sc1
    v_mfma_f32_16x16x32_bf16 v[180:183], a[172:175], a[132:135], v[180:183]
    v_mfma_f32_16x16x32_bf16 v[184:187], a[160:163], a[136:139], v[184:187]
    v_mfma_f32_16x16x32_bf16 v[188:191], a[164:167], a[136:139], v[188:191]
    v_mfma_f32_16x16x32_bf16 v[192:195], a[168:171], a[136:139], v[192:195]
    v_mfma_f32_16x16x32_bf16 v[196:199], a[172:175], a[136:139], v[196:199]
    v_mfma_f32_16x16x32_bf16 v[200:203], a[160:163], a[140:143], v[200:203]
    v_mfma_f32_16x16x32_bf16 v[204:207], a[164:167], a[140:143], v[204:207]
    v_mfma_f32_16x16x32_bf16 v[208:211], a[168:171], a[140:143], v[208:211]
    v_mfma_f32_16x16x32_bf16 v[212:215], a[172:175], a[140:143], v[212:215]
    s_add_u32 s13, s13, 2048
    s_waitcnt vmcnt(16) lgkmcnt(0)
    v_mfma_f32_16x16x32_bf16 v[88:91], a[144:147], a[16:19], v[88:91]
    ds_read_b64_tr_b16 a[160:161], v28 offset:12288
    v_mfma_f32_16x16x32_bf16 v[92:95], a[148:151], a[16:19], v[92:95]
    buffer_load_dwordx4 a[112:115], v16, s[28:31], s13 offen offset:0 sc1
    v_mfma_f32_16x16x32_bf16 v[96:99], a[152:155], a[16:19], v[96:99]
    ds_read_b64_tr_b16 a[162:163], v28 offset:12800
    v_mfma_f32_16x16x32_bf16 v[100:103], a[156:159], a[16:19], v[100:103]
    v_mfma_f32_16x16x32_bf16 v[104:107], a[144:147], a[20:23], v[104:107]
    ds_read_b64_tr_b16 a[164:165], v29 offset:12288
    buffer_load_dwordx4 a[116:119], v16, s[28:31], s13 offen offset:256 sc1
    v_mfma_f32_16x16x32_bf16 v[108:111], a[148:151], a[20:23], v[108:111]
    v_mfma_f32_16x16x32_bf16 v[112:115], a[152:155], a[20:23], v[112:115]
    ds_read_b64_tr_b16 a[166:167], v29 offset:12800
    v_mfma_f32_16x16x32_bf16 v[116:119], a[156:159], a[20:23], v[116:119]
    buffer_load_dwordx4 a[120:123], v17, s[28:31], s13 offen offset:0 sc1
    v_mfma_f32_16x16x32_bf16 v[120:123], a[144:147], a[24:27], v[120:123]
    ds_read_b64_tr_b16 a[168:169], v30 offset:12288
    v_mfma_f32_16x16x32_bf16 v[124:127], a[148:151], a[24:27], v[124:127]
    v_mfma_f32_16x16x32_bf16 v[128:131], a[152:155], a[24:27], v[128:131]
    ds_read_b64_tr_b16 a[170:171], v30 offset:12800
    buffer_load_dwordx4 a[124:127], v17, s[28:31], s13 offen offset:256 sc1
    v_mfma_f32_16x16x32_bf16 v[132:135], a[156:159], a[24:27], v[132:135]
    v_mfma_f32_16x16x32_bf16 v[136:139], a[144:147], a[28:31], v[136:139]
    ds_read_b64_tr_b16 a[172:173], v31 offset:12288
    v_mfma_f32_16x16x32_bf16 v[140:143], a[148:151], a[28:31], v[140:143]
    buffer_load_dwordx4 a[128:131], v18, s[28:31], s13 offen offset:0 sc1
    v_mfma_f32_16x16x32_bf16 v[144:147], a[152:155], a[28:31], v[144:147]
    ds_read_b64_tr_b16 a[174:175], v31 offset:12800
    v_mfma_f32_16x16x32_bf16 v[148:151], a[156:159], a[28:31], v[148:151]
    v_mfma_f32_16x16x32_bf16 v[152:155], a[144:147], a[32:35], v[152:155]
    buffer_load_dwordx4 a[132:135], v18, s[28:31], s13 offen offset:256 sc1
    v_mfma_f32_16x16x32_bf16 v[156:159], a[148:151], a[32:35], v[156:159]
    v_mfma_f32_16x16x32_bf16 v[160:163], a[152:155], a[32:35], v[160:163]
    v_mfma_f32_16x16x32_bf16 v[164:167], a[156:159], a[32:35], v[164:167]
    buffer_load_dwordx4 a[136:139], v19, s[28:31], s13 offen offset:0 sc1
    v_mfma_f32_16x16x32_bf16 v[168:171], a[144:147], a[36:39], v[168:171]
    v_mfma_f32_16x16x32_bf16 v[172:175], a[148:151], a[36:39], v[172:175]
    v_mfma_f32_16x16x32_bf16 v[176:179], a[152:155], a[36:39], v[176:179]
    buffer_load_dwordx4 a[140:143], v19, s[28:31], s13 offen offset:256 sc1
    v_mfma_f32_16x16x32_bf16 v[180:183], a[156:159], a[36:39], v[180:183]
    v_mfma_f32_16x16x32_bf16 v[184:187], a[144:147], a[40:43], v[184:187]
    v_mfma_f32_16x16x32_bf16 v[188:191], a[148:151], a[40:43], v[188:191]
    v_mfma_f32_16x16x32_bf16 v[192:195], a[152:155], a[40:43], v[192:195]
    v_mfma_f32_16x16x32_bf16 v[196:199], a[156:159], a[40:43], v[196:199]
    v_mfma_f32_16x16x32_bf16 v[200:203], a[144:147], a[44:47], v[200:203]
    v_mfma_f32_16x16x32_bf16 v[204:207], a[148:151], a[44:47], v[204:207]
    v_mfma_f32_16x16x32_bf16 v[208:211], a[152:155], a[44:47], v[208:211]
    v_mfma_f32_16x16x32_bf16 v[212:215], a[156:159], a[44:47], v[212:215]
    s_add_u32 s13, s13, 2048
    s_waitcnt vmcnt(16) lgkmcnt(0)
    v_mfma_f32_16x16x32_bf16 v[88:91], a[160:163], a[48:51], v[88:91]
    ds_read_b64_tr_b16 a[144:145], v24 offset:0
    v_mfma_f32_16x16x32_bf16 v[92:95], a[164:167], a[48:51], v[92:95]
    v_mfma_f32_16x16x32_bf16 v[96:99], a[168:171], a[48:51], v[96:99]
    ds_read_b64_tr_b16 a[146:147], v24 offset:512
    v_mfma_f32_16x16x32_bf16 v[100:103], a[172:175], a[48:51], v[100:103]
    v_mfma_f32_16x16x32_bf16 v[104:107], a[160:163], a[52:55], v[104:107]
    ds_read_b64_tr_b16 a[148:149], v25 offset:0
    v_mfma_f32_16x16x32_bf16 v[108:111], a[164:167], a[52:55], v[108:111]
    v_mfma_f32_16x16x32_bf16 v[112:115], a[168:171], a[52:55], v[112:115]
    ds_read_b64_tr_b16 a[150:151], v25 offset:512
    v_mfma_f32_16x16x32_bf16 v[116:119], a[172:175], a[52:55], v[116:119]
    v_mfma_f32_16x16x32_bf16 v[120:123], a[160:163], a[56:59], v[120:123]
    ds_read_b64_tr_b16 a[152:153], v26 offset:0
    v_mfma_f32_16x16x32_bf16 v[124:127], a[164:167], a[56:59], v[124:127]
    v_mfma_f32_16x16x32_bf16 v[128:131], a[168:171], a[56:59], v[128:131]
    ds_read_b64_tr_b16 a[154:155], v26 offset:512
    v_mfma_f32_16x16x32_bf16 v[132:135], a[172:175], a[56:59], v[132:135]
    v_mfma_f32_16x16x32_bf16 v[136:139], a[160:163], a[60:63], v[136:139]
    ds_read_b64_tr_b16 a[156:157], v27 offset:0
    v_mfma_f32_16x16x32_bf16 v[140:143], a[164:167], a[60:63], v[140:143]
    v_mfma_f32_16x16x32_bf16 v[144:147], a[168:171], a[60:63], v[144:147]
    ds_read_b64_tr_b16 a[158:159], v27 offset:512
    v_mfma_f32_16x16x32_bf16 v[148:151], a[172:175], a[60:63], v[148:151]
    v_mfma_f32_16x16x32_bf16 v[152:155], a[160:163], a[64:67], v[152:155]
    v_mfma_f32_16x16x32_bf16 v[156:159], a[164:167], a[64:67], v[156:159]
    v_mfma_f32_16x16x32_bf16 v[160:163], a[168:171], a[64:67], v[160:163]
    v_mfma_f32_16x16x32_bf16 v[164:167], a[172:175], a[64:67], v[164:167]
    v_mfma_f32_16x16x32_bf16 v[168:171], a[160:163], a[68:71], v[168:171]
    v_mfma_f32_16x16x32_bf16 v[172:175], a[164:167], a[68:71], v[172:175]
    v_mfma_f32_16x16x32_bf16 v[176:179], a[168:171], a[68:71], v[176:179]
    v_mfma_f32_16x16x32_bf16 v[180:183], a[172:175], a[68:71], v[180:183]
    v_mfma_f32_16x16x32_bf16 v[184:187], a[160:163], a[72:75], v[184:187]
    v_mfma_f32_16x16x32_bf16 v[188:191], a[164:167], a[72:75], v[188:191]
    v_mfma_f32_16x16x32_bf16 v[192:195], a[168:171], a[72:75], v[192:195]
    v_mfma_f32_16x16x32_bf16 v[196:199], a[172:175], a[72:75], v[196:199]
    v_mfma_f32_16x16x32_bf16 v[200:203], a[160:163], a[76:79], v[200:203]
    v_mfma_f32_16x16x32_bf16 v[204:207], a[164:167], a[76:79], v[204:207]
    v_mfma_f32_16x16x32_bf16 v[208:211], a[168:171], a[76:79], v[208:211]
    v_mfma_f32_16x16x32_bf16 v[212:215], a[172:175], a[76:79], v[212:215]
    s_waitcnt vmcnt(8) lgkmcnt(0)
    v_mfma_f32_16x16x32_bf16 v[88:91], a[144:147], a[80:83], v[88:91]
    ds_read_b64_tr_b16 a[160:161], v24 offset:4096
    s_add_u32 s19, s36, 1
    v_mfma_f32_16x16x32_bf16 v[92:95], a[148:151], a[80:83], v[92:95]
    s_and_b32 s19, s19, 3
    v_mfma_f32_16x16x32_bf16 v[96:99], a[152:155], a[80:83], v[96:99]
    ds_read_b64_tr_b16 a[162:163], v24 offset:4608
    s_mul_i32 s19, s19, 24576
    v_mfma_f32_16x16x32_bf16 v[100:103], a[156:159], a[80:83], v[100:103]
    s_add_u32 s19, s19, 0
    v_mfma_f32_16x16x32_bf16 v[104:107], a[144:147], a[84:87], v[104:107]
    ds_read_b64_tr_b16 a[164:165], v25 offset:4096
    v_add_u32 v4, s19, v2
    v_mfma_f32_16x16x32_bf16 v[108:111], a[148:151], a[84:87], v[108:111]
    s_add_u32 s19, s36, 2
    v_mfma_f32_16x16x32_bf16 v[112:115], a[152:155], a[84:87], v[112:115]
    ds_read_b64_tr_b16 a[166:167], v25 offset:4608
    s_and_b32 s19, s19, 3
    v_mfma_f32_16x16x32_bf16 v[116:119], a[156:159], a[84:87], v[116:119]
    s_mul_i32 s19, s19, 24576
    v_mfma_f32_16x16x32_bf16 v[120:123], a[144:147], a[88:91], v[120:123]
    ds_read_b64_tr_b16 a[168:169], v26 offset:4096
    s_add_u32 s19, s19, 8192
    v_mfma_f32_16x16x32_bf16 v[124:127], a[148:151], a[88:91], v[124:127]
    v_add_u32 v5, s19, v2
    v_mfma_f32_16x16x32_bf16 v[128:131], a[152:155], a[88:91], v[128:131]
    ds_read_b64_tr_b16 a[170:171], v26 offset:4608
    s_add_u32 s19, s36, 3
    v_mfma_f32_16x16x32_bf16 v[132:135], a[156:159], a[88:91], v[132:135]
    s_and_b32 s19, s19, 3
    v_mfma_f32_16x16x32_bf16 v[136:139], a[144:147], a[92:95], v[136:139]
    ds_read_b64_tr_b16 a[172:173], v27 offset:4096
    s_mul_i32 s19, s19, 24576
    v_mfma_f32_16x16x32_bf16 v[140:143], a[148:151], a[92:95], v[140:143]
    s_add_u32 s19, s19, 16384
    v_mfma_f32_16x16x32_bf16 v[144:147], a[152:155], a[92:95], v[144:147]
    ds_read_b64_tr_b16 a[174:175], v27 offset:4608
    v_add_u32 v6, s19, v2
    v_mfma_f32_16x16x32_bf16 v[148:151], a[156:159], a[92:95], v[148:151]
    s_mul_i32 s19, s36, 24576
    v_mfma_f32_16x16x32_bf16 v[152:155], a[144:147], a[96:99], v[152:155]
    v_add_u32 v3, s19, v2
    v_mfma_f32_16x16x32_bf16 v[156:159], a[148:151], a[96:99], v[156:159]
    s_lshl_b32 s19, s83, 18
    v_mfma_f32_16x16x32_bf16 v[160:163], a[152:155], a[96:99], v[160:163]
    s_lshl_b32 s20, s36, 16
    v_mfma_f32_16x16x32_bf16 v[164:167], a[156:159], a[96:99], v[164:167]
    s_add_u32 s19, s19, s20
    v_mfma_f32_16x16x32_bf16 v[168:171], a[144:147], a[100:103], v[168:171]
    s_lshl_b32 s20, s8, 7
    v_mfma_f32_16x16x32_bf16 v[172:175], a[148:151], a[100:103], v[172:175]
    s_add_u32 s19, s19, s20
    v_mfma_f32_16x16x32_bf16 v[176:179], a[152:155], a[100:103], v[176:179]
    s_add_u32 s20, s19, 32768
    v_mfma_f32_16x16x32_bf16 v[180:183], a[156:159], a[100:103], v[180:183]
    v_and_b32 v34, 8, v1
    v_mfma_f32_16x16x32_bf16 v[184:187], a[144:147], a[104:107], v[184:187]
    v_mul_u32_u24 v34, 2040, v34
    v_mfma_f32_16x16x32_bf16 v[188:191], a[148:151], a[104:107], v[188:191]
    v_sub_u32 v33, v33, v34
    v_mfma_f32_16x16x32_bf16 v[192:195], a[152:155], a[104:107], v[192:195]
    v_add_u32 v34, 16384, v33
    v_mfma_f32_16x16x32_bf16 v[196:199], a[156:159], a[104:107], v[196:199]
    v_mfma_f32_16x16x32_bf16 v[200:203], a[144:147], a[108:111], v[200:203]
    v_mfma_f32_16x16x32_bf16 v[204:207], a[148:151], a[108:111], v[204:207]
    v_mfma_f32_16x16x32_bf16 v[208:211], a[152:155], a[108:111], v[208:211]
    s_barrier
    v_mfma_f32_16x16x32_bf16 v[212:215], a[156:159], a[108:111], v[212:215]
    s_waitcnt vmcnt(0) lgkmcnt(0)
    v_mfma_f32_16x16x32_bf16 v[120:123], a[160:163], a[120:123], v[120:123]
    v_mfma_f32_16x16x32_bf16 v[124:127], a[164:167], a[120:123], v[124:127]
    v_mfma_f32_16x16x32_bf16 v[128:131], a[168:171], a[120:123], v[128:131]
    v_mfma_f32_16x16x32_bf16 v[132:135], a[172:175], a[120:123], v[132:135]
    v_mfma_f32_16x16x32_bf16 v[136:139], a[160:163], a[124:127], v[136:139]
    v_mfma_f32_16x16x32_bf16 v[140:143], a[164:167], a[124:127], v[140:143]
    v_mfma_f32_16x16x32_bf16 v[144:147], a[168:171], a[124:127], v[144:147]
    v_mfma_f32_16x16x32_bf16 v[148:151], a[172:175], a[124:127], v[148:151]
    v_mfma_f32_16x16x32_bf16 v[152:155], a[160:163], a[128:131], v[152:155]
    ds_write_b128 v4, v[120:123] offset:0
    v_mfma_f32_16x16x32_bf16 v[156:159], a[164:167], a[128:131], v[156:159]
    ds_write_b128 v4, v[124:127] offset:1024
    v_mfma_f32_16x16x32_bf16 v[160:163], a[168:171], a[128:131], v[160:163]
    ds_write_b128 v4, v[128:131] offset:2048
    v_mfma_f32_16x16x32_bf16 v[164:167], a[172:175], a[128:131], v[164:167]
    ds_write_b128 v4, v[132:135] offset:3072
    v_mfma_f32_16x16x32_bf16 v[168:171], a[160:163], a[132:135], v[168:171]
    ds_write_b128 v4, v[136:139] offset:4096
    v_mfma_f32_16x16x32_bf16 v[172:175], a[164:167], a[132:135], v[172:175]
    ds_write_b128 v4, v[140:143] offset:5120
    v_mfma_f32_16x16x32_bf16 v[176:179], a[168:171], a[132:135], v[176:179]
    ds_write_b128 v4, v[144:147] offset:6144
    v_mfma_f32_16x16x32_bf16 v[180:183], a[172:175], a[132:135], v[180:183]
    ds_write_b128 v4, v[148:151] offset:7168
    v_mfma_f32_16x16x32_bf16 v[184:187], a[160:163], a[136:139], v[184:187]
    ds_write_b128 v5, v[152:155] offset:0
    v_mfma_f32_16x16x32_bf16 v[188:191], a[164:167], a[136:139], v[188:191]
    ds_write_b128 v5, v[156:159] offset:1024
    v_mfma_f32_16x16x32_bf16 v[192:195], a[168:171], a[136:139], v[192:195]
    ds_write_b128 v5, v[160:163] offset:2048
    v_mfma_f32_16x16x32_bf16 v[196:199], a[172:175], a[136:139], v[196:199]
    ds_write_b128 v5, v[164:167] offset:3072
    v_mfma_f32_16x16x32_bf16 v[200:203], a[160:163], a[140:143], v[200:203]
    ds_write_b128 v5, v[168:171] offset:4096
    v_mfma_f32_16x16x32_bf16 v[204:207], a[164:167], a[140:143], v[204:207]
    ds_write_b128 v5, v[172:175] offset:5120
    v_mfma_f32_16x16x32_bf16 v[208:211], a[168:171], a[140:143], v[208:211]
    ds_write_b128 v5, v[176:179] offset:6144
    v_mfma_f32_16x16x32_bf16 v[212:215], a[172:175], a[140:143], v[212:215]
    ds_write_b128 v5, v[180:183] offset:7168
    v_mfma_f32_16x16x32_bf16 v[88:91], a[160:163], a[112:115], v[88:91]
    ds_write_b128 v6, v[184:187] offset:0
    v_mfma_f32_16x16x32_bf16 v[92:95], a[164:167], a[112:115], v[92:95]
    ds_write_b128 v6, v[188:191] offset:1024
    v_mfma_f32_16x16x32_bf16 v[96:99], a[168:171], a[112:115], v[96:99]
    ds_write_b128 v6, v[192:195] offset:2048
    v_mfma_f32_16x16x32_bf16 v[100:103], a[172:175], a[112:115], v[100:103]
    ds_write_b128 v6, v[196:199] offset:3072
    v_mfma_f32_16x16x32_bf16 v[104:107], a[160:163], a[116:119], v[104:107]
    ds_write_b128 v6, v[200:203] offset:4096
    v_mfma_f32_16x16x32_bf16 v[108:111], a[164:167], a[116:119], v[108:111]
    ds_write_b128 v6, v[204:207] offset:5120
    v_mfma_f32_16x16x32_bf16 v[112:115], a[168:171], a[116:119], v[112:115]
    ds_write_b128 v6, v[208:211] offset:6144
    v_mfma_f32_16x16x32_bf16 v[116:119], a[172:175], a[116:119], v[116:119]
    ds_write_b128 v6, v[212:215] offset:7168
    s_waitcnt lgkmcnt(0)
    s_barrier
    ds_read_b128 v[120:123], v3 offset:0
    ds_read_b128 v[152:155], v3 offset:8192
    ds_read_b128 v[184:187], v3 offset:16384
    ds_read_b128 v[124:127], v3 offset:1024
    ds_read_b128 v[156:159], v3 offset:9216
    ds_read_b128 v[188:191], v3 offset:17408
    ds_read_b128 v[128:131], v3 offset:2048
    ds_read_b128 v[160:163], v3 offset:10240
    ds_read_b128 v[192:195], v3 offset:18432
    ds_read_b128 v[132:135], v3 offset:3072
    ds_read_b128 v[164:167], v3 offset:11264
    ds_read_b128 v[196:199], v3 offset:19456
    ds_read_b128 v[136:139], v3 offset:4096
    ds_read_b128 v[168:171], v3 offset:12288
    ds_read_b128 v[200:203], v3 offset:20480
    ds_read_b128 v[140:143], v3 offset:5120
    ds_read_b128 v[172:175], v3 offset:13312
    ds_read_b128 v[204:207], v3 offset:21504
    ds_read_b128 v[144:147], v3 offset:6144
    ds_read_b128 v[176:179], v3 offset:14336
    ds_read_b128 v[208:211], v3 offset:22528
    ds_read_b128 v[148:151], v3 offset:7168
    ds_read_b128 v[180:183], v3 offset:15360
    ds_read_b128 v[212:215], v3 offset:23552
    s_waitcnt lgkmcnt(15)
    v_pk_add_f32 v[88:89], v[88:89], v[120:121]
    v_pk_add_f32 v[152:153], v[152:153], v[184:185]
    v_pk_add_f32 v[90:91], v[90:91], v[122:123]
    v_pk_add_f32 v[154:155], v[154:155], v[186:187]
    v_pk_add_f32 v[88:89], v[88:89], v[152:153]
    v_pk_add_f32 v[90:91], v[90:91], v[154:155]
    v_cvt_pk_bf16_f32 v40, v88, v89
    v_cvt_pk_bf16_f32 v41, v90, v91
    s_waitcnt lgkmcnt(15)
    v_pk_add_f32 v[92:93], v[92:93], v[124:125]
    v_pk_add_f32 v[156:157], v[156:157], v[188:189]
    v_pk_add_f32 v[94:95], v[94:95], v[126:127]
    v_pk_add_f32 v[158:159], v[158:159], v[190:191]
    v_pk_add_f32 v[92:93], v[92:93], v[156:157]
    v_pk_add_f32 v[94:95], v[94:95], v[158:159]
    v_cvt_pk_bf16_f32 v42, v92, v93
    v_cvt_pk_bf16_f32 v43, v94, v95
    s_nop 1
    v_permlane16_swap_b32 v40, v42
    v_permlane16_swap_b32 v41, v43
    s_waitcnt lgkmcnt(15)
    v_pk_add_f32 v[96:97], v[96:97], v[128:129]
    v_pk_add_f32 v[160:161], v[160:161], v[192:193]
    v_pk_add_f32 v[98:99], v[98:99], v[130:131]
    v_pk_add_f32 v[162:163], v[162:163], v[194:195]
    v_pk_add_f32 v[96:97], v[96:97], v[160:161]
    v_pk_add_f32 v[98:99], v[98:99], v[162:163]
    v_cvt_pk_bf16_f32 v44, v96, v97
    v_cvt_pk_bf16_f32 v45, v98, v99
    s_waitcnt lgkmcnt(12)
    v_pk_add_f32 v[100:101], v[100:101], v[132:133]
    v_pk_add_f32 v[164:165], v[164:165], v[196:197]
    v_pk_add_f32 v[102:103], v[102:103], v[134:135]
    v_pk_add_f32 v[166:167], v[166:167], v[198:199]
    v_pk_add_f32 v[100:101], v[100:101], v[164:165]
    v_pk_add_f32 v[102:103], v[102:103], v[166:167]
    v_cvt_pk_bf16_f32 v46, v100, v101
    v_cvt_pk_bf16_f32 v47, v102, v103
    s_nop 1
    v_permlane16_swap_b32 v44, v46
    v_permlane16_swap_b32 v45, v47
    v_mov_b32 v56, v44
    v_mov_b32 v57, v45
    v_mov_b32 v58, v46
    v_mov_b32 v59, v47
    v_mov_b32_dpp v44, v40 row_ror:8 row_mask:0xf bank_mask:0x3
    v_mov_b32_dpp v45, v41 row_ror:8 row_mask:0xf bank_mask:0x3
    v_mov_b32_dpp v46, v42 row_ror:8 row_mask:0xf bank_mask:0x3
    v_mov_b32_dpp v47, v43 row_ror:8 row_mask:0xf bank_mask:0x3
    v_mov_b32_dpp v40, v56 row_ror:8 row_mask:0xf bank_mask:0xc
    v_mov_b32_dpp v41, v57 row_ror:8 row_mask:0xf bank_mask:0xc
    v_mov_b32_dpp v42, v58 row_ror:8 row_mask:0xf bank_mask:0xc
    v_mov_b32_dpp v43, v59 row_ror:8 row_mask:0xf bank_mask:0xc
    buffer_store_dwordx4 v[40:43], v33, s[72:75], s19 offen sc1
    buffer_store_dwordx4 v[44:47], v34, s[72:75], s19 offen sc1
    s_waitcnt lgkmcnt(9)
    v_pk_add_f32 v[104:105], v[104:105], v[136:137]
    v_pk_add_f32 v[168:169], v[168:169], v[200:201]
    v_pk_add_f32 v[106:107], v[106:107], v[138:139]
    v_pk_add_f32 v[170:171], v[170:171], v[202:203]
    v_pk_add_f32 v[104:105], v[104:105], v[168:169]
    v_pk_add_f32 v[106:107], v[106:107], v[170:171]
    v_cvt_pk_bf16_f32 v48, v104, v105
    v_cvt_pk_bf16_f32 v49, v106, v107
    s_waitcnt lgkmcnt(6)
    v_pk_add_f32 v[108:109], v[108:109], v[140:141]
    v_pk_add_f32 v[172:173], v[172:173], v[204:205]
    v_pk_add_f32 v[110:111], v[110:111], v[142:143]
    v_pk_add_f32 v[174:175], v[174:175], v[206:207]
    v_pk_add_f32 v[108:109], v[108:109], v[172:173]
    v_pk_add_f32 v[110:111], v[110:111], v[174:175]
    v_cvt_pk_bf16_f32 v50, v108, v109
    v_cvt_pk_bf16_f32 v51, v110, v111
    s_nop 1
    v_permlane16_swap_b32 v48, v50
    v_permlane16_swap_b32 v49, v51
    s_waitcnt lgkmcnt(3)
    v_pk_add_f32 v[112:113], v[112:113], v[144:145]
    v_pk_add_f32 v[176:177], v[176:177], v[208:209]
    v_pk_add_f32 v[114:115], v[114:115], v[146:147]
    v_pk_add_f32 v[178:179], v[178:179], v[210:211]
    v_pk_add_f32 v[112:113], v[112:113], v[176:177]
    v_pk_add_f32 v[114:115], v[114:115], v[178:179]
    v_cvt_pk_bf16_f32 v52, v112, v113
    v_cvt_pk_bf16_f32 v53, v114, v115
    s_waitcnt lgkmcnt(0)
    v_pk_add_f32 v[116:117], v[116:117], v[148:149]
    v_pk_add_f32 v[180:181], v[180:181], v[212:213]
    v_pk_add_f32 v[118:119], v[118:119], v[150:151]
    v_pk_add_f32 v[182:183], v[182:183], v[214:215]
    v_pk_add_f32 v[116:117], v[116:117], v[180:181]
    v_pk_add_f32 v[118:119], v[118:119], v[182:183]
    v_cvt_pk_bf16_f32 v54, v116, v117
    v_cvt_pk_bf16_f32 v55, v118, v119
    s_nop 1
    v_permlane16_swap_b32 v52, v54
    v_permlane16_swap_b32 v53, v55
    v_mov_b32 v56, v52
    v_mov_b32 v57, v53
    v_mov_b32 v58, v54
    v_mov_b32 v59, v55
    v_mov_b32_dpp v52, v48 row_ror:8 row_mask:0xf bank_mask:0x3
    v_mov_b32_dpp v53, v49 row_ror:8 row_mask:0xf bank_mask:0x3
    v_mov_b32_dpp v54, v50 row_ror:8 row_mask:0xf bank_mask:0x3
    v_mov_b32_dpp v55, v51 row_ror:8 row_mask:0xf bank_mask:0x3
    v_mov_b32_dpp v48, v56 row_ror:8 row_mask:0xf bank_mask:0xc
    v_mov_b32_dpp v49, v57 row_ror:8 row_mask:0xf bank_mask:0xc
    v_mov_b32_dpp v50, v58 row_ror:8 row_mask:0xf bank_mask:0xc
    v_mov_b32_dpp v51, v59 row_ror:8 row_mask:0xf bank_mask:0xc
    buffer_store_dwordx4 v[48:51], v33, s[72:75], s20 offen sc1
    buffer_store_dwordx4 v[52:55], v34, s[72:75], s20 offen sc1
    s_endpgm
k5_slow:
    s_waitcnt lgkmcnt(0)
    s_lshl_b32 s20, s80, 17
    s_add_u32 s10, s20, 8388608
    s_add_u32 s9, s20, 4194304
    s_mov_b32 s18, 64
    v_mov_b32 v216, 0xff800000
    v_mov_b32 v217, 0
    v_mov_b32 v224, 0
    v_mov_b32 v225, 0
    v_mov_b32 v226, 0
    v_mov_b32 v227, 0
    v_mov_b32 v228, 0
    v_mov_b32 v229, 0
    v_mov_b32 v230, 0
    v_mov_b32 v231, 0
    v_mov_b32 v232, 0
    v_mov_b32 v233, 0
    v_mov_b32 v234, 0
    v_mov_b32 v235, 0
    v_mov_b32 v236, 0
    v_mov_b32 v237, 0
    v_mov_b32 v238, 0
    v_mov_b32 v239, 0
k5_slow_loop0:
    buffer_load_dwordx4 a[176:179], v2, s[28:31], s9 offen offset:0 sc1
    buffer_load_dwordx4 a[180:183], v2, s[28:31], s9 offen offset:1024 sc1
    buffer_load_dwordx4 a[192:195], v2, s[28:31], s10 offen offset:0 sc1
    buffer_load_dwordx4 a[196:199], v2, s[28:31], s10 offen offset:1024 sc1
    s_add_u32 s9, s9, 2048
    s_add_u32 s10, s10, 2048
    s_waitcnt vmcnt(0)
    v_mfma_f32_32x32x16_bf16 v[40:55], a[176:179], a[0:3], 0
    v_mfma_f32_32x32x16_bf16 v[40:55], a[180:183], a[4:7], v[40:55]
    s_nop 15
    v_max3_f32 v220, v40, v41, v216
    v_max3_f32 v220, v42, v43, v220
    v_max3_f32 v220, v44, v45, v220
    v_max3_f32 v220, v46, v47, v220
    v_max3_f32 v220, v48, v49, v220
    v_max3_f32 v220, v50, v51, v220
    v_max3_f32 v220, v52, v53, v220
    v_max3_f32 v220, v54, v55, v220
    v_mov_b32 v221, v220
    s_nop 1
    v_permlane32_swap_b32 v220, v221
    s_nop 1
    v_max_f32 v220, v220, v221
    v_sub_f32 v218, v216, v220
    v_exp_f32 v218, v218
    v_mov_b32 v216, v220
    v_sub_f32 v40, v40, v216
    v_sub_f32 v41, v41, v216
    v_sub_f32 v42, v42, v216
    v_sub_f32 v43, v43, v216
    v_sub_f32 v44, v44, v216
    v_sub_f32 v45, v45, v216
    v_sub_f32 v46, v46, v216
    v_sub_f32 v47, v47, v216
    v_sub_f32 v48, v48, v216
    v_sub_f32 v49, v49, v216
    v_sub_f32 v50, v50, v216
    v_sub_f32 v51, v51, v216
    v_sub_f32 v52, v52, v216
    v_sub_f32 v53, v53, v216
    v_sub_f32 v54, v54, v216
    v_sub_f32 v55, v55, v216
    v_exp_f32 v40, v40
    v_exp_f32 v41, v41
    v_exp_f32 v42, v42
    v_exp_f32 v43, v43
    v_exp_f32 v44, v44
    v_exp_f32 v45, v45
    v_exp_f32 v46, v46
    v_exp_f32 v47, v47
    v_exp_f32 v48, v48
    v_exp_f32 v49, v49
    v_exp_f32 v50, v50
    v_exp_f32 v51, v51
    v_exp_f32 v52, v52
    v_exp_f32 v53, v53
    v_exp_f32 v54, v54
    v_exp_f32 v55, v55
    v_mul_f32 v217, v217, v218
    v_mul_f32 v224, v224, v218
    v_mul_f32 v225, v225, v218
    v_mul_f32 v226, v226, v218
    v_mul_f32 v227, v227, v218
    v_mul_f32 v228, v228, v218
    v_mul_f32 v229, v229, v218
    v_mul_f32 v230, v230, v218
    v_mul_f32 v231, v231, v218
    v_mul_f32 v232, v232, v218
    v_mul_f32 v233, v233, v218
    v_mul_f32 v234, v234, v218
    v_mul_f32 v235, v235, v218
    v_mul_f32 v236, v236, v218
    v_mul_f32 v237, v237, v218
    v_mul_f32 v238, v238, v218
    v_mul_f32 v239, v239, v218
    v_cvt_pk_bf16_f32 v72, v40, v41
    v_cvt_pk_bf16_f32 v73, v42, v43
    v_cvt_pk_bf16_f32 v74, v44, v45
    v_cvt_pk_bf16_f32 v75, v46, v47
    v_cvt_pk_bf16_f32 v76, v48, v49
    v_cvt_pk_bf16_f32 v77, v50, v51
    v_cvt_pk_bf16_f32 v78, v52, v53
    v_cvt_pk_bf16_f32 v79, v54, v55
    v_add_f32 v217, v217, v40
    v_add_f32 v217, v217, v41
    v_add_f32 v217, v217, v42
    v_add_f32 v217, v217, v43
    v_add_f32 v217, v217, v44
    v_add_f32 v217, v217, v45
    v_add_f32 v217, v217, v46
    v_add_f32 v217, v217, v47
    v_add_f32 v217, v217, v48
    v_add_f32 v217, v217, v49
    v_add_f32 v217, v217, v50
    v_add_f32 v217, v217, v51
    v_add_f32 v217, v217, v52
    v_add_f32 v217, v217, v53
    v_add_f32 v217, v217, v54
    v_add_f32 v217, v217, v55
    v_mfma_f32_32x32x16_bf16 v[224:239], a[192:195], v[72:75], v[224:239]
    v_mfma_f32_32x32x16_bf16 v[224:239], a[196:199], v[76:79], v[224:239]
    s_sub_u32 s18, s18, 1
    s_cmp_lg_u32 s18, 0
    s_nop 15
    s_cbranch_scc1 k5_slow_loop0
    v_mov_b32 v220, v217
    s_nop 1
    v_permlane32_swap_b32 v220, v217
    s_nop 1
    v_add_f32 v217, v217, v220
    v_accvgpr_write_b32 a208, v224
    v_accvgpr_write_b32 a209, v225
    v_accvgpr_write_b32 a210, v226
    v_accvgpr_write_b32 a211, v227
    v_accvgpr_write_b32 a212, v228
    v_accvgpr_write_b32 a213, v229
    v_accvgpr_write_b32 a214, v230
    v_accvgpr_write_b32 a215, v231
    v_accvgpr_write_b32 a216, v232
    v_accvgpr_write_b32 a217, v233
    v_accvgpr_write_b32 a218, v234
    v_accvgpr_write_b32 a219, v235
    v_accvgpr_write_b32 a220, v236
    v_accvgpr_write_b32 a221, v237
    v_accvgpr_write_b32 a222, v238
    v_accvgpr_write_b32 a223, v239
    v_accvgpr_write_b32 a240, v217
    s_lshl_b32 s20, s80, 17
    s_add_u32 s10, s20, 8388608
    s_add_u32 s9, s20, 4194304
    s_mov_b32 s18, 64
    v_mov_b32 v216, 0xff800000
    v_mov_b32 v217, 0
    v_mov_b32 v224, 0
    v_mov_b32 v225, 0
    v_mov_b32 v226, 0
    v_mov_b32 v227, 0
    v_mov_b32 v228, 0
    v_mov_b32 v229, 0
    v_mov_b32 v230, 0
    v_mov_b32 v231, 0
    v_mov_b32 v232, 0
    v_mov_b32 v233, 0
    v_mov_b32 v234, 0
    v_mov_b32 v235, 0
    v_mov_b32 v236, 0
    v_mov_b32 v237, 0
    v_mov_b32 v238, 0
    v_mov_b32 v239, 0
k5_slow_loop1:
    buffer_load_dwordx4 a[176:179], v2, s[28:31], s9 offen offset:0 sc1
    buffer_load_dwordx4 a[180:183], v2, s[28:31], s9 offen offset:1024 sc1
    buffer_load_dwordx4 a[192:195], v2, s[28:31], s10 offen offset:0 sc1
    buffer_load_dwordx4 a[196:199], v2, s[28:31], s10 offen offset:1024 sc1
    s_add_u32 s9, s9, 2048
    s_add_u32 s10, s10, 2048
    s_waitcnt vmcnt(0)
    v_mfma_f32_32x32x16_bf16 v[56:71], a[176:179], a[8:11], 0
    v_mfma_f32_32x32x16_bf16 v[56:71], a[180:183], a[12:15], v[56:71]
    s_nop 15
    v_max3_f32 v220, v56, v57, v216
    v_max3_f32 v220, v58, v59, v220
    v_max3_f32 v220, v60, v61, v220
    v_max3_f32 v220, v62, v63, v220
    v_max3_f32 v220, v64, v65, v220
    v_max3_f32 v220, v66, v67, v220
    v_max3_f32 v220, v68, v69, v220
    v_max3_f32 v220, v70, v71, v220
    v_mov_b32 v221, v220
    s_nop 1
    v_permlane32_swap_b32 v220, v221
    s_nop 1
    v_max_f32 v220, v220, v221
    v_sub_f32 v218, v216, v220
    v_exp_f32 v218, v218
    v_mov_b32 v216, v220
    v_sub_f32 v56, v56, v216
    v_sub_f32 v57, v57, v216
    v_sub_f32 v58, v58, v216
    v_sub_f32 v59, v59, v216
    v_sub_f32 v60, v60, v216
    v_sub_f32 v61, v61, v216
    v_sub_f32 v62, v62, v216
    v_sub_f32 v63, v63, v216
    v_sub_f32 v64, v64, v216
    v_sub_f32 v65, v65, v216
    v_sub_f32 v66, v66, v216
    v_sub_f32 v67, v67, v216
    v_sub_f32 v68, v68, v216
    v_sub_f32 v69, v69, v216
    v_sub_f32 v70, v70, v216
    v_sub_f32 v71, v71, v216
    v_exp_f32 v56, v56
    v_exp_f32 v57, v57
    v_exp_f32 v58, v58
    v_exp_f32 v59, v59
    v_exp_f32 v60, v60
    v_exp_f32 v61, v61
    v_exp_f32 v62, v62
    v_exp_f32 v63, v63
    v_exp_f32 v64, v64
    v_exp_f32 v65, v65
    v_exp_f32 v66, v66
    v_exp_f32 v67, v67
    v_exp_f32 v68, v68
    v_exp_f32 v69, v69
    v_exp_f32 v70, v70
    v_exp_f32 v71, v71
    v_mul_f32 v217, v217, v218
    v_mul_f32 v224, v224, v218
    v_mul_f32 v225, v225, v218
    v_mul_f32 v226, v226, v218
    v_mul_f32 v227, v227, v218
    v_mul_f32 v228, v228, v218
    v_mul_f32 v229, v229, v218
    v_mul_f32 v230, v230, v218
    v_mul_f32 v231, v231, v218
    v_mul_f32 v232, v232, v218
    v_mul_f32 v233, v233, v218
    v_mul_f32 v234, v234, v218
    v_mul_f32 v235, v235, v218
    v_mul_f32 v236, v236, v218
    v_mul_f32 v237, v237, v218
    v_mul_f32 v238, v238, v218
    v_mul_f32 v239, v239, v218
    v_cvt_pk_bf16_f32 v80, v56, v57
    v_cvt_pk_bf16_f32 v81, v58, v59
    v_cvt_pk_bf16_f32 v82, v60, v61
    v_cvt_pk_bf16_f32 v83, v62, v63
    v_cvt_pk_bf16_f32 v84, v64, v65
    v_cvt_pk_bf16_f32 v85, v66, v67
    v_cvt_pk_bf16_f32 v86, v68, v69
    v_cvt_pk_bf16_f32 v87, v70, v71
    v_add_f32 v217, v217, v56
    v_add_f32 v217, v217, v57
    v_add_f32 v217, v217, v58
    v_add_f32 v217, v217, v59
    v_add_f32 v217, v217, v60
    v_add_f32 v217, v217, v61
    v_add_f32 v217, v217, v62
    v_add_f32 v217, v217, v63
    v_add_f32 v217, v217, v64
    v_add_f32 v217, v217, v65
    v_add_f32 v217, v217, v66
    v_add_f32 v217, v217, v67
    v_add_f32 v217, v217, v68
    v_add_f32 v217, v217, v69
    v_add_f32 v217, v217, v70
    v_add_f32 v217, v217, v71
    v_mfma_f32_32x32x16_bf16 v[224:239], a[192:195], v[80:83], v[224:239]
    v_mfma_f32_32x32x16_bf16 v[224:239], a[196:199], v[84:87], v[224:239]
    s_sub_u32 s18, s18, 1
    s_cmp_lg_u32 s18, 0
    s_nop 15
    s_cbranch_scc1 k5_slow_loop1
    v_mov_b32 v220, v217
    s_nop 1
    v_permlane32_swap_b32 v220, v217
    s_nop 1
    v_add_f32 v217, v217, v220
    v_accvgpr_write_b32 a224, v224
    v_accvgpr_write_b32 a225, v225
    v_accvgpr_write_b32 a226, v226
    v_accvgpr_write_b32 a227, v227
    v_accvgpr_write_b32 a228, v228
    v_accvgpr_write_b32 a229, v229
    v_accvgpr_write_b32 a230, v230
    v_accvgpr_write_b32 a231, v231
    v_accvgpr_write_b32 a232, v232
    v_accvgpr_write_b32 a233, v233
    v_accvgpr_write_b32 a234, v234
    v_accvgpr_write_b32 a235, v235
    v_accvgpr_write_b32 a236, v236
    v_accvgpr_write_b32 a237, v237
    v_accvgpr_write_b32 a238, v238
    v_accvgpr_write_b32 a239, v239
    v_accvgpr_write_b32 a244, v217
    s_nop 1
    s_branch k5_store
k_exit:
    s_endpgm

code_end:
    s_endpgm
.section .rodata,"a"
.p2align 6
.amdhsa_kernel gated_mix__softmax_full_mha__glu_gated_geglu__prompt_kernel
  .amdhsa_next_free_vgpr 512
  .amdhsa_next_free_sgpr 102
  .amdhsa_accum_offset 256
  .amdhsa_group_segment_fixed_size 0
  .amdhsa_kernarg_size 88
  .amdhsa_user_sgpr_count 2
  .amdhsa_user_sgpr_kernarg_segment_ptr 1
  .amdhsa_system_sgpr_workgroup_id_x 1
.end_amdhsa_kernel
```
